```python
import torch

def _softmax(x, axis=-1):
    return torch.softmax(x, dim=axis)
def _gelu(x):
    return torch.nn.functional.gelu(x, approximate="tanh")
def _silu(x):
    return torch.nn.functional.silu(x)
def _sigmoid(x):
    return torch.sigmoid(x)
def _layernorm(x, axis=-1, eps=1e-5):
    m = x.mean(dim=axis, keepdim=True)
    v = x.var(dim=axis, keepdim=True, unbiased=False)
    return (x - m) / torch.sqrt(v + eps)
def _scatter_add(tgt, idx, src, axis=0):
    return tgt.clone().index_add_(axis, idx, src)
def _segment_sum(src, seg, n):
    out = torch.zeros((n,) + src.shape[1:], dtype=src.dtype)
    return out.index_add_(0, seg, src)
def _pad(x, pw):
    flat = tuple(v for pair in reversed(pw) for v in pair)
    return torch.nn.functional.pad(x, flat)

kernel_name = 'sequential_preLN__sliding_block__glu_gated_glu__prompt'

def setup_inputs():

    _w = (lambda a: (lambda t: t.to(torch.bfloat16) if t.is_floating_point() else t)(torch.as_tensor(a)))
    def _A_setup():
        B, S, D = 1, 2048, 1024
        return {
            "x": _w((lambda *s: torch.randn(*s, dtype=torch.bfloat16) * 0.05)(B, S, D)),
            "wqkv": _w((lambda *s: torch.randn(*s, dtype=torch.bfloat16) * 0.05)(D, 3 * D)),
            "wo": _w((lambda *s: torch.randn(*s, dtype=torch.bfloat16) * 0.05)(D, D)),
        }
    _A_in = _A_setup()

    def _B_setup():
        B, S, D, F = 1, 2048, 1024, 3584
        return {
            "x": _w((lambda *s: torch.randn(*s, dtype=torch.bfloat16) * 0.05)(B, S, D)),
            "w_gate": _w((lambda *s: torch.randn(*s, dtype=torch.bfloat16) * 0.05)(D, F)),
            "w_up": _w((lambda *s: torch.randn(*s, dtype=torch.bfloat16) * 0.05)(D, F)),
            "w_down": _w((lambda *s: torch.randn(*s, dtype=torch.bfloat16) * 0.05)(F, D)),
        }
    _B_in = _B_setup()

    return {
        "A_x": _A_in["x"],
        "A_wqkv": _A_in["wqkv"],
        "A_wo": _A_in["wo"],
        "B_x": _B_in["x"],
        "B_w_gate": _B_in["w_gate"],
        "B_w_up": _B_in["w_up"],
        "B_w_down": _B_in["w_down"],
    }

def reference(A_x, A_wqkv, A_wo, B_x, B_w_gate, B_w_up, B_w_down):
    def _A_ref(x, wqkv, wo):
        B, S, D = x.shape
        H = 32; Dh = D // H; W = 256
        qkv = (lambda x, *d: x.permute(*d))((x @ wqkv).reshape(B, S, 3, H, Dh), 2, 0, 3, 1, 4)
        q, k, v = qkv[0], qkv[1], qkv[2]
        scores = torch.einsum("bhqd,bhkd->bhqk", q, k) * (Dh ** -0.5)
        idx = torch.arange(S)
        mask = (idx[:, None] - idx[None, :] >= 0) & (idx[:, None] - idx[None, :] < W)
        scores = torch.where(mask[None, None], scores, -1e9)
        p = _softmax(scores, axis=-1)
        o = torch.einsum("bhqk,bhkd->bhqd", p, v)
        return (lambda x, *d: x.permute(*d))(o, 0, 2, 1, 3).reshape(B, S, D) @ wo

    def _B_ref(x, w_gate, w_up, w_down):
        g = torch.einsum("bsd,df->bsf", x, w_gate)
        u = torch.einsum("bsd,df->bsf", x, w_up)
        h = _sigmoid(g) * u
        return torch.einsum("bsf,fd->bsd", h, w_down)

    x = A_x
    h = x + _A_ref(_layernorm(x, axis=-1), A_wqkv, A_wo)
    h2 = h + _B_ref(_layernorm(h, axis=-1), B_w_gate, B_w_up, B_w_down)
    return h2
```

```asm
; @launch grid=(256,1,1) block=(256,1,1) lds=163840
.amdgcn_target "amdgcn-amd-amdhsa--gfx950"
.text
.globl sequential_preLN__sliding_block__glu_gated_glu__prompt_kernel
.p2align 8
.type sequential_preLN__sliding_block__glu_gated_glu__prompt_kernel,@function
sequential_preLN__sliding_block__glu_gated_glu__prompt_kernel:
    s_cmp_ge_u32 s2, 256
    s_cbranch_scc1 L_end
    s_load_dwordx16 s[4:19], s[0:1], 0
    s_load_dwordx4 s[20:23], s[0:1], 64
    v_lshrrev_b32 v3, 6, v0
    v_and_b32 v0, 63, v0
    v_readfirstlane_b32 s3, v3
    v_and_b32 v1, 15, v0
    v_lshrrev_b32 v2, 4, v0
    s_cmp_lg_u32 s3, 3
    s_cbranch_scc1 CT_1
    s_getpc_b64 s[72:73]
CTH_2:
    s_add_u32 s72, s72, E_notag-CTH_2
    s_addc_u32 s73, s73, (E_notag-CTH_2)>>32
    s_lshr_b32 s52, s2, 3
    s_mul_i32 s52, s52, ((C_p3-E_notag)/4096+1)
    v_min_u32 v20, ((C_p3-E_notag)/4096), v0
    v_add_u32 v20, s52, v20
    v_min_u32 v20, ((C_p3-E_notag)/128), v20
    v_lshlrev_b32 v20, 7, v20
    v_mov_b32 v21, s73
    v_add_co_u32 v20, vcc, s72, v20
    s_nop 1
    v_addc_co_u32 v21, vcc, 0, v21, vcc
    global_load_dword v22, v[20:21], off
CT_1:
    s_and_b32 s52, s2, 7
    s_lshr_b32 s53, s2, 3
    s_and_b32 s54, s53, 3
    s_lshr_b32 s55, s53, 2
    s_xor_b32 s55, s55, 0
    s_and_b32 s24, s52, 4
    s_add_u32 s24, s24, s54
    s_and_b32 s25, s52, 3
    s_lshl_b32 s25, s25, 3
    s_add_u32 s25, s25, s55
    s_lshr_b32 s26, s52, 1
    s_lshl_b32 s26, s26, 2
    s_add_u32 s26, s26, s54
    s_and_b32 s27, s52, 1
    s_lshl_b32 s56, s55, 1
    s_add_u32 s27, s27, s56
    s_lshl_b32 s54, s54, 1
    s_add_u32 s58, s54, s55
    s_and_b32 s58, s58, 7
    s_or_b32 s52, s2, s3
    s_cbranch_scc1 E_notag
    s_memrealtime s[52:53]
    s_waitcnt lgkmcnt(0)
    s_or_b32 s52, s52, 1
    v_mov_b32 v4, s52
    v_lshlrev_b32 v5, 20, v0
    s_mov_b32 s72, s20
    s_mov_b32 s73, s21
    s_mov_b32 s74, 4
    s_mov_b32 s75, 0x00020000
    buffer_store_dword v4, v5, s[72:75], 0 offen sc1
E_notag:
    s_waitcnt lgkmcnt(0)
    s_lshl_b32 s52, s26, 2
    s_add_u32 s52, s52, s3
    s_lshl_b32 s52, s52, 16
    s_add_u32 s36, s4, s52
    s_addc_u32 s37, s5, 0
    s_mov_b32 s38, 65536
    s_mov_b32 s39, 0x00020000
    v_lshrrev_b32 v12, 3, v0
    v_and_b32 v15, 7, v0
    v_xor_b32 v13, v15, v2
    v_lshlrev_b32 v248, 11, v12
    v_lshl_add_u32 v248, v13, 4, v248
    v_xor_b32 v249, 64, v248
    v_add_u32 v249, 15360, v249
    v_add_u32 v250, 30720, v248
    v_add_u32 v251, 30720, v249
    s_lshl_b32 s59, s3, 12
    s_add_u32 s59, s59, 98304
    s_mov_b32 s60, 0
    s_mul_i32 s50, s60, 0
    s_and_b32 s11, s3, 1
    s_lshr_b32 s52, s2, 8
    s_lshl_b32 s52, s52, 2
    s_add_u32 s52, s52, s3
    s_lshl_b32 s52, s52, 8
    s_and_b32 s53, s2, 255
    s_add_u32 s52, s52, s53
    s_mul_i32 s52, s52, 6144
    s_add_u32 s68, s6, s52
    s_addc_u32 s69, s7, 0
    s_mov_b32 s70, 6144
    s_mov_b32 s71, 0x00020000
    v_lshlrev_b32 v13, 7, v0
    s_cmp_le_u32 s3, 0
    s_cbranch_scc0 P1_t0
    buffer_load_dword v16, v13, s[68:71], 0 offen
P1_t0:
    s_add_u32 m0, s59, 0
    s_nop 0
    buffer_load_dwordx4 v248, s[36:39], s50 offen offset:0 lds
    buffer_load_dwordx4 v249, s[36:39], s50 offen offset:1024 lds
    buffer_load_dwordx4 v250, s[36:39], s50 offen offset:2048 lds
    buffer_load_dwordx4 v251, s[36:39], s50 offen offset:3072 lds
    s_lshl_b32 s52, s27, 7
    s_sub_u32 s53, 0x600000, s52
    s_add_u32 s28, s6, s52
    s_addc_u32 s29, s7, 0
    s_mov_b32 s30, s53
    s_mov_b32 s31, 0x00020000
    s_mul_i32 s53, s3, 98304
    s_mul_i32 s48, s3, 6144
    s_mul_i32 s49, s60, 0
    s_lshr_b32 s60, s26, 0
    s_lshl_b32 s61, s11, 6
    s_add_u32 s60, s60, s61
    s_add_u32 s50, s50, 128
    s_and_b32 s50, s50, 2047
    v_and_b32 v10, 2, v12
    v_xor_b32 v10, v10, v15
    v_mul_u32_u24 v252, 6144, v12
    v_lshl_add_u32 v252, v10, 4, v252
    v_add_u32 v252, s53, v252
    v_xor_b32 v253, 64, v252
    v_add_u32 v253, 48128, v253
    v_add_u32 v254, 4096, v252
    v_add_u32 v255, 4096, v253
    s_add_u32 m0, s48, 0
    s_nop 0
    buffer_load_dwordx4 v252, s[28:31], s49 offen offset:0 lds
    buffer_load_dwordx4 v253, s[28:31], s49 offen offset:1024 lds
    buffer_load_dwordx4 v252, s[28:31], s49 offen offset:2048 lds
    buffer_load_dwordx4 v253, s[28:31], s49 offen offset:3072 lds
    s_add_u32 m0, s48, 4096
    s_nop 0
    buffer_load_dwordx4 v254, s[28:31], s49 offen offset:0 lds
    buffer_load_dwordx4 v255, s[28:31], s49 offen offset:1024 lds
    s_add_u32 s49, s49, 393216
    s_lshl_b32 s52, s26, 4
    s_add_u32 s56, s52, s27
    s_lshl_b32 s57, s56, 2
    s_add_u32 s57, s57, s3
    s_lshl_b32 s53, s57, 12
    s_add_u32 s32, s4, s53
    s_addc_u32 s33, s5, 0
    s_mov_b32 s34, 4096
    s_mov_b32 s35, 0x00020000
    s_mov_b32 s62, s57
    s_lshl_b32 s53, s57, 11
    s_add_u32 s44, s8, s53
    s_addc_u32 s45, s9, 0
    s_mov_b32 s46, 2048
    s_mov_b32 s47, 0x00020000
    v_lshlrev_b32 v23, 4, v0
    s_add_u32 s64, s22, 42991616
    s_addc_u32 s65, s23, 0
    s_mov_b32 s66, 106496
    s_mov_b32 s67, 0x00020000
    v_lshlrev_b32 v14, 20, v0
    buffer_load_dwordx4 v[192:195], v23, s[32:35], 0 offen offset:0
    buffer_load_dwordx4 v[196:199], v23, s[32:35], 0 offen offset:1024
    buffer_load_dwordx4 v[200:203], v23, s[32:35], 0 offen offset:2048
    buffer_load_dwordx4 v[204:207], v23, s[32:35], 0 offen offset:3072
    buffer_load_dwordx4 v[208:211], v23, s[44:47], 0 offen offset:0
    buffer_load_dwordx4 v[212:215], v23, s[44:47], 0 offen offset:1024
    s_mov_b32 s72, s20
    s_mov_b32 s73, s21
    s_mov_b32 s74, 4
    s_mov_b32 s75, 0x00020000
    v_lshrrev_b32 v12, 1, v2
    v_mul_u32_u24 v8, 6144, v12
    v_and_b32 v12, 1, v2
    v_lshl_add_u32 v8, v12, 10, v8
    v_lshrrev_b32 v11, 2, v1
    v_lshl_add_u32 v8, v11, 7, v8
    v_and_b32 v11, 3, v0
    v_lshl_add_u32 v8, v11, 3, v8
    v_lshrrev_b32 v11, 3, v1
    v_lshl_add_u32 v11, v12, 1, v11
    s_and_b32 s52, s3, 2
    v_xor_b32 v11, s52, v11
    v_lshl_add_u32 v8, v11, 5, v8
    v_xor_b32 v9, 32, v8
    v_add_u32 v10, 49152, v8
    v_add_u32 v11, 49152, v9
    v_lshrrev_b32 v12, 1, v1
    v_xor_b32 v12, v12, v2
    v_lshlrev_b32 v12, 4, v12
    v_lshl_add_u32 v12, v1, 7, v12
    s_lshl_b32 s52, s11, 13
    s_add_u32 s52, s52, 98304
    v_add_u32 v3, s52, v12
    v_xor_b32 v12, 64, v12
    v_add_u32 v4, s52, v12
    v_mov_b32 v12, 0x3f803f80
    v_accvgpr_write_b32 a152, v12
    v_accvgpr_write_b32 a153, v12
    v_accvgpr_write_b32 a154, v12
    v_accvgpr_write_b32 a155, v12
    s_waitcnt vmcnt(6)
    s_barrier
    ds_read_b64_tr_b16 a[96:97], v8 offset:0
    ds_read_b64_tr_b16 a[98:99], v8 offset:512
    ds_read_b128 a[0:3], v3 offset:0
    ds_read_b128 a[4:7], v3 offset:2048
    ds_read_b128 a[8:11], v3 offset:4096
    ds_read_b128 a[12:15], v3 offset:6144
    ds_read_b64_tr_b16 a[100:101], v9 offset:0
    ds_read_b64_tr_b16 a[102:103], v9 offset:512
    ds_read_b64_tr_b16 a[104:105], v8 offset:2048
    ds_read_b64_tr_b16 a[106:107], v8 offset:2560
P1_code:
    s_waitcnt lgkmcnt(4)
    v_mfma_f32_16x16x32_bf16 v[32:35], a[96:99], a[0:3], 0
    s_add_u32 m0, s59, 16384
    v_mfma_f32_16x16x32_bf16 v[36:39], a[96:99], a[4:7], 0
    buffer_load_dwordx4 v248, s[36:39], s50 offen offset:0 lds
    v_mfma_f32_16x16x32_bf16 v[40:43], a[96:99], a[8:11], 0
    ds_read_b64_tr_b16 a[108:109], v9 offset:2048
    v_mfma_f32_16x16x32_bf16 v[44:47], a[96:99], a[12:15], 0
    ds_read_b64_tr_b16 a[110:111], v9 offset:2560
    buffer_load_dwordx4 v249, s[36:39], s50 offen offset:1024 lds
    s_waitcnt lgkmcnt(4)
    v_mfma_f32_16x16x32_bf16 v[60:63], a[100:103], a[12:15], 0
    ds_read_b64_tr_b16 a[112:113], v8 offset:4096
    v_mfma_f32_16x16x32_bf16 v[56:59], a[100:103], a[8:11], 0
    ds_read_b64_tr_b16 a[114:115], v8 offset:4608
    v_mfma_f32_16x16x32_bf16 v[52:55], a[100:103], a[4:7], 0
    buffer_load_dwordx4 v250, s[36:39], s50 offen offset:2048 lds
    v_mfma_f32_16x16x32_bf16 v[48:51], a[100:103], a[0:3], 0
    s_waitcnt lgkmcnt(4)
    v_mfma_f32_16x16x32_bf16 v[64:67], a[104:107], a[0:3], 0
    buffer_load_dwordx4 v251, s[36:39], s50 offen offset:3072 lds
    v_mfma_f32_16x16x32_bf16 v[68:71], a[104:107], a[4:7], 0
    s_add_u32 s50, s50, 128
    s_add_u32 m0, s48, 24576
    v_mfma_f32_16x16x32_bf16 v[72:75], a[104:107], a[8:11], 0
    ds_read_b64_tr_b16 a[116:117], v9 offset:4096
    buffer_load_dwordx4 v252, s[28:31], s49 offen offset:0 lds
    v_mfma_f32_16x16x32_bf16 v[76:79], a[104:107], a[12:15], 0
    ds_read_b64_tr_b16 a[118:119], v9 offset:4608
    s_waitcnt lgkmcnt(4)
    v_mfma_f32_16x16x32_bf16 v[92:95], a[108:111], a[12:15], 0
    ds_read_b64_tr_b16 a[120:121], v8 offset:12288
    v_mfma_f32_16x16x32_bf16 v[88:91], a[108:111], a[8:11], 0
    buffer_load_dwordx4 v253, s[28:31], s49 offen offset:1024 lds
    v_mfma_f32_16x16x32_bf16 v[84:87], a[108:111], a[4:7], 0
    ds_read_b64_tr_b16 a[122:123], v8 offset:12800
    ds_read_b128 a[16:19], v4 offset:0
    v_mfma_f32_16x16x32_bf16 v[80:83], a[108:111], a[0:3], 0
    ds_read_b128 a[20:23], v4 offset:2048
    buffer_load_dwordx4 v252, s[28:31], s49 offen offset:2048 lds
    s_waitcnt lgkmcnt(6)
    v_mfma_f32_16x16x32_bf16 v[96:99], a[0:3], a[112:115], 0
    ds_read_b64_tr_b16 a[124:125], v9 offset:12288
    v_mfma_f32_16x16x32_bf16 v[100:103], a[4:7], a[112:115], 0
    ds_read_b64_tr_b16 a[126:127], v9 offset:12800
    v_mfma_f32_16x16x32_bf16 v[104:107], a[8:11], a[112:115], 0
    ds_read_b128 a[24:27], v4 offset:4096
    buffer_load_dwordx4 v253, s[28:31], s49 offen offset:3072 lds
    v_mfma_f32_16x16x32_bf16 v[108:111], a[12:15], a[112:115], 0
    ds_read_b128 a[28:31], v4 offset:6144
    s_add_u32 m0, s48, 28672
    s_waitcnt lgkmcnt(8)
    v_mfma_f32_16x16x32_bf16 v[124:127], a[12:15], a[116:119], 0
    buffer_load_dwordx4 v254, s[28:31], s49 offen offset:0 lds
    s_cmp_eq_u32 s3, 1
    s_cbranch_scc0 P1_t1
    buffer_load_dword v15, v13, s[68:71], 0 offen
P1_t1:
    v_mfma_f32_16x16x32_bf16 v[120:123], a[8:11], a[116:119], 0
    ds_read_b64_tr_b16 a[128:129], v8 offset:14336
    v_mfma_f32_16x16x32_bf16 v[116:119], a[4:7], a[116:119], 0
    buffer_load_dwordx4 v255, s[28:31], s49 offen offset:1024 lds
    s_waitcnt vmcnt(10)
    v_lshlrev_b32 v216, 16, v192
    v_and_b32 v217, 0xffff0000, v192
    v_lshlrev_b32 v232, 16, v200
    v_and_b32 v233, 0xffff0000, v200
    v_lshlrev_b32 v152, 16, v208
    v_and_b32 v153, 0xffff0000, v208
    v_lshlrev_b32 v218, 16, v193
    v_and_b32 v219, 0xffff0000, v193
    v_lshlrev_b32 v234, 16, v201
    v_and_b32 v235, 0xffff0000, v201
    v_lshlrev_b32 v154, 16, v209
    v_and_b32 v155, 0xffff0000, v209
    v_lshlrev_b32 v220, 16, v194
    v_and_b32 v221, 0xffff0000, v194
    v_lshlrev_b32 v236, 16, v202
    v_and_b32 v237, 0xffff0000, v202
    v_lshlrev_b32 v156, 16, v210
    v_and_b32 v157, 0xffff0000, v210
    v_lshlrev_b32 v222, 16, v195
    v_and_b32 v223, 0xffff0000, v195
    v_lshlrev_b32 v238, 16, v203
    v_and_b32 v239, 0xffff0000, v203
    v_lshlrev_b32 v158, 16, v211
    v_and_b32 v159, 0xffff0000, v211
    v_lshlrev_b32 v224, 16, v196
    v_and_b32 v225, 0xffff0000, v196
    v_lshlrev_b32 v240, 16, v204
    v_and_b32 v241, 0xffff0000, v204
    v_lshlrev_b32 v160, 16, v212
    v_and_b32 v161, 0xffff0000, v212
    v_lshlrev_b32 v226, 16, v197
    v_and_b32 v227, 0xffff0000, v197
    v_lshlrev_b32 v242, 16, v205
    v_and_b32 v243, 0xffff0000, v205
    v_lshlrev_b32 v162, 16, v213
    v_and_b32 v163, 0xffff0000, v213
    v_lshlrev_b32 v228, 16, v198
    v_and_b32 v229, 0xffff0000, v198
    v_lshlrev_b32 v244, 16, v206
    v_and_b32 v245, 0xffff0000, v206
    v_lshlrev_b32 v164, 16, v214
    v_and_b32 v165, 0xffff0000, v214
    v_lshlrev_b32 v230, 16, v199
    v_and_b32 v231, 0xffff0000, v199
    v_lshlrev_b32 v246, 16, v207
    v_and_b32 v247, 0xffff0000, v207
    v_lshlrev_b32 v166, 16, v215
    v_and_b32 v167, 0xffff0000, v215
    v_pk_add_f32 v[168:169], v[216:217], v[224:225]
    v_pk_add_f32 v[170:171], v[218:219], v[226:227]
    v_pk_add_f32 v[172:173], v[220:221], v[228:229]
    v_pk_add_f32 v[174:175], v[222:223], v[230:231]
    v_pk_add_f32 v[176:177], v[232:233], v[240:241]
    v_pk_add_f32 v[178:179], v[234:235], v[242:243]
    v_pk_add_f32 v[180:181], v[236:237], v[244:245]
    v_pk_add_f32 v[182:183], v[238:239], v[246:247]
    v_pk_add_f32 v[184:185], v[152:153], v[160:161]
    v_pk_add_f32 v[186:187], v[154:155], v[162:163]
    v_pk_add_f32 v[188:189], v[156:157], v[164:165]
    v_pk_add_f32 v[190:191], v[158:159], v[166:167]
    v_pk_add_f32 v[168:169], v[168:169], v[172:173]
    v_pk_add_f32 v[170:171], v[170:171], v[174:175]
    v_pk_add_f32 v[176:177], v[176:177], v[180:181]
    v_pk_add_f32 v[178:179], v[178:179], v[182:183]
    v_pk_add_f32 v[184:185], v[184:185], v[188:189]
    v_pk_add_f32 v[186:187], v[186:187], v[190:191]
    v_pk_add_f32 v[168:169], v[168:169], v[170:171]
    v_pk_add_f32 v[176:177], v[176:177], v[178:179]
    v_pk_add_f32 v[184:185], v[184:185], v[186:187]
    v_add_f32 v168, v168, v169
    v_add_f32 v176, v176, v177
    v_add_f32 v184, v184, v185
    v_add_f32_dpp v168, v168, v168 quad_perm:[1,0,3,2] row_mask:0xf bank_mask:0xf
    v_add_f32_dpp v176, v176, v176 quad_perm:[1,0,3,2] row_mask:0xf bank_mask:0xf
    v_add_f32_dpp v184, v184, v184 quad_perm:[1,0,3,2] row_mask:0xf bank_mask:0xf
    v_add_f32_dpp v168, v168, v168 quad_perm:[2,3,0,1] row_mask:0xf bank_mask:0xf
    v_add_f32_dpp v176, v176, v176 quad_perm:[2,3,0,1] row_mask:0xf bank_mask:0xf
    v_add_f32_dpp v184, v184, v184 quad_perm:[2,3,0,1] row_mask:0xf bank_mask:0xf
    v_add_f32_dpp v168, v168, v168 row_half_mirror row_mask:0xf bank_mask:0xf
    v_add_f32_dpp v176, v176, v176 row_half_mirror row_mask:0xf bank_mask:0xf
    v_add_f32_dpp v184, v184, v184 row_half_mirror row_mask:0xf bank_mask:0xf
    v_add_f32_dpp v168, v168, v168 row_mirror row_mask:0xf bank_mask:0xf
    v_add_f32_dpp v176, v176, v176 row_mirror row_mask:0xf bank_mask:0xf
    v_add_f32_dpp v184, v184, v184 row_mirror row_mask:0xf bank_mask:0xf
    v_mov_b32 v169, v168
    v_mov_b32 v177, v176
    v_mov_b32 v185, v184
    v_permlane16_swap_b32 v169, v168
    v_permlane16_swap_b32 v177, v176
    v_permlane16_swap_b32 v185, v184
    v_add_f32 v168, v169, v168
    v_add_f32 v176, v177, v176
    v_add_f32 v184, v185, v184
    v_mov_b32 v169, v168
    v_mov_b32 v177, v176
    v_mov_b32 v185, v184
    v_permlane32_swap_b32 v169, v168
    v_permlane32_swap_b32 v177, v176
    v_permlane32_swap_b32 v185, v184
    v_add_f32 v168, v169, v168
    v_add_f32 v176, v177, v176
    v_add_f32 v184, v185, v184
    v_mul_f32 v192, 0x3a800000, v168
    v_mul_f32 v193, 0x3a800000, v176
    v_mul_f32 v194, 0x3a800000, v184
    v_mov_b32 v198, v193
    v_pk_add_f32 v[216:217], v[216:217], v[192:193] op_sel_hi:[1,0] neg_lo:[0,1] neg_hi:[0,1]
    v_pk_add_f32 v[218:219], v[218:219], v[192:193] op_sel_hi:[1,0] neg_lo:[0,1] neg_hi:[0,1]
    v_pk_add_f32 v[220:221], v[220:221], v[192:193] op_sel_hi:[1,0] neg_lo:[0,1] neg_hi:[0,1]
    v_pk_add_f32 v[222:223], v[222:223], v[192:193] op_sel_hi:[1,0] neg_lo:[0,1] neg_hi:[0,1]
    v_pk_add_f32 v[224:225], v[224:225], v[192:193] op_sel_hi:[1,0] neg_lo:[0,1] neg_hi:[0,1]
    v_pk_add_f32 v[226:227], v[226:227], v[192:193] op_sel_hi:[1,0] neg_lo:[0,1] neg_hi:[0,1]
    v_pk_add_f32 v[228:229], v[228:229], v[192:193] op_sel_hi:[1,0] neg_lo:[0,1] neg_hi:[0,1]
    v_pk_add_f32 v[230:231], v[230:231], v[192:193] op_sel_hi:[1,0] neg_lo:[0,1] neg_hi:[0,1]
    v_pk_add_f32 v[232:233], v[232:233], v[198:199] op_sel_hi:[1,0] neg_lo:[0,1] neg_hi:[0,1]
    v_pk_add_f32 v[234:235], v[234:235], v[198:199] op_sel_hi:[1,0] neg_lo:[0,1] neg_hi:[0,1]
    v_pk_add_f32 v[236:237], v[236:237], v[198:199] op_sel_hi:[1,0] neg_lo:[0,1] neg_hi:[0,1]
    v_pk_add_f32 v[238:239], v[238:239], v[198:199] op_sel_hi:[1,0] neg_lo:[0,1] neg_hi:[0,1]
    v_pk_add_f32 v[240:241], v[240:241], v[198:199] op_sel_hi:[1,0] neg_lo:[0,1] neg_hi:[0,1]
    v_pk_add_f32 v[242:243], v[242:243], v[198:199] op_sel_hi:[1,0] neg_lo:[0,1] neg_hi:[0,1]
    v_pk_add_f32 v[244:245], v[244:245], v[198:199] op_sel_hi:[1,0] neg_lo:[0,1] neg_hi:[0,1]
    v_pk_add_f32 v[246:247], v[246:247], v[198:199] op_sel_hi:[1,0] neg_lo:[0,1] neg_hi:[0,1]
    s_lshl_b32 s53, s62, 2
    s_add_u32 s53, s53, 41959424
    s_add_u32 s44, s22, s53
    s_addc_u32 s45, s23, 0
    s_mov_b32 s46, 4
    s_mov_b32 s47, 0x00020000
    buffer_store_dword v194, v14, s[44:47], 0 offen sc1
    v_pk_mul_f32 v[168:169], v[216:217], v[216:217]
    v_pk_mul_f32 v[170:171], v[218:219], v[218:219]
    v_pk_mul_f32 v[172:173], v[220:221], v[220:221]
    v_pk_mul_f32 v[174:175], v[222:223], v[222:223]
    v_pk_fma_f32 v[168:169], v[224:225], v[224:225], v[168:169]
    v_pk_fma_f32 v[170:171], v[226:227], v[226:227], v[170:171]
    v_pk_fma_f32 v[172:173], v[228:229], v[228:229], v[172:173]
    v_pk_fma_f32 v[174:175], v[230:231], v[230:231], v[174:175]
    v_pk_mul_f32 v[176:177], v[232:233], v[232:233]
    v_pk_mul_f32 v[178:179], v[234:235], v[234:235]
    v_pk_mul_f32 v[180:181], v[236:237], v[236:237]
    v_pk_mul_f32 v[182:183], v[238:239], v[238:239]
    v_pk_fma_f32 v[176:177], v[240:241], v[240:241], v[176:177]
    v_pk_fma_f32 v[178:179], v[242:243], v[242:243], v[178:179]
    v_pk_fma_f32 v[180:181], v[244:245], v[244:245], v[180:181]
    v_pk_fma_f32 v[182:183], v[246:247], v[246:247], v[182:183]
    v_pk_add_f32 v[168:169], v[168:169], v[172:173]
    v_pk_add_f32 v[170:171], v[170:171], v[174:175]
    v_pk_add_f32 v[176:177], v[176:177], v[180:181]
    v_pk_add_f32 v[178:179], v[178:179], v[182:183]
    v_pk_add_f32 v[168:169], v[168:169], v[170:171]
    v_pk_add_f32 v[176:177], v[176:177], v[178:179]
    v_add_f32 v168, v168, v169
    v_add_f32 v176, v176, v177
    s_nop 0
    v_add_f32_dpp v168, v168, v168 quad_perm:[1,0,3,2] row_mask:0xf bank_mask:0xf
    v_add_f32_dpp v176, v176, v176 quad_perm:[1,0,3,2] row_mask:0xf bank_mask:0xf
    s_nop 0
    v_add_f32_dpp v168, v168, v168 quad_perm:[2,3,0,1] row_mask:0xf bank_mask:0xf
    v_add_f32_dpp v176, v176, v176 quad_perm:[2,3,0,1] row_mask:0xf bank_mask:0xf
    s_nop 0
    v_add_f32_dpp v168, v168, v168 row_half_mirror row_mask:0xf bank_mask:0xf
    v_add_f32_dpp v176, v176, v176 row_half_mirror row_mask:0xf bank_mask:0xf
    s_nop 0
    v_add_f32_dpp v168, v168, v168 row_mirror row_mask:0xf bank_mask:0xf
    v_add_f32_dpp v176, v176, v176 row_mirror row_mask:0xf bank_mask:0xf
    v_mov_b32 v169, v168
    v_mov_b32 v177, v176
    s_nop 0
    v_permlane16_swap_b32 v169, v168
    v_permlane16_swap_b32 v177, v176
    v_add_f32 v168, v169, v168
    v_add_f32 v176, v177, v176
    v_mov_b32 v169, v168
    v_mov_b32 v177, v176
    s_nop 0
    v_permlane32_swap_b32 v169, v168
    v_permlane32_swap_b32 v177, v176
    v_add_f32 v168, v169, v168
    v_add_f32 v176, v177, v176
    v_cmp_eq_u32 vcc, 1, v0
    v_mov_b32 v198, 0x3727c5ac
    s_lshl_b32 s53, s57, 3
    s_add_u32 s53, s53, 41943040
    v_cndmask_b32 v192, v192, v193, vcc
    v_cndmask_b32 v168, v168, v176, vcc
    v_fmac_f32 v198, 0x3a800000, v168
    v_rsq_f32 v198, v198
    s_add_u32 s32, s22, s53
    s_addc_u32 s33, s23, 0
    s_mov_b32 s34, 8200
    s_mov_b32 s35, 0x00020000
    v_lshrrev_b32 v199, 1, v0
    v_lshlrev_b32 v199, 20, v199
    v_lshl_add_u32 v199, v0, 2, v199
    s_mov_b32 s53, 8192
    buffer_store_dword v192, v199, s[32:35], 0 offen sc1
    buffer_store_dword v198, v199, s[32:35], s53 offen sc1
    v_mov_b32 v12, 0
    buffer_load_dword v17, v12, s[72:75], 0 offen sc1
    v_mfma_f32_16x16x32_bf16 v[112:115], a[0:3], a[116:119], 0
    ds_read_b64_tr_b16 a[130:131], v8 offset:14848
    s_add_u32 s49, s49, 393216
    s_cmp_eq_u32 s11, 0
    s_cbranch_scc0 P1_c0
    v_mfma_f32_16x16x32_bf16 v[128:131], a[96:99], a[152:155], 0
    v_mfma_f32_16x16x32_bf16 v[132:135], a[100:103], a[152:155], 0
    v_mfma_f32_16x16x32_bf16 v[136:139], a[104:107], a[152:155], 0
    v_mfma_f32_16x16x32_bf16 v[140:143], a[108:111], a[152:155], 0
    v_mfma_f32_16x16x32_bf16 v[144:147], a[152:155], a[112:115], 0
    v_mfma_f32_16x16x32_bf16 v[148:151], a[152:155], a[116:119], 0
P1_c0:
    s_waitcnt lgkmcnt(2)
    v_mfma_f32_16x16x32_bf16 v[32:35], a[120:123], a[16:19], v[32:35]
    s_add_u32 m0, s59, 32768
    v_mfma_f32_16x16x32_bf16 v[36:39], a[120:123], a[20:23], v[36:39]
    buffer_load_dwordx4 v248, s[36:39], s50 offen offset:0 lds
    v_mfma_f32_16x16x32_bf16 v[40:43], a[120:123], a[24:27], v[40:43]
    ds_read_b64_tr_b16 a[96:97], v9 offset:14336
    v_mfma_f32_16x16x32_bf16 v[44:47], a[120:123], a[28:31], v[44:47]
    ds_read_b64_tr_b16 a[98:99], v9 offset:14848
    s_waitcnt lgkmcnt(6)
    v_mfma_f32_16x16x32_bf16 v[60:63], a[124:127], a[28:31], v[60:63]
    buffer_load_dwordx4 v249, s[36:39], s50 offen offset:1024 lds
    v_mfma_f32_16x16x32_bf16 v[56:59], a[124:127], a[24:27], v[56:59]
    ds_read_b64_tr_b16 a[100:101], v8 offset:16384
    v_mfma_f32_16x16x32_bf16 v[52:55], a[124:127], a[20:23], v[52:55]
    ds_read_b64_tr_b16 a[102:103], v8 offset:16896
    v_mfma_f32_16x16x32_bf16 v[48:51], a[124:127], a[16:19], v[48:51]
    buffer_load_dwordx4 v250, s[36:39], s50 offen offset:2048 lds
    s_waitcnt lgkmcnt(4)
    v_mfma_f32_16x16x32_bf16 v[64:67], a[128:131], a[16:19], v[64:67]
    ds_read_b64_tr_b16 a[104:105], v9 offset:16384
    v_mfma_f32_16x16x32_bf16 v[68:71], a[128:131], a[20:23], v[68:71]
    ds_read_b64_tr_b16 a[106:107], v9 offset:16896
    v_mfma_f32_16x16x32_bf16 v[72:75], a[128:131], a[24:27], v[72:75]
    buffer_load_dwordx4 v251, s[36:39], s50 offen offset:3072 lds
    v_mfma_f32_16x16x32_bf16 v[76:79], a[128:131], a[28:31], v[76:79]
    s_add_u32 s50, s50, 128
    s_waitcnt vmcnt(8)
    s_barrier
    s_waitcnt lgkmcnt(4)
    v_mfma_f32_16x16x32_bf16 v[92:95], a[96:99], a[28:31], v[92:95]
    s_add_u32 m0, s48, 49152
    v_mfma_f32_16x16x32_bf16 v[88:91], a[96:99], a[24:27], v[88:91]
    buffer_load_dwordx4 v252, s[28:31], s49 offen offset:0 lds
    v_mfma_f32_16x16x32_bf16 v[84:87], a[96:99], a[20:23], v[84:87]
    ds_read_b64_tr_b16 a[108:109], v8 offset:24576
    ds_read_b128 a[32:35], v3 offset:16384
    v_mfma_f32_16x16x32_bf16 v[80:83], a[96:99], a[16:19], v[80:83]
    ds_read_b64_tr_b16 a[110:111], v8 offset:25088
    ds_read_b128 a[36:39], v3 offset:18432
    s_waitcnt lgkmcnt(6)
    v_mfma_f32_16x16x32_bf16 v[96:99], a[16:19], a[100:103], v[96:99]
    buffer_load_dwordx4 v253, s[28:31], s49 offen offset:1024 lds
    v_mfma_f32_16x16x32_bf16 v[100:103], a[20:23], a[100:103], v[100:103]
    ds_read_b64_tr_b16 a[112:113], v9 offset:24576
    v_mfma_f32_16x16x32_bf16 v[104:107], a[24:27], a[100:103], v[104:107]
    ds_read_b64_tr_b16 a[114:115], v9 offset:25088
    ds_read_b128 a[40:43], v3 offset:20480
    v_mfma_f32_16x16x32_bf16 v[108:111], a[28:31], a[100:103], v[108:111]
    ds_read_b128 a[44:47], v3 offset:22528
    buffer_load_dwordx4 v252, s[28:31], s49 offen offset:2048 lds
    s_waitcnt lgkmcnt(8)
    v_mfma_f32_16x16x32_bf16 v[124:127], a[28:31], a[104:107], v[124:127]
    ds_read_b64_tr_b16 a[116:117], v8 offset:26624
    v_mfma_f32_16x16x32_bf16 v[120:123], a[24:27], a[104:107], v[120:123]
    ds_read_b64_tr_b16 a[118:119], v8 offset:27136
    v_mfma_f32_16x16x32_bf16 v[116:119], a[20:23], a[104:107], v[116:119]
    buffer_load_dwordx4 v253, s[28:31], s49 offen offset:3072 lds
    v_mfma_f32_16x16x32_bf16 v[112:115], a[16:19], a[104:107], v[112:115]
    s_cmp_eq_u32 s11, 1
    s_cbranch_scc0 P1_c1
    v_mfma_f32_16x16x32_bf16 v[128:131], a[120:123], a[152:155], 0
    v_mfma_f32_16x16x32_bf16 v[132:135], a[124:127], a[152:155], 0
    v_mfma_f32_16x16x32_bf16 v[136:139], a[128:131], a[152:155], 0
    v_mfma_f32_16x16x32_bf16 v[140:143], a[96:99], a[152:155], 0
    v_mfma_f32_16x16x32_bf16 v[144:147], a[152:155], a[100:103], 0
    v_mfma_f32_16x16x32_bf16 v[148:151], a[152:155], a[104:107], 0
P1_c1:
    s_waitcnt lgkmcnt(2)
    v_mfma_f32_16x16x32_bf16 v[32:35], a[108:111], a[32:35], v[32:35]
    s_add_u32 m0, s48, 53248
    v_mfma_f32_16x16x32_bf16 v[36:39], a[108:111], a[36:39], v[36:39]
    buffer_load_dwordx4 v254, s[28:31], s49 offen offset:0 lds
    v_mfma_f32_16x16x32_bf16 v[40:43], a[108:111], a[40:43], v[40:43]
    ds_read_b64_tr_b16 a[120:121], v9 offset:26624
    v_mfma_f32_16x16x32_bf16 v[44:47], a[108:111], a[44:47], v[44:47]
    ds_read_b64_tr_b16 a[122:123], v9 offset:27136
    s_waitcnt lgkmcnt(6)
    v_mfma_f32_16x16x32_bf16 v[60:63], a[112:115], a[44:47], v[60:63]
    buffer_load_dwordx4 v255, s[28:31], s49 offen offset:1024 lds
    v_mfma_f32_16x16x32_bf16 v[56:59], a[112:115], a[40:43], v[56:59]
    s_add_u32 s49, s49, 393216
    v_mfma_f32_16x16x32_bf16 v[52:55], a[112:115], a[36:39], v[52:55]
    ds_read_b64_tr_b16 a[124:125], v8 offset:28672
    s_add_u32 m0, s59, 49152
    v_mfma_f32_16x16x32_bf16 v[48:51], a[112:115], a[32:35], v[48:51]
    ds_read_b64_tr_b16 a[126:127], v8 offset:29184
    buffer_load_dwordx4 v248, s[36:39], s50 offen offset:0 lds
    s_waitcnt lgkmcnt(4)
    v_mfma_f32_16x16x32_bf16 v[64:67], a[116:119], a[32:35], v[64:67]
    ds_read_b64_tr_b16 a[128:129], v9 offset:28672
    v_mfma_f32_16x16x32_bf16 v[68:71], a[116:119], a[36:39], v[68:71]
    ds_read_b64_tr_b16 a[130:131], v9 offset:29184
    v_mfma_f32_16x16x32_bf16 v[72:75], a[116:119], a[40:43], v[72:75]
    buffer_load_dwordx4 v249, s[36:39], s50 offen offset:1024 lds
    v_mfma_f32_16x16x32_bf16 v[76:79], a[116:119], a[44:47], v[76:79]
    s_waitcnt lgkmcnt(4)
    v_mfma_f32_16x16x32_bf16 v[92:95], a[120:123], a[44:47], v[92:95]
    ds_read_b64_tr_b16 a[96:97], v8 offset:36864
    v_mfma_f32_16x16x32_bf16 v[88:91], a[120:123], a[40:43], v[88:91]
    buffer_load_dwordx4 v250, s[36:39], s50 offen offset:2048 lds
    v_mfma_f32_16x16x32_bf16 v[84:87], a[120:123], a[36:39], v[84:87]
    ds_read_b64_tr_b16 a[98:99], v8 offset:37376
    ds_read_b128 a[48:51], v4 offset:16384
    v_mfma_f32_16x16x32_bf16 v[80:83], a[120:123], a[32:35], v[80:83]
    ds_read_b128 a[52:55], v4 offset:18432
    s_waitcnt lgkmcnt(6)
    v_mfma_f32_16x16x32_bf16 v[96:99], a[32:35], a[124:127], v[96:99]
    buffer_load_dwordx4 v251, s[36:39], s50 offen offset:3072 lds
    v_mfma_f32_16x16x32_bf16 v[100:103], a[36:39], a[124:127], v[100:103]
    s_add_u32 s50, s50, 128
    v_mfma_f32_16x16x32_bf16 v[104:107], a[40:43], a[124:127], v[104:107]
    ds_read_b64_tr_b16 a[100:101], v9 offset:36864
    ds_read_b128 a[56:59], v4 offset:20480
    s_add_u32 m0, s48, 73728
    v_mfma_f32_16x16x32_bf16 v[108:111], a[44:47], a[124:127], v[108:111]
    ds_read_b64_tr_b16 a[102:103], v9 offset:37376
    ds_read_b128 a[60:63], v4 offset:22528
    buffer_load_dwordx4 v252, s[28:31], s49 offen offset:0 lds
    s_waitcnt lgkmcnt(8)
    v_mfma_f32_16x16x32_bf16 v[124:127], a[44:47], a[128:131], v[124:127]
    ds_read_b64_tr_b16 a[104:105], v8 offset:38912
    v_mfma_f32_16x16x32_bf16 v[120:123], a[40:43], a[128:131], v[120:123]
    ds_read_b64_tr_b16 a[106:107], v8 offset:39424
    v_mfma_f32_16x16x32_bf16 v[116:119], a[36:39], a[128:131], v[116:119]
    buffer_load_dwordx4 v253, s[28:31], s49 offen offset:1024 lds
    v_mfma_f32_16x16x32_bf16 v[112:115], a[32:35], a[128:131], v[112:115]
    s_cmp_eq_u32 s11, 0
    s_cbranch_scc0 P1_c2
    v_mfma_f32_16x16x32_bf16 v[128:131], a[108:111], a[152:155], v[128:131]
    v_mfma_f32_16x16x32_bf16 v[132:135], a[112:115], a[152:155], v[132:135]
    v_mfma_f32_16x16x32_bf16 v[136:139], a[116:119], a[152:155], v[136:139]
    v_mfma_f32_16x16x32_bf16 v[140:143], a[120:123], a[152:155], v[140:143]
    v_mfma_f32_16x16x32_bf16 v[144:147], a[152:155], a[124:127], v[144:147]
    v_mfma_f32_16x16x32_bf16 v[148:151], a[152:155], a[128:131], v[148:151]
P1_c2:
    s_waitcnt lgkmcnt(2)
    v_mfma_f32_16x16x32_bf16 v[32:35], a[96:99], a[48:51], v[32:35]
    ds_read_b64_tr_b16 a[108:109], v9 offset:38912
    v_mfma_f32_16x16x32_bf16 v[36:39], a[96:99], a[52:55], v[36:39]
    buffer_load_dwordx4 v252, s[28:31], s49 offen offset:2048 lds
    v_mfma_f32_16x16x32_bf16 v[40:43], a[96:99], a[56:59], v[40:43]
    ds_read_b64_tr_b16 a[110:111], v9 offset:39424
    v_mfma_f32_16x16x32_bf16 v[44:47], a[96:99], a[60:63], v[44:47]
    s_waitcnt lgkmcnt(5)
    v_mfma_f32_16x16x32_bf16 v[60:63], a[100:103], a[60:63], v[60:63]
    buffer_load_dwordx4 v253, s[28:31], s49 offen offset:3072 lds
    v_mfma_f32_16x16x32_bf16 v[56:59], a[100:103], a[56:59], v[56:59]
    ds_read_b64_tr_b16 a[112:113], v8 offset:40960
    v_mfma_f32_16x16x32_bf16 v[52:55], a[100:103], a[52:55], v[52:55]
    s_add_u32 m0, s48, 77824
    v_mfma_f32_16x16x32_bf16 v[48:51], a[100:103], a[48:51], v[48:51]
    ds_read_b64_tr_b16 a[114:115], v8 offset:41472
    buffer_load_dwordx4 v254, s[28:31], s49 offen offset:0 lds
    s_waitcnt lgkmcnt(4)
    v_mfma_f32_16x16x32_bf16 v[64:67], a[104:107], a[48:51], v[64:67]
    ds_read_b64_tr_b16 a[116:117], v9 offset:40960
    v_mfma_f32_16x16x32_bf16 v[68:71], a[104:107], a[52:55], v[68:71]
    ds_read_b64_tr_b16 a[118:119], v9 offset:41472
    v_mfma_f32_16x16x32_bf16 v[72:75], a[104:107], a[56:59], v[72:75]
    buffer_load_dwordx4 v255, s[28:31], s49 offen offset:1024 lds
    v_mfma_f32_16x16x32_bf16 v[76:79], a[104:107], a[60:63], v[76:79]
    s_add_u32 s49, s49, 393216
    s_waitcnt vmcnt(10)
    s_barrier
    s_waitcnt lgkmcnt(4)
    v_mfma_f32_16x16x32_bf16 v[92:95], a[108:111], a[60:63], v[92:95]
    s_add_u32 m0, s59, 0
    v_mfma_f32_16x16x32_bf16 v[88:91], a[108:111], a[56:59], v[88:91]
    buffer_load_dwordx4 v248, s[36:39], s50 offen offset:0 lds
    v_mfma_f32_16x16x32_bf16 v[84:87], a[108:111], a[52:55], v[84:87]
    ds_read_b64_tr_b16 a[120:121], v10 offset:0
    ds_read_b128 a[64:67], v3 offset:32768
    v_mfma_f32_16x16x32_bf16 v[80:83], a[108:111], a[48:51], v[80:83]
    ds_read_b64_tr_b16 a[122:123], v10 offset:512
    ds_read_b128 a[68:71], v3 offset:34816
    s_waitcnt lgkmcnt(6)
    v_mfma_f32_16x16x32_bf16 v[96:99], a[48:51], a[112:115], v[96:99]
    buffer_load_dwordx4 v249, s[36:39], s50 offen offset:1024 lds
    v_mfma_f32_16x16x32_bf16 v[100:103], a[52:55], a[112:115], v[100:103]
    ds_read_b64_tr_b16 a[124:125], v11 offset:0
    v_mfma_f32_16x16x32_bf16 v[104:107], a[56:59], a[112:115], v[104:107]
    ds_read_b64_tr_b16 a[126:127], v11 offset:512
    ds_read_b128 a[72:75], v3 offset:36864
    v_mfma_f32_16x16x32_bf16 v[108:111], a[60:63], a[112:115], v[108:111]
    ds_read_b128 a[76:79], v3 offset:38912
    buffer_load_dwordx4 v250, s[36:39], s50 offen offset:2048 lds
    s_waitcnt lgkmcnt(8)
    v_mfma_f32_16x16x32_bf16 v[124:127], a[60:63], a[116:119], v[124:127]
    ds_read_b64_tr_b16 a[128:129], v10 offset:2048
    v_mfma_f32_16x16x32_bf16 v[120:123], a[56:59], a[116:119], v[120:123]
    ds_read_b64_tr_b16 a[130:131], v10 offset:2560
    v_mfma_f32_16x16x32_bf16 v[116:119], a[52:55], a[116:119], v[116:119]
    buffer_load_dwordx4 v251, s[36:39], s50 offen offset:3072 lds
    v_mfma_f32_16x16x32_bf16 v[112:115], a[48:51], a[116:119], v[112:115]
    s_add_u32 s50, s50, 128
    s_cmp_eq_u32 s11, 1
    s_cbranch_scc0 P1_c3
    v_mfma_f32_16x16x32_bf16 v[128:131], a[96:99], a[152:155], v[128:131]
    v_mfma_f32_16x16x32_bf16 v[132:135], a[100:103], a[152:155], v[132:135]
    v_mfma_f32_16x16x32_bf16 v[136:139], a[104:107], a[152:155], v[136:139]
    v_mfma_f32_16x16x32_bf16 v[140:143], a[108:111], a[152:155], v[140:143]
    v_mfma_f32_16x16x32_bf16 v[144:147], a[152:155], a[112:115], v[144:147]
    v_mfma_f32_16x16x32_bf16 v[148:151], a[152:155], a[116:119], v[148:151]
P1_c3:
    s_waitcnt lgkmcnt(2)
    v_mfma_f32_16x16x32_bf16 v[32:35], a[120:123], a[64:67], v[32:35]
    ds_read_b64_tr_b16 a[96:97], v11 offset:2048
    v_mfma_f32_16x16x32_bf16 v[36:39], a[120:123], a[68:71], v[36:39]
    s_add_u32 m0, s48, 0
    v_mfma_f32_16x16x32_bf16 v[40:43], a[120:123], a[72:75], v[40:43]
    buffer_load_dwordx4 v252, s[28:31], s49 offen offset:0 lds
    v_mfma_f32_16x16x32_bf16 v[44:47], a[120:123], a[76:79], v[44:47]
    ds_read_b64_tr_b16 a[98:99], v11 offset:2560
    s_waitcnt lgkmcnt(6)
    v_mfma_f32_16x16x32_bf16 v[60:63], a[124:127], a[76:79], v[60:63]
    ds_read_b64_tr_b16 a[100:101], v10 offset:4096
    v_mfma_f32_16x16x32_bf16 v[56:59], a[124:127], a[72:75], v[56:59]
    ds_read_b64_tr_b16 a[102:103], v10 offset:4608
    v_mfma_f32_16x16x32_bf16 v[52:55], a[124:127], a[68:71], v[52:55]
    v_mfma_f32_16x16x32_bf16 v[48:51], a[124:127], a[64:67], v[48:51]
    buffer_load_dwordx4 v253, s[28:31], s49 offen offset:1024 lds
    s_waitcnt lgkmcnt(4)
    v_mfma_f32_16x16x32_bf16 v[64:67], a[128:131], a[64:67], v[64:67]
    ds_read_b64_tr_b16 a[104:105], v11 offset:4096
    v_mfma_f32_16x16x32_bf16 v[68:71], a[128:131], a[68:71], v[68:71]
    ds_read_b64_tr_b16 a[106:107], v11 offset:4608
    v_mfma_f32_16x16x32_bf16 v[72:75], a[128:131], a[72:75], v[72:75]
    v_mfma_f32_16x16x32_bf16 v[76:79], a[128:131], a[76:79], v[76:79]
    s_waitcnt lgkmcnt(4)
    v_mfma_f32_16x16x32_bf16 v[92:95], a[96:99], a[76:79], v[92:95]
    buffer_load_dwordx4 v252, s[28:31], s49 offen offset:2048 lds
    v_mfma_f32_16x16x32_bf16 v[88:91], a[96:99], a[72:75], v[88:91]
    ds_read_b64_tr_b16 a[108:109], v10 offset:12288
    v_mfma_f32_16x16x32_bf16 v[84:87], a[96:99], a[68:71], v[84:87]
    ds_read_b64_tr_b16 a[110:111], v10 offset:12800
    ds_read_b128 a[80:83], v4 offset:32768
    v_mfma_f32_16x16x32_bf16 v[80:83], a[96:99], a[64:67], v[80:83]
    ds_read_b128 a[84:87], v4 offset:34816
    s_waitcnt lgkmcnt(6)
    v_mfma_f32_16x16x32_bf16 v[96:99], a[64:67], a[100:103], v[96:99]
    buffer_load_dwordx4 v253, s[28:31], s49 offen offset:3072 lds
    v_mfma_f32_16x16x32_bf16 v[100:103], a[68:71], a[100:103], v[100:103]
    ds_read_b64_tr_b16 a[112:113], v11 offset:12288
    v_mfma_f32_16x16x32_bf16 v[104:107], a[72:75], a[100:103], v[104:107]
    ds_read_b64_tr_b16 a[114:115], v11 offset:12800
    ds_read_b128 a[88:91], v4 offset:36864
    v_mfma_f32_16x16x32_bf16 v[108:111], a[76:79], a[100:103], v[108:111]
    ds_read_b128 a[92:95], v4 offset:38912
    s_waitcnt lgkmcnt(8)
    v_mfma_f32_16x16x32_bf16 v[124:127], a[76:79], a[104:107], v[124:127]
    s_add_u32 m0, s48, 4096
    s_cmp_eq_u32 s3, 2
    s_cbranch_scc0 P1_t2
    buffer_load_dword v15, v13, s[68:71], 0 offen
P1_t2:
    v_mfma_f32_16x16x32_bf16 v[120:123], a[72:75], a[104:107], v[120:123]
    buffer_load_dwordx4 v254, s[28:31], s49 offen offset:0 lds
    v_mfma_f32_16x16x32_bf16 v[116:119], a[68:71], a[104:107], v[116:119]
    ds_read_b64_tr_b16 a[116:117], v10 offset:14336
    v_mfma_f32_16x16x32_bf16 v[112:115], a[64:67], a[104:107], v[112:115]
    ds_read_b64_tr_b16 a[118:119], v10 offset:14848
    s_cmp_eq_u32 s11, 0
    s_cbranch_scc0 P1_c4
    v_mfma_f32_16x16x32_bf16 v[128:131], a[120:123], a[152:155], v[128:131]
    v_mfma_f32_16x16x32_bf16 v[132:135], a[124:127], a[152:155], v[132:135]
    v_mfma_f32_16x16x32_bf16 v[136:139], a[128:131], a[152:155], v[136:139]
    v_mfma_f32_16x16x32_bf16 v[140:143], a[96:99], a[152:155], v[140:143]
    v_mfma_f32_16x16x32_bf16 v[144:147], a[152:155], a[100:103], v[144:147]
    v_mfma_f32_16x16x32_bf16 v[148:151], a[152:155], a[104:107], v[148:151]
P1_c4:
    s_waitcnt lgkmcnt(2)
    v_mfma_f32_16x16x32_bf16 v[32:35], a[108:111], a[80:83], v[32:35]
    ds_read_b64_tr_b16 a[120:121], v11 offset:14336
    v_mfma_f32_16x16x32_bf16 v[36:39], a[108:111], a[84:87], v[36:39]
    ds_read_b64_tr_b16 a[122:123], v11 offset:14848
    v_mfma_f32_16x16x32_bf16 v[40:43], a[108:111], a[88:91], v[40:43]
    buffer_load_dwordx4 v255, s[28:31], s49 offen offset:1024 lds
    v_mfma_f32_16x16x32_bf16 v[44:47], a[108:111], a[92:95], v[44:47]
    s_add_u32 s49, s49, 393216
    s_waitcnt vmcnt(30)
    v_readfirstlane_b32 s10, v17
    s_nop 0
    s_cmp_lg_u32 s10, 0
    s_cbranch_scc1 P1_tag
    s_mov_b32 s52, 0x40000
    v_mov_b32 v12, 0
P1_tagpoll:
    buffer_load_dword v17, v12, s[72:75], 0 offen sc1
    s_waitcnt vmcnt(0)
    v_readfirstlane_b32 s10, v17
    s_sub_u32 s52, s52, 1
    s_cbranch_scc1 P1_tag
    s_cmp_eq_u32 s10, 0
    s_cbranch_scc1 P1_tagpoll
P1_tag:
    s_waitcnt lgkmcnt(6)
    v_mfma_f32_16x16x32_bf16 v[60:63], a[112:115], a[92:95], v[60:63]
    ds_read_b64_tr_b16 a[124:125], v10 offset:16384
    v_mfma_f32_16x16x32_bf16 v[56:59], a[112:115], a[88:91], v[56:59]
    ds_read_b64_tr_b16 a[126:127], v10 offset:16896
    v_mfma_f32_16x16x32_bf16 v[52:55], a[112:115], a[84:87], v[52:55]
    s_add_u32 m0, s59, 16384
    v_mfma_f32_16x16x32_bf16 v[48:51], a[112:115], a[80:83], v[48:51]
    buffer_load_dwordx4 v248, s[36:39], s50 offen offset:0 lds
    s_waitcnt lgkmcnt(4)
    v_mfma_f32_16x16x32_bf16 v[64:67], a[116:119], a[80:83], v[64:67]
    ds_read_b64_tr_b16 a[128:129], v11 offset:16384
    v_mfma_f32_16x16x32_bf16 v[68:71], a[116:119], a[84:87], v[68:71]
    ds_read_b64_tr_b16 a[130:131], v11 offset:16896
    v_mfma_f32_16x16x32_bf16 v[72:75], a[116:119], a[88:91], v[72:75]
    v_mfma_f32_16x16x32_bf16 v[76:79], a[116:119], a[92:95], v[76:79]
    s_waitcnt vmcnt(11)
    s_barrier
    s_waitcnt lgkmcnt(4)
    v_mfma_f32_16x16x32_bf16 v[92:95], a[120:123], a[92:95], v[92:95]
    buffer_load_dwordx4 v249, s[36:39], s50 offen offset:1024 lds
    v_mfma_f32_16x16x32_bf16 v[88:91], a[120:123], a[88:91], v[88:91]
    ds_read_b64_tr_b16 a[96:97], v10 offset:24576
    v_mfma_f32_16x16x32_bf16 v[84:87], a[120:123], a[84:87], v[84:87]
    ds_read_b64_tr_b16 a[98:99], v10 offset:25088
    ds_read_b128 a[0:3], v3 offset:49152
    v_mfma_f32_16x16x32_bf16 v[80:83], a[120:123], a[80:83], v[80:83]
    ds_read_b128 a[4:7], v3 offset:51200
    s_waitcnt lgkmcnt(6)
    v_mfma_f32_16x16x32_bf16 v[96:99], a[80:83], a[124:127], v[96:99]
    buffer_load_dwordx4 v250, s[36:39], s50 offen offset:2048 lds
    v_mfma_f32_16x16x32_bf16 v[100:103], a[84:87], a[124:127], v[100:103]
    ds_read_b64_tr_b16 a[100:101], v11 offset:24576
    v_mfma_f32_16x16x32_bf16 v[104:107], a[88:91], a[124:127], v[104:107]
    ds_read_b64_tr_b16 a[102:103], v11 offset:25088
    ds_read_b128 a[8:11], v3 offset:53248
    v_mfma_f32_16x16x32_bf16 v[108:111], a[92:95], a[124:127], v[108:111]
    ds_read_b128 a[12:15], v3 offset:55296
    s_waitcnt lgkmcnt(8)
    v_mfma_f32_16x16x32_bf16 v[124:127], a[92:95], a[128:131], v[124:127]
    ds_read_b64_tr_b16 a[104:105], v10 offset:26624
    v_mfma_f32_16x16x32_bf16 v[120:123], a[88:91], a[128:131], v[120:123]
    buffer_load_dwordx4 v251, s[36:39], s50 offen offset:3072 lds
    v_mfma_f32_16x16x32_bf16 v[116:119], a[84:87], a[128:131], v[116:119]
    s_add_u32 s50, s50, 128
    v_mfma_f32_16x16x32_bf16 v[112:115], a[80:83], a[128:131], v[112:115]
    ds_read_b64_tr_b16 a[106:107], v10 offset:27136
    s_cmp_eq_u32 s11, 1
    s_cbranch_scc0 P1_c5
    v_mfma_f32_16x16x32_bf16 v[128:131], a[108:111], a[152:155], v[128:131]
    v_mfma_f32_16x16x32_bf16 v[132:135], a[112:115], a[152:155], v[132:135]
    v_mfma_f32_16x16x32_bf16 v[136:139], a[116:119], a[152:155], v[136:139]
    v_mfma_f32_16x16x32_bf16 v[140:143], a[120:123], a[152:155], v[140:143]
    v_mfma_f32_16x16x32_bf16 v[144:147], a[152:155], a[124:127], v[144:147]
    v_mfma_f32_16x16x32_bf16 v[148:151], a[152:155], a[128:131], v[148:151]
P1_c5:
    s_waitcnt lgkmcnt(2)
    v_mfma_f32_16x16x32_bf16 v[32:35], a[96:99], a[0:3], v[32:35]
    ds_read_b64_tr_b16 a[108:109], v11 offset:26624
    v_mfma_f32_16x16x32_bf16 v[36:39], a[96:99], a[4:7], v[36:39]
    s_add_u32 m0, s48, 24576
    v_mfma_f32_16x16x32_bf16 v[40:43], a[96:99], a[8:11], v[40:43]
    buffer_load_dwordx4 v252, s[28:31], s49 offen offset:0 lds
    v_mfma_f32_16x16x32_bf16 v[44:47], a[96:99], a[12:15], v[44:47]
    ds_read_b64_tr_b16 a[110:111], v11 offset:27136
    s_cmp_eq_u32 s3, 0
    s_cbranch_scc0 P1_a
    v_mov_b32 v12, s10
    s_lshl_b32 s52, s56, 2
    buffer_store_dword v12, v14, s[64:67], s52 offen sc1
P1_a:
    s_waitcnt lgkmcnt(6)
    v_mfma_f32_16x16x32_bf16 v[60:63], a[100:103], a[12:15], v[60:63]
    ds_read_b64_tr_b16 a[112:113], v10 offset:28672
    v_mfma_f32_16x16x32_bf16 v[56:59], a[100:103], a[8:11], v[56:59]
    ds_read_b64_tr_b16 a[114:115], v10 offset:29184
    v_mfma_f32_16x16x32_bf16 v[52:55], a[100:103], a[4:7], v[52:55]
    v_mfma_f32_16x16x32_bf16 v[48:51], a[100:103], a[0:3], v[48:51]
    buffer_load_dwordx4 v253, s[28:31], s49 offen offset:1024 lds
    s_waitcnt lgkmcnt(4)
    v_mfma_f32_16x16x32_bf16 v[64:67], a[104:107], a[0:3], v[64:67]
    ds_read_b64_tr_b16 a[116:117], v11 offset:28672
    v_mfma_f32_16x16x32_bf16 v[68:71], a[104:107], a[4:7], v[68:71]
    ds_read_b64_tr_b16 a[118:119], v11 offset:29184
    v_mfma_f32_16x16x32_bf16 v[72:75], a[104:107], a[8:11], v[72:75]
    v_mfma_f32_16x16x32_bf16 v[76:79], a[104:107], a[12:15], v[76:79]
    s_waitcnt lgkmcnt(4)
    v_mfma_f32_16x16x32_bf16 v[92:95], a[108:111], a[12:15], v[92:95]
    buffer_load_dwordx4 v252, s[28:31], s49 offen offset:2048 lds
    v_mfma_f32_16x16x32_bf16 v[88:91], a[108:111], a[8:11], v[88:91]
    ds_read_b64_tr_b16 a[120:121], v10 offset:36864
    v_mfma_f32_16x16x32_bf16 v[84:87], a[108:111], a[4:7], v[84:87]
    ds_read_b64_tr_b16 a[122:123], v10 offset:37376
    ds_read_b128 a[16:19], v4 offset:49152
    v_mfma_f32_16x16x32_bf16 v[80:83], a[108:111], a[0:3], v[80:83]
    ds_read_b128 a[20:23], v4 offset:51200
    s_waitcnt lgkmcnt(6)
    v_mfma_f32_16x16x32_bf16 v[96:99], a[0:3], a[112:115], v[96:99]
    buffer_load_dwordx4 v253, s[28:31], s49 offen offset:3072 lds
    v_mfma_f32_16x16x32_bf16 v[100:103], a[4:7], a[112:115], v[100:103]
    ds_read_b64_tr_b16 a[124:125], v11 offset:36864
    v_mfma_f32_16x16x32_bf16 v[104:107], a[8:11], a[112:115], v[104:107]
    ds_read_b64_tr_b16 a[126:127], v11 offset:37376
    ds_read_b128 a[24:27], v4 offset:53248
    v_mfma_f32_16x16x32_bf16 v[108:111], a[12:15], a[112:115], v[108:111]
    ds_read_b128 a[28:31], v4 offset:55296
    s_waitcnt lgkmcnt(8)
    v_mfma_f32_16x16x32_bf16 v[124:127], a[12:15], a[116:119], v[124:127]
    s_add_u32 m0, s48, 28672
    v_mfma_f32_16x16x32_bf16 v[120:123], a[8:11], a[116:119], v[120:123]
    buffer_load_dwordx4 v254, s[28:31], s49 offen offset:0 lds
    v_mfma_f32_16x16x32_bf16 v[116:119], a[4:7], a[116:119], v[116:119]
    ds_read_b64_tr_b16 a[128:129], v10 offset:38912
    v_mfma_f32_16x16x32_bf16 v[112:115], a[0:3], a[116:119], v[112:115]
    ds_read_b64_tr_b16 a[130:131], v10 offset:39424
    s_cmp_eq_u32 s11, 0
    s_cbranch_scc0 P1_c6
    v_mfma_f32_16x16x32_bf16 v[128:131], a[96:99], a[152:155], v[128:131]
    v_mfma_f32_16x16x32_bf16 v[132:135], a[100:103], a[152:155], v[132:135]
    v_mfma_f32_16x16x32_bf16 v[136:139], a[104:107], a[152:155], v[136:139]
    v_mfma_f32_16x16x32_bf16 v[140:143], a[108:111], a[152:155], v[140:143]
    v_mfma_f32_16x16x32_bf16 v[144:147], a[152:155], a[112:115], v[144:147]
    v_mfma_f32_16x16x32_bf16 v[148:151], a[152:155], a[116:119], v[148:151]
P1_c6:
    s_waitcnt lgkmcnt(2)
    v_mfma_f32_16x16x32_bf16 v[32:35], a[120:123], a[16:19], v[32:35]
    ds_read_b64_tr_b16 a[96:97], v11 offset:38912
    v_mfma_f32_16x16x32_bf16 v[36:39], a[120:123], a[20:23], v[36:39]
    ds_read_b64_tr_b16 a[98:99], v11 offset:39424
    v_mfma_f32_16x16x32_bf16 v[40:43], a[120:123], a[24:27], v[40:43]
    buffer_load_dwordx4 v255, s[28:31], s49 offen offset:1024 lds
    v_mfma_f32_16x16x32_bf16 v[44:47], a[120:123], a[28:31], v[44:47]
    s_add_u32 s49, s49, 393216
    s_waitcnt lgkmcnt(6)
    v_mfma_f32_16x16x32_bf16 v[60:63], a[124:127], a[28:31], v[60:63]
    ds_read_b64_tr_b16 a[100:101], v10 offset:40960
    v_mfma_f32_16x16x32_bf16 v[56:59], a[124:127], a[24:27], v[56:59]
    ds_read_b64_tr_b16 a[102:103], v10 offset:41472
    v_mfma_f32_16x16x32_bf16 v[52:55], a[124:127], a[20:23], v[52:55]
    s_add_u32 m0, s59, 32768
    v_mfma_f32_16x16x32_bf16 v[48:51], a[124:127], a[16:19], v[48:51]
    buffer_load_dwordx4 v248, s[36:39], s50 offen offset:0 lds
    s_waitcnt lgkmcnt(4)
    v_mfma_f32_16x16x32_bf16 v[64:67], a[128:131], a[16:19], v[64:67]
    ds_read_b64_tr_b16 a[104:105], v11 offset:40960
    v_mfma_f32_16x16x32_bf16 v[68:71], a[128:131], a[20:23], v[68:71]
    ds_read_b64_tr_b16 a[106:107], v11 offset:41472
    v_mfma_f32_16x16x32_bf16 v[72:75], a[128:131], a[24:27], v[72:75]
    v_mfma_f32_16x16x32_bf16 v[76:79], a[128:131], a[28:31], v[76:79]
    s_waitcnt vmcnt(11)
    s_barrier
    s_waitcnt lgkmcnt(4)
    v_mfma_f32_16x16x32_bf16 v[92:95], a[96:99], a[28:31], v[92:95]
    buffer_load_dwordx4 v249, s[36:39], s50 offen offset:1024 lds
    v_mfma_f32_16x16x32_bf16 v[88:91], a[96:99], a[24:27], v[88:91]
    ds_read_b64_tr_b16 a[108:109], v8 offset:0
    v_mfma_f32_16x16x32_bf16 v[84:87], a[96:99], a[20:23], v[84:87]
    ds_read_b64_tr_b16 a[110:111], v8 offset:512
    ds_read_b128 a[32:35], v3 offset:0
    v_mfma_f32_16x16x32_bf16 v[80:83], a[96:99], a[16:19], v[80:83]
    ds_read_b128 a[36:39], v3 offset:2048
    s_waitcnt lgkmcnt(6)
    v_mfma_f32_16x16x32_bf16 v[96:99], a[16:19], a[100:103], v[96:99]
    buffer_load_dwordx4 v250, s[36:39], s50 offen offset:2048 lds
    v_mfma_f32_16x16x32_bf16 v[100:103], a[20:23], a[100:103], v[100:103]
    ds_read_b64_tr_b16 a[112:113], v9 offset:0
    v_mfma_f32_16x16x32_bf16 v[104:107], a[24:27], a[100:103], v[104:107]
    ds_read_b64_tr_b16 a[114:115], v9 offset:512
    ds_read_b128 a[40:43], v3 offset:4096
    v_mfma_f32_16x16x32_bf16 v[108:111], a[28:31], a[100:103], v[108:111]
    ds_read_b128 a[44:47], v3 offset:6144
    s_waitcnt lgkmcnt(8)
    v_mfma_f32_16x16x32_bf16 v[124:127], a[28:31], a[104:107], v[124:127]
    ds_read_b64_tr_b16 a[116:117], v8 offset:2048
    v_mfma_f32_16x16x32_bf16 v[120:123], a[24:27], a[104:107], v[120:123]
    buffer_load_dwordx4 v251, s[36:39], s50 offen offset:3072 lds
    v_mfma_f32_16x16x32_bf16 v[116:119], a[20:23], a[104:107], v[116:119]
    s_add_u32 s50, s50, 128
    v_mfma_f32_16x16x32_bf16 v[112:115], a[16:19], a[104:107], v[112:115]
    ds_read_b64_tr_b16 a[118:119], v8 offset:2560
    s_cmp_eq_u32 s11, 1
    s_cbranch_scc0 P1_c7
    v_mfma_f32_16x16x32_bf16 v[128:131], a[120:123], a[152:155], v[128:131]
    v_mfma_f32_16x16x32_bf16 v[132:135], a[124:127], a[152:155], v[132:135]
    v_mfma_f32_16x16x32_bf16 v[136:139], a[128:131], a[152:155], v[136:139]
    v_mfma_f32_16x16x32_bf16 v[140:143], a[96:99], a[152:155], v[140:143]
    v_mfma_f32_16x16x32_bf16 v[144:147], a[152:155], a[100:103], v[144:147]
    v_mfma_f32_16x16x32_bf16 v[148:151], a[152:155], a[104:107], v[148:151]
P1_c7:
    s_waitcnt lgkmcnt(2)
    v_mfma_f32_16x16x32_bf16 v[32:35], a[108:111], a[32:35], v[32:35]
    ds_read_b64_tr_b16 a[120:121], v9 offset:2048
    v_mfma_f32_16x16x32_bf16 v[36:39], a[108:111], a[36:39], v[36:39]
    s_add_u32 m0, s48, 49152
    v_mfma_f32_16x16x32_bf16 v[40:43], a[108:111], a[40:43], v[40:43]
    buffer_load_dwordx4 v252, s[28:31], s49 offen offset:0 lds
    v_mfma_f32_16x16x32_bf16 v[44:47], a[108:111], a[44:47], v[44:47]
    ds_read_b64_tr_b16 a[122:123], v9 offset:2560
    s_waitcnt lgkmcnt(6)
    v_mfma_f32_16x16x32_bf16 v[60:63], a[112:115], a[44:47], v[60:63]
    ds_read_b64_tr_b16 a[124:125], v8 offset:4096
    v_mfma_f32_16x16x32_bf16 v[56:59], a[112:115], a[40:43], v[56:59]
    ds_read_b64_tr_b16 a[126:127], v8 offset:4608
    v_mfma_f32_16x16x32_bf16 v[52:55], a[112:115], a[36:39], v[52:55]
    v_mfma_f32_16x16x32_bf16 v[48:51], a[112:115], a[32:35], v[48:51]
    buffer_load_dwordx4 v253, s[28:31], s49 offen offset:1024 lds
    s_waitcnt lgkmcnt(4)
    v_mfma_f32_16x16x32_bf16 v[64:67], a[116:119], a[32:35], v[64:67]
    ds_read_b64_tr_b16 a[128:129], v9 offset:4096
    v_mfma_f32_16x16x32_bf16 v[68:71], a[116:119], a[36:39], v[68:71]
    ds_read_b64_tr_b16 a[130:131], v9 offset:4608
    v_mfma_f32_16x16x32_bf16 v[72:75], a[116:119], a[40:43], v[72:75]
    v_mfma_f32_16x16x32_bf16 v[76:79], a[116:119], a[44:47], v[76:79]
    s_waitcnt lgkmcnt(4)
    v_mfma_f32_16x16x32_bf16 v[92:95], a[120:123], a[44:47], v[92:95]
    buffer_load_dwordx4 v252, s[28:31], s49 offen offset:2048 lds
    v_mfma_f32_16x16x32_bf16 v[88:91], a[120:123], a[40:43], v[88:91]
    ds_read_b64_tr_b16 a[96:97], v8 offset:12288
    v_mfma_f32_16x16x32_bf16 v[84:87], a[120:123], a[36:39], v[84:87]
    ds_read_b64_tr_b16 a[98:99], v8 offset:12800
    ds_read_b128 a[48:51], v4 offset:0
    v_mfma_f32_16x16x32_bf16 v[80:83], a[120:123], a[32:35], v[80:83]
    ds_read_b128 a[52:55], v4 offset:2048
    s_waitcnt lgkmcnt(6)
    v_mfma_f32_16x16x32_bf16 v[96:99], a[32:35], a[124:127], v[96:99]
    buffer_load_dwordx4 v253, s[28:31], s49 offen offset:3072 lds
    v_mfma_f32_16x16x32_bf16 v[100:103], a[36:39], a[124:127], v[100:103]
    ds_read_b64_tr_b16 a[100:101], v9 offset:12288
    v_mfma_f32_16x16x32_bf16 v[104:107], a[40:43], a[124:127], v[104:107]
    ds_read_b64_tr_b16 a[102:103], v9 offset:12800
    ds_read_b128 a[56:59], v4 offset:4096
    v_mfma_f32_16x16x32_bf16 v[108:111], a[44:47], a[124:127], v[108:111]
    ds_read_b128 a[60:63], v4 offset:6144
    s_waitcnt lgkmcnt(8)
    v_mfma_f32_16x16x32_bf16 v[124:127], a[44:47], a[128:131], v[124:127]
    s_add_u32 m0, s48, 53248
    v_mfma_f32_16x16x32_bf16 v[120:123], a[40:43], a[128:131], v[120:123]
    buffer_load_dwordx4 v254, s[28:31], s49 offen offset:0 lds
    v_mfma_f32_16x16x32_bf16 v[116:119], a[36:39], a[128:131], v[116:119]
    ds_read_b64_tr_b16 a[104:105], v8 offset:14336
    v_mfma_f32_16x16x32_bf16 v[112:115], a[32:35], a[128:131], v[112:115]
    ds_read_b64_tr_b16 a[106:107], v8 offset:14848
    s_cmp_eq_u32 s11, 0
    s_cbranch_scc0 P1_c8
    v_mfma_f32_16x16x32_bf16 v[128:131], a[108:111], a[152:155], v[128:131]
    v_mfma_f32_16x16x32_bf16 v[132:135], a[112:115], a[152:155], v[132:135]
    v_mfma_f32_16x16x32_bf16 v[136:139], a[116:119], a[152:155], v[136:139]
    v_mfma_f32_16x16x32_bf16 v[140:143], a[120:123], a[152:155], v[140:143]
    v_mfma_f32_16x16x32_bf16 v[144:147], a[152:155], a[124:127], v[144:147]
    v_mfma_f32_16x16x32_bf16 v[148:151], a[152:155], a[128:131], v[148:151]
P1_c8:
    s_waitcnt lgkmcnt(2)
    v_mfma_f32_16x16x32_bf16 v[32:35], a[96:99], a[48:51], v[32:35]
    ds_read_b64_tr_b16 a[108:109], v9 offset:14336
    v_mfma_f32_16x16x32_bf16 v[36:39], a[96:99], a[52:55], v[36:39]
    ds_read_b64_tr_b16 a[110:111], v9 offset:14848
    v_mfma_f32_16x16x32_bf16 v[40:43], a[96:99], a[56:59], v[40:43]
    buffer_load_dwordx4 v255, s[28:31], s49 offen offset:1024 lds
    v_mfma_f32_16x16x32_bf16 v[44:47], a[96:99], a[60:63], v[44:47]
    s_add_u32 s49, s49, 393216
    s_waitcnt lgkmcnt(6)
    v_mfma_f32_16x16x32_bf16 v[60:63], a[100:103], a[60:63], v[60:63]
    ds_read_b64_tr_b16 a[112:113], v8 offset:16384
    v_mfma_f32_16x16x32_bf16 v[56:59], a[100:103], a[56:59], v[56:59]
    ds_read_b64_tr_b16 a[114:115], v8 offset:16896
    v_mfma_f32_16x16x32_bf16 v[52:55], a[100:103], a[52:55], v[52:55]
    s_add_u32 m0, s59, 49152
    v_mfma_f32_16x16x32_bf16 v[48:51], a[100:103], a[48:51], v[48:51]
    buffer_load_dwordx4 v248, s[36:39], s50 offen offset:0 lds
    s_waitcnt lgkmcnt(4)
    v_mfma_f32_16x16x32_bf16 v[64:67], a[104:107], a[48:51], v[64:67]
    ds_read_b64_tr_b16 a[116:117], v9 offset:16384
    v_mfma_f32_16x16x32_bf16 v[68:71], a[104:107], a[52:55], v[68:71]
    ds_read_b64_tr_b16 a[118:119], v9 offset:16896
    v_mfma_f32_16x16x32_bf16 v[72:75], a[104:107], a[56:59], v[72:75]
    v_mfma_f32_16x16x32_bf16 v[76:79], a[104:107], a[60:63], v[76:79]
    s_waitcnt vmcnt(11)
    s_barrier
    s_waitcnt lgkmcnt(4)
    v_mfma_f32_16x16x32_bf16 v[92:95], a[108:111], a[60:63], v[92:95]
    buffer_load_dwordx4 v249, s[36:39], s50 offen offset:1024 lds
    v_mfma_f32_16x16x32_bf16 v[88:91], a[108:111], a[56:59], v[88:91]
    ds_read_b64_tr_b16 a[120:121], v8 offset:24576
    v_mfma_f32_16x16x32_bf16 v[84:87], a[108:111], a[52:55], v[84:87]
    ds_read_b64_tr_b16 a[122:123], v8 offset:25088
    ds_read_b128 a[64:67], v3 offset:16384
    v_mfma_f32_16x16x32_bf16 v[80:83], a[108:111], a[48:51], v[80:83]
    ds_read_b128 a[68:71], v3 offset:18432
    s_waitcnt lgkmcnt(6)
    v_mfma_f32_16x16x32_bf16 v[96:99], a[48:51], a[112:115], v[96:99]
    buffer_load_dwordx4 v250, s[36:39], s50 offen offset:2048 lds
    v_mfma_f32_16x16x32_bf16 v[100:103], a[52:55], a[112:115], v[100:103]
    ds_read_b64_tr_b16 a[124:125], v9 offset:24576
    v_mfma_f32_16x16x32_bf16 v[104:107], a[56:59], a[112:115], v[104:107]
    ds_read_b64_tr_b16 a[126:127], v9 offset:25088
    ds_read_b128 a[72:75], v3 offset:20480
    v_mfma_f32_16x16x32_bf16 v[108:111], a[60:63], a[112:115], v[108:111]
    ds_read_b128 a[76:79], v3 offset:22528
    s_waitcnt lgkmcnt(8)
    v_mfma_f32_16x16x32_bf16 v[124:127], a[60:63], a[116:119], v[124:127]
    ds_read_b64_tr_b16 a[128:129], v8 offset:26624
    v_mfma_f32_16x16x32_bf16 v[120:123], a[56:59], a[116:119], v[120:123]
    buffer_load_dwordx4 v251, s[36:39], s50 offen offset:3072 lds
    v_mfma_f32_16x16x32_bf16 v[116:119], a[52:55], a[116:119], v[116:119]
    s_add_u32 s50, s50, 128
    v_mfma_f32_16x16x32_bf16 v[112:115], a[48:51], a[116:119], v[112:115]
    ds_read_b64_tr_b16 a[130:131], v8 offset:27136
    s_cmp_eq_u32 s11, 1
    s_cbranch_scc0 P1_c9
    v_mfma_f32_16x16x32_bf16 v[128:131], a[96:99], a[152:155], v[128:131]
    v_mfma_f32_16x16x32_bf16 v[132:135], a[100:103], a[152:155], v[132:135]
    v_mfma_f32_16x16x32_bf16 v[136:139], a[104:107], a[152:155], v[136:139]
    v_mfma_f32_16x16x32_bf16 v[140:143], a[108:111], a[152:155], v[140:143]
    v_mfma_f32_16x16x32_bf16 v[144:147], a[152:155], a[112:115], v[144:147]
    v_mfma_f32_16x16x32_bf16 v[148:151], a[152:155], a[116:119], v[148:151]
P1_c9:
    s_waitcnt lgkmcnt(2)
    v_mfma_f32_16x16x32_bf16 v[32:35], a[120:123], a[64:67], v[32:35]
    ds_read_b64_tr_b16 a[96:97], v9 offset:26624
    v_mfma_f32_16x16x32_bf16 v[36:39], a[120:123], a[68:71], v[36:39]
    s_add_u32 m0, s48, 73728
    v_mfma_f32_16x16x32_bf16 v[40:43], a[120:123], a[72:75], v[40:43]
    buffer_load_dwordx4 v252, s[28:31], s49 offen offset:0 lds
    v_mfma_f32_16x16x32_bf16 v[44:47], a[120:123], a[76:79], v[44:47]
    ds_read_b64_tr_b16 a[98:99], v9 offset:27136
    s_waitcnt lgkmcnt(6)
    v_mfma_f32_16x16x32_bf16 v[60:63], a[124:127], a[76:79], v[60:63]
    ds_read_b64_tr_b16 a[100:101], v8 offset:28672
    v_mfma_f32_16x16x32_bf16 v[56:59], a[124:127], a[72:75], v[56:59]
    ds_read_b64_tr_b16 a[102:103], v8 offset:29184
    v_mfma_f32_16x16x32_bf16 v[52:55], a[124:127], a[68:71], v[52:55]
    v_mfma_f32_16x16x32_bf16 v[48:51], a[124:127], a[64:67], v[48:51]
    buffer_load_dwordx4 v253, s[28:31], s49 offen offset:1024 lds
    s_waitcnt lgkmcnt(4)
    v_mfma_f32_16x16x32_bf16 v[64:67], a[128:131], a[64:67], v[64:67]
    ds_read_b64_tr_b16 a[104:105], v9 offset:28672
    v_mfma_f32_16x16x32_bf16 v[68:71], a[128:131], a[68:71], v[68:71]
    ds_read_b64_tr_b16 a[106:107], v9 offset:29184
    v_mfma_f32_16x16x32_bf16 v[72:75], a[128:131], a[72:75], v[72:75]
    v_mfma_f32_16x16x32_bf16 v[76:79], a[128:131], a[76:79], v[76:79]
    s_waitcnt lgkmcnt(4)
    v_mfma_f32_16x16x32_bf16 v[92:95], a[96:99], a[76:79], v[92:95]
    buffer_load_dwordx4 v252, s[28:31], s49 offen offset:2048 lds
    v_mfma_f32_16x16x32_bf16 v[88:91], a[96:99], a[72:75], v[88:91]
    ds_read_b64_tr_b16 a[108:109], v8 offset:36864
    v_mfma_f32_16x16x32_bf16 v[84:87], a[96:99], a[68:71], v[84:87]
    ds_read_b64_tr_b16 a[110:111], v8 offset:37376
    ds_read_b128 a[80:83], v4 offset:16384
    v_mfma_f32_16x16x32_bf16 v[80:83], a[96:99], a[64:67], v[80:83]
    ds_read_b128 a[84:87], v4 offset:18432
    s_waitcnt lgkmcnt(6)
    v_mfma_f32_16x16x32_bf16 v[96:99], a[64:67], a[100:103], v[96:99]
    buffer_load_dwordx4 v253, s[28:31], s49 offen offset:3072 lds
    v_mfma_f32_16x16x32_bf16 v[100:103], a[68:71], a[100:103], v[100:103]
    ds_read_b64_tr_b16 a[112:113], v9 offset:36864
    v_mfma_f32_16x16x32_bf16 v[104:107], a[72:75], a[100:103], v[104:107]
    ds_read_b64_tr_b16 a[114:115], v9 offset:37376
    ds_read_b128 a[88:91], v4 offset:20480
    v_mfma_f32_16x16x32_bf16 v[108:111], a[76:79], a[100:103], v[108:111]
    ds_read_b128 a[92:95], v4 offset:22528
    s_waitcnt lgkmcnt(8)
    v_mfma_f32_16x16x32_bf16 v[124:127], a[76:79], a[104:107], v[124:127]
    s_add_u32 m0, s48, 77824
    s_cmp_eq_u32 s3, 3
    s_cbranch_scc0 P1_t3
    buffer_load_dword v15, v13, s[68:71], 0 offen
P1_t3:
    v_mfma_f32_16x16x32_bf16 v[120:123], a[72:75], a[104:107], v[120:123]
    buffer_load_dwordx4 v254, s[28:31], s49 offen offset:0 lds
    v_mfma_f32_16x16x32_bf16 v[116:119], a[68:71], a[104:107], v[116:119]
    ds_read_b64_tr_b16 a[116:117], v8 offset:38912
    v_mfma_f32_16x16x32_bf16 v[112:115], a[64:67], a[104:107], v[112:115]
    ds_read_b64_tr_b16 a[118:119], v8 offset:39424
    s_cmp_eq_u32 s11, 0
    s_cbranch_scc0 P1_c10
    v_mfma_f32_16x16x32_bf16 v[128:131], a[120:123], a[152:155], v[128:131]
    v_mfma_f32_16x16x32_bf16 v[132:135], a[124:127], a[152:155], v[132:135]
    v_mfma_f32_16x16x32_bf16 v[136:139], a[128:131], a[152:155], v[136:139]
    v_mfma_f32_16x16x32_bf16 v[140:143], a[96:99], a[152:155], v[140:143]
    v_mfma_f32_16x16x32_bf16 v[144:147], a[152:155], a[100:103], v[144:147]
    v_mfma_f32_16x16x32_bf16 v[148:151], a[152:155], a[104:107], v[148:151]
P1_c10:
    s_waitcnt lgkmcnt(2)
    v_mfma_f32_16x16x32_bf16 v[32:35], a[108:111], a[80:83], v[32:35]
    ds_read_b64_tr_b16 a[120:121], v9 offset:38912
    v_mfma_f32_16x16x32_bf16 v[36:39], a[108:111], a[84:87], v[36:39]
    ds_read_b64_tr_b16 a[122:123], v9 offset:39424
    v_mfma_f32_16x16x32_bf16 v[40:43], a[108:111], a[88:91], v[40:43]
    buffer_load_dwordx4 v255, s[28:31], s49 offen offset:1024 lds
    v_mfma_f32_16x16x32_bf16 v[44:47], a[108:111], a[92:95], v[44:47]
    s_add_u32 s49, s49, 393216
    s_waitcnt lgkmcnt(6)
    v_mfma_f32_16x16x32_bf16 v[60:63], a[112:115], a[92:95], v[60:63]
    ds_read_b64_tr_b16 a[124:125], v8 offset:40960
    v_mfma_f32_16x16x32_bf16 v[56:59], a[112:115], a[88:91], v[56:59]
    ds_read_b64_tr_b16 a[126:127], v8 offset:41472
    v_mfma_f32_16x16x32_bf16 v[52:55], a[112:115], a[84:87], v[52:55]
    s_add_u32 m0, s59, 0
    v_mfma_f32_16x16x32_bf16 v[48:51], a[112:115], a[80:83], v[48:51]
    buffer_load_dwordx4 v248, s[36:39], s50 offen offset:0 lds
    s_waitcnt lgkmcnt(4)
    v_mfma_f32_16x16x32_bf16 v[64:67], a[116:119], a[80:83], v[64:67]
    ds_read_b64_tr_b16 a[128:129], v9 offset:40960
    v_mfma_f32_16x16x32_bf16 v[68:71], a[116:119], a[84:87], v[68:71]
    ds_read_b64_tr_b16 a[130:131], v9 offset:41472
    v_mfma_f32_16x16x32_bf16 v[72:75], a[116:119], a[88:91], v[72:75]
    v_mfma_f32_16x16x32_bf16 v[76:79], a[116:119], a[92:95], v[76:79]
    s_waitcnt vmcnt(11)
    s_barrier
    s_waitcnt lgkmcnt(4)
    v_mfma_f32_16x16x32_bf16 v[92:95], a[120:123], a[92:95], v[92:95]
    buffer_load_dwordx4 v249, s[36:39], s50 offen offset:1024 lds
    v_mfma_f32_16x16x32_bf16 v[88:91], a[120:123], a[88:91], v[88:91]
    ds_read_b64_tr_b16 a[96:97], v10 offset:0
    v_mfma_f32_16x16x32_bf16 v[84:87], a[120:123], a[84:87], v[84:87]
    ds_read_b64_tr_b16 a[98:99], v10 offset:512
    ds_read_b128 a[0:3], v3 offset:32768
    v_mfma_f32_16x16x32_bf16 v[80:83], a[120:123], a[80:83], v[80:83]
    ds_read_b128 a[4:7], v3 offset:34816
    s_waitcnt lgkmcnt(6)
    v_mfma_f32_16x16x32_bf16 v[96:99], a[80:83], a[124:127], v[96:99]
    buffer_load_dwordx4 v250, s[36:39], s50 offen offset:2048 lds
    v_mfma_f32_16x16x32_bf16 v[100:103], a[84:87], a[124:127], v[100:103]
    ds_read_b64_tr_b16 a[100:101], v11 offset:0
    v_mfma_f32_16x16x32_bf16 v[104:107], a[88:91], a[124:127], v[104:107]
    ds_read_b64_tr_b16 a[102:103], v11 offset:512
    ds_read_b128 a[8:11], v3 offset:36864
    v_mfma_f32_16x16x32_bf16 v[108:111], a[92:95], a[124:127], v[108:111]
    ds_read_b128 a[12:15], v3 offset:38912
    s_waitcnt lgkmcnt(8)
    v_mfma_f32_16x16x32_bf16 v[124:127], a[92:95], a[128:131], v[124:127]
    ds_read_b64_tr_b16 a[104:105], v10 offset:2048
    v_mfma_f32_16x16x32_bf16 v[120:123], a[88:91], a[128:131], v[120:123]
    buffer_load_dwordx4 v251, s[36:39], s50 offen offset:3072 lds
    v_mfma_f32_16x16x32_bf16 v[116:119], a[84:87], a[128:131], v[116:119]
    s_add_u32 s50, s50, 128
    v_mfma_f32_16x16x32_bf16 v[112:115], a[80:83], a[128:131], v[112:115]
    ds_read_b64_tr_b16 a[106:107], v10 offset:2560
    s_cmp_eq_u32 s11, 1
    s_cbranch_scc0 P1_c11
    v_mfma_f32_16x16x32_bf16 v[128:131], a[108:111], a[152:155], v[128:131]
    v_mfma_f32_16x16x32_bf16 v[132:135], a[112:115], a[152:155], v[132:135]
    v_mfma_f32_16x16x32_bf16 v[136:139], a[116:119], a[152:155], v[136:139]
    v_mfma_f32_16x16x32_bf16 v[140:143], a[120:123], a[152:155], v[140:143]
    v_mfma_f32_16x16x32_bf16 v[144:147], a[152:155], a[124:127], v[144:147]
    v_mfma_f32_16x16x32_bf16 v[148:151], a[152:155], a[128:131], v[148:151]
P1_c11:
    s_waitcnt lgkmcnt(2)
    v_mfma_f32_16x16x32_bf16 v[32:35], a[96:99], a[0:3], v[32:35]
    ds_read_b64_tr_b16 a[108:109], v11 offset:2048
    v_mfma_f32_16x16x32_bf16 v[36:39], a[96:99], a[4:7], v[36:39]
    s_add_u32 m0, s48, 0
    v_mfma_f32_16x16x32_bf16 v[40:43], a[96:99], a[8:11], v[40:43]
    buffer_load_dwordx4 v252, s[28:31], s49 offen offset:0 lds
    v_mfma_f32_16x16x32_bf16 v[44:47], a[96:99], a[12:15], v[44:47]
    ds_read_b64_tr_b16 a[110:111], v11 offset:2560
    s_waitcnt lgkmcnt(6)
    v_mfma_f32_16x16x32_bf16 v[60:63], a[100:103], a[12:15], v[60:63]
    ds_read_b64_tr_b16 a[112:113], v10 offset:4096
    v_mfma_f32_16x16x32_bf16 v[56:59], a[100:103], a[8:11], v[56:59]
    ds_read_b64_tr_b16 a[114:115], v10 offset:4608
    v_mfma_f32_16x16x32_bf16 v[52:55], a[100:103], a[4:7], v[52:55]
    v_mfma_f32_16x16x32_bf16 v[48:51], a[100:103], a[0:3], v[48:51]
    buffer_load_dwordx4 v253, s[28:31], s49 offen offset:1024 lds
    s_waitcnt lgkmcnt(4)
    v_mfma_f32_16x16x32_bf16 v[64:67], a[104:107], a[0:3], v[64:67]
    ds_read_b64_tr_b16 a[116:117], v11 offset:4096
    v_mfma_f32_16x16x32_bf16 v[68:71], a[104:107], a[4:7], v[68:71]
    ds_read_b64_tr_b16 a[118:119], v11 offset:4608
    v_mfma_f32_16x16x32_bf16 v[72:75], a[104:107], a[8:11], v[72:75]
    v_mfma_f32_16x16x32_bf16 v[76:79], a[104:107], a[12:15], v[76:79]
    s_waitcnt lgkmcnt(4)
    v_mfma_f32_16x16x32_bf16 v[92:95], a[108:111], a[12:15], v[92:95]
    buffer_load_dwordx4 v252, s[28:31], s49 offen offset:2048 lds
    v_mfma_f32_16x16x32_bf16 v[88:91], a[108:111], a[8:11], v[88:91]
    ds_read_b64_tr_b16 a[120:121], v10 offset:12288
    v_mfma_f32_16x16x32_bf16 v[84:87], a[108:111], a[4:7], v[84:87]
    ds_read_b64_tr_b16 a[122:123], v10 offset:12800
    ds_read_b128 a[16:19], v4 offset:32768
    v_mfma_f32_16x16x32_bf16 v[80:83], a[108:111], a[0:3], v[80:83]
    ds_read_b128 a[20:23], v4 offset:34816
    s_waitcnt lgkmcnt(6)
    v_mfma_f32_16x16x32_bf16 v[96:99], a[0:3], a[112:115], v[96:99]
    buffer_load_dwordx4 v253, s[28:31], s49 offen offset:3072 lds
    v_mfma_f32_16x16x32_bf16 v[100:103], a[4:7], a[112:115], v[100:103]
    ds_read_b64_tr_b16 a[124:125], v11 offset:12288
    v_mfma_f32_16x16x32_bf16 v[104:107], a[8:11], a[112:115], v[104:107]
    ds_read_b64_tr_b16 a[126:127], v11 offset:12800
    ds_read_b128 a[24:27], v4 offset:36864
    v_mfma_f32_16x16x32_bf16 v[108:111], a[12:15], a[112:115], v[108:111]
    ds_read_b128 a[28:31], v4 offset:38912
    s_waitcnt lgkmcnt(8)
    v_mfma_f32_16x16x32_bf16 v[124:127], a[12:15], a[116:119], v[124:127]
    s_add_u32 m0, s48, 4096
    v_mfma_f32_16x16x32_bf16 v[120:123], a[8:11], a[116:119], v[120:123]
    buffer_load_dwordx4 v254, s[28:31], s49 offen offset:0 lds
    v_mfma_f32_16x16x32_bf16 v[116:119], a[4:7], a[116:119], v[116:119]
    ds_read_b64_tr_b16 a[128:129], v10 offset:14336
    v_mfma_f32_16x16x32_bf16 v[112:115], a[0:3], a[116:119], v[112:115]
    ds_read_b64_tr_b16 a[130:131], v10 offset:14848
    s_cmp_eq_u32 s11, 0
    s_cbranch_scc0 P1_c12
    v_mfma_f32_16x16x32_bf16 v[128:131], a[96:99], a[152:155], v[128:131]
    v_mfma_f32_16x16x32_bf16 v[132:135], a[100:103], a[152:155], v[132:135]
    v_mfma_f32_16x16x32_bf16 v[136:139], a[104:107], a[152:155], v[136:139]
    v_mfma_f32_16x16x32_bf16 v[140:143], a[108:111], a[152:155], v[140:143]
    v_mfma_f32_16x16x32_bf16 v[144:147], a[152:155], a[112:115], v[144:147]
    v_mfma_f32_16x16x32_bf16 v[148:151], a[152:155], a[116:119], v[148:151]
P1_c12:
    s_waitcnt lgkmcnt(2)
    v_mfma_f32_16x16x32_bf16 v[32:35], a[120:123], a[16:19], v[32:35]
    ds_read_b64_tr_b16 a[96:97], v11 offset:14336
    v_mfma_f32_16x16x32_bf16 v[36:39], a[120:123], a[20:23], v[36:39]
    ds_read_b64_tr_b16 a[98:99], v11 offset:14848
    v_mfma_f32_16x16x32_bf16 v[40:43], a[120:123], a[24:27], v[40:43]
    buffer_load_dwordx4 v255, s[28:31], s49 offen offset:1024 lds
    v_mfma_f32_16x16x32_bf16 v[44:47], a[120:123], a[28:31], v[44:47]
    s_add_u32 s49, s49, 393216
    s_waitcnt lgkmcnt(6)
    v_mfma_f32_16x16x32_bf16 v[60:63], a[124:127], a[28:31], v[60:63]
    ds_read_b64_tr_b16 a[100:101], v10 offset:16384
    v_mfma_f32_16x16x32_bf16 v[56:59], a[124:127], a[24:27], v[56:59]
    ds_read_b64_tr_b16 a[102:103], v10 offset:16896
    v_mfma_f32_16x16x32_bf16 v[52:55], a[124:127], a[20:23], v[52:55]
    s_add_u32 m0, s59, 16384
    v_mfma_f32_16x16x32_bf16 v[48:51], a[124:127], a[16:19], v[48:51]
    buffer_load_dwordx4 v248, s[36:39], s50 offen offset:0 lds
    s_waitcnt lgkmcnt(4)
    v_mfma_f32_16x16x32_bf16 v[64:67], a[128:131], a[16:19], v[64:67]
    ds_read_b64_tr_b16 a[104:105], v11 offset:16384
    v_mfma_f32_16x16x32_bf16 v[68:71], a[128:131], a[20:23], v[68:71]
    ds_read_b64_tr_b16 a[106:107], v11 offset:16896
    v_mfma_f32_16x16x32_bf16 v[72:75], a[128:131], a[24:27], v[72:75]
    v_mfma_f32_16x16x32_bf16 v[76:79], a[128:131], a[28:31], v[76:79]
    s_waitcnt vmcnt(11)
    s_barrier
    s_waitcnt lgkmcnt(4)
    v_mfma_f32_16x16x32_bf16 v[92:95], a[96:99], a[28:31], v[92:95]
    buffer_load_dwordx4 v249, s[36:39], s50 offen offset:1024 lds
    v_mfma_f32_16x16x32_bf16 v[88:91], a[96:99], a[24:27], v[88:91]
    ds_read_b64_tr_b16 a[108:109], v10 offset:24576
    v_mfma_f32_16x16x32_bf16 v[84:87], a[96:99], a[20:23], v[84:87]
    ds_read_b64_tr_b16 a[110:111], v10 offset:25088
    ds_read_b128 a[32:35], v3 offset:49152
    v_mfma_f32_16x16x32_bf16 v[80:83], a[96:99], a[16:19], v[80:83]
    ds_read_b128 a[36:39], v3 offset:51200
    s_waitcnt lgkmcnt(6)
    v_mfma_f32_16x16x32_bf16 v[96:99], a[16:19], a[100:103], v[96:99]
    buffer_load_dwordx4 v250, s[36:39], s50 offen offset:2048 lds
    v_mfma_f32_16x16x32_bf16 v[100:103], a[20:23], a[100:103], v[100:103]
    ds_read_b64_tr_b16 a[112:113], v11 offset:24576
    v_mfma_f32_16x16x32_bf16 v[104:107], a[24:27], a[100:103], v[104:107]
    ds_read_b64_tr_b16 a[114:115], v11 offset:25088
    ds_read_b128 a[40:43], v3 offset:53248
    v_mfma_f32_16x16x32_bf16 v[108:111], a[28:31], a[100:103], v[108:111]
    ds_read_b128 a[44:47], v3 offset:55296
    s_waitcnt lgkmcnt(8)
    v_mfma_f32_16x16x32_bf16 v[124:127], a[28:31], a[104:107], v[124:127]
    ds_read_b64_tr_b16 a[116:117], v10 offset:26624
    v_mfma_f32_16x16x32_bf16 v[120:123], a[24:27], a[104:107], v[120:123]
    buffer_load_dwordx4 v251, s[36:39], s50 offen offset:3072 lds
    v_mfma_f32_16x16x32_bf16 v[116:119], a[20:23], a[104:107], v[116:119]
    s_add_u32 s50, s50, 128
    v_mfma_f32_16x16x32_bf16 v[112:115], a[16:19], a[104:107], v[112:115]
    ds_read_b64_tr_b16 a[118:119], v10 offset:27136
    s_cmp_eq_u32 s11, 1
    s_cbranch_scc0 P1_c13
    v_mfma_f32_16x16x32_bf16 v[128:131], a[120:123], a[152:155], v[128:131]
    v_mfma_f32_16x16x32_bf16 v[132:135], a[124:127], a[152:155], v[132:135]
    v_mfma_f32_16x16x32_bf16 v[136:139], a[128:131], a[152:155], v[136:139]
    v_mfma_f32_16x16x32_bf16 v[140:143], a[96:99], a[152:155], v[140:143]
    v_mfma_f32_16x16x32_bf16 v[144:147], a[152:155], a[100:103], v[144:147]
    v_mfma_f32_16x16x32_bf16 v[148:151], a[152:155], a[104:107], v[148:151]
P1_c13:
    s_waitcnt lgkmcnt(2)
    v_mfma_f32_16x16x32_bf16 v[32:35], a[108:111], a[32:35], v[32:35]
    ds_read_b64_tr_b16 a[120:121], v11 offset:26624
    v_mfma_f32_16x16x32_bf16 v[36:39], a[108:111], a[36:39], v[36:39]
    s_add_u32 m0, s48, 24576
    v_mfma_f32_16x16x32_bf16 v[40:43], a[108:111], a[40:43], v[40:43]
    buffer_load_dwordx4 v252, s[28:31], s49 offen offset:0 lds
    v_mfma_f32_16x16x32_bf16 v[44:47], a[108:111], a[44:47], v[44:47]
    ds_read_b64_tr_b16 a[122:123], v11 offset:27136
    s_waitcnt lgkmcnt(6)
    v_mfma_f32_16x16x32_bf16 v[60:63], a[112:115], a[44:47], v[60:63]
    ds_read_b64_tr_b16 a[124:125], v10 offset:28672
    v_mfma_f32_16x16x32_bf16 v[56:59], a[112:115], a[40:43], v[56:59]
    ds_read_b64_tr_b16 a[126:127], v10 offset:29184
    v_mfma_f32_16x16x32_bf16 v[52:55], a[112:115], a[36:39], v[52:55]
    v_mfma_f32_16x16x32_bf16 v[48:51], a[112:115], a[32:35], v[48:51]
    buffer_load_dwordx4 v253, s[28:31], s49 offen offset:1024 lds
    s_waitcnt lgkmcnt(4)
    v_mfma_f32_16x16x32_bf16 v[64:67], a[116:119], a[32:35], v[64:67]
    ds_read_b64_tr_b16 a[128:129], v11 offset:28672
    v_mfma_f32_16x16x32_bf16 v[68:71], a[116:119], a[36:39], v[68:71]
    ds_read_b64_tr_b16 a[130:131], v11 offset:29184
    v_mfma_f32_16x16x32_bf16 v[72:75], a[116:119], a[40:43], v[72:75]
    v_mfma_f32_16x16x32_bf16 v[76:79], a[116:119], a[44:47], v[76:79]
    s_waitcnt lgkmcnt(4)
    v_mfma_f32_16x16x32_bf16 v[92:95], a[120:123], a[44:47], v[92:95]
    buffer_load_dwordx4 v252, s[28:31], s49 offen offset:2048 lds
    v_mfma_f32_16x16x32_bf16 v[88:91], a[120:123], a[40:43], v[88:91]
    ds_read_b64_tr_b16 a[96:97], v10 offset:36864
    v_mfma_f32_16x16x32_bf16 v[84:87], a[120:123], a[36:39], v[84:87]
    ds_read_b64_tr_b16 a[98:99], v10 offset:37376
    ds_read_b128 a[48:51], v4 offset:49152
    v_mfma_f32_16x16x32_bf16 v[80:83], a[120:123], a[32:35], v[80:83]
    ds_read_b128 a[52:55], v4 offset:51200
    s_waitcnt lgkmcnt(6)
    v_mfma_f32_16x16x32_bf16 v[96:99], a[32:35], a[124:127], v[96:99]
    buffer_load_dwordx4 v253, s[28:31], s49 offen offset:3072 lds
    v_mfma_f32_16x16x32_bf16 v[100:103], a[36:39], a[124:127], v[100:103]
    ds_read_b64_tr_b16 a[100:101], v11 offset:36864
    v_mfma_f32_16x16x32_bf16 v[104:107], a[40:43], a[124:127], v[104:107]
    ds_read_b64_tr_b16 a[102:103], v11 offset:37376
    ds_read_b128 a[56:59], v4 offset:53248
    v_mfma_f32_16x16x32_bf16 v[108:111], a[44:47], a[124:127], v[108:111]
    ds_read_b128 a[60:63], v4 offset:55296
    s_waitcnt lgkmcnt(8)
    v_mfma_f32_16x16x32_bf16 v[124:127], a[44:47], a[128:131], v[124:127]
    s_add_u32 m0, s48, 28672
    v_mfma_f32_16x16x32_bf16 v[120:123], a[40:43], a[128:131], v[120:123]
    buffer_load_dwordx4 v254, s[28:31], s49 offen offset:0 lds
    v_mfma_f32_16x16x32_bf16 v[116:119], a[36:39], a[128:131], v[116:119]
    ds_read_b64_tr_b16 a[104:105], v10 offset:38912
    v_mfma_f32_16x16x32_bf16 v[112:115], a[32:35], a[128:131], v[112:115]
    ds_read_b64_tr_b16 a[106:107], v10 offset:39424
    s_cmp_eq_u32 s11, 0
    s_cbranch_scc0 P1_c14
    v_mfma_f32_16x16x32_bf16 v[128:131], a[108:111], a[152:155], v[128:131]
    v_mfma_f32_16x16x32_bf16 v[132:135], a[112:115], a[152:155], v[132:135]
    v_mfma_f32_16x16x32_bf16 v[136:139], a[116:119], a[152:155], v[136:139]
    v_mfma_f32_16x16x32_bf16 v[140:143], a[120:123], a[152:155], v[140:143]
    v_mfma_f32_16x16x32_bf16 v[144:147], a[152:155], a[124:127], v[144:147]
    v_mfma_f32_16x16x32_bf16 v[148:151], a[152:155], a[128:131], v[148:151]
P1_c14:
    s_waitcnt lgkmcnt(2)
    v_mfma_f32_16x16x32_bf16 v[32:35], a[96:99], a[48:51], v[32:35]
    ds_read_b64_tr_b16 a[108:109], v11 offset:38912
    v_mfma_f32_16x16x32_bf16 v[36:39], a[96:99], a[52:55], v[36:39]
    ds_read_b64_tr_b16 a[110:111], v11 offset:39424
    v_mfma_f32_16x16x32_bf16 v[40:43], a[96:99], a[56:59], v[40:43]
    buffer_load_dwordx4 v255, s[28:31], s49 offen offset:1024 lds
    v_mfma_f32_16x16x32_bf16 v[44:47], a[96:99], a[60:63], v[44:47]
    s_add_u32 s49, s49, 393216
    s_waitcnt lgkmcnt(6)
    v_mfma_f32_16x16x32_bf16 v[60:63], a[100:103], a[60:63], v[60:63]
    ds_read_b64_tr_b16 a[112:113], v10 offset:40960
    v_mfma_f32_16x16x32_bf16 v[56:59], a[100:103], a[56:59], v[56:59]
    ds_read_b64_tr_b16 a[114:115], v10 offset:41472
    v_mfma_f32_16x16x32_bf16 v[52:55], a[100:103], a[52:55], v[52:55]
    s_add_u32 m0, s59, 32768
    v_mfma_f32_16x16x32_bf16 v[48:51], a[100:103], a[48:51], v[48:51]
    buffer_load_dwordx4 v248, s[36:39], s50 offen offset:0 lds
    s_waitcnt lgkmcnt(4)
    v_mfma_f32_16x16x32_bf16 v[64:67], a[104:107], a[48:51], v[64:67]
    ds_read_b64_tr_b16 a[116:117], v11 offset:40960
    v_mfma_f32_16x16x32_bf16 v[68:71], a[104:107], a[52:55], v[68:71]
    ds_read_b64_tr_b16 a[118:119], v11 offset:41472
    v_mfma_f32_16x16x32_bf16 v[72:75], a[104:107], a[56:59], v[72:75]
    v_mfma_f32_16x16x32_bf16 v[76:79], a[104:107], a[60:63], v[76:79]
    s_waitcnt vmcnt(11)
    s_barrier
    s_waitcnt lgkmcnt(4)
    v_mfma_f32_16x16x32_bf16 v[92:95], a[108:111], a[60:63], v[92:95]
    buffer_load_dwordx4 v249, s[36:39], s50 offen offset:1024 lds
    v_mfma_f32_16x16x32_bf16 v[88:91], a[108:111], a[56:59], v[88:91]
    ds_read_b64_tr_b16 a[120:121], v8 offset:0
    v_mfma_f32_16x16x32_bf16 v[84:87], a[108:111], a[52:55], v[84:87]
    ds_read_b64_tr_b16 a[122:123], v8 offset:512
    ds_read_b128 a[64:67], v3 offset:0
    v_mfma_f32_16x16x32_bf16 v[80:83], a[108:111], a[48:51], v[80:83]
    ds_read_b128 a[68:71], v3 offset:2048
    s_waitcnt lgkmcnt(6)
    v_mfma_f32_16x16x32_bf16 v[96:99], a[48:51], a[112:115], v[96:99]
    buffer_load_dwordx4 v250, s[36:39], s50 offen offset:2048 lds
    v_mfma_f32_16x16x32_bf16 v[100:103], a[52:55], a[112:115], v[100:103]
    ds_read_b64_tr_b16 a[124:125], v9 offset:0
    v_mfma_f32_16x16x32_bf16 v[104:107], a[56:59], a[112:115], v[104:107]
    ds_read_b64_tr_b16 a[126:127], v9 offset:512
    ds_read_b128 a[72:75], v3 offset:4096
    v_mfma_f32_16x16x32_bf16 v[108:111], a[60:63], a[112:115], v[108:111]
    ds_read_b128 a[76:79], v3 offset:6144
    s_waitcnt lgkmcnt(8)
    v_mfma_f32_16x16x32_bf16 v[124:127], a[60:63], a[116:119], v[124:127]
    ds_read_b64_tr_b16 a[128:129], v8 offset:2048
    v_mfma_f32_16x16x32_bf16 v[120:123], a[56:59], a[116:119], v[120:123]
    buffer_load_dwordx4 v251, s[36:39], s50 offen offset:3072 lds
    v_mfma_f32_16x16x32_bf16 v[116:119], a[52:55], a[116:119], v[116:119]
    s_add_u32 s50, s50, 128
    v_mfma_f32_16x16x32_bf16 v[112:115], a[48:51], a[116:119], v[112:115]
    ds_read_b64_tr_b16 a[130:131], v8 offset:2560
    s_cmp_eq_u32 s11, 1
    s_cbranch_scc0 P1_c15
    v_mfma_f32_16x16x32_bf16 v[128:131], a[96:99], a[152:155], v[128:131]
    v_mfma_f32_16x16x32_bf16 v[132:135], a[100:103], a[152:155], v[132:135]
    v_mfma_f32_16x16x32_bf16 v[136:139], a[104:107], a[152:155], v[136:139]
    v_mfma_f32_16x16x32_bf16 v[140:143], a[108:111], a[152:155], v[140:143]
    v_mfma_f32_16x16x32_bf16 v[144:147], a[152:155], a[112:115], v[144:147]
    v_mfma_f32_16x16x32_bf16 v[148:151], a[152:155], a[116:119], v[148:151]
P1_c15:
    s_waitcnt lgkmcnt(2)
    v_mfma_f32_16x16x32_bf16 v[32:35], a[120:123], a[64:67], v[32:35]
    ds_read_b64_tr_b16 a[96:97], v9 offset:2048
    v_mfma_f32_16x16x32_bf16 v[36:39], a[120:123], a[68:71], v[36:39]
    s_add_u32 m0, s48, 49152
    v_mfma_f32_16x16x32_bf16 v[40:43], a[120:123], a[72:75], v[40:43]
    buffer_load_dwordx4 v252, s[28:31], s49 offen offset:0 lds
    v_mfma_f32_16x16x32_bf16 v[44:47], a[120:123], a[76:79], v[44:47]
    ds_read_b64_tr_b16 a[98:99], v9 offset:2560
    s_waitcnt lgkmcnt(6)
    v_mfma_f32_16x16x32_bf16 v[60:63], a[124:127], a[76:79], v[60:63]
    ds_read_b64_tr_b16 a[100:101], v8 offset:4096
    v_mfma_f32_16x16x32_bf16 v[56:59], a[124:127], a[72:75], v[56:59]
    ds_read_b64_tr_b16 a[102:103], v8 offset:4608
    v_mfma_f32_16x16x32_bf16 v[52:55], a[124:127], a[68:71], v[52:55]
    v_mfma_f32_16x16x32_bf16 v[48:51], a[124:127], a[64:67], v[48:51]
    buffer_load_dwordx4 v253, s[28:31], s49 offen offset:1024 lds
    s_waitcnt lgkmcnt(4)
    v_mfma_f32_16x16x32_bf16 v[64:67], a[128:131], a[64:67], v[64:67]
    ds_read_b64_tr_b16 a[104:105], v9 offset:4096
    v_mfma_f32_16x16x32_bf16 v[68:71], a[128:131], a[68:71], v[68:71]
    ds_read_b64_tr_b16 a[106:107], v9 offset:4608
    v_mfma_f32_16x16x32_bf16 v[72:75], a[128:131], a[72:75], v[72:75]
    v_mfma_f32_16x16x32_bf16 v[76:79], a[128:131], a[76:79], v[76:79]
    s_waitcnt lgkmcnt(4)
    v_mfma_f32_16x16x32_bf16 v[92:95], a[96:99], a[76:79], v[92:95]
    buffer_load_dwordx4 v252, s[28:31], s49 offen offset:2048 lds
    v_mfma_f32_16x16x32_bf16 v[88:91], a[96:99], a[72:75], v[88:91]
    ds_read_b64_tr_b16 a[108:109], v8 offset:12288
    v_mfma_f32_16x16x32_bf16 v[84:87], a[96:99], a[68:71], v[84:87]
    ds_read_b64_tr_b16 a[110:111], v8 offset:12800
    ds_read_b128 a[80:83], v4 offset:0
    v_mfma_f32_16x16x32_bf16 v[80:83], a[96:99], a[64:67], v[80:83]
    ds_read_b128 a[84:87], v4 offset:2048
    s_waitcnt lgkmcnt(6)
    v_mfma_f32_16x16x32_bf16 v[96:99], a[64:67], a[100:103], v[96:99]
    buffer_load_dwordx4 v253, s[28:31], s49 offen offset:3072 lds
    v_mfma_f32_16x16x32_bf16 v[100:103], a[68:71], a[100:103], v[100:103]
    ds_read_b64_tr_b16 a[112:113], v9 offset:12288
    v_mfma_f32_16x16x32_bf16 v[104:107], a[72:75], a[100:103], v[104:107]
    ds_read_b64_tr_b16 a[114:115], v9 offset:12800
    ds_read_b128 a[88:91], v4 offset:4096
    v_mfma_f32_16x16x32_bf16 v[108:111], a[76:79], a[100:103], v[108:111]
    ds_read_b128 a[92:95], v4 offset:6144
    s_waitcnt lgkmcnt(8)
    v_mfma_f32_16x16x32_bf16 v[124:127], a[76:79], a[104:107], v[124:127]
    s_add_u32 m0, s48, 53248
    v_mfma_f32_16x16x32_bf16 v[120:123], a[72:75], a[104:107], v[120:123]
    buffer_load_dwordx4 v254, s[28:31], s49 offen offset:0 lds
    v_mfma_f32_16x16x32_bf16 v[116:119], a[68:71], a[104:107], v[116:119]
    ds_read_b64_tr_b16 a[116:117], v8 offset:14336
    v_mfma_f32_16x16x32_bf16 v[112:115], a[64:67], a[104:107], v[112:115]
    ds_read_b64_tr_b16 a[118:119], v8 offset:14848
    s_cmp_eq_u32 s11, 0
    s_cbranch_scc0 P1_c16
    v_mfma_f32_16x16x32_bf16 v[128:131], a[120:123], a[152:155], v[128:131]
    v_mfma_f32_16x16x32_bf16 v[132:135], a[124:127], a[152:155], v[132:135]
    v_mfma_f32_16x16x32_bf16 v[136:139], a[128:131], a[152:155], v[136:139]
    v_mfma_f32_16x16x32_bf16 v[140:143], a[96:99], a[152:155], v[140:143]
    v_mfma_f32_16x16x32_bf16 v[144:147], a[152:155], a[100:103], v[144:147]
    v_mfma_f32_16x16x32_bf16 v[148:151], a[152:155], a[104:107], v[148:151]
P1_c16:
    s_waitcnt lgkmcnt(2)
    v_mfma_f32_16x16x32_bf16 v[32:35], a[108:111], a[80:83], v[32:35]
    ds_read_b64_tr_b16 a[120:121], v9 offset:14336
    v_mfma_f32_16x16x32_bf16 v[36:39], a[108:111], a[84:87], v[36:39]
    ds_read_b64_tr_b16 a[122:123], v9 offset:14848
    v_mfma_f32_16x16x32_bf16 v[40:43], a[108:111], a[88:91], v[40:43]
    buffer_load_dwordx4 v255, s[28:31], s49 offen offset:1024 lds
    v_mfma_f32_16x16x32_bf16 v[44:47], a[108:111], a[92:95], v[44:47]
    s_add_u32 s49, s49, 393216
    v_lshlrev_b32 v12, 4, v0
    s_waitcnt lgkmcnt(6)
    v_mfma_f32_16x16x32_bf16 v[60:63], a[112:115], a[92:95], v[60:63]
    ds_read_b64_tr_b16 a[124:125], v8 offset:16384
    v_mfma_f32_16x16x32_bf16 v[56:59], a[112:115], a[88:91], v[56:59]
    ds_read_b64_tr_b16 a[126:127], v8 offset:16896
    v_mfma_f32_16x16x32_bf16 v[52:55], a[112:115], a[84:87], v[52:55]
    s_add_u32 m0, s59, 49152
    buffer_load_dwordx4 v[16:19], v12, s[64:67], 0 offen sc1
    v_mfma_f32_16x16x32_bf16 v[48:51], a[112:115], a[80:83], v[48:51]
    buffer_load_dwordx4 v248, s[36:39], s50 offen offset:0 lds
    s_waitcnt lgkmcnt(4)
    v_mfma_f32_16x16x32_bf16 v[64:67], a[116:119], a[80:83], v[64:67]
    ds_read_b64_tr_b16 a[128:129], v9 offset:16384
    v_mfma_f32_16x16x32_bf16 v[68:71], a[116:119], a[84:87], v[68:71]
    ds_read_b64_tr_b16 a[130:131], v9 offset:16896
    v_mfma_f32_16x16x32_bf16 v[72:75], a[116:119], a[88:91], v[72:75]
    v_mfma_f32_16x16x32_bf16 v[76:79], a[116:119], a[92:95], v[76:79]
    s_waitcnt vmcnt(12)
    s_barrier
    s_waitcnt lgkmcnt(4)
    v_mfma_f32_16x16x32_bf16 v[92:95], a[120:123], a[92:95], v[92:95]
    buffer_load_dwordx4 v249, s[36:39], s50 offen offset:1024 lds
    v_mfma_f32_16x16x32_bf16 v[88:91], a[120:123], a[88:91], v[88:91]
    ds_read_b64_tr_b16 a[96:97], v8 offset:24576
    v_mfma_f32_16x16x32_bf16 v[84:87], a[120:123], a[84:87], v[84:87]
    ds_read_b64_tr_b16 a[98:99], v8 offset:25088
    ds_read_b128 a[0:3], v3 offset:16384
    v_mfma_f32_16x16x32_bf16 v[80:83], a[120:123], a[80:83], v[80:83]
    ds_read_b128 a[4:7], v3 offset:18432
    s_waitcnt lgkmcnt(6)
    v_mfma_f32_16x16x32_bf16 v[96:99], a[80:83], a[124:127], v[96:99]
    buffer_load_dwordx4 v250, s[36:39], s50 offen offset:2048 lds
    v_mfma_f32_16x16x32_bf16 v[100:103], a[84:87], a[124:127], v[100:103]
    ds_read_b64_tr_b16 a[100:101], v9 offset:24576
    v_mfma_f32_16x16x32_bf16 v[104:107], a[88:91], a[124:127], v[104:107]
    ds_read_b64_tr_b16 a[102:103], v9 offset:25088
    ds_read_b128 a[8:11], v3 offset:20480
    v_mfma_f32_16x16x32_bf16 v[108:111], a[92:95], a[124:127], v[108:111]
    ds_read_b128 a[12:15], v3 offset:22528
    s_waitcnt lgkmcnt(8)
    v_mfma_f32_16x16x32_bf16 v[124:127], a[92:95], a[128:131], v[124:127]
    ds_read_b64_tr_b16 a[104:105], v8 offset:26624
    v_mfma_f32_16x16x32_bf16 v[120:123], a[88:91], a[128:131], v[120:123]
    buffer_load_dwordx4 v251, s[36:39], s50 offen offset:3072 lds
    v_mfma_f32_16x16x32_bf16 v[116:119], a[84:87], a[128:131], v[116:119]
    s_add_u32 s50, s50, 128
    v_mfma_f32_16x16x32_bf16 v[112:115], a[80:83], a[128:131], v[112:115]
    ds_read_b64_tr_b16 a[106:107], v8 offset:27136
    s_cmp_eq_u32 s11, 1
    s_cbranch_scc0 P1_c17
    v_mfma_f32_16x16x32_bf16 v[128:131], a[108:111], a[152:155], v[128:131]
    v_mfma_f32_16x16x32_bf16 v[132:135], a[112:115], a[152:155], v[132:135]
    v_mfma_f32_16x16x32_bf16 v[136:139], a[116:119], a[152:155], v[136:139]
    v_mfma_f32_16x16x32_bf16 v[140:143], a[120:123], a[152:155], v[140:143]
    v_mfma_f32_16x16x32_bf16 v[144:147], a[152:155], a[124:127], v[144:147]
    v_mfma_f32_16x16x32_bf16 v[148:151], a[152:155], a[128:131], v[148:151]
P1_c17:
    s_waitcnt lgkmcnt(2)
    v_mfma_f32_16x16x32_bf16 v[32:35], a[96:99], a[0:3], v[32:35]
    ds_read_b64_tr_b16 a[108:109], v9 offset:26624
    v_mfma_f32_16x16x32_bf16 v[36:39], a[96:99], a[4:7], v[36:39]
    s_add_u32 m0, s48, 73728
    v_mfma_f32_16x16x32_bf16 v[40:43], a[96:99], a[8:11], v[40:43]
    buffer_load_dwordx4 v252, s[28:31], s49 offen offset:0 lds
    v_mfma_f32_16x16x32_bf16 v[44:47], a[96:99], a[12:15], v[44:47]
    ds_read_b64_tr_b16 a[110:111], v9 offset:27136
    s_waitcnt lgkmcnt(6)
    v_mfma_f32_16x16x32_bf16 v[60:63], a[100:103], a[12:15], v[60:63]
    ds_read_b64_tr_b16 a[112:113], v8 offset:28672
    v_mfma_f32_16x16x32_bf16 v[56:59], a[100:103], a[8:11], v[56:59]
    ds_read_b64_tr_b16 a[114:115], v8 offset:29184
    v_mfma_f32_16x16x32_bf16 v[52:55], a[100:103], a[4:7], v[52:55]
    v_mfma_f32_16x16x32_bf16 v[48:51], a[100:103], a[0:3], v[48:51]
    buffer_load_dwordx4 v253, s[28:31], s49 offen offset:1024 lds
    s_waitcnt lgkmcnt(4)
    v_mfma_f32_16x16x32_bf16 v[64:67], a[104:107], a[0:3], v[64:67]
    ds_read_b64_tr_b16 a[116:117], v9 offset:28672
    v_mfma_f32_16x16x32_bf16 v[68:71], a[104:107], a[4:7], v[68:71]
    ds_read_b64_tr_b16 a[118:119], v9 offset:29184
    v_mfma_f32_16x16x32_bf16 v[72:75], a[104:107], a[8:11], v[72:75]
    v_mfma_f32_16x16x32_bf16 v[76:79], a[104:107], a[12:15], v[76:79]
    s_waitcnt lgkmcnt(4)
    v_mfma_f32_16x16x32_bf16 v[92:95], a[108:111], a[12:15], v[92:95]
    buffer_load_dwordx4 v252, s[28:31], s49 offen offset:2048 lds
    v_mfma_f32_16x16x32_bf16 v[88:91], a[108:111], a[8:11], v[88:91]
    ds_read_b64_tr_b16 a[120:121], v8 offset:36864
    v_mfma_f32_16x16x32_bf16 v[84:87], a[108:111], a[4:7], v[84:87]
    ds_read_b64_tr_b16 a[122:123], v8 offset:37376
    ds_read_b128 a[16:19], v4 offset:16384
    v_mfma_f32_16x16x32_bf16 v[80:83], a[108:111], a[0:3], v[80:83]
    ds_read_b128 a[20:23], v4 offset:18432
    s_waitcnt lgkmcnt(6)
    v_mfma_f32_16x16x32_bf16 v[96:99], a[0:3], a[112:115], v[96:99]
    buffer_load_dwordx4 v253, s[28:31], s49 offen offset:3072 lds
    v_mfma_f32_16x16x32_bf16 v[100:103], a[4:7], a[112:115], v[100:103]
    ds_read_b64_tr_b16 a[124:125], v9 offset:36864
    v_mfma_f32_16x16x32_bf16 v[104:107], a[8:11], a[112:115], v[104:107]
    ds_read_b64_tr_b16 a[126:127], v9 offset:37376
    ds_read_b128 a[24:27], v4 offset:20480
    v_mfma_f32_16x16x32_bf16 v[108:111], a[12:15], a[112:115], v[108:111]
    ds_read_b128 a[28:31], v4 offset:22528
    s_waitcnt lgkmcnt(8)
    v_mfma_f32_16x16x32_bf16 v[124:127], a[12:15], a[116:119], v[124:127]
    s_add_u32 m0, s48, 77824
    v_mfma_f32_16x16x32_bf16 v[120:123], a[8:11], a[116:119], v[120:123]
    buffer_load_dwordx4 v254, s[28:31], s49 offen offset:0 lds
    v_mfma_f32_16x16x32_bf16 v[116:119], a[4:7], a[116:119], v[116:119]
    ds_read_b64_tr_b16 a[128:129], v8 offset:38912
    v_mfma_f32_16x16x32_bf16 v[112:115], a[0:3], a[116:119], v[112:115]
    ds_read_b64_tr_b16 a[130:131], v8 offset:39424
    s_cmp_eq_u32 s11, 0
    s_cbranch_scc0 P1_c18
    v_mfma_f32_16x16x32_bf16 v[128:131], a[96:99], a[152:155], v[128:131]
    v_mfma_f32_16x16x32_bf16 v[132:135], a[100:103], a[152:155], v[132:135]
    v_mfma_f32_16x16x32_bf16 v[136:139], a[104:107], a[152:155], v[136:139]
    v_mfma_f32_16x16x32_bf16 v[140:143], a[108:111], a[152:155], v[140:143]
    v_mfma_f32_16x16x32_bf16 v[144:147], a[152:155], a[112:115], v[144:147]
    v_mfma_f32_16x16x32_bf16 v[148:151], a[152:155], a[116:119], v[148:151]
P1_c18:
    s_waitcnt lgkmcnt(2)
    v_mfma_f32_16x16x32_bf16 v[32:35], a[120:123], a[16:19], v[32:35]
    ds_read_b64_tr_b16 a[96:97], v9 offset:38912
    v_mfma_f32_16x16x32_bf16 v[36:39], a[120:123], a[20:23], v[36:39]
    ds_read_b64_tr_b16 a[98:99], v9 offset:39424
    v_mfma_f32_16x16x32_bf16 v[40:43], a[120:123], a[24:27], v[40:43]
    buffer_load_dwordx4 v255, s[28:31], s49 offen offset:1024 lds
    v_mfma_f32_16x16x32_bf16 v[44:47], a[120:123], a[28:31], v[44:47]
    s_add_u32 s49, s49, 393216
    s_waitcnt lgkmcnt(6)
    v_mfma_f32_16x16x32_bf16 v[60:63], a[124:127], a[28:31], v[60:63]
    ds_read_b64_tr_b16 a[100:101], v8 offset:40960
    v_mfma_f32_16x16x32_bf16 v[56:59], a[124:127], a[24:27], v[56:59]
    ds_read_b64_tr_b16 a[102:103], v8 offset:41472
    v_mfma_f32_16x16x32_bf16 v[52:55], a[124:127], a[20:23], v[52:55]
    s_add_u32 m0, s59, 0
    v_mfma_f32_16x16x32_bf16 v[48:51], a[124:127], a[16:19], v[48:51]
    buffer_load_dwordx4 v248, s[36:39], s50 offen offset:0 lds
    s_waitcnt lgkmcnt(4)
    v_mfma_f32_16x16x32_bf16 v[64:67], a[128:131], a[16:19], v[64:67]
    ds_read_b64_tr_b16 a[104:105], v9 offset:40960
    v_mfma_f32_16x16x32_bf16 v[68:71], a[128:131], a[20:23], v[68:71]
    ds_read_b64_tr_b16 a[106:107], v9 offset:41472
    v_mfma_f32_16x16x32_bf16 v[72:75], a[128:131], a[24:27], v[72:75]
    v_mfma_f32_16x16x32_bf16 v[76:79], a[128:131], a[28:31], v[76:79]
    s_waitcnt vmcnt(12)
    s_barrier
    s_waitcnt lgkmcnt(4)
    v_mfma_f32_16x16x32_bf16 v[92:95], a[96:99], a[28:31], v[92:95]
    buffer_load_dwordx4 v249, s[36:39], s50 offen offset:1024 lds
    v_mfma_f32_16x16x32_bf16 v[88:91], a[96:99], a[24:27], v[88:91]
    ds_read_b64_tr_b16 a[108:109], v10 offset:0
    v_mfma_f32_16x16x32_bf16 v[84:87], a[96:99], a[20:23], v[84:87]
    ds_read_b64_tr_b16 a[110:111], v10 offset:512
    ds_read_b128 a[32:35], v3 offset:32768
    v_mfma_f32_16x16x32_bf16 v[80:83], a[96:99], a[16:19], v[80:83]
    ds_read_b128 a[36:39], v3 offset:34816
    s_waitcnt lgkmcnt(6)
    v_mfma_f32_16x16x32_bf16 v[96:99], a[16:19], a[100:103], v[96:99]
    buffer_load_dwordx4 v250, s[36:39], s50 offen offset:2048 lds
    v_mfma_f32_16x16x32_bf16 v[100:103], a[20:23], a[100:103], v[100:103]
    ds_read_b64_tr_b16 a[112:113], v11 offset:0
    v_mfma_f32_16x16x32_bf16 v[104:107], a[24:27], a[100:103], v[104:107]
    ds_read_b64_tr_b16 a[114:115], v11 offset:512
    ds_read_b128 a[40:43], v3 offset:36864
    v_mfma_f32_16x16x32_bf16 v[108:111], a[28:31], a[100:103], v[108:111]
    ds_read_b128 a[44:47], v3 offset:38912
    s_waitcnt lgkmcnt(8)
    v_mfma_f32_16x16x32_bf16 v[124:127], a[28:31], a[104:107], v[124:127]
    ds_read_b64_tr_b16 a[116:117], v10 offset:2048
    v_mfma_f32_16x16x32_bf16 v[120:123], a[24:27], a[104:107], v[120:123]
    buffer_load_dwordx4 v251, s[36:39], s50 offen offset:3072 lds
    v_mfma_f32_16x16x32_bf16 v[116:119], a[20:23], a[104:107], v[116:119]
    s_add_u32 s50, s50, 128
    v_mfma_f32_16x16x32_bf16 v[112:115], a[16:19], a[104:107], v[112:115]
    ds_read_b64_tr_b16 a[118:119], v10 offset:2560
    s_cmp_eq_u32 s11, 1
    s_cbranch_scc0 P1_c19
    v_mfma_f32_16x16x32_bf16 v[128:131], a[120:123], a[152:155], v[128:131]
    v_mfma_f32_16x16x32_bf16 v[132:135], a[124:127], a[152:155], v[132:135]
    v_mfma_f32_16x16x32_bf16 v[136:139], a[128:131], a[152:155], v[136:139]
    v_mfma_f32_16x16x32_bf16 v[140:143], a[96:99], a[152:155], v[140:143]
    v_mfma_f32_16x16x32_bf16 v[144:147], a[152:155], a[100:103], v[144:147]
    v_mfma_f32_16x16x32_bf16 v[148:151], a[152:155], a[104:107], v[148:151]
P1_c19:
    s_waitcnt lgkmcnt(2)
    v_mfma_f32_16x16x32_bf16 v[32:35], a[108:111], a[32:35], v[32:35]
    ds_read_b64_tr_b16 a[120:121], v11 offset:2048
    v_mfma_f32_16x16x32_bf16 v[36:39], a[108:111], a[36:39], v[36:39]
    s_add_u32 m0, s48, 0
    v_mfma_f32_16x16x32_bf16 v[40:43], a[108:111], a[40:43], v[40:43]
    buffer_load_dwordx4 v252, s[28:31], s49 offen offset:0 lds
    v_mfma_f32_16x16x32_bf16 v[44:47], a[108:111], a[44:47], v[44:47]
    ds_read_b64_tr_b16 a[122:123], v11 offset:2560
    s_waitcnt vmcnt(15)
    v_xor_b32 v16, s10, v16
    v_xor_b32 v17, s10, v17
    v_xor_b32 v18, s10, v18
    v_xor_b32 v19, s10, v19
    v_or3_b32 v16, v16, v17, v18
    v_or_b32 v16, v16, v19
    v_cmp_ne_u32 vcc, 0, v16
    s_cbranch_vccz P1_ok
    s_mov_b32 s52, 0x40000
P1_poll:
    buffer_load_dwordx4 v[16:19], v12, s[64:67], 0 offen sc1
    s_waitcnt vmcnt(0)
    v_xor_b32 v16, s10, v16
    v_xor_b32 v17, s10, v17
    v_xor_b32 v18, s10, v18
    v_xor_b32 v19, s10, v19
    v_or3_b32 v16, v16, v17, v18
    v_or_b32 v16, v16, v19
    v_cmp_ne_u32 vcc, 0, v16
    s_sub_u32 s52, s52, 1
    s_cbranch_scc1 P1_ok
    s_cbranch_vccnz P1_poll
P1_ok:
    s_waitcnt lgkmcnt(6)
    v_mfma_f32_16x16x32_bf16 v[60:63], a[112:115], a[44:47], v[60:63]
    ds_read_b64_tr_b16 a[124:125], v10 offset:4096
    v_mfma_f32_16x16x32_bf16 v[56:59], a[112:115], a[40:43], v[56:59]
    ds_read_b64_tr_b16 a[126:127], v10 offset:4608
    v_mfma_f32_16x16x32_bf16 v[52:55], a[112:115], a[36:39], v[52:55]
    v_mfma_f32_16x16x32_bf16 v[48:51], a[112:115], a[32:35], v[48:51]
    buffer_load_dwordx4 v253, s[28:31], s49 offen offset:1024 lds
    s_waitcnt lgkmcnt(4)
    v_mfma_f32_16x16x32_bf16 v[64:67], a[116:119], a[32:35], v[64:67]
    ds_read_b64_tr_b16 a[128:129], v11 offset:4096
    v_mfma_f32_16x16x32_bf16 v[68:71], a[116:119], a[36:39], v[68:71]
    ds_read_b64_tr_b16 a[130:131], v11 offset:4608
    v_mfma_f32_16x16x32_bf16 v[72:75], a[116:119], a[40:43], v[72:75]
    v_mfma_f32_16x16x32_bf16 v[76:79], a[116:119], a[44:47], v[76:79]
    s_waitcnt lgkmcnt(4)
    v_mfma_f32_16x16x32_bf16 v[92:95], a[120:123], a[44:47], v[92:95]
    buffer_load_dwordx4 v252, s[28:31], s49 offen offset:2048 lds
    v_mfma_f32_16x16x32_bf16 v[88:91], a[120:123], a[40:43], v[88:91]
    ds_read_b64_tr_b16 a[96:97], v10 offset:12288
    v_mfma_f32_16x16x32_bf16 v[84:87], a[120:123], a[36:39], v[84:87]
    ds_read_b64_tr_b16 a[98:99], v10 offset:12800
    ds_read_b128 a[48:51], v4 offset:32768
    v_mfma_f32_16x16x32_bf16 v[80:83], a[120:123], a[32:35], v[80:83]
    ds_read_b128 a[52:55], v4 offset:34816
    s_waitcnt lgkmcnt(6)
    v_mfma_f32_16x16x32_bf16 v[96:99], a[32:35], a[124:127], v[96:99]
    buffer_load_dwordx4 v253, s[28:31], s49 offen offset:3072 lds
    v_mfma_f32_16x16x32_bf16 v[100:103], a[36:39], a[124:127], v[100:103]
    ds_read_b64_tr_b16 a[100:101], v11 offset:12288
    v_mfma_f32_16x16x32_bf16 v[104:107], a[40:43], a[124:127], v[104:107]
    ds_read_b64_tr_b16 a[102:103], v11 offset:12800
    ds_read_b128 a[56:59], v4 offset:36864
    v_mfma_f32_16x16x32_bf16 v[108:111], a[44:47], a[124:127], v[108:111]
    ds_read_b128 a[60:63], v4 offset:38912
    s_waitcnt lgkmcnt(8)
    v_mfma_f32_16x16x32_bf16 v[124:127], a[44:47], a[128:131], v[124:127]
    s_add_u32 m0, s48, 4096
    v_mfma_f32_16x16x32_bf16 v[120:123], a[40:43], a[128:131], v[120:123]
    buffer_load_dwordx4 v254, s[28:31], s49 offen offset:0 lds
    v_mfma_f32_16x16x32_bf16 v[116:119], a[36:39], a[128:131], v[116:119]
    ds_read_b64_tr_b16 a[104:105], v10 offset:14336
    v_mfma_f32_16x16x32_bf16 v[112:115], a[32:35], a[128:131], v[112:115]
    ds_read_b64_tr_b16 a[106:107], v10 offset:14848
    s_cmp_eq_u32 s11, 0
    s_cbranch_scc0 P1_c20
    v_mfma_f32_16x16x32_bf16 v[128:131], a[108:111], a[152:155], v[128:131]
    v_mfma_f32_16x16x32_bf16 v[132:135], a[112:115], a[152:155], v[132:135]
    v_mfma_f32_16x16x32_bf16 v[136:139], a[116:119], a[152:155], v[136:139]
    v_mfma_f32_16x16x32_bf16 v[140:143], a[120:123], a[152:155], v[140:143]
    v_mfma_f32_16x16x32_bf16 v[144:147], a[152:155], a[124:127], v[144:147]
    v_mfma_f32_16x16x32_bf16 v[148:151], a[152:155], a[128:131], v[148:151]
P1_c20:
    s_waitcnt lgkmcnt(2)
    v_mfma_f32_16x16x32_bf16 v[32:35], a[96:99], a[48:51], v[32:35]
    s_lshl_b32 s52, s26, 1
    v_mfma_f32_16x16x32_bf16 v[36:39], a[96:99], a[52:55], v[36:39]
    ds_read_b64_tr_b16 a[108:109], v11 offset:14336
    v_mfma_f32_16x16x32_bf16 v[40:43], a[96:99], a[56:59], v[40:43]
    buffer_load_dwordx4 v255, s[28:31], s49 offen offset:1024 lds
    v_mfma_f32_16x16x32_bf16 v[44:47], a[96:99], a[60:63], v[44:47]
    ds_read_b64_tr_b16 a[110:111], v11 offset:14848
    s_add_u32 s49, s49, 393216
    s_waitcnt lgkmcnt(6)
    v_mfma_f32_16x16x32_bf16 v[60:63], a[100:103], a[60:63], v[60:63]
    ds_read_b64_tr_b16 a[112:113], v10 offset:16384
    v_mfma_f32_16x16x32_bf16 v[56:59], a[100:103], a[56:59], v[56:59]
    ds_read_b64_tr_b16 a[114:115], v10 offset:16896
    v_mfma_f32_16x16x32_bf16 v[52:55], a[100:103], a[52:55], v[52:55]
    s_add_u32 m0, s59, 16384
    s_add_u32 s52, s52, s11
    v_mfma_f32_16x16x32_bf16 v[48:51], a[100:103], a[48:51], v[48:51]
    buffer_load_dwordx4 v248, s[36:39], s50 offen offset:0 lds
    s_waitcnt lgkmcnt(4)
    v_mfma_f32_16x16x32_bf16 v[64:67], a[104:107], a[48:51], v[64:67]
    ds_read_b64_tr_b16 a[116:117], v11 offset:16384
    v_mfma_f32_16x16x32_bf16 v[68:71], a[104:107], a[52:55], v[68:71]
    ds_read_b64_tr_b16 a[118:119], v11 offset:16896
    v_mfma_f32_16x16x32_bf16 v[72:75], a[104:107], a[56:59], v[72:75]
    v_mfma_f32_16x16x32_bf16 v[76:79], a[104:107], a[60:63], v[76:79]
    s_waitcnt vmcnt(11)
    s_barrier
    s_waitcnt lgkmcnt(4)
    v_mfma_f32_16x16x32_bf16 v[92:95], a[108:111], a[60:63], v[92:95]
    buffer_load_dwordx4 v249, s[36:39], s50 offen offset:1024 lds
    s_lshl_b32 s52, s52, 8
    v_mfma_f32_16x16x32_bf16 v[88:91], a[108:111], a[56:59], v[88:91]
    ds_read_b64_tr_b16 a[120:121], v10 offset:24576
    v_mfma_f32_16x16x32_bf16 v[84:87], a[108:111], a[52:55], v[84:87]
    ds_read_b64_tr_b16 a[122:123], v10 offset:25088
    ds_read_b128 a[64:67], v3 offset:49152
    v_mfma_f32_16x16x32_bf16 v[80:83], a[108:111], a[48:51], v[80:83]
    ds_read_b128 a[68:71], v3 offset:51200
    s_waitcnt lgkmcnt(6)
    v_mfma_f32_16x16x32_bf16 v[96:99], a[48:51], a[112:115], v[96:99]
    buffer_load_dwordx4 v250, s[36:39], s50 offen offset:2048 lds
    v_mfma_f32_16x16x32_bf16 v[100:103], a[52:55], a[112:115], v[100:103]
    ds_read_b64_tr_b16 a[124:125], v11 offset:24576
    v_mfma_f32_16x16x32_bf16 v[104:107], a[56:59], a[112:115], v[104:107]
    ds_read_b128 a[72:75], v3 offset:53248
    s_add_u32 s52, s52, 41943040
    v_mfma_f32_16x16x32_bf16 v[108:111], a[60:63], a[112:115], v[108:111]
    ds_read_b64_tr_b16 a[126:127], v11 offset:25088
    ds_read_b128 a[76:79], v3 offset:55296
    s_waitcnt lgkmcnt(8)
    v_mfma_f32_16x16x32_bf16 v[124:127], a[60:63], a[116:119], v[124:127]
    ds_read_b64_tr_b16 a[128:129], v10 offset:26624
    v_mfma_f32_16x16x32_bf16 v[120:123], a[56:59], a[116:119], v[120:123]
    buffer_load_dwordx4 v251, s[36:39], s50 offen offset:3072 lds
    v_mfma_f32_16x16x32_bf16 v[116:119], a[52:55], a[116:119], v[116:119]
    s_add_u32 s50, s50, 128
    v_mfma_f32_16x16x32_bf16 v[112:115], a[48:51], a[116:119], v[112:115]
    ds_read_b64_tr_b16 a[130:131], v10 offset:27136
    s_cmp_eq_u32 s11, 1
    s_cbranch_scc0 P1_c21
    v_mfma_f32_16x16x32_bf16 v[128:131], a[96:99], a[152:155], v[128:131]
    v_mfma_f32_16x16x32_bf16 v[132:135], a[100:103], a[152:155], v[132:135]
    v_mfma_f32_16x16x32_bf16 v[136:139], a[104:107], a[152:155], v[136:139]
    v_mfma_f32_16x16x32_bf16 v[140:143], a[108:111], a[152:155], v[140:143]
    v_mfma_f32_16x16x32_bf16 v[144:147], a[152:155], a[112:115], v[144:147]
    v_mfma_f32_16x16x32_bf16 v[148:151], a[152:155], a[116:119], v[148:151]
P1_c21:
    s_waitcnt lgkmcnt(2)
    v_mfma_f32_16x16x32_bf16 v[32:35], a[120:123], a[64:67], v[32:35]
    s_add_u32 s32, s22, s52
    s_addc_u32 s33, s23, 0
    v_mfma_f32_16x16x32_bf16 v[36:39], a[120:123], a[68:71], v[36:39]
    s_add_u32 m0, s48, 24576
    v_mfma_f32_16x16x32_bf16 v[40:43], a[120:123], a[72:75], v[40:43]
    ds_read_b64_tr_b16 a[96:97], v11 offset:26624
    buffer_load_dwordx4 v252, s[28:31], s49 offen offset:0 lds
    v_mfma_f32_16x16x32_bf16 v[44:47], a[120:123], a[76:79], v[44:47]
    ds_read_b64_tr_b16 a[98:99], v11 offset:27136
    s_waitcnt lgkmcnt(5)
    v_mfma_f32_16x16x32_bf16 v[60:63], a[124:127], a[76:79], v[60:63]
    ds_read_b64_tr_b16 a[100:101], v10 offset:28672
    v_mfma_f32_16x16x32_bf16 v[56:59], a[124:127], a[72:75], v[56:59]
    ds_read_b64_tr_b16 a[102:103], v10 offset:29184
    v_mfma_f32_16x16x32_bf16 v[52:55], a[124:127], a[68:71], v[52:55]
    v_mfma_f32_16x16x32_bf16 v[48:51], a[124:127], a[64:67], v[48:51]
    buffer_load_dwordx4 v253, s[28:31], s49 offen offset:1024 lds
    s_waitcnt lgkmcnt(4)
    v_mfma_f32_16x16x32_bf16 v[64:67], a[128:131], a[64:67], v[64:67]
    ds_read_b64_tr_b16 a[104:105], v11 offset:28672
    v_mfma_f32_16x16x32_bf16 v[68:71], a[128:131], a[68:71], v[68:71]
    ds_read_b64_tr_b16 a[106:107], v11 offset:29184
    v_mfma_f32_16x16x32_bf16 v[72:75], a[128:131], a[72:75], v[72:75]
    v_mfma_f32_16x16x32_bf16 v[76:79], a[128:131], a[76:79], v[76:79]
    s_waitcnt lgkmcnt(4)
    v_mfma_f32_16x16x32_bf16 v[92:95], a[96:99], a[76:79], v[92:95]
    buffer_load_dwordx4 v252, s[28:31], s49 offen offset:2048 lds
    v_mfma_f32_16x16x32_bf16 v[88:91], a[96:99], a[72:75], v[88:91]
    s_mov_b32 s34, 8448
    v_mfma_f32_16x16x32_bf16 v[84:87], a[96:99], a[68:71], v[84:87]
    ds_read_b64_tr_b16 a[108:109], v10 offset:36864
    ds_read_b128 a[80:83], v4 offset:49152
    v_mfma_f32_16x16x32_bf16 v[80:83], a[96:99], a[64:67], v[80:83]
    ds_read_b64_tr_b16 a[110:111], v10 offset:37376
    ds_read_b128 a[84:87], v4 offset:51200
    s_waitcnt lgkmcnt(6)
    v_mfma_f32_16x16x32_bf16 v[96:99], a[64:67], a[100:103], v[96:99]
    buffer_load_dwordx4 v253, s[28:31], s49 offen offset:3072 lds
    v_mfma_f32_16x16x32_bf16 v[100:103], a[68:71], a[100:103], v[100:103]
    ds_read_b64_tr_b16 a[112:113], v11 offset:36864
    v_mfma_f32_16x16x32_bf16 v[104:107], a[72:75], a[100:103], v[104:107]
    ds_read_b64_tr_b16 a[114:115], v11 offset:37376
    ds_read_b128 a[88:91], v4 offset:53248
    v_mfma_f32_16x16x32_bf16 v[108:111], a[76:79], a[100:103], v[108:111]
    ds_read_b128 a[92:95], v4 offset:55296
    s_mov_b32 s35, 0x00020000
    s_waitcnt lgkmcnt(8)
    v_mfma_f32_16x16x32_bf16 v[124:127], a[76:79], a[104:107], v[124:127]
    s_add_u32 m0, s48, 28672
    v_mfma_f32_16x16x32_bf16 v[120:123], a[72:75], a[104:107], v[120:123]
    buffer_load_dwordx4 v254, s[28:31], s49 offen offset:0 lds
    v_mfma_f32_16x16x32_bf16 v[116:119], a[68:71], a[104:107], v[116:119]
    ds_read_b64_tr_b16 a[116:117], v10 offset:38912
    v_mfma_f32_16x16x32_bf16 v[112:115], a[64:67], a[104:107], v[112:115]
    ds_read_b64_tr_b16 a[118:119], v10 offset:39424
    s_cmp_eq_u32 s11, 0
    s_cbranch_scc0 P1_c22
    v_mfma_f32_16x16x32_bf16 v[128:131], a[120:123], a[152:155], v[128:131]
    v_mfma_f32_16x16x32_bf16 v[132:135], a[124:127], a[152:155], v[132:135]
    v_mfma_f32_16x16x32_bf16 v[136:139], a[128:131], a[152:155], v[136:139]
    v_mfma_f32_16x16x32_bf16 v[140:143], a[96:99], a[152:155], v[140:143]
    v_mfma_f32_16x16x32_bf16 v[144:147], a[152:155], a[100:103], v[144:147]
    v_mfma_f32_16x16x32_bf16 v[148:151], a[152:155], a[104:107], v[148:151]
P1_c22:
    s_waitcnt lgkmcnt(2)
    v_mfma_f32_16x16x32_bf16 v[32:35], a[108:111], a[80:83], v[32:35]
    ds_read_b64_tr_b16 a[120:121], v11 offset:38912
    v_mfma_f32_16x16x32_bf16 v[36:39], a[108:111], a[84:87], v[36:39]
    s_mov_b32 s53, 8192
    v_mfma_f32_16x16x32_bf16 v[40:43], a[108:111], a[88:91], v[40:43]
    buffer_load_dwordx4 v255, s[28:31], s49 offen offset:1024 lds
    v_mfma_f32_16x16x32_bf16 v[44:47], a[108:111], a[92:95], v[44:47]
    ds_read_b64_tr_b16 a[122:123], v11 offset:39424
    s_add_u32 s49, s49, 393216
    s_waitcnt lgkmcnt(6)
    v_mfma_f32_16x16x32_bf16 v[60:63], a[112:115], a[92:95], v[60:63]
    ds_read_b64_tr_b16 a[124:125], v10 offset:40960
    v_mfma_f32_16x16x32_bf16 v[56:59], a[112:115], a[88:91], v[56:59]
    ds_read_b64_tr_b16 a[126:127], v10 offset:41472
    v_mfma_f32_16x16x32_bf16 v[52:55], a[112:115], a[84:87], v[52:55]
    s_add_u32 m0, s59, 32768
    v_mfma_f32_16x16x32_bf16 v[48:51], a[112:115], a[80:83], v[48:51]
    buffer_load_dwordx4 v248, s[36:39], s50 offen offset:0 lds
    s_waitcnt lgkmcnt(4)
    v_mfma_f32_16x16x32_bf16 v[64:67], a[116:119], a[80:83], v[64:67]
    v_lshlrev_b32 v12, 2, v1
    v_mfma_f32_16x16x32_bf16 v[68:71], a[116:119], a[84:87], v[68:71]
    ds_read_b64_tr_b16 a[128:129], v11 offset:40960
    v_mfma_f32_16x16x32_bf16 v[72:75], a[116:119], a[88:91], v[72:75]
    ds_read_b64_tr_b16 a[130:131], v11 offset:41472
    v_mfma_f32_16x16x32_bf16 v[76:79], a[116:119], a[92:95], v[76:79]
    s_waitcnt vmcnt(11)
    s_barrier
    s_waitcnt lgkmcnt(4)
    v_mfma_f32_16x16x32_bf16 v[92:95], a[120:123], a[92:95], v[92:95]
    buffer_load_dwordx4 v249, s[36:39], s50 offen offset:1024 lds
    v_mfma_f32_16x16x32_bf16 v[88:91], a[120:123], a[88:91], v[88:91]
    ds_read_b64_tr_b16 a[96:97], v8 offset:0
    v_mfma_f32_16x16x32_bf16 v[84:87], a[120:123], a[84:87], v[84:87]
    ds_read_b128 a[0:3], v3 offset:0
    v_lshlrev_b32 v13, 4, v2
    v_mfma_f32_16x16x32_bf16 v[80:83], a[120:123], a[80:83], v[80:83]
    ds_read_b64_tr_b16 a[98:99], v8 offset:512
    ds_read_b128 a[4:7], v3 offset:2048
    s_waitcnt lgkmcnt(6)
    v_mfma_f32_16x16x32_bf16 v[96:99], a[80:83], a[124:127], v[96:99]
    buffer_load_dwordx4 v250, s[36:39], s50 offen offset:2048 lds
    v_mfma_f32_16x16x32_bf16 v[100:103], a[84:87], a[124:127], v[100:103]
    ds_read_b64_tr_b16 a[100:101], v9 offset:0
    v_mfma_f32_16x16x32_bf16 v[104:107], a[88:91], a[124:127], v[104:107]
    ds_read_b64_tr_b16 a[102:103], v9 offset:512
    ds_read_b128 a[8:11], v3 offset:4096
    v_mfma_f32_16x16x32_bf16 v[108:111], a[92:95], a[124:127], v[108:111]
    ds_read_b128 a[12:15], v3 offset:6144
    s_waitcnt lgkmcnt(8)
    v_mfma_f32_16x16x32_bf16 v[124:127], a[92:95], a[128:131], v[124:127]
    buffer_load_dword v224, v12, s[32:35], 0 offen offset:0 sc1
    v_mfma_f32_16x16x32_bf16 v[120:123], a[88:91], a[128:131], v[120:123]
    buffer_load_dwordx4 v251, s[36:39], s50 offen offset:3072 lds
    v_mfma_f32_16x16x32_bf16 v[116:119], a[84:87], a[128:131], v[116:119]
    ds_read_b64_tr_b16 a[104:105], v8 offset:2048
    s_add_u32 s50, s50, 128
    v_mfma_f32_16x16x32_bf16 v[112:115], a[80:83], a[128:131], v[112:115]
    ds_read_b64_tr_b16 a[106:107], v8 offset:2560
    s_cmp_eq_u32 s11, 1
    s_cbranch_scc0 P1_c23
    v_mfma_f32_16x16x32_bf16 v[128:131], a[108:111], a[152:155], v[128:131]
    v_mfma_f32_16x16x32_bf16 v[132:135], a[112:115], a[152:155], v[132:135]
    v_mfma_f32_16x16x32_bf16 v[136:139], a[116:119], a[152:155], v[136:139]
    v_mfma_f32_16x16x32_bf16 v[140:143], a[120:123], a[152:155], v[140:143]
    v_mfma_f32_16x16x32_bf16 v[144:147], a[152:155], a[124:127], v[144:147]
    v_mfma_f32_16x16x32_bf16 v[148:151], a[152:155], a[128:131], v[148:151]
P1_c23:
    s_waitcnt lgkmcnt(2)
    v_mfma_f32_16x16x32_bf16 v[32:35], a[96:99], a[0:3], v[32:35]
    ds_read_b64_tr_b16 a[108:109], v9 offset:2048
    v_mfma_f32_16x16x32_bf16 v[36:39], a[96:99], a[4:7], v[36:39]
    s_add_u32 m0, s48, 49152
    v_mfma_f32_16x16x32_bf16 v[40:43], a[96:99], a[8:11], v[40:43]
    buffer_load_dwordx4 v252, s[28:31], s49 offen offset:0 lds
    buffer_load_dword v232, v12, s[32:35], s53 offen offset:0 sc1
    v_mfma_f32_16x16x32_bf16 v[44:47], a[96:99], a[12:15], v[44:47]
    ds_read_b64_tr_b16 a[110:111], v9 offset:2560
    s_waitcnt lgkmcnt(6)
    v_mfma_f32_16x16x32_bf16 v[60:63], a[100:103], a[12:15], v[60:63]
    ds_read_b64_tr_b16 a[112:113], v8 offset:4096
    v_mfma_f32_16x16x32_bf16 v[56:59], a[100:103], a[8:11], v[56:59]
    ds_read_b64_tr_b16 a[114:115], v8 offset:4608
    v_mfma_f32_16x16x32_bf16 v[52:55], a[100:103], a[4:7], v[52:55]
    v_mfma_f32_16x16x32_bf16 v[48:51], a[100:103], a[0:3], v[48:51]
    buffer_load_dwordx4 v253, s[28:31], s49 offen offset:1024 lds
    s_waitcnt lgkmcnt(4)
    v_mfma_f32_16x16x32_bf16 v[64:67], a[104:107], a[0:3], v[64:67]
    buffer_load_dwordx4 v[160:163], v13, s[32:35], 0 offen offset:0 sc1
    v_mfma_f32_16x16x32_bf16 v[68:71], a[104:107], a[4:7], v[68:71]
    ds_read_b64_tr_b16 a[116:117], v9 offset:4096
    v_mfma_f32_16x16x32_bf16 v[72:75], a[104:107], a[8:11], v[72:75]
    ds_read_b64_tr_b16 a[118:119], v9 offset:4608
    v_mfma_f32_16x16x32_bf16 v[76:79], a[104:107], a[12:15], v[76:79]
    s_waitcnt lgkmcnt(4)
    v_mfma_f32_16x16x32_bf16 v[92:95], a[108:111], a[12:15], v[92:95]
    buffer_load_dwordx4 v252, s[28:31], s49 offen offset:2048 lds
    v_mfma_f32_16x16x32_bf16 v[88:91], a[108:111], a[8:11], v[88:91]
    ds_read_b64_tr_b16 a[120:121], v8 offset:12288
    v_mfma_f32_16x16x32_bf16 v[84:87], a[108:111], a[4:7], v[84:87]
    ds_read_b64_tr_b16 a[122:123], v8 offset:12800
    ds_read_b128 a[16:19], v4 offset:0
    v_mfma_f32_16x16x32_bf16 v[80:83], a[108:111], a[0:3], v[80:83]
    ds_read_b128 a[20:23], v4 offset:2048
    buffer_load_dwordx4 v[176:179], v13, s[32:35], s53 offen offset:0 sc1
    s_waitcnt lgkmcnt(6)
    v_mfma_f32_16x16x32_bf16 v[96:99], a[0:3], a[112:115], v[96:99]
    buffer_load_dwordx4 v253, s[28:31], s49 offen offset:3072 lds
    v_mfma_f32_16x16x32_bf16 v[100:103], a[4:7], a[112:115], v[100:103]
    ds_read_b64_tr_b16 a[124:125], v9 offset:12288
    v_mfma_f32_16x16x32_bf16 v[104:107], a[8:11], a[112:115], v[104:107]
    ds_read_b64_tr_b16 a[126:127], v9 offset:12800
    ds_read_b128 a[24:27], v4 offset:4096
    v_mfma_f32_16x16x32_bf16 v[108:111], a[12:15], a[112:115], v[108:111]
    ds_read_b128 a[28:31], v4 offset:6144
    s_waitcnt lgkmcnt(8)
    v_mfma_f32_16x16x32_bf16 v[124:127], a[12:15], a[116:119], v[124:127]
    s_add_u32 m0, s48, 53248
    v_mfma_f32_16x16x32_bf16 v[120:123], a[8:11], a[116:119], v[120:123]
    buffer_load_dwordx4 v254, s[28:31], s49 offen offset:0 lds
    buffer_load_dword v226, v12, s[32:35], 0 offen offset:64 sc1
    v_mfma_f32_16x16x32_bf16 v[116:119], a[4:7], a[116:119], v[116:119]
    ds_read_b64_tr_b16 a[128:129], v8 offset:14336
    v_mfma_f32_16x16x32_bf16 v[112:115], a[0:3], a[116:119], v[112:115]
    ds_read_b64_tr_b16 a[130:131], v8 offset:14848
    s_cmp_eq_u32 s11, 0
    s_cbranch_scc0 P1_c24
    v_mfma_f32_16x16x32_bf16 v[128:131], a[96:99], a[152:155], v[128:131]
    v_mfma_f32_16x16x32_bf16 v[132:135], a[100:103], a[152:155], v[132:135]
    v_mfma_f32_16x16x32_bf16 v[136:139], a[104:107], a[152:155], v[136:139]
    v_mfma_f32_16x16x32_bf16 v[140:143], a[108:111], a[152:155], v[140:143]
    v_mfma_f32_16x16x32_bf16 v[144:147], a[152:155], a[112:115], v[144:147]
    v_mfma_f32_16x16x32_bf16 v[148:151], a[152:155], a[116:119], v[148:151]
P1_c24:
    s_waitcnt lgkmcnt(2)
    v_mfma_f32_16x16x32_bf16 v[32:35], a[120:123], a[16:19], v[32:35]
    ds_read_b64_tr_b16 a[96:97], v9 offset:14336
    v_mfma_f32_16x16x32_bf16 v[36:39], a[120:123], a[20:23], v[36:39]
    ds_read_b64_tr_b16 a[98:99], v9 offset:14848
    v_mfma_f32_16x16x32_bf16 v[40:43], a[120:123], a[24:27], v[40:43]
    buffer_load_dwordx4 v255, s[28:31], s49 offen offset:1024 lds
    v_mfma_f32_16x16x32_bf16 v[44:47], a[120:123], a[28:31], v[44:47]
    s_add_u32 s49, s49, 393216
    buffer_load_dword v234, v12, s[32:35], s53 offen offset:64 sc1
    s_waitcnt lgkmcnt(6)
    v_mfma_f32_16x16x32_bf16 v[60:63], a[124:127], a[28:31], v[60:63]
    ds_read_b64_tr_b16 a[100:101], v8 offset:16384
    v_mfma_f32_16x16x32_bf16 v[56:59], a[124:127], a[24:27], v[56:59]
    ds_read_b64_tr_b16 a[102:103], v8 offset:16896
    v_mfma_f32_16x16x32_bf16 v[52:55], a[124:127], a[20:23], v[52:55]
    s_add_u32 m0, s59, 49152
    v_mfma_f32_16x16x32_bf16 v[48:51], a[124:127], a[16:19], v[48:51]
    buffer_load_dwordx4 v248, s[36:39], s50 offen offset:0 lds
    s_waitcnt lgkmcnt(4)
    v_mfma_f32_16x16x32_bf16 v[64:67], a[128:131], a[16:19], v[64:67]
    ds_read_b64_tr_b16 a[104:105], v9 offset:16384
    v_mfma_f32_16x16x32_bf16 v[68:71], a[128:131], a[20:23], v[68:71]
    buffer_load_dwordx4 v[164:167], v13, s[32:35], 0 offen offset:64 sc1
    v_mfma_f32_16x16x32_bf16 v[72:75], a[128:131], a[24:27], v[72:75]
    ds_read_b64_tr_b16 a[106:107], v9 offset:16896
    v_mfma_f32_16x16x32_bf16 v[76:79], a[128:131], a[28:31], v[76:79]
    s_waitcnt vmcnt(18)
    s_barrier
    s_waitcnt lgkmcnt(4)
    v_mfma_f32_16x16x32_bf16 v[92:95], a[96:99], a[28:31], v[92:95]
    buffer_load_dwordx4 v249, s[36:39], s50 offen offset:1024 lds
    v_mfma_f32_16x16x32_bf16 v[88:91], a[96:99], a[24:27], v[88:91]
    ds_read_b64_tr_b16 a[108:109], v8 offset:26624
    v_mfma_f32_16x16x32_bf16 v[84:87], a[96:99], a[20:23], v[84:87]
    ds_read_b64_tr_b16 a[110:111], v8 offset:27136
    ds_read_b128 a[32:35], v3 offset:16384
    v_mfma_f32_16x16x32_bf16 v[80:83], a[96:99], a[16:19], v[80:83]
    ds_read_b128 a[36:39], v3 offset:18432
    s_waitcnt lgkmcnt(6)
    v_mfma_f32_16x16x32_bf16 v[96:99], a[16:19], a[100:103], v[96:99]
    buffer_load_dwordx4 v250, s[36:39], s50 offen offset:2048 lds
    buffer_load_dwordx4 v[180:183], v13, s[32:35], s53 offen offset:64 sc1
    v_mfma_f32_16x16x32_bf16 v[100:103], a[20:23], a[100:103], v[100:103]
    ds_read_b64_tr_b16 a[112:113], v9 offset:26624
    v_mfma_f32_16x16x32_bf16 v[104:107], a[24:27], a[100:103], v[104:107]
    ds_read_b64_tr_b16 a[114:115], v9 offset:27136
    ds_read_b128 a[40:43], v3 offset:20480
    v_mfma_f32_16x16x32_bf16 v[108:111], a[28:31], a[100:103], v[108:111]
    ds_read_b128 a[44:47], v3 offset:22528
    s_waitcnt lgkmcnt(8)
    v_mfma_f32_16x16x32_bf16 v[124:127], a[28:31], a[104:107], v[124:127]
    ds_read_b64_tr_b16 a[116:117], v8 offset:28672
    v_mfma_f32_16x16x32_bf16 v[120:123], a[24:27], a[104:107], v[120:123]
    buffer_load_dwordx4 v251, s[36:39], s50 offen offset:3072 lds
    v_mfma_f32_16x16x32_bf16 v[116:119], a[20:23], a[104:107], v[116:119]
    s_add_u32 s50, s50, 128
    buffer_load_dword v228, v12, s[32:35], 0 offen offset:128 sc1
    v_mfma_f32_16x16x32_bf16 v[112:115], a[16:19], a[104:107], v[112:115]
    ds_read_b64_tr_b16 a[118:119], v8 offset:29184
    s_cmp_eq_u32 s11, 1
    s_cbranch_scc0 P1_c25
    v_mfma_f32_16x16x32_bf16 v[128:131], a[120:123], a[152:155], v[128:131]
    v_mfma_f32_16x16x32_bf16 v[132:135], a[124:127], a[152:155], v[132:135]
    v_mfma_f32_16x16x32_bf16 v[136:139], a[128:131], a[152:155], v[136:139]
    v_mfma_f32_16x16x32_bf16 v[140:143], a[96:99], a[152:155], v[140:143]
    v_mfma_f32_16x16x32_bf16 v[144:147], a[152:155], a[100:103], v[144:147]
    v_mfma_f32_16x16x32_bf16 v[148:151], a[152:155], a[104:107], v[148:151]
P1_c25:
    s_waitcnt lgkmcnt(2)
    v_mfma_f32_16x16x32_bf16 v[64:67], a[108:111], a[32:35], v[64:67]
    ds_read_b64_tr_b16 a[120:121], v9 offset:28672
    v_mfma_f32_16x16x32_bf16 v[68:71], a[108:111], a[36:39], v[68:71]
    s_add_u32 m0, s48, 73728
    v_mfma_f32_16x16x32_bf16 v[72:75], a[108:111], a[40:43], v[72:75]
    buffer_load_dwordx4 v252, s[28:31], s49 offen offset:0 lds
    buffer_load_dword v236, v12, s[32:35], s53 offen offset:128 sc1
    v_mfma_f32_16x16x32_bf16 v[76:79], a[108:111], a[44:47], v[76:79]
    ds_read_b64_tr_b16 a[122:123], v9 offset:29184
    s_waitcnt lgkmcnt(6)
    v_mfma_f32_16x16x32_bf16 v[92:95], a[112:115], a[44:47], v[92:95]
    ds_read_b64_tr_b16 a[124:125], v8 offset:38912
    v_mfma_f32_16x16x32_bf16 v[88:91], a[112:115], a[40:43], v[88:91]
    ds_read_b64_tr_b16 a[126:127], v8 offset:39424
    v_mfma_f32_16x16x32_bf16 v[84:87], a[112:115], a[36:39], v[84:87]
    ds_read_b128 a[48:51], v4 offset:16384
    buffer_load_dwordx4 v[168:171], v13, s[32:35], 0 offen offset:128 sc1
    v_mfma_f32_16x16x32_bf16 v[80:83], a[112:115], a[32:35], v[80:83]
    ds_read_b128 a[52:55], v4 offset:18432
    s_waitcnt lgkmcnt(6)
    v_mfma_f32_16x16x32_bf16 v[96:99], a[32:35], a[116:119], v[96:99]
    buffer_load_dwordx4 v253, s[28:31], s49 offen offset:1024 lds
    v_mfma_f32_16x16x32_bf16 v[100:103], a[36:39], a[116:119], v[100:103]
    ds_read_b64_tr_b16 a[128:129], v9 offset:38912
    v_mfma_f32_16x16x32_bf16 v[104:107], a[40:43], a[116:119], v[104:107]
    ds_read_b128 a[56:59], v4 offset:20480
    buffer_load_dwordx4 v[184:187], v13, s[32:35], s53 offen offset:128 sc1
    v_mfma_f32_16x16x32_bf16 v[108:111], a[44:47], a[116:119], v[108:111]
    ds_read_b64_tr_b16 a[130:131], v9 offset:39424
    ds_read_b128 a[60:63], v4 offset:22528
    s_waitcnt lgkmcnt(8)
    v_mfma_f32_16x16x32_bf16 v[124:127], a[44:47], a[120:123], v[124:127]
    ds_read_b64_tr_b16 a[96:97], v8 offset:40960
    v_mfma_f32_16x16x32_bf16 v[120:123], a[40:43], a[120:123], v[120:123]
    buffer_load_dwordx4 v252, s[28:31], s49 offen offset:2048 lds
    v_mfma_f32_16x16x32_bf16 v[116:119], a[36:39], a[120:123], v[116:119]
    buffer_load_dword v230, v12, s[32:35], 0 offen offset:192 sc1
    v_mfma_f32_16x16x32_bf16 v[112:115], a[32:35], a[120:123], v[112:115]
    ds_read_b64_tr_b16 a[98:99], v8 offset:41472
    s_cmp_eq_u32 s11, 0
    s_cbranch_scc0 P1_c26
    v_mfma_f32_16x16x32_bf16 v[136:139], a[108:111], a[152:155], v[136:139]
    v_mfma_f32_16x16x32_bf16 v[140:143], a[112:115], a[152:155], v[140:143]
    v_mfma_f32_16x16x32_bf16 v[144:147], a[152:155], a[116:119], v[144:147]
    v_mfma_f32_16x16x32_bf16 v[148:151], a[152:155], a[120:123], v[148:151]
P1_c26:
    s_waitcnt lgkmcnt(2)
    v_mfma_f32_16x16x32_bf16 v[64:67], a[124:127], a[48:51], v[64:67]
    ds_read_b64_tr_b16 a[100:101], v9 offset:40960
    v_mfma_f32_16x16x32_bf16 v[68:71], a[124:127], a[52:55], v[68:71]
    ds_read_b64_tr_b16 a[102:103], v9 offset:41472
    v_mfma_f32_16x16x32_bf16 v[72:75], a[124:127], a[56:59], v[72:75]
    buffer_load_dwordx4 v253, s[28:31], s49 offen offset:3072 lds
    v_mfma_f32_16x16x32_bf16 v[76:79], a[124:127], a[60:63], v[76:79]
    buffer_load_dword v238, v12, s[32:35], s53 offen offset:192 sc1
    s_waitcnt vmcnt(17)
    s_barrier
    s_waitcnt lgkmcnt(5)
    v_mfma_f32_16x16x32_bf16 v[92:95], a[128:131], a[60:63], v[92:95]
    ds_read_b64_tr_b16 a[104:105], v10 offset:2048
    v_mfma_f32_16x16x32_bf16 v[88:91], a[128:131], a[56:59], v[88:91]
    ds_read_b64_tr_b16 a[106:107], v10 offset:2560
    v_mfma_f32_16x16x32_bf16 v[84:87], a[128:131], a[52:55], v[84:87]
    ds_read_b128 a[64:67], v3 offset:32768
    v_mfma_f32_16x16x32_bf16 v[80:83], a[128:131], a[48:51], v[80:83]
    ds_read_b128 a[68:71], v3 offset:34816
    s_add_u32 m0, s48, 77824
    buffer_load_dwordx4 v[172:175], v13, s[32:35], 0 offen offset:192 sc1
    s_waitcnt lgkmcnt(6)
    v_mfma_f32_16x16x32_bf16 v[96:99], a[48:51], a[96:99], v[96:99]
    buffer_load_dwordx4 v254, s[28:31], s49 offen offset:0 lds
    v_mfma_f32_16x16x32_bf16 v[100:103], a[52:55], a[96:99], v[100:103]
    ds_read_b64_tr_b16 a[108:109], v11 offset:2048
    v_mfma_f32_16x16x32_bf16 v[104:107], a[56:59], a[96:99], v[104:107]
    ds_read_b64_tr_b16 a[110:111], v11 offset:2560
    ds_read_b128 a[72:75], v3 offset:36864
    v_mfma_f32_16x16x32_bf16 v[108:111], a[60:63], a[96:99], v[108:111]
    ds_read_b128 a[76:79], v3 offset:38912
    buffer_load_dwordx4 v[188:191], v13, s[32:35], s53 offen offset:192 sc1
    s_waitcnt lgkmcnt(8)
    v_mfma_f32_16x16x32_bf16 v[124:127], a[60:63], a[100:103], v[124:127]
    ds_read_b64_tr_b16 a[112:113], v10 offset:4096
    v_mfma_f32_16x16x32_bf16 v[120:123], a[56:59], a[100:103], v[120:123]
    buffer_load_dwordx4 v255, s[28:31], s49 offen offset:1024 lds
    v_mfma_f32_16x16x32_bf16 v[116:119], a[52:55], a[100:103], v[116:119]
    s_add_u32 s49, s49, 393216
    v_mfma_f32_16x16x32_bf16 v[112:115], a[48:51], a[100:103], v[112:115]
    ds_read_b64_tr_b16 a[114:115], v10 offset:4608
    s_cmp_eq_u32 s11, 1
    s_cbranch_scc0 P1_c27
    v_mfma_f32_16x16x32_bf16 v[136:139], a[124:127], a[152:155], v[136:139]
    v_mfma_f32_16x16x32_bf16 v[140:143], a[128:131], a[152:155], v[140:143]
    v_mfma_f32_16x16x32_bf16 v[144:147], a[152:155], a[96:99], v[144:147]
    v_mfma_f32_16x16x32_bf16 v[148:151], a[152:155], a[100:103], v[148:151]
P1_c27:
    s_waitcnt lgkmcnt(2)
    v_mfma_f32_16x16x32_bf16 v[64:67], a[104:107], a[64:67], v[64:67]
    ds_read_b64_tr_b16 a[116:117], v11 offset:4096
    v_mfma_f32_16x16x32_bf16 v[68:71], a[104:107], a[68:71], v[68:71]
    ds_read_b64_tr_b16 a[118:119], v11 offset:4608
    v_mfma_f32_16x16x32_bf16 v[72:75], a[104:107], a[72:75], v[72:75]
    v_mfma_f32_16x16x32_bf16 v[76:79], a[104:107], a[76:79], v[76:79]
    s_waitcnt lgkmcnt(6)
    v_mfma_f32_16x16x32_bf16 v[92:95], a[108:111], a[76:79], v[92:95]
    ds_read_b64_tr_b16 a[120:121], v10 offset:14336
    v_mfma_f32_16x16x32_bf16 v[88:91], a[108:111], a[72:75], v[88:91]
    ds_read_b64_tr_b16 a[122:123], v10 offset:14848
    v_mfma_f32_16x16x32_bf16 v[84:87], a[108:111], a[68:71], v[84:87]
    ds_read_b128 a[80:83], v4 offset:32768
    v_mfma_f32_16x16x32_bf16 v[80:83], a[108:111], a[64:67], v[80:83]
    ds_read_b128 a[84:87], v4 offset:34816
    s_waitcnt lgkmcnt(6)
    v_mfma_f32_16x16x32_bf16 v[96:99], a[64:67], a[112:115], v[96:99]
    ds_read_b64_tr_b16 a[124:125], v11 offset:14336
    v_mfma_f32_16x16x32_bf16 v[100:103], a[68:71], a[112:115], v[100:103]
    ds_read_b64_tr_b16 a[126:127], v11 offset:14848
    v_mfma_f32_16x16x32_bf16 v[104:107], a[72:75], a[112:115], v[104:107]
    ds_read_b128 a[88:91], v4 offset:36864
    v_mfma_f32_16x16x32_bf16 v[108:111], a[76:79], a[112:115], v[108:111]
    ds_read_b128 a[92:95], v4 offset:38912
    s_waitcnt lgkmcnt(8)
    v_mfma_f32_16x16x32_bf16 v[124:127], a[76:79], a[116:119], v[124:127]
    ds_read_b64_tr_b16 a[128:129], v10 offset:16384
    v_mfma_f32_16x16x32_bf16 v[120:123], a[72:75], a[116:119], v[120:123]
    ds_read_b64_tr_b16 a[130:131], v10 offset:16896
    v_mfma_f32_16x16x32_bf16 v[116:119], a[68:71], a[116:119], v[116:119]
    v_mfma_f32_16x16x32_bf16 v[112:115], a[64:67], a[116:119], v[112:115]
    s_cmp_eq_u32 s11, 0
    s_cbranch_scc0 P1_c28
    v_mfma_f32_16x16x32_bf16 v[136:139], a[104:107], a[152:155], v[136:139]
    v_mfma_f32_16x16x32_bf16 v[140:143], a[108:111], a[152:155], v[140:143]
    v_mfma_f32_16x16x32_bf16 v[144:147], a[152:155], a[112:115], v[144:147]
    v_mfma_f32_16x16x32_bf16 v[148:151], a[152:155], a[116:119], v[148:151]
P1_c28:
    s_waitcnt lgkmcnt(2)
    v_mfma_f32_16x16x32_bf16 v[64:67], a[120:123], a[80:83], v[64:67]
    s_lshl_b32 s52, s56, 2
    v_mfma_f32_16x16x32_bf16 v[68:71], a[120:123], a[84:87], v[68:71]
    s_add_u32 s52, s52, s3
    v_mfma_f32_16x16x32_bf16 v[72:75], a[120:123], a[88:91], v[72:75]
    ds_read_b64_tr_b16 a[96:97], v11 offset:16384
    s_lshl_b32 s52, s52, 13
    v_mfma_f32_16x16x32_bf16 v[76:79], a[120:123], a[92:95], v[76:79]
    ds_read_b64_tr_b16 a[98:99], v11 offset:16896
    s_waitcnt vmcnt(0)
    s_barrier
    s_waitcnt lgkmcnt(6)
    v_mfma_f32_16x16x32_bf16 v[92:95], a[124:127], a[92:95], v[92:95]
    s_add_u32 s52, s52, 8388608
    v_mfma_f32_16x16x32_bf16 v[88:91], a[124:127], a[88:91], v[88:91]
    ds_read_b64_tr_b16 a[100:101], v10 offset:26624
    v_mfma_f32_16x16x32_bf16 v[84:87], a[124:127], a[84:87], v[84:87]
    ds_read_b128 a[0:3], v3 offset:49152
    v_lshlrev_b32 v12, 4, v0
    v_mfma_f32_16x16x32_bf16 v[80:83], a[124:127], a[80:83], v[80:83]
    ds_read_b64_tr_b16 a[102:103], v10 offset:27136
    ds_read_b128 a[4:7], v3 offset:51200
    s_lshr_b32 s54, s3, 1
    s_waitcnt lgkmcnt(6)
    v_mfma_f32_16x16x32_bf16 v[96:99], a[80:83], a[128:131], v[96:99]
    s_mul_i32 s54, s54, 49152
    v_mfma_f32_16x16x32_bf16 v[100:103], a[84:87], a[128:131], v[100:103]
    ds_read_b64_tr_b16 a[104:105], v11 offset:26624
    v_mfma_f32_16x16x32_bf16 v[104:107], a[88:91], a[128:131], v[104:107]
    ds_read_b128 a[8:11], v3 offset:53248
    s_lshl_b32 s55, s11, 12
    v_mfma_f32_16x16x32_bf16 v[108:111], a[92:95], a[128:131], v[108:111]
    ds_read_b64_tr_b16 a[106:107], v11 offset:27136
    ds_read_b128 a[12:15], v3 offset:55296
    s_waitcnt lgkmcnt(8)
    v_mfma_f32_16x16x32_bf16 v[124:127], a[92:95], a[96:99], v[124:127]
    s_add_u32 s54, s54, s55
    v_mfma_f32_16x16x32_bf16 v[120:123], a[88:91], a[96:99], v[120:123]
    s_add_u32 s57, s54, 43008
    v_mfma_f32_16x16x32_bf16 v[116:119], a[84:87], a[96:99], v[116:119]
    ds_read_b64_tr_b16 a[108:109], v10 offset:28672
    v_add_u32 v13, s57, v12
    v_mfma_f32_16x16x32_bf16 v[112:115], a[80:83], a[96:99], v[112:115]
    ds_read_b64_tr_b16 a[110:111], v10 offset:29184
    s_cmp_eq_u32 s11, 1
    s_cbranch_scc0 P1_c29
    v_mfma_f32_16x16x32_bf16 v[136:139], a[120:123], a[152:155], v[136:139]
    v_mfma_f32_16x16x32_bf16 v[140:143], a[124:127], a[152:155], v[140:143]
    v_mfma_f32_16x16x32_bf16 v[144:147], a[152:155], a[128:131], v[144:147]
    v_mfma_f32_16x16x32_bf16 v[148:151], a[152:155], a[96:99], v[148:151]
P1_c29:
    s_waitcnt lgkmcnt(2)
    v_mfma_f32_16x16x32_bf16 v[64:67], a[100:103], a[0:3], v[64:67]
    s_mul_i32 s54, s3, 6144
    v_mfma_f32_16x16x32_bf16 v[68:71], a[100:103], a[4:7], v[68:71]
    ds_read_b64_tr_b16 a[112:113], v11 offset:28672
    v_mfma_f32_16x16x32_bf16 v[72:75], a[100:103], a[8:11], v[72:75]
    v_add_u32 v5, s54, v12
    v_mfma_f32_16x16x32_bf16 v[76:79], a[100:103], a[12:15], v[76:79]
    ds_read_b64_tr_b16 a[114:115], v11 offset:29184
    s_xor_b32 s54, s3, 1
    s_waitcnt lgkmcnt(5)
    v_mfma_f32_16x16x32_bf16 v[92:95], a[104:107], a[12:15], v[92:95]
    ds_read_b64_tr_b16 a[116:117], v10 offset:38912
    v_mfma_f32_16x16x32_bf16 v[88:91], a[104:107], a[8:11], v[88:91]
    s_mul_i32 s54, s54, 6144
    v_mfma_f32_16x16x32_bf16 v[84:87], a[104:107], a[4:7], v[84:87]
    ds_read_b128 a[16:19], v4 offset:49152
    v_add_u32 v6, s54, v12
    v_mfma_f32_16x16x32_bf16 v[80:83], a[104:107], a[0:3], v[80:83]
    ds_read_b64_tr_b16 a[118:119], v10 offset:39424
    ds_read_b128 a[20:23], v4 offset:51200
    s_waitcnt lgkmcnt(6)
    v_mfma_f32_16x16x32_bf16 v[96:99], a[0:3], a[108:111], v[96:99]
    s_add_u32 s40, s22, s52
    s_addc_u32 s41, s23, 0
    v_mfma_f32_16x16x32_bf16 v[100:103], a[4:7], a[108:111], v[100:103]
    ds_read_b64_tr_b16 a[120:121], v11 offset:38912
    v_mfma_f32_16x16x32_bf16 v[104:107], a[8:11], a[108:111], v[104:107]
    ds_read_b64_tr_b16 a[122:123], v11 offset:39424
    ds_read_b128 a[24:27], v4 offset:53248
    v_mfma_f32_16x16x32_bf16 v[108:111], a[12:15], a[108:111], v[108:111]
    ds_read_b128 a[28:31], v4 offset:55296
    s_mov_b32 s42, 0
    s_waitcnt lgkmcnt(8)
    v_mfma_f32_16x16x32_bf16 v[124:127], a[12:15], a[112:115], v[124:127]
    s_mov_b32 s43, 0x00020000
    v_mfma_f32_16x16x32_bf16 v[120:123], a[8:11], a[112:115], v[120:123]
    ds_read_b64_tr_b16 a[124:125], v10 offset:40960
    v_mfma_f32_16x16x32_bf16 v[116:119], a[4:7], a[112:115], v[116:119]
    s_mov_b32 s54, 4096
    v_mfma_f32_16x16x32_bf16 v[112:115], a[0:3], a[112:115], v[112:115]
    ds_read_b64_tr_b16 a[126:127], v10 offset:41472
    s_cmp_eq_u32 s11, 0
    s_cbranch_scc0 P1_c30
    v_mfma_f32_16x16x32_bf16 v[136:139], a[100:103], a[152:155], v[136:139]
    v_mfma_f32_16x16x32_bf16 v[140:143], a[104:107], a[152:155], v[140:143]
    v_mfma_f32_16x16x32_bf16 v[144:147], a[152:155], a[108:111], v[144:147]
    v_mfma_f32_16x16x32_bf16 v[148:151], a[152:155], a[112:115], v[148:151]
P1_c30:
    s_waitcnt lgkmcnt(2)
    v_mfma_f32_16x16x32_bf16 v[64:67], a[116:119], a[16:19], v[64:67]
    ds_read_b64_tr_b16 a[128:129], v11 offset:40960
    v_mfma_f32_16x16x32_bf16 v[68:71], a[116:119], a[20:23], v[68:71]
    ds_read_b64_tr_b16 a[130:131], v11 offset:41472
    v_mfma_f32_16x16x32_bf16 v[72:75], a[116:119], a[24:27], v[72:75]
    s_cmp_lg_u32 s26, 15
    s_cselect_b32 s42, 8192, 0
    v_mfma_f32_16x16x32_bf16 v[76:79], a[116:119], a[28:31], v[76:79]
    s_waitcnt lgkmcnt(6)
    v_mfma_f32_16x16x32_bf16 v[92:95], a[120:123], a[28:31], v[92:95]
    v_mfma_f32_16x16x32_bf16 v[88:91], a[120:123], a[24:27], v[88:91]
    v_mfma_f32_16x16x32_bf16 v[84:87], a[120:123], a[20:23], v[84:87]
    v_mfma_f32_16x16x32_bf16 v[80:83], a[120:123], a[16:19], v[80:83]
    s_waitcnt lgkmcnt(2)
    v_mfma_f32_16x16x32_bf16 v[96:99], a[16:19], a[124:127], v[96:99]
    v_mfma_f32_16x16x32_bf16 v[100:103], a[20:23], a[124:127], v[100:103]
    v_mfma_f32_16x16x32_bf16 v[104:107], a[24:27], a[124:127], v[104:107]
    v_mfma_f32_16x16x32_bf16 v[108:111], a[28:31], a[124:127], v[108:111]
    s_waitcnt lgkmcnt(0)
    v_mfma_f32_16x16x32_bf16 v[124:127], a[28:31], a[128:131], v[124:127]
    v_mfma_f32_16x16x32_bf16 v[120:123], a[24:27], a[128:131], v[120:123]
    v_mfma_f32_16x16x32_bf16 v[116:119], a[20:23], a[128:131], v[116:119]
    v_mfma_f32_16x16x32_bf16 v[112:115], a[16:19], a[128:131], v[112:115]
    s_cmp_eq_u32 s11, 1
    s_cbranch_scc0 P1_c31
    v_mfma_f32_16x16x32_bf16 v[136:139], a[116:119], a[152:155], v[136:139]
    v_mfma_f32_16x16x32_bf16 v[140:143], a[120:123], a[152:155], v[140:143]
    v_mfma_f32_16x16x32_bf16 v[144:147], a[152:155], a[124:127], v[144:147]
    v_mfma_f32_16x16x32_bf16 v[148:151], a[152:155], a[128:131], v[148:151]
P1_c31:
    ds_write_b128 v5, v[128:131] offset:0
    ds_write_b128 v5, v[132:135] offset:1024
    s_nop 2
    ds_write_b128 v5, v[136:139] offset:2048
    ds_write_b128 v5, v[140:143] offset:3072
    ds_write_b128 v5, v[144:147] offset:4096
    ds_write_b128 v5, v[148:151] offset:5120
    s_waitcnt lgkmcnt(0)
    s_barrier
    ds_read_b128 v[192:195], v6 offset:0
    ds_read_b128 v[196:199], v6 offset:1024
    ds_read_b128 v[200:203], v6 offset:2048
    ds_read_b128 v[204:207], v6 offset:3072
    ds_read_b128 v[208:211], v6 offset:4096
    ds_read_b128 v[212:215], v6 offset:5120
    s_waitcnt vmcnt(0) lgkmcnt(0)
    v_pk_add_f32 v[136:137], v[136:137], v[200:201]
    v_pk_add_f32 v[138:139], v[138:139], v[202:203]
    v_pk_add_f32 v[140:141], v[140:141], v[204:205]
    v_pk_add_f32 v[142:143], v[142:143], v[206:207]
    v_pk_add_f32 v[144:145], v[144:145], v[208:209]
    v_pk_add_f32 v[146:147], v[146:147], v[210:211]
    v_pk_add_f32 v[148:149], v[148:149], v[212:213]
    v_pk_add_f32 v[150:151], v[150:151], v[214:215]
    v_pk_add_f32 v[128:129], v[128:129], v[192:193]
    v_pk_add_f32 v[130:131], v[130:131], v[194:195]
    v_pk_add_f32 v[132:133], v[132:133], v[196:197]
    v_pk_add_f32 v[134:135], v[134:135], v[198:199]
    v_pk_fma_f32 v[64:65], v[136:137], v[224:225], v[64:65] op_sel_hi:[1,0,1] neg_lo:[0,1,0] neg_hi:[0,1,0]
    v_pk_fma_f32 v[66:67], v[138:139], v[224:225], v[66:67] op_sel_hi:[1,0,1] neg_lo:[0,1,0] neg_hi:[0,1,0]
    v_pk_mul_f32 v[64:65], v[64:65], v[232:233] op_sel_hi:[1,0]
    v_pk_mul_f32 v[66:67], v[66:67], v[232:233] op_sel_hi:[1,0]
    v_pk_fma_f32 v[80:81], v[140:141], v[224:225], v[80:81] op_sel_hi:[1,0,1] neg_lo:[0,1,0] neg_hi:[0,1,0]
    v_pk_fma_f32 v[82:83], v[142:143], v[224:225], v[82:83] op_sel_hi:[1,0,1] neg_lo:[0,1,0] neg_hi:[0,1,0]
    v_pk_mul_f32 v[80:81], v[80:81], v[232:233] op_sel_hi:[1,0]
    v_pk_mul_f32 v[82:83], v[82:83], v[232:233] op_sel_hi:[1,0]
    v_cvt_pk_bf16_f32 v192, v64, v65
    v_cvt_pk_bf16_f32 v193, v66, v67
    v_cvt_pk_bf16_f32 v194, v80, v81
    v_cvt_pk_bf16_f32 v195, v82, v83
    buffer_store_dwordx4 v[192:195], v12, s[40:43], 0 offen offset:0 sc1
    v_pk_fma_f32 v[68:69], v[136:137], v[226:227], v[68:69] op_sel_hi:[1,0,1] neg_lo:[0,1,0] neg_hi:[0,1,0]
    v_pk_fma_f32 v[70:71], v[138:139], v[226:227], v[70:71] op_sel_hi:[1,0,1] neg_lo:[0,1,0] neg_hi:[0,1,0]
    v_pk_mul_f32 v[68:69], v[68:69], v[234:235] op_sel_hi:[1,0]
    v_pk_mul_f32 v[70:71], v[70:71], v[234:235] op_sel_hi:[1,0]
    v_pk_fma_f32 v[84:85], v[140:141], v[226:227], v[84:85] op_sel_hi:[1,0,1] neg_lo:[0,1,0] neg_hi:[0,1,0]
    v_pk_fma_f32 v[86:87], v[142:143], v[226:227], v[86:87] op_sel_hi:[1,0,1] neg_lo:[0,1,0] neg_hi:[0,1,0]
    v_pk_mul_f32 v[84:85], v[84:85], v[234:235] op_sel_hi:[1,0]
    v_pk_mul_f32 v[86:87], v[86:87], v[234:235] op_sel_hi:[1,0]
    v_cvt_pk_bf16_f32 v196, v68, v69
    v_cvt_pk_bf16_f32 v197, v70, v71
    v_cvt_pk_bf16_f32 v198, v84, v85
    v_cvt_pk_bf16_f32 v199, v86, v87
    buffer_store_dwordx4 v[196:199], v12, s[40:43], 0 offen offset:1024 sc1
    v_pk_fma_f32 v[72:73], v[136:137], v[228:229], v[72:73] op_sel_hi:[1,0,1] neg_lo:[0,1,0] neg_hi:[0,1,0]
    v_pk_fma_f32 v[74:75], v[138:139], v[228:229], v[74:75] op_sel_hi:[1,0,1] neg_lo:[0,1,0] neg_hi:[0,1,0]
    v_pk_mul_f32 v[72:73], v[72:73], v[236:237] op_sel_hi:[1,0]
    v_pk_mul_f32 v[74:75], v[74:75], v[236:237] op_sel_hi:[1,0]
    v_pk_fma_f32 v[88:89], v[140:141], v[228:229], v[88:89] op_sel_hi:[1,0,1] neg_lo:[0,1,0] neg_hi:[0,1,0]
    v_pk_fma_f32 v[90:91], v[142:143], v[228:229], v[90:91] op_sel_hi:[1,0,1] neg_lo:[0,1,0] neg_hi:[0,1,0]
    v_pk_mul_f32 v[88:89], v[88:89], v[236:237] op_sel_hi:[1,0]
    v_pk_mul_f32 v[90:91], v[90:91], v[236:237] op_sel_hi:[1,0]
    v_cvt_pk_bf16_f32 v200, v72, v73
    v_cvt_pk_bf16_f32 v201, v74, v75
    v_cvt_pk_bf16_f32 v202, v88, v89
    v_cvt_pk_bf16_f32 v203, v90, v91
    buffer_store_dwordx4 v[200:203], v12, s[40:43], 0 offen offset:2048 sc1
    v_pk_fma_f32 v[76:77], v[136:137], v[230:231], v[76:77] op_sel_hi:[1,0,1] neg_lo:[0,1,0] neg_hi:[0,1,0]
    v_pk_fma_f32 v[78:79], v[138:139], v[230:231], v[78:79] op_sel_hi:[1,0,1] neg_lo:[0,1,0] neg_hi:[0,1,0]
    v_pk_mul_f32 v[76:77], v[76:77], v[238:239] op_sel_hi:[1,0]
    v_pk_mul_f32 v[78:79], v[78:79], v[238:239] op_sel_hi:[1,0]
    v_pk_fma_f32 v[92:93], v[140:141], v[230:231], v[92:93] op_sel_hi:[1,0,1] neg_lo:[0,1,0] neg_hi:[0,1,0]
    v_pk_fma_f32 v[94:95], v[142:143], v[230:231], v[94:95] op_sel_hi:[1,0,1] neg_lo:[0,1,0] neg_hi:[0,1,0]
    v_pk_mul_f32 v[92:93], v[92:93], v[238:239] op_sel_hi:[1,0]
    v_pk_mul_f32 v[94:95], v[94:95], v[238:239] op_sel_hi:[1,0]
    v_cvt_pk_bf16_f32 v204, v76, v77
    v_cvt_pk_bf16_f32 v205, v78, v79
    v_cvt_pk_bf16_f32 v206, v92, v93
    v_cvt_pk_bf16_f32 v207, v94, v95
    buffer_store_dwordx4 v[204:207], v12, s[40:43], 0 offen offset:3072 sc1
    v_pk_fma_f32 v[96:97], v[160:161], v[144:145], v[96:97] op_sel_hi:[1,0,1] neg_lo:[0,1,0] neg_hi:[0,1,0]
    v_pk_fma_f32 v[98:99], v[162:163], v[144:145], v[98:99] op_sel_hi:[1,0,1] neg_lo:[0,1,0] neg_hi:[0,1,0]
    v_pk_mul_f32 v[96:97], v[96:97], v[176:177]
    v_pk_mul_f32 v[98:99], v[98:99], v[178:179]
    v_pk_fma_f32 v[100:101], v[164:165], v[144:145], v[100:101] op_sel_hi:[1,0,1] neg_lo:[0,1,0] neg_hi:[0,1,0]
    v_pk_fma_f32 v[102:103], v[166:167], v[144:145], v[102:103] op_sel_hi:[1,0,1] neg_lo:[0,1,0] neg_hi:[0,1,0]
    v_pk_mul_f32 v[100:101], v[100:101], v[180:181]
    v_pk_mul_f32 v[102:103], v[102:103], v[182:183]
    v_cvt_pk_bf16_f32 v208, v96, v97
    v_cvt_pk_bf16_f32 v209, v98, v99
    v_cvt_pk_bf16_f32 v210, v100, v101
    v_cvt_pk_bf16_f32 v211, v102, v103
    buffer_store_dwordx4 v[208:211], v12, s[40:43], s54 offen offset:0 sc1
    v_pk_fma_f32 v[112:113], v[160:161], v[148:149], v[112:113] op_sel_hi:[1,0,1] neg_lo:[0,1,0] neg_hi:[0,1,0]
    v_pk_fma_f32 v[114:115], v[162:163], v[148:149], v[114:115] op_sel_hi:[1,0,1] neg_lo:[0,1,0] neg_hi:[0,1,0]
    v_pk_mul_f32 v[112:113], v[112:113], v[176:177]
    v_pk_mul_f32 v[114:115], v[114:115], v[178:179]
    v_pk_fma_f32 v[116:117], v[164:165], v[148:149], v[116:117] op_sel_hi:[1,0,1] neg_lo:[0,1,0] neg_hi:[0,1,0]
    v_pk_fma_f32 v[118:119], v[166:167], v[148:149], v[118:119] op_sel_hi:[1,0,1] neg_lo:[0,1,0] neg_hi:[0,1,0]
    v_pk_mul_f32 v[116:117], v[116:117], v[180:181]
    v_pk_mul_f32 v[118:119], v[118:119], v[182:183]
    v_cvt_pk_bf16_f32 v212, v112, v113
    v_cvt_pk_bf16_f32 v213, v114, v115
    v_cvt_pk_bf16_f32 v214, v116, v117
    v_cvt_pk_bf16_f32 v215, v118, v119
    buffer_store_dwordx4 v[212:215], v12, s[40:43], s54 offen offset:1024 sc1
    v_pk_fma_f32 v[104:105], v[168:169], v[144:145], v[104:105] op_sel_hi:[1,0,1] neg_lo:[0,1,0] neg_hi:[0,1,0]
    v_pk_fma_f32 v[106:107], v[170:171], v[144:145], v[106:107] op_sel_hi:[1,0,1] neg_lo:[0,1,0] neg_hi:[0,1,0]
    v_pk_mul_f32 v[104:105], v[104:105], v[184:185]
    v_pk_mul_f32 v[106:107], v[106:107], v[186:187]
    v_pk_fma_f32 v[108:109], v[172:173], v[144:145], v[108:109] op_sel_hi:[1,0,1] neg_lo:[0,1,0] neg_hi:[0,1,0]
    v_pk_fma_f32 v[110:111], v[174:175], v[144:145], v[110:111] op_sel_hi:[1,0,1] neg_lo:[0,1,0] neg_hi:[0,1,0]
    v_pk_mul_f32 v[108:109], v[108:109], v[188:189]
    v_pk_mul_f32 v[110:111], v[110:111], v[190:191]
    v_cvt_pk_bf16_f32 v216, v104, v105
    v_cvt_pk_bf16_f32 v217, v106, v107
    v_cvt_pk_bf16_f32 v218, v108, v109
    v_cvt_pk_bf16_f32 v219, v110, v111
    buffer_store_dwordx4 v[216:219], v12, s[40:43], s54 offen offset:2048 sc1
    v_pk_fma_f32 v[120:121], v[168:169], v[148:149], v[120:121] op_sel_hi:[1,0,1] neg_lo:[0,1,0] neg_hi:[0,1,0]
    v_pk_fma_f32 v[122:123], v[170:171], v[148:149], v[122:123] op_sel_hi:[1,0,1] neg_lo:[0,1,0] neg_hi:[0,1,0]
    v_pk_mul_f32 v[120:121], v[120:121], v[184:185]
    v_pk_mul_f32 v[122:123], v[122:123], v[186:187]
    v_pk_fma_f32 v[124:125], v[172:173], v[148:149], v[124:125] op_sel_hi:[1,0,1] neg_lo:[0,1,0] neg_hi:[0,1,0]
    v_pk_fma_f32 v[126:127], v[174:175], v[148:149], v[126:127] op_sel_hi:[1,0,1] neg_lo:[0,1,0] neg_hi:[0,1,0]
    v_pk_mul_f32 v[124:125], v[124:125], v[188:189]
    v_pk_mul_f32 v[126:127], v[126:127], v[190:191]
    v_cvt_pk_bf16_f32 v220, v120, v121
    v_cvt_pk_bf16_f32 v221, v122, v123
    v_cvt_pk_bf16_f32 v222, v124, v125
    v_cvt_pk_bf16_f32 v223, v126, v127
    buffer_store_dwordx4 v[220:223], v12, s[40:43], s54 offen offset:3072 sc1
    ds_read_b64_tr_b16 a[96:97], v8 offset:24576
    ds_read_b64_tr_b16 a[98:99], v8 offset:25088
    ds_read_b64_tr_b16 a[100:101], v9 offset:24576
    ds_read_b64_tr_b16 a[102:103], v9 offset:25088
    ds_read_b64_tr_b16 a[104:105], v8 offset:36864
    ds_read_b64_tr_b16 a[106:107], v8 offset:37376
    s_waitcnt lgkmcnt(4)
    v_mfma_f32_16x16x32_bf16 v[32:35], a[96:99], a[32:35], v[32:35]
    ds_read_b64_tr_b16 a[108:109], v9 offset:36864
    v_mfma_f32_16x16x32_bf16 v[36:39], a[96:99], a[36:39], v[36:39]
    ds_read_b64_tr_b16 a[110:111], v9 offset:37376
    v_mfma_f32_16x16x32_bf16 v[40:43], a[96:99], a[40:43], v[40:43]
    v_mfma_f32_16x16x32_bf16 v[44:47], a[96:99], a[44:47], v[44:47]
    v_mfma_f32_16x16x32_bf16 v[128:131], a[96:99], a[152:155], v[128:131]
    s_waitcnt lgkmcnt(4)
    v_mfma_f32_16x16x32_bf16 v[60:63], a[100:103], a[44:47], v[60:63]
    ds_read_b64_tr_b16 a[112:113], v10 offset:0
    v_mfma_f32_16x16x32_bf16 v[56:59], a[100:103], a[40:43], v[56:59]
    ds_read_b64_tr_b16 a[114:115], v10 offset:512
    v_mfma_f32_16x16x32_bf16 v[52:55], a[100:103], a[36:39], v[52:55]
    v_mfma_f32_16x16x32_bf16 v[48:51], a[100:103], a[32:35], v[48:51]
    v_mfma_f32_16x16x32_bf16 v[132:135], a[100:103], a[152:155], v[132:135]
    s_waitcnt lgkmcnt(4)
    v_mfma_f32_16x16x32_bf16 v[32:35], a[104:107], a[48:51], v[32:35]
    ds_read_b64_tr_b16 a[116:117], v11 offset:0
    v_mfma_f32_16x16x32_bf16 v[36:39], a[104:107], a[52:55], v[36:39]
    ds_read_b64_tr_b16 a[118:119], v11 offset:512
    v_mfma_f32_16x16x32_bf16 v[40:43], a[104:107], a[56:59], v[40:43]
    v_mfma_f32_16x16x32_bf16 v[44:47], a[104:107], a[60:63], v[44:47]
    v_mfma_f32_16x16x32_bf16 v[128:131], a[104:107], a[152:155], v[128:131]
    s_waitcnt lgkmcnt(4)
    v_mfma_f32_16x16x32_bf16 v[60:63], a[108:111], a[60:63], v[60:63]
    ds_read_b64_tr_b16 a[120:121], v10 offset:12288
    v_mfma_f32_16x16x32_bf16 v[56:59], a[108:111], a[56:59], v[56:59]
    ds_read_b64_tr_b16 a[122:123], v10 offset:12800
    v_mfma_f32_16x16x32_bf16 v[52:55], a[108:111], a[52:55], v[52:55]
    v_mfma_f32_16x16x32_bf16 v[48:51], a[108:111], a[48:51], v[48:51]
    v_mfma_f32_16x16x32_bf16 v[132:135], a[108:111], a[152:155], v[132:135]
    s_waitcnt lgkmcnt(4)
    v_mfma_f32_16x16x32_bf16 v[32:35], a[112:115], a[64:67], v[32:35]
    ds_read_b64_tr_b16 a[124:125], v11 offset:12288
    v_mfma_f32_16x16x32_bf16 v[36:39], a[112:115], a[68:71], v[36:39]
    ds_read_b64_tr_b16 a[126:127], v11 offset:12800
    v_mfma_f32_16x16x32_bf16 v[40:43], a[112:115], a[72:75], v[40:43]
    v_mfma_f32_16x16x32_bf16 v[44:47], a[112:115], a[76:79], v[44:47]
    v_mfma_f32_16x16x32_bf16 v[128:131], a[112:115], a[152:155], v[128:131]
    s_waitcnt lgkmcnt(4)
    v_mfma_f32_16x16x32_bf16 v[60:63], a[116:119], a[76:79], v[60:63]
    ds_read_b64_tr_b16 a[128:129], v10 offset:24576
    v_mfma_f32_16x16x32_bf16 v[56:59], a[116:119], a[72:75], v[56:59]
    ds_read_b64_tr_b16 a[130:131], v10 offset:25088
    v_mfma_f32_16x16x32_bf16 v[52:55], a[116:119], a[68:71], v[52:55]
    v_mfma_f32_16x16x32_bf16 v[48:51], a[116:119], a[64:67], v[48:51]
    v_mfma_f32_16x16x32_bf16 v[132:135], a[116:119], a[152:155], v[132:135]
    s_waitcnt lgkmcnt(4)
    v_mfma_f32_16x16x32_bf16 v[32:35], a[120:123], a[80:83], v[32:35]
    ds_read_b64_tr_b16 a[96:97], v11 offset:24576
    v_mfma_f32_16x16x32_bf16 v[36:39], a[120:123], a[84:87], v[36:39]
    ds_read_b64_tr_b16 a[98:99], v11 offset:25088
    v_mfma_f32_16x16x32_bf16 v[40:43], a[120:123], a[88:91], v[40:43]
    v_mfma_f32_16x16x32_bf16 v[44:47], a[120:123], a[92:95], v[44:47]
    v_mfma_f32_16x16x32_bf16 v[128:131], a[120:123], a[152:155], v[128:131]
    s_waitcnt lgkmcnt(4)
    v_mfma_f32_16x16x32_bf16 v[60:63], a[124:127], a[92:95], v[60:63]
    ds_read_b64_tr_b16 a[100:101], v10 offset:36864
    v_mfma_f32_16x16x32_bf16 v[56:59], a[124:127], a[88:91], v[56:59]
    ds_read_b64_tr_b16 a[102:103], v10 offset:37376
    v_mfma_f32_16x16x32_bf16 v[52:55], a[124:127], a[84:87], v[52:55]
    v_mfma_f32_16x16x32_bf16 v[48:51], a[124:127], a[80:83], v[48:51]
    v_mfma_f32_16x16x32_bf16 v[132:135], a[124:127], a[152:155], v[132:135]
    s_waitcnt lgkmcnt(4)
    v_mfma_f32_16x16x32_bf16 v[32:35], a[128:131], a[0:3], v[32:35]
    ds_read_b64_tr_b16 a[104:105], v11 offset:36864
    v_mfma_f32_16x16x32_bf16 v[36:39], a[128:131], a[4:7], v[36:39]
    ds_read_b64_tr_b16 a[106:107], v11 offset:37376
    v_mfma_f32_16x16x32_bf16 v[40:43], a[128:131], a[8:11], v[40:43]
    v_mfma_f32_16x16x32_bf16 v[44:47], a[128:131], a[12:15], v[44:47]
    v_mfma_f32_16x16x32_bf16 v[128:131], a[128:131], a[152:155], v[128:131]
    s_waitcnt lgkmcnt(4)
    v_mfma_f32_16x16x32_bf16 v[60:63], a[96:99], a[12:15], v[60:63]
    v_mfma_f32_16x16x32_bf16 v[56:59], a[96:99], a[8:11], v[56:59]
    v_mfma_f32_16x16x32_bf16 v[52:55], a[96:99], a[4:7], v[52:55]
    v_mfma_f32_16x16x32_bf16 v[48:51], a[96:99], a[0:3], v[48:51]
    v_mfma_f32_16x16x32_bf16 v[132:135], a[96:99], a[152:155], v[132:135]
    s_waitcnt lgkmcnt(2)
    v_mfma_f32_16x16x32_bf16 v[32:35], a[100:103], a[16:19], v[32:35]
    v_mfma_f32_16x16x32_bf16 v[36:39], a[100:103], a[20:23], v[36:39]
    v_mfma_f32_16x16x32_bf16 v[40:43], a[100:103], a[24:27], v[40:43]
    v_mfma_f32_16x16x32_bf16 v[44:47], a[100:103], a[28:31], v[44:47]
    v_mfma_f32_16x16x32_bf16 v[128:131], a[100:103], a[152:155], v[128:131]
    s_waitcnt lgkmcnt(0)
    v_mfma_f32_16x16x32_bf16 v[60:63], a[104:107], a[28:31], v[60:63]
    v_mfma_f32_16x16x32_bf16 v[56:59], a[104:107], a[24:27], v[56:59]
    v_mfma_f32_16x16x32_bf16 v[52:55], a[104:107], a[20:23], v[52:55]
    v_mfma_f32_16x16x32_bf16 v[48:51], a[104:107], a[16:19], v[48:51]
    v_mfma_f32_16x16x32_bf16 v[132:135], a[104:107], a[152:155], v[132:135]
    s_lshl_b32 s52, s56, 5
    s_add_u32 s52, s52, s3
    s_lshl_b32 s52, s52, 2
    s_add_u32 s63, s52, 8192
    v_mov_b32 v15, s10
    s_waitcnt vmcnt(0)
    buffer_store_dword v15, v14, s[64:67], s63 offen sc1
    s_barrier
    ds_write_b128 v13, v[192:195] offset:16384
    ds_write_b128 v13, v[196:199] offset:17408
    ds_write_b128 v13, v[200:203] offset:18432
    ds_write_b128 v13, v[204:207] offset:19456
    ds_write_b128 v13, v[208:211] offset:40960
    ds_write_b128 v13, v[212:215] offset:41984
    ds_write_b128 v13, v[216:219] offset:43008
    ds_write_b128 v13, v[220:223] offset:44032
    v_mul_f32 v232, 0x3e8293ee, v232
    v_mul_f32 v234, 0x3e8293ee, v234
    v_mul_f32 v236, 0x3e8293ee, v236
    v_mul_f32 v238, 0x3e8293ee, v238
    s_sub_u32 s52, s63, 2048
    s_sub_u32 s53, s63, 4096
    s_cmp_lt_u32 s26, 2
    s_cselect_b32 s53, s52, s53
    v_mov_b32 v241, s53
    v_writelane_b32 v241, s52, 0
    v_pk_fma_f32 v[32:33], v[128:129], v[224:225], v[32:33] op_sel_hi:[1,0,1] neg_lo:[0,1,0] neg_hi:[0,1,0]
    v_pk_fma_f32 v[34:35], v[130:131], v[224:225], v[34:35] op_sel_hi:[1,0,1] neg_lo:[0,1,0] neg_hi:[0,1,0]
    v_pk_mul_f32 v[32:33], v[32:33], v[232:233] op_sel_hi:[1,0]
    v_pk_mul_f32 v[34:35], v[34:35], v[232:233] op_sel_hi:[1,0]
    v_pk_fma_f32 v[48:49], v[132:133], v[224:225], v[48:49] op_sel_hi:[1,0,1] neg_lo:[0,1,0] neg_hi:[0,1,0]
    v_pk_fma_f32 v[50:51], v[134:135], v[224:225], v[50:51] op_sel_hi:[1,0,1] neg_lo:[0,1,0] neg_hi:[0,1,0]
    v_pk_mul_f32 v[48:49], v[48:49], v[232:233] op_sel_hi:[1,0]
    v_pk_mul_f32 v[50:51], v[50:51], v[232:233] op_sel_hi:[1,0]
    v_cvt_pk_bf16_f32 v16, v32, v33
    v_cvt_pk_bf16_f32 v17, v34, v35
    v_cvt_pk_bf16_f32 v18, v48, v49
    v_cvt_pk_bf16_f32 v19, v50, v51
    v_pk_fma_f32 v[36:37], v[128:129], v[226:227], v[36:37] op_sel_hi:[1,0,1] neg_lo:[0,1,0] neg_hi:[0,1,0]
    v_pk_fma_f32 v[38:39], v[130:131], v[226:227], v[38:39] op_sel_hi:[1,0,1] neg_lo:[0,1,0] neg_hi:[0,1,0]
    v_pk_mul_f32 v[36:37], v[36:37], v[234:235] op_sel_hi:[1,0]
    v_pk_mul_f32 v[38:39], v[38:39], v[234:235] op_sel_hi:[1,0]
    v_pk_fma_f32 v[52:53], v[132:133], v[226:227], v[52:53] op_sel_hi:[1,0,1] neg_lo:[0,1,0] neg_hi:[0,1,0]
    v_pk_fma_f32 v[54:55], v[134:135], v[226:227], v[54:55] op_sel_hi:[1,0,1] neg_lo:[0,1,0] neg_hi:[0,1,0]
    v_pk_mul_f32 v[52:53], v[52:53], v[234:235] op_sel_hi:[1,0]
    v_pk_mul_f32 v[54:55], v[54:55], v[234:235] op_sel_hi:[1,0]
    v_cvt_pk_bf16_f32 v20, v36, v37
    v_cvt_pk_bf16_f32 v21, v38, v39
    v_cvt_pk_bf16_f32 v22, v52, v53
    v_cvt_pk_bf16_f32 v23, v54, v55
    v_pk_fma_f32 v[40:41], v[128:129], v[228:229], v[40:41] op_sel_hi:[1,0,1] neg_lo:[0,1,0] neg_hi:[0,1,0]
    v_pk_fma_f32 v[42:43], v[130:131], v[228:229], v[42:43] op_sel_hi:[1,0,1] neg_lo:[0,1,0] neg_hi:[0,1,0]
    v_pk_mul_f32 v[40:41], v[40:41], v[236:237] op_sel_hi:[1,0]
    v_pk_mul_f32 v[42:43], v[42:43], v[236:237] op_sel_hi:[1,0]
    v_pk_fma_f32 v[56:57], v[132:133], v[228:229], v[56:57] op_sel_hi:[1,0,1] neg_lo:[0,1,0] neg_hi:[0,1,0]
    v_pk_fma_f32 v[58:59], v[134:135], v[228:229], v[58:59] op_sel_hi:[1,0,1] neg_lo:[0,1,0] neg_hi:[0,1,0]
    v_pk_mul_f32 v[56:57], v[56:57], v[236:237] op_sel_hi:[1,0]
    v_pk_mul_f32 v[58:59], v[58:59], v[236:237] op_sel_hi:[1,0]
    v_cvt_pk_bf16_f32 v24, v40, v41
    v_cvt_pk_bf16_f32 v25, v42, v43
    v_cvt_pk_bf16_f32 v26, v56, v57
    v_cvt_pk_bf16_f32 v27, v58, v59
    v_pk_fma_f32 v[44:45], v[128:129], v[230:231], v[44:45] op_sel_hi:[1,0,1] neg_lo:[0,1,0] neg_hi:[0,1,0]
    v_pk_fma_f32 v[46:47], v[130:131], v[230:231], v[46:47] op_sel_hi:[1,0,1] neg_lo:[0,1,0] neg_hi:[0,1,0]
    v_pk_mul_f32 v[44:45], v[44:45], v[238:239] op_sel_hi:[1,0]
    v_pk_mul_f32 v[46:47], v[46:47], v[238:239] op_sel_hi:[1,0]
    v_pk_fma_f32 v[60:61], v[132:133], v[230:231], v[60:61] op_sel_hi:[1,0,1] neg_lo:[0,1,0] neg_hi:[0,1,0]
    v_pk_fma_f32 v[62:63], v[134:135], v[230:231], v[62:63] op_sel_hi:[1,0,1] neg_lo:[0,1,0] neg_hi:[0,1,0]
    v_pk_mul_f32 v[60:61], v[60:61], v[238:239] op_sel_hi:[1,0]
    v_pk_mul_f32 v[62:63], v[62:63], v[238:239] op_sel_hi:[1,0]
    v_cvt_pk_bf16_f32 v28, v44, v45
    v_cvt_pk_bf16_f32 v29, v46, v47
    v_cvt_pk_bf16_f32 v30, v60, v61
    v_cvt_pk_bf16_f32 v31, v62, v63
    buffer_load_dword v240, v241, s[64:67], 0 offen sc1
    s_lshl_b32 s52, s27, 7
    s_sub_u32 s53, 2097152, s52
    s_add_u32 s28, s8, s52
    s_addc_u32 s29, s9, 0
    s_mov_b32 s30, s53
    s_mov_b32 s31, 0x00020000
    s_lshl_b32 s48, s3, 10
    s_mov_b32 s49, 0
    v_lshrrev_b32 v243, 3, v0
    v_and_b32 v244, 7, v0
    v_and_b32 v245, 2, v243
    s_and_b32 s52, s3, 1
    s_lshl_b32 s52, s52, 2
    v_or_b32 v245, s52, v245
    v_xor_b32 v244, v244, v245
    s_lshl_b32 s52, s3, 14
    v_lshlrev_b32 v242, 11, v243
    v_lshl_add_u32 v242, v244, 4, v242
    v_add_u32 v242, s52, v242
    s_lshl_b32 s56, s26, 2
    s_add_u32 s56, s56, s3
    s_lshl_b32 s52, s56, 16
    s_lshl_b32 s53, s27, 7
    s_add_u32 s52, s52, s53
    s_sub_u32 s53, 65536, s53
    s_add_u32 s44, s4, s52
    s_addc_u32 s45, s5, 0
    s_mov_b32 s46, s53
    s_mov_b32 s47, 0x00020000
    v_lshrrev_b32 v245, 3, v0
    v_lshrrev_b32 v246, 4, v0
    v_and_b32 v244, 7, v0
    v_xor_b32 v244, v244, v246
    v_lshlrev_b32 v243, 11, v245
    v_lshl_add_u32 v243, v244, 4, v243
    v_xor_b32 v244, 64, v243
    v_add_u32 v244, 15360, v244
    s_lshl_b32 s61, s3, 12
    s_add_u32 s61, s61, 141312
    s_mov_b32 s59, 0
    s_add_u32 s62, s48, 0
    s_lshl_b32 s52, s26, 1
    s_add_u32 s52, s52, s11
    s_lshl_b32 s52, s52, 17
    s_lshl_b32 s53, s27, 1
    s_lshr_b32 s54, s3, 1
    s_add_u32 s53, s53, s54
    s_lshl_b32 s53, s53, 11
    s_add_u32 s52, s52, s53
    s_add_u32 s52, s52, 16777216
    s_add_u32 s40, s22, s52
    s_addc_u32 s41, s23, 0
    s_mov_b32 s42, 67584
    s_mov_b32 s43, 0x00020000
    s_add_u32 s36, s22, 8388608
    s_addc_u32 s37, s23, 0
    s_mov_b32 s38, 8388608
    s_mov_b32 s39, 0x00020000
    v_lshlrev_b32 v4, 4, v0
    s_lshl_b32 s52, s26, 4
    s_add_u32 s52, s52, s27
    s_lshl_b32 s52, s52, 2
    s_add_u32 s52, s52, s3
    s_lshl_b32 s52, s52, 13
    s_sub_u32 s53, s52, 1048576
    s_cselect_b32 s53, 0x7f000000, s53
    v_add_u32 v3, s53, v4
    s_sub_u32 s53, s52, 524288
    s_cselect_b32 s53, 0x7f000000, s53
    v_add_u32 v247, s53, v4
    v_add_u32 v5, s57, v4
    v_mov_b32 v6, 0xf149f2ca
    v_lshlrev_b32 v7, 2, v2
    s_mov_b32 s56, 4096
    v_add_u32 v12, 0, v7
    v_cmp_gt_u32 vcc, v12, v1
    s_nop 1
    v_cndmask_b32 v32, 0, v6, vcc
    v_cndmask_b32_e64 v8, v6, 0, vcc
    v_add_u32 v12, 1, v7
    v_cmp_gt_u32 vcc, v12, v1
    s_nop 1
    v_cndmask_b32 v33, 0, v6, vcc
    v_cndmask_b32_e64 v9, v6, 0, vcc
    v_add_u32 v12, 2, v7
    v_cmp_gt_u32 vcc, v12, v1
    s_nop 1
    v_cndmask_b32 v34, 0, v6, vcc
    v_cndmask_b32_e64 v10, v6, 0, vcc
    v_add_u32 v12, 3, v7
    v_cmp_gt_u32 vcc, v12, v1
    s_nop 1
    v_cndmask_b32 v35, 0, v6, vcc
    v_cndmask_b32_e64 v11, v6, 0, vcc
    v_mov_b32 v12, 0x3f803f80
    v_accvgpr_write_b32 a144, v12
    v_mov_b32 v12, 0x3f803f80
    v_accvgpr_write_b32 a145, v12
    v_mov_b32 v12, 0x3f803f80
    v_accvgpr_write_b32 a146, v12
    v_mov_b32 v12, 0x3f803f80
    v_accvgpr_write_b32 a147, v12
    v_mov_b32 v234, 0
    v_mov_b32 v235, 0
    v_mov_b32 v236, 0
    v_mov_b32 v237, 0
    v_mov_b32 v40, 0
    v_mov_b32 v41, 0
    v_mov_b32 v42, 0
    v_mov_b32 v43, 0
    v_mov_b32 v44, 0
    v_mov_b32 v45, 0
    v_mov_b32 v46, 0
    v_mov_b32 v47, 0
    v_mov_b32 v48, 0
    v_mov_b32 v49, 0
    v_mov_b32 v50, 0
    v_mov_b32 v51, 0
    v_mov_b32 v52, 0
    v_mov_b32 v53, 0
    v_mov_b32 v54, 0
    v_mov_b32 v55, 0
    v_mov_b32 v56, 0
    v_mov_b32 v57, 0
    v_mov_b32 v58, 0
    v_mov_b32 v59, 0
    v_mov_b32 v60, 0
    v_mov_b32 v61, 0
    v_mov_b32 v62, 0
    v_mov_b32 v63, 0
    v_mov_b32 v64, 0
    v_mov_b32 v65, 0
    v_mov_b32 v66, 0
    v_mov_b32 v67, 0
    v_mov_b32 v68, 0
    v_mov_b32 v69, 0
    v_mov_b32 v70, 0
    v_mov_b32 v71, 0
    v_mov_b32 v36, v8
    v_mov_b32 v37, v9
    v_mov_b32 v38, v10
    v_mov_b32 v39, v11
    s_lshl_b32 s52, s2, 2
    s_add_u32 s52, s52, s3
    s_mul_i32 s52, s52, 3584
    s_add_u32 s68, s12, s52
    s_addc_u32 s69, s13, 0
    s_mov_b32 s70, 3584
    s_mov_b32 s71, 0x00020000
    v_lshlrev_b32 v246, 7, v0
    s_mov_b32 s60, s52
    s_cmp_eq_u32 s26, 0
    s_cbranch_scc1 S1_ok
    s_mov_b32 s52, 0x40000
    s_branch S1_chk
S1_poll:
    s_sleep 1
    buffer_load_dword v240, v241, s[64:67], 0 offen sc1
S1_chk:
    s_waitcnt vmcnt(0)
    v_cmp_ne_u32 vcc, s10, v240
    s_sub_u32 s52, s52, 1
    s_cbranch_scc1 S1_ok
    s_cbranch_vccnz S1_poll
S1_ok:
    s_add_u32 m0, s57, 0
    s_nop 0
    buffer_load_dwordx4 v3, s[36:39], 0 offen offset:0 sc1 lds
    buffer_load_dwordx4 v3, s[36:39], 0 offen offset:1024 sc1 lds
    buffer_load_dwordx4 v3, s[36:39], 0 offen offset:2048 sc1 lds
    buffer_load_dwordx4 v3, s[36:39], 0 offen offset:3072 sc1 lds
    s_add_u32 m0, s57, 8192
    s_nop 0
    buffer_load_dwordx4 v247, s[36:39], 0 offen offset:0 sc1 lds
    buffer_load_dwordx4 v247, s[36:39], 0 offen offset:1024 sc1 lds
    buffer_load_dwordx4 v247, s[36:39], 0 offen offset:2048 sc1 lds
    buffer_load_dwordx4 v247, s[36:39], 0 offen offset:3072 sc1 lds
    s_add_u32 m0, s57, 24576
    s_nop 0
    buffer_load_dwordx4 v3, s[36:39], s56 offen offset:0 sc1 lds
    buffer_load_dwordx4 v3, s[36:39], s56 offen offset:1024 sc1 lds
    buffer_load_dwordx4 v3, s[36:39], s56 offen offset:2048 sc1 lds
    buffer_load_dwordx4 v3, s[36:39], s56 offen offset:3072 sc1 lds
    s_add_u32 m0, s57, 32768
    s_nop 0
    buffer_load_dwordx4 v247, s[36:39], s56 offen offset:0 sc1 lds
    buffer_load_dwordx4 v247, s[36:39], s56 offen offset:1024 sc1 lds
    buffer_load_dwordx4 v247, s[36:39], s56 offen offset:2048 sc1 lds
    buffer_load_dwordx4 v247, s[36:39], s56 offen offset:3072 sc1 lds
    s_lshl_b32 s52, s26, 2
    s_add_u32 s52, s52, s3
    s_lshl_b32 s52, s52, 7
    s_add_u32 s52, s52, 41943040
    v_lshlrev_b32 v13, 2, v1
    s_add_u32 s32, s22, s52
    s_addc_u32 s33, s23, 0
    s_mov_b32 s34, 128
    s_mov_b32 s35, 0x00020000
    buffer_load_dword a164, v13, s[32:35], 0 offen sc1
    buffer_load_dword a165, v13, s[32:35], 0 offen offset:64 sc1
    s_lshl_b32 s53, s27, 1
    s_lshr_b32 s54, s3, 1
    s_add_u32 s53, s53, s54
    s_lshl_b32 s52, s53, 7
    s_add_u32 s52, s52, 41959424
    v_lshlrev_b32 v12, 4, v2
    s_add_u32 s32, s22, s52
    s_addc_u32 s33, s23, 0
    s_mov_b32 s34, 128
    s_mov_b32 s35, 0x00020000
    buffer_load_dwordx4 v[248:251], v12, s[32:35], 0 offen sc1
    buffer_load_dwordx4 v[252:255], v12, s[32:35], 0 offen offset:64 sc1
    s_lshl_b32 s53, s53, 13
    s_lshl_b32 s52, s26, 1
    s_add_u32 s52, s52, s11
    s_lshl_b32 s52, s52, 8
    s_add_u32 s52, s52, s53
    s_add_u32 s52, s52, 42098688
    v_lshrrev_b32 v7, 5, v0
    v_lshlrev_b32 v7, 20, v7
    v_lshl_add_u32 v7, v0, 2, v7
    s_mov_b32 s54, 0
    s_add_u32 s32, s22, s52
    s_addc_u32 s33, s23, 0
    s_mov_b32 s34, 256
    s_mov_b32 s35, 0x00020000
    s_cmp_lg_u32 s3, 1
    s_cbranch_scc1 CT_3
    s_getpc_b64 s[0:1]
CTH_4:
    s_add_u32 s0, s0, C_p3-CTH_4
    s_addc_u32 s1, s1, (C_p3-CTH_4)>>32
    s_lshr_b32 s52, s2, 3
    s_mul_i32 s52, s52, ((C_end-C_p3)/4096+1)
    v_min_u32 v14, ((C_end-C_p3)/4096), v0
    v_add_u32 v14, s52, v14
    v_min_u32 v14, ((C_end-C_p3)/128), v14
    v_lshlrev_b32 v14, 7, v14
    v_mov_b32 v15, s1
    v_add_co_u32 v14, vcc, s0, v14
    s_nop 1
    v_addc_co_u32 v15, vcc, 0, v15, vcc
    global_load_dword v241, v[14:15], off
CT_3:
    s_waitcnt vmcnt(12) lgkmcnt(0)
    s_barrier
    s_lshl_b32 s63, s26, 1
    s_add_u32 s63, s63, s11
    s_lshl_b32 s63, s63, 1
    s_mov_b32 s55, 0
    s_mov_b32 s51, 2
    ds_read_b128 a[0:3], v5 offset:0
    ds_read_b128 a[4:7], v5 offset:1024
    ds_read_b128 a[8:11], v5 offset:2048
    ds_read_b128 a[12:15], v5 offset:3072
    ds_read_b128 a[16:19], v5 offset:4096
    ds_read_b128 a[20:23], v5 offset:5120
    ds_read_b128 a[24:27], v5 offset:6144
    ds_read_b128 a[28:31], v5 offset:7168
P2_loop:
    s_cmp_ge_u32 s26, 2
    s_cbranch_scc1 P2_nobias
    s_cmp_lt_u32 s63, 8
    s_cselect_b32 s53, 0xf149f2ca, 0
    v_mov_b32 v40, s53
    v_mov_b32 v41, s53
    v_mov_b32 v42, s53
    v_mov_b32 v43, s53
    s_cmp_lt_u32 s63, 7
    s_cselect_b32 s53, 0xf149f2ca, 0
    v_mov_b32 v44, s53
    v_mov_b32 v45, s53
    v_mov_b32 v46, s53
    v_mov_b32 v47, s53
    s_cmp_lt_u32 s63, 6
    s_cselect_b32 s53, 0xf149f2ca, 0
    v_mov_b32 v48, s53
    v_mov_b32 v49, s53
    v_mov_b32 v50, s53
    v_mov_b32 v51, s53
    s_cmp_lt_u32 s63, 5
    s_cselect_b32 s53, 0xf149f2ca, 0
    v_mov_b32 v52, s53
    v_mov_b32 v53, s53
    v_mov_b32 v54, s53
    v_mov_b32 v55, s53
    s_cmp_lt_u32 s63, 4
    s_cselect_b32 s53, 0xf149f2ca, 0
    v_mov_b32 v56, s53
    v_mov_b32 v57, s53
    v_mov_b32 v58, s53
    v_mov_b32 v59, s53
    s_cmp_lt_u32 s63, 3
    s_cselect_b32 s53, 0xf149f2ca, 0
    v_mov_b32 v60, s53
    v_mov_b32 v61, s53
    v_mov_b32 v62, s53
    v_mov_b32 v63, s53
    s_cmp_lt_u32 s63, 2
    s_cselect_b32 s53, 0xf149f2ca, 0
    v_mov_b32 v64, s53
    v_mov_b32 v65, s53
    v_mov_b32 v66, s53
    v_mov_b32 v67, s53
    s_cmp_lt_u32 s63, 1
    s_cselect_b32 s53, 0xf149f2ca, 0
    v_mov_b32 v68, s53
    v_mov_b32 v69, s53
    v_mov_b32 v70, s53
    v_mov_b32 v71, s53
    v_add_f32 v36, v8, v40
    v_add_f32 v37, v9, v40
    v_add_f32 v38, v10, v40
    v_add_f32 v39, v11, v40
P2_nobias:
    s_waitcnt lgkmcnt(6)
    s_nop 0
    v_mfma_f32_16x16x32_bf16 v[96:99], a[0:3], v[16:19], v[36:39]
    ds_read_b128 a[32:35], v5 offset:8192
    v_mfma_f32_16x16x32_bf16 v[100:103], a[4:7], v[16:19], v[40:43]
    ds_read_b128 a[36:39], v5 offset:9216
    v_mfma_f32_16x16x32_bf16 v[164:167], a[4:7], v[20:23], v[36:39]
    ds_read_b128 a[40:43], v5 offset:10240
    s_waitcnt lgkmcnt(7)
    v_mfma_f32_16x16x32_bf16 v[104:107], a[8:11], v[16:19], v[44:47]
    ds_read_b128 a[44:47], v5 offset:11264
    v_mfma_f32_16x16x32_bf16 v[168:171], a[8:11], v[20:23], v[44:47]
    ds_read_b128 a[48:51], v5 offset:12288
    v_max3_f32 v12, v96, v97, v98
    v_max_f32 v12, v12, v99
    v_mfma_f32_16x16x32_bf16 v[108:111], a[12:15], v[16:19], v[44:47]
    ds_read_b128 a[52:55], v5 offset:13312
    v_max3_f32 v12, v12, v100, v101
    v_max3_f32 v12, v12, v102, v103
    v_mfma_f32_16x16x32_bf16 v[172:175], a[12:15], v[20:23], v[44:47]
    ds_read_b128 a[56:59], v5 offset:14336
    v_max3_f32 v14, v164, v165, v166
    v_max_f32 v14, v14, v167
    s_waitcnt lgkmcnt(9)
    v_mfma_f32_16x16x32_bf16 v[112:115], a[16:19], v[16:19], v[48:51]
    ds_read_b128 a[60:63], v5 offset:15360
    v_max3_f32 v12, v12, v104, v105
    v_max3_f32 v12, v12, v106, v107
    v_mfma_f32_16x16x32_bf16 v[176:179], a[16:19], v[20:23], v[48:51]
    ds_read_b128 a[64:67], v5 offset:16384
    v_max3_f32 v14, v14, v168, v169
    v_max3_f32 v14, v14, v170, v171
    v_mfma_f32_16x16x32_bf16 v[116:119], a[20:23], v[16:19], v[48:51]
    ds_read_b128 a[68:71], v5 offset:17408
    v_max3_f32 v12, v12, v108, v109
    v_max3_f32 v12, v12, v110, v111
    v_mfma_f32_16x16x32_bf16 v[180:183], a[20:23], v[20:23], v[48:51]
    v_max3_f32 v14, v14, v172, v173
    v_max3_f32 v14, v14, v174, v175
    s_waitcnt lgkmcnt(10)
    v_mfma_f32_16x16x32_bf16 v[120:123], a[24:27], v[16:19], v[52:55]
    v_max3_f32 v12, v12, v112, v113
    v_max3_f32 v12, v12, v114, v115
    v_mfma_f32_16x16x32_bf16 v[184:187], a[24:27], v[20:23], v[52:55]
    v_max3_f32 v14, v14, v176, v177
    v_max3_f32 v14, v14, v178, v179
    v_mfma_f32_16x16x32_bf16 v[124:127], a[28:31], v[16:19], v[52:55]
    v_max3_f32 v12, v12, v116, v117
    v_max3_f32 v12, v12, v118, v119
    v_mfma_f32_16x16x32_bf16 v[188:191], a[28:31], v[20:23], v[52:55]
    v_max3_f32 v14, v14, v180, v181
    v_max3_f32 v14, v14, v182, v183
    s_waitcnt lgkmcnt(8)
    v_mfma_f32_16x16x32_bf16 v[128:131], a[32:35], v[16:19], v[56:59]
    v_max3_f32 v12, v12, v120, v121
    v_max3_f32 v12, v12, v122, v123
    v_mfma_f32_16x16x32_bf16 v[192:195], a[32:35], v[20:23], v[56:59]
    v_max3_f32 v14, v14, v184, v185
    v_max3_f32 v14, v14, v186, v187
    v_mfma_f32_16x16x32_bf16 v[132:135], a[36:39], v[16:19], v[56:59]
    v_max3_f32 v12, v12, v124, v125
    v_max3_f32 v12, v12, v126, v127
    v_mfma_f32_16x16x32_bf16 v[196:199], a[36:39], v[20:23], v[56:59]
    v_max3_f32 v14, v14, v188, v189
    v_max3_f32 v14, v14, v190, v191
    s_waitcnt lgkmcnt(6)
    v_mfma_f32_16x16x32_bf16 v[136:139], a[40:43], v[16:19], v[60:63]
    v_max3_f32 v12, v12, v128, v129
    v_max3_f32 v12, v12, v130, v131
    v_mfma_f32_16x16x32_bf16 v[200:203], a[40:43], v[20:23], v[60:63]
    v_max3_f32 v14, v14, v192, v193
    v_max3_f32 v14, v14, v194, v195
    v_mfma_f32_16x16x32_bf16 v[140:143], a[44:47], v[16:19], v[60:63]
    s_waitcnt vmcnt(4)
    s_barrier
    ds_read_b128 a[72:75], v5 offset:24576
    v_max3_f32 v12, v12, v132, v133
    v_max3_f32 v12, v12, v134, v135
    v_mfma_f32_16x16x32_bf16 v[204:207], a[44:47], v[20:23], v[60:63]
    ds_read_b128 a[76:79], v5 offset:25600
    v_max3_f32 v14, v14, v196, v197
    v_max3_f32 v14, v14, v198, v199
    s_waitcnt lgkmcnt(6)
    v_mfma_f32_16x16x32_bf16 v[144:147], a[48:51], v[16:19], v[64:67]
    ds_read_b128 a[80:83], v5 offset:26624
    v_max3_f32 v12, v12, v136, v137
    v_max3_f32 v12, v12, v138, v139
    v_mfma_f32_16x16x32_bf16 v[208:211], a[48:51], v[20:23], v[64:67]
    ds_read_b128 a[84:87], v5 offset:27648
    v_max3_f32 v14, v14, v200, v201
    v_max3_f32 v14, v14, v202, v203
    v_mfma_f32_16x16x32_bf16 v[148:151], a[52:55], v[16:19], v[64:67]
    ds_read_b128 a[88:91], v5 offset:28672
    v_max3_f32 v12, v12, v140, v141
    v_max3_f32 v12, v12, v142, v143
    v_mfma_f32_16x16x32_bf16 v[212:215], a[52:55], v[20:23], v[64:67]
    ds_read_b128 a[92:95], v5 offset:29696
    v_max3_f32 v14, v14, v204, v205
    v_max3_f32 v14, v14, v206, v207
    s_waitcnt lgkmcnt(8)
    v_mfma_f32_16x16x32_bf16 v[152:155], a[56:59], v[16:19], v[68:71]
    ds_read_b128 a[96:99], v5 offset:30720
    v_max3_f32 v12, v12, v144, v145
    v_max3_f32 v12, v12, v146, v147
    v_mfma_f32_16x16x32_bf16 v[216:219], a[56:59], v[20:23], v[68:71]
    ds_read_b128 a[100:103], v5 offset:31744
    v_max3_f32 v14, v14, v208, v209
    v_max3_f32 v14, v14, v210, v211
    v_mfma_f32_16x16x32_bf16 v[156:159], a[60:63], v[16:19], v[68:71]
    ds_read_b128 a[104:107], v5 offset:32768
    v_max3_f32 v12, v12, v148, v149
    v_max3_f32 v12, v12, v150, v151
    v_mfma_f32_16x16x32_bf16 v[220:223], a[60:63], v[20:23], v[68:71]
    ds_read_b128 a[108:111], v5 offset:33792
    v_max3_f32 v14, v14, v212, v213
    v_max3_f32 v14, v14, v214, v215
    s_waitcnt lgkmcnt(10)
    v_mfma_f32_16x16x32_bf16 v[160:163], a[64:67], v[16:19], v[32:35]
    ds_read_b128 a[112:115], v5 offset:34816
    v_max3_f32 v12, v12, v152, v153
    v_max3_f32 v12, v12, v154, v155
    v_mfma_f32_16x16x32_bf16 v[224:227], a[64:67], v[20:23], 0
    v_max3_f32 v14, v14, v216, v217
    v_max3_f32 v14, v14, v218, v219
    v_mfma_f32_16x16x32_bf16 v[228:231], a[68:71], v[20:23], v[32:35]
    ds_read_b128 a[116:119], v5 offset:35840
    v_max3_f32 v12, v12, v156, v157
    v_max3_f32 v12, v12, v158, v159
    v_mov_b32 v16, v24
    v_mov_b32 v17, v25
    v_mov_b32 v18, v26
    v_mov_b32 v19, v27
    v_mov_b32 v20, v28
    v_mov_b32 v21, v29
    v_mov_b32 v22, v30
    v_mov_b32 v23, v31
    v_max3_f32 v14, v14, v220, v221
    v_max3_f32 v14, v14, v222, v223
    v_max3_f32 v12, v12, v160, v161
    v_max3_f32 v12, v12, v162, v163
    v_max3_f32 v14, v14, v224, v225
    v_max3_f32 v14, v14, v226, v227
    v_max3_f32 v14, v14, v228, v229
    v_max3_f32 v14, v14, v230, v231
    s_waitcnt lgkmcnt(6)
    ds_read_b128 a[120:123], v5 offset:36864
    ds_read_b128 a[124:127], v5 offset:37888
    ds_read_b128 a[128:131], v5 offset:38912
    ds_read_b128 a[132:135], v5 offset:39936
    ds_read_b128 a[136:139], v5 offset:40960
    ds_read_b128 a[140:143], v5 offset:41984
    v_mov_b32 v13, v12
    v_mov_b32 v15, v14
    s_nop 0
    v_permlane16_swap_b32 v13, v12
    v_permlane16_swap_b32 v15, v14
    v_max_f32 v12, v13, v12
    v_max_f32 v14, v15, v14
    v_mov_b32 v13, v12
    v_mov_b32 v15, v14
    s_nop 0
    v_permlane32_swap_b32 v13, v12
    v_permlane32_swap_b32 v15, v14
    v_max_f32 v12, v13, v12
    v_max_f32 v14, v15, v14
    v_pk_add_f32 v[96:97], v[96:97], v[12:13] op_sel_hi:[1,0] neg_lo:[0,1] neg_hi:[0,1]
    v_pk_add_f32 v[98:99], v[98:99], v[12:13] op_sel_hi:[1,0] neg_lo:[0,1] neg_hi:[0,1]
    v_pk_add_f32 v[100:101], v[100:101], v[12:13] op_sel_hi:[1,0] neg_lo:[0,1] neg_hi:[0,1]
    v_pk_add_f32 v[102:103], v[102:103], v[12:13] op_sel_hi:[1,0] neg_lo:[0,1] neg_hi:[0,1]
    v_exp_f32 v96, v96
    v_exp_f32 v97, v97
    v_exp_f32 v98, v98
    v_exp_f32 v99, v99
    v_exp_f32 v100, v100
    v_exp_f32 v101, v101
    v_exp_f32 v102, v102
    v_exp_f32 v103, v103
    v_pk_add_f32 v[164:165], v[164:165], v[14:15] op_sel_hi:[1,0] neg_lo:[0,1] neg_hi:[0,1]
    v_pk_add_f32 v[166:167], v[166:167], v[14:15] op_sel_hi:[1,0] neg_lo:[0,1] neg_hi:[0,1]
    v_cvt_pk_bf16_f32 v96, v96, v97
    v_cvt_pk_bf16_f32 v97, v98, v99
    v_cvt_pk_bf16_f32 v98, v100, v101
    v_cvt_pk_bf16_f32 v99, v102, v103
    s_waitcnt lgkmcnt(0)
    v_exp_f32 v164, v164
    v_exp_f32 v165, v165
    v_mfma_f32_16x16x32_bf16 v[72:75], a[72:75], v[96:99], 0
    v_exp_f32 v166, v166
    v_exp_f32 v167, v167
    v_mfma_f32_16x16x32_bf16 v[76:79], a[76:79], v[96:99], 0
    v_mfma_f32_16x16x32_bf16 v[80:83], a[144:147], v[96:99], 0
    v_pk_add_f32 v[104:105], v[104:105], v[12:13] op_sel_hi:[1,0] neg_lo:[0,1] neg_hi:[0,1]
    v_pk_add_f32 v[106:107], v[106:107], v[12:13] op_sel_hi:[1,0] neg_lo:[0,1] neg_hi:[0,1]
    v_pk_add_f32 v[108:109], v[108:109], v[12:13] op_sel_hi:[1,0] neg_lo:[0,1] neg_hi:[0,1]
    v_pk_add_f32 v[110:111], v[110:111], v[12:13] op_sel_hi:[1,0] neg_lo:[0,1] neg_hi:[0,1]
    v_cvt_pk_bf16_f32 v238, v164, v165
    v_cvt_pk_bf16_f32 v239, v166, v167
    v_exp_f32 v104, v104
    v_exp_f32 v105, v105
    v_mfma_f32_16x16x32_bf16 v[84:87], a[72:75], v[236:239], 0
    v_exp_f32 v106, v106
    buffer_load_dword v240, v246, s[68:71], 0 offen
    v_exp_f32 v107, v107
    v_mfma_f32_16x16x32_bf16 v[88:91], a[76:79], v[236:239], 0
    v_exp_f32 v108, v108
    v_exp_f32 v109, v109
    v_mfma_f32_16x16x32_bf16 v[92:95], a[144:147], v[236:239], 0
    v_exp_f32 v110, v110
    v_exp_f32 v111, v111
    v_pk_add_f32 v[168:169], v[168:169], v[14:15] op_sel_hi:[1,0] neg_lo:[0,1] neg_hi:[0,1]
    v_pk_add_f32 v[170:171], v[170:171], v[14:15] op_sel_hi:[1,0] neg_lo:[0,1] neg_hi:[0,1]
    v_pk_add_f32 v[172:173], v[172:173], v[14:15] op_sel_hi:[1,0] neg_lo:[0,1] neg_hi:[0,1]
    v_pk_add_f32 v[174:175], v[174:175], v[14:15] op_sel_hi:[1,0] neg_lo:[0,1] neg_hi:[0,1]
    v_cvt_pk_bf16_f32 v104, v104, v105
    v_cvt_pk_bf16_f32 v105, v106, v107
    v_cvt_pk_bf16_f32 v106, v108, v109
    v_cvt_pk_bf16_f32 v107, v110, v111
    v_exp_f32 v168, v168
    v_exp_f32 v169, v169
    v_mfma_f32_16x16x32_bf16 v[72:75], a[80:83], v[104:107], v[72:75]
    v_exp_f32 v170, v170
    v_exp_f32 v171, v171
    v_mfma_f32_16x16x32_bf16 v[76:79], a[84:87], v[104:107], v[76:79]
    v_exp_f32 v172, v172
    v_exp_f32 v173, v173
    v_mfma_f32_16x16x32_bf16 v[80:83], a[144:147], v[104:107], v[80:83]
    v_exp_f32 v174, v174
    v_exp_f32 v175, v175
    v_pk_add_f32 v[112:113], v[112:113], v[12:13] op_sel_hi:[1,0] neg_lo:[0,1] neg_hi:[0,1]
    v_pk_add_f32 v[114:115], v[114:115], v[12:13] op_sel_hi:[1,0] neg_lo:[0,1] neg_hi:[0,1]
    v_pk_add_f32 v[116:117], v[116:117], v[12:13] op_sel_hi:[1,0] neg_lo:[0,1] neg_hi:[0,1]
    v_pk_add_f32 v[118:119], v[118:119], v[12:13] op_sel_hi:[1,0] neg_lo:[0,1] neg_hi:[0,1]
    v_cvt_pk_bf16_f32 v168, v168, v169
    v_cvt_pk_bf16_f32 v169, v170, v171
    v_cvt_pk_bf16_f32 v170, v172, v173
    v_cvt_pk_bf16_f32 v171, v174, v175
    v_exp_f32 v112, v112
    v_exp_f32 v113, v113
    s_mov_b32 m0, s62
    s_add_u32 s62, s62, 4096
    buffer_load_dwordx4 v242, s[28:31], s49 offen lds
    s_add_u32 s49, s49, 65536
    v_mfma_f32_16x16x32_bf16 v[84:87], a[80:83], v[168:171], v[84:87]
    v_exp_f32 v114, v114
    v_exp_f32 v115, v115
    v_mfma_f32_16x16x32_bf16 v[88:91], a[84:87], v[168:171], v[88:91]
    v_exp_f32 v116, v116
    v_exp_f32 v117, v117
    v_mfma_f32_16x16x32_bf16 v[92:95], a[144:147], v[168:171], v[92:95]
    v_exp_f32 v118, v118
    v_exp_f32 v119, v119
    v_pk_add_f32 v[176:177], v[176:177], v[14:15] op_sel_hi:[1,0] neg_lo:[0,1] neg_hi:[0,1]
    v_pk_add_f32 v[178:179], v[178:179], v[14:15] op_sel_hi:[1,0] neg_lo:[0,1] neg_hi:[0,1]
    v_pk_add_f32 v[180:181], v[180:181], v[14:15] op_sel_hi:[1,0] neg_lo:[0,1] neg_hi:[0,1]
    v_pk_add_f32 v[182:183], v[182:183], v[14:15] op_sel_hi:[1,0] neg_lo:[0,1] neg_hi:[0,1]
    v_cvt_pk_bf16_f32 v112, v112, v113
    v_cvt_pk_bf16_f32 v113, v114, v115
    v_cvt_pk_bf16_f32 v114, v116, v117
    v_cvt_pk_bf16_f32 v115, v118, v119
    v_exp_f32 v176, v176
    v_exp_f32 v177, v177
    v_mfma_f32_16x16x32_bf16 v[72:75], a[88:91], v[112:115], v[72:75]
    v_exp_f32 v178, v178
    v_exp_f32 v179, v179
    v_mfma_f32_16x16x32_bf16 v[76:79], a[92:95], v[112:115], v[76:79]
    v_exp_f32 v180, v180
    v_exp_f32 v181, v181
    v_mfma_f32_16x16x32_bf16 v[80:83], a[144:147], v[112:115], v[80:83]
    v_exp_f32 v182, v182
    v_exp_f32 v183, v183
    v_pk_add_f32 v[120:121], v[120:121], v[12:13] op_sel_hi:[1,0] neg_lo:[0,1] neg_hi:[0,1]
    v_pk_add_f32 v[122:123], v[122:123], v[12:13] op_sel_hi:[1,0] neg_lo:[0,1] neg_hi:[0,1]
    v_pk_add_f32 v[124:125], v[124:125], v[12:13] op_sel_hi:[1,0] neg_lo:[0,1] neg_hi:[0,1]
    v_pk_add_f32 v[126:127], v[126:127], v[12:13] op_sel_hi:[1,0] neg_lo:[0,1] neg_hi:[0,1]
    v_cvt_pk_bf16_f32 v176, v176, v177
    v_cvt_pk_bf16_f32 v177, v178, v179
    v_cvt_pk_bf16_f32 v178, v180, v181
    v_cvt_pk_bf16_f32 v179, v182, v183
    s_mov_b32 m0, s62
    s_add_u32 s62, s62, 4096
    buffer_load_dwordx4 v242, s[28:31], s49 offen lds
    s_add_u32 s49, s49, 65536
    v_exp_f32 v120, v120
    v_exp_f32 v121, v121
    v_mfma_f32_16x16x32_bf16 v[84:87], a[88:91], v[176:179], v[84:87]
    v_exp_f32 v122, v122
    v_exp_f32 v123, v123
    v_mfma_f32_16x16x32_bf16 v[88:91], a[92:95], v[176:179], v[88:91]
    v_exp_f32 v124, v124
    v_exp_f32 v125, v125
    v_mfma_f32_16x16x32_bf16 v[92:95], a[144:147], v[176:179], v[92:95]
    v_exp_f32 v126, v126
    v_exp_f32 v127, v127
    v_pk_add_f32 v[184:185], v[184:185], v[14:15] op_sel_hi:[1,0] neg_lo:[0,1] neg_hi:[0,1]
    v_pk_add_f32 v[186:187], v[186:187], v[14:15] op_sel_hi:[1,0] neg_lo:[0,1] neg_hi:[0,1]
    v_pk_add_f32 v[188:189], v[188:189], v[14:15] op_sel_hi:[1,0] neg_lo:[0,1] neg_hi:[0,1]
    v_pk_add_f32 v[190:191], v[190:191], v[14:15] op_sel_hi:[1,0] neg_lo:[0,1] neg_hi:[0,1]
    v_cvt_pk_bf16_f32 v120, v120, v121
    v_cvt_pk_bf16_f32 v121, v122, v123
    v_cvt_pk_bf16_f32 v122, v124, v125
    v_cvt_pk_bf16_f32 v123, v126, v127
    v_exp_f32 v184, v184
    v_exp_f32 v185, v185
    v_mfma_f32_16x16x32_bf16 v[72:75], a[96:99], v[120:123], v[72:75]
    v_exp_f32 v186, v186
    v_exp_f32 v187, v187
    v_mfma_f32_16x16x32_bf16 v[76:79], a[100:103], v[120:123], v[76:79]
    v_exp_f32 v188, v188
    v_exp_f32 v189, v189
    v_mfma_f32_16x16x32_bf16 v[80:83], a[144:147], v[120:123], v[80:83]
    v_exp_f32 v190, v190
    v_exp_f32 v191, v191
    v_pk_add_f32 v[128:129], v[128:129], v[12:13] op_sel_hi:[1,0] neg_lo:[0,1] neg_hi:[0,1]
    v_pk_add_f32 v[130:131], v[130:131], v[12:13] op_sel_hi:[1,0] neg_lo:[0,1] neg_hi:[0,1]
    v_pk_add_f32 v[132:133], v[132:133], v[12:13] op_sel_hi:[1,0] neg_lo:[0,1] neg_hi:[0,1]
    v_pk_add_f32 v[134:135], v[134:135], v[12:13] op_sel_hi:[1,0] neg_lo:[0,1] neg_hi:[0,1]
    v_cvt_pk_bf16_f32 v184, v184, v185
    v_cvt_pk_bf16_f32 v185, v186, v187
    s_mov_b32 m0, s61
    s_add_u32 s61, s61, 2048
    buffer_load_dwordx4 v243, s[44:47], s59 offen lds
    v_cvt_pk_bf16_f32 v186, v188, v189
    v_cvt_pk_bf16_f32 v187, v190, v191
    v_exp_f32 v128, v128
    v_exp_f32 v129, v129
    v_mfma_f32_16x16x32_bf16 v[84:87], a[96:99], v[184:187], v[84:87]
    v_exp_f32 v130, v130
    v_exp_f32 v131, v131
    v_mfma_f32_16x16x32_bf16 v[88:91], a[100:103], v[184:187], v[88:91]
    v_exp_f32 v132, v132
    v_exp_f32 v133, v133
    v_mfma_f32_16x16x32_bf16 v[92:95], a[144:147], v[184:187], v[92:95]
    v_exp_f32 v134, v134
    v_exp_f32 v135, v135
    v_pk_add_f32 v[192:193], v[192:193], v[14:15] op_sel_hi:[1,0] neg_lo:[0,1] neg_hi:[0,1]
    v_pk_add_f32 v[194:195], v[194:195], v[14:15] op_sel_hi:[1,0] neg_lo:[0,1] neg_hi:[0,1]
    v_pk_add_f32 v[196:197], v[196:197], v[14:15] op_sel_hi:[1,0] neg_lo:[0,1] neg_hi:[0,1]
    v_pk_add_f32 v[198:199], v[198:199], v[14:15] op_sel_hi:[1,0] neg_lo:[0,1] neg_hi:[0,1]
    v_cvt_pk_bf16_f32 v128, v128, v129
    v_cvt_pk_bf16_f32 v129, v130, v131
    v_cvt_pk_bf16_f32 v130, v132, v133
    v_cvt_pk_bf16_f32 v131, v134, v135
    v_exp_f32 v192, v192
    v_exp_f32 v193, v193
    v_mfma_f32_16x16x32_bf16 v[72:75], a[104:107], v[128:131], v[72:75]
    v_exp_f32 v194, v194
    v_exp_f32 v195, v195
    v_mfma_f32_16x16x32_bf16 v[76:79], a[108:111], v[128:131], v[76:79]
    v_exp_f32 v196, v196
    v_exp_f32 v197, v197
    v_mfma_f32_16x16x32_bf16 v[80:83], a[144:147], v[128:131], v[80:83]
    v_exp_f32 v198, v198
    v_exp_f32 v199, v199
    v_pk_add_f32 v[136:137], v[136:137], v[12:13] op_sel_hi:[1,0] neg_lo:[0,1] neg_hi:[0,1]
    v_pk_add_f32 v[138:139], v[138:139], v[12:13] op_sel_hi:[1,0] neg_lo:[0,1] neg_hi:[0,1]
    v_pk_add_f32 v[140:141], v[140:141], v[12:13] op_sel_hi:[1,0] neg_lo:[0,1] neg_hi:[0,1]
    v_pk_add_f32 v[142:143], v[142:143], v[12:13] op_sel_hi:[1,0] neg_lo:[0,1] neg_hi:[0,1]
    s_mov_b32 m0, s62
    s_add_u32 s62, s62, 4096
    buffer_load_dwordx4 v242, s[28:31], s49 offen lds
    s_add_u32 s49, s49, 65536
    v_cvt_pk_bf16_f32 v192, v192, v193
    v_cvt_pk_bf16_f32 v193, v194, v195
    v_cvt_pk_bf16_f32 v194, v196, v197
    v_cvt_pk_bf16_f32 v195, v198, v199
    v_exp_f32 v136, v136
    v_exp_f32 v137, v137
    v_mfma_f32_16x16x32_bf16 v[84:87], a[104:107], v[192:195], v[84:87]
    v_exp_f32 v138, v138
    v_exp_f32 v139, v139
    v_mfma_f32_16x16x32_bf16 v[88:91], a[108:111], v[192:195], v[88:91]
    v_exp_f32 v140, v140
    v_exp_f32 v141, v141
    v_mfma_f32_16x16x32_bf16 v[92:95], a[144:147], v[192:195], v[92:95]
    v_exp_f32 v142, v142
    v_exp_f32 v143, v143
    v_pk_add_f32 v[200:201], v[200:201], v[14:15] op_sel_hi:[1,0] neg_lo:[0,1] neg_hi:[0,1]
    v_pk_add_f32 v[202:203], v[202:203], v[14:15] op_sel_hi:[1,0] neg_lo:[0,1] neg_hi:[0,1]
    v_pk_add_f32 v[204:205], v[204:205], v[14:15] op_sel_hi:[1,0] neg_lo:[0,1] neg_hi:[0,1]
    v_pk_add_f32 v[206:207], v[206:207], v[14:15] op_sel_hi:[1,0] neg_lo:[0,1] neg_hi:[0,1]
    v_cvt_pk_bf16_f32 v136, v136, v137
    v_cvt_pk_bf16_f32 v137, v138, v139
    v_cvt_pk_bf16_f32 v138, v140, v141
    v_cvt_pk_bf16_f32 v139, v142, v143
    v_exp_f32 v200, v200
    v_exp_f32 v201, v201
    v_mfma_f32_16x16x32_bf16 v[72:75], a[112:115], v[136:139], v[72:75]
    v_exp_f32 v202, v202
    v_exp_f32 v203, v203
    v_mfma_f32_16x16x32_bf16 v[76:79], a[116:119], v[136:139], v[76:79]
    v_exp_f32 v204, v204
    v_exp_f32 v205, v205
    v_mfma_f32_16x16x32_bf16 v[80:83], a[144:147], v[136:139], v[80:83]
    v_exp_f32 v206, v206
    v_exp_f32 v207, v207
    v_pk_add_f32 v[144:145], v[144:145], v[12:13] op_sel_hi:[1,0] neg_lo:[0,1] neg_hi:[0,1]
    v_pk_add_f32 v[146:147], v[146:147], v[12:13] op_sel_hi:[1,0] neg_lo:[0,1] neg_hi:[0,1]
    s_mov_b32 m0, s62
    s_add_u32 s62, s62, 4096
    buffer_load_dwordx4 v242, s[28:31], s49 offen lds
    s_add_u32 s49, s49, 65536
    v_pk_add_f32 v[148:149], v[148:149], v[12:13] op_sel_hi:[1,0] neg_lo:[0,1] neg_hi:[0,1]
    v_pk_add_f32 v[150:151], v[150:151], v[12:13] op_sel_hi:[1,0] neg_lo:[0,1] neg_hi:[0,1]
    v_cvt_pk_bf16_f32 v200, v200, v201
    v_cvt_pk_bf16_f32 v201, v202, v203
    v_cvt_pk_bf16_f32 v202, v204, v205
    v_cvt_pk_bf16_f32 v203, v206, v207
    v_exp_f32 v144, v144
    v_exp_f32 v145, v145
    v_mfma_f32_16x16x32_bf16 v[84:87], a[112:115], v[200:203], v[84:87]
    v_exp_f32 v146, v146
    v_exp_f32 v147, v147
    v_mfma_f32_16x16x32_bf16 v[88:91], a[116:119], v[200:203], v[88:91]
    v_exp_f32 v148, v148
    v_exp_f32 v149, v149
    v_mfma_f32_16x16x32_bf16 v[92:95], a[144:147], v[200:203], v[92:95]
    v_exp_f32 v150, v150
    v_exp_f32 v151, v151
    v_pk_add_f32 v[208:209], v[208:209], v[14:15] op_sel_hi:[1,0] neg_lo:[0,1] neg_hi:[0,1]
    v_pk_add_f32 v[210:211], v[210:211], v[14:15] op_sel_hi:[1,0] neg_lo:[0,1] neg_hi:[0,1]
    v_pk_add_f32 v[212:213], v[212:213], v[14:15] op_sel_hi:[1,0] neg_lo:[0,1] neg_hi:[0,1]
    v_pk_add_f32 v[214:215], v[214:215], v[14:15] op_sel_hi:[1,0] neg_lo:[0,1] neg_hi:[0,1]
    v_cvt_pk_bf16_f32 v144, v144, v145
    v_cvt_pk_bf16_f32 v145, v146, v147
    v_cvt_pk_bf16_f32 v146, v148, v149
    v_cvt_pk_bf16_f32 v147, v150, v151
    v_exp_f32 v208, v208
    v_exp_f32 v209, v209
    v_mfma_f32_16x16x32_bf16 v[72:75], a[120:123], v[144:147], v[72:75]
    v_exp_f32 v210, v210
    v_exp_f32 v211, v211
    v_mfma_f32_16x16x32_bf16 v[76:79], a[124:127], v[144:147], v[76:79]
    v_exp_f32 v212, v212
    v_exp_f32 v213, v213
    v_mfma_f32_16x16x32_bf16 v[80:83], a[144:147], v[144:147], v[80:83]
    v_exp_f32 v214, v214
    v_exp_f32 v215, v215
    s_sub_u32 m0, s61, 2048
    s_nop 0
    buffer_load_dwordx4 v244, s[44:47], s59 offen offset:1024 lds
    s_add_u32 s59, s59, 32768
    v_pk_add_f32 v[152:153], v[152:153], v[12:13] op_sel_hi:[1,0] neg_lo:[0,1] neg_hi:[0,1]
    v_pk_add_f32 v[154:155], v[154:155], v[12:13] op_sel_hi:[1,0] neg_lo:[0,1] neg_hi:[0,1]
    v_pk_add_f32 v[156:157], v[156:157], v[12:13] op_sel_hi:[1,0] neg_lo:[0,1] neg_hi:[0,1]
    v_pk_add_f32 v[158:159], v[158:159], v[12:13] op_sel_hi:[1,0] neg_lo:[0,1] neg_hi:[0,1]
    v_cvt_pk_bf16_f32 v208, v208, v209
    v_cvt_pk_bf16_f32 v209, v210, v211
    v_cvt_pk_bf16_f32 v210, v212, v213
    v_cvt_pk_bf16_f32 v211, v214, v215
    v_exp_f32 v152, v152
    v_exp_f32 v153, v153
    v_mfma_f32_16x16x32_bf16 v[84:87], a[120:123], v[208:211], v[84:87]
    v_exp_f32 v154, v154
    v_exp_f32 v155, v155
    v_mfma_f32_16x16x32_bf16 v[88:91], a[124:127], v[208:211], v[88:91]
    v_exp_f32 v156, v156
    v_exp_f32 v157, v157
    v_mfma_f32_16x16x32_bf16 v[92:95], a[144:147], v[208:211], v[92:95]
    v_exp_f32 v158, v158
    v_exp_f32 v159, v159
    v_pk_add_f32 v[216:217], v[216:217], v[14:15] op_sel_hi:[1,0] neg_lo:[0,1] neg_hi:[0,1]
    v_pk_add_f32 v[218:219], v[218:219], v[14:15] op_sel_hi:[1,0] neg_lo:[0,1] neg_hi:[0,1]
    v_pk_add_f32 v[220:221], v[220:221], v[14:15] op_sel_hi:[1,0] neg_lo:[0,1] neg_hi:[0,1]
    v_pk_add_f32 v[222:223], v[222:223], v[14:15] op_sel_hi:[1,0] neg_lo:[0,1] neg_hi:[0,1]
    v_cvt_pk_bf16_f32 v152, v152, v153
    v_cvt_pk_bf16_f32 v153, v154, v155
    v_cvt_pk_bf16_f32 v154, v156, v157
    v_cvt_pk_bf16_f32 v155, v158, v159
    v_exp_f32 v216, v216
    v_exp_f32 v217, v217
    v_mfma_f32_16x16x32_bf16 v[72:75], a[128:131], v[152:155], v[72:75]
    v_exp_f32 v218, v218
    v_exp_f32 v219, v219
    v_mfma_f32_16x16x32_bf16 v[76:79], a[132:135], v[152:155], v[76:79]
    v_exp_f32 v220, v220
    v_exp_f32 v221, v221
    v_mfma_f32_16x16x32_bf16 v[80:83], a[144:147], v[152:155], v[80:83]
    s_mov_b32 m0, s62
    s_add_u32 s62, s62, 4096
    buffer_load_dwordx4 v242, s[28:31], s49 offen lds
    s_add_u32 s49, s49, 65536
    v_exp_f32 v222, v222
    v_exp_f32 v223, v223
    v_pk_add_f32 v[160:161], v[160:161], v[12:13] op_sel_hi:[1,0] neg_lo:[0,1] neg_hi:[0,1]
    v_pk_add_f32 v[162:163], v[162:163], v[12:13] op_sel_hi:[1,0] neg_lo:[0,1] neg_hi:[0,1]
    v_cvt_pk_bf16_f32 v216, v216, v217
    v_cvt_pk_bf16_f32 v217, v218, v219
    v_cvt_pk_bf16_f32 v218, v220, v221
    v_cvt_pk_bf16_f32 v219, v222, v223
    v_exp_f32 v160, v160
    v_exp_f32 v161, v161
    v_mfma_f32_16x16x32_bf16 v[84:87], a[128:131], v[216:219], v[84:87]
    v_exp_f32 v162, v162
    v_exp_f32 v163, v163
    v_mfma_f32_16x16x32_bf16 v[88:91], a[132:135], v[216:219], v[88:91]
    v_mfma_f32_16x16x32_bf16 v[92:95], a[144:147], v[216:219], v[92:95]
    v_pk_add_f32 v[224:225], v[224:225], v[14:15] op_sel_hi:[1,0] neg_lo:[0,1] neg_hi:[0,1]
    v_pk_add_f32 v[226:227], v[226:227], v[14:15] op_sel_hi:[1,0] neg_lo:[0,1] neg_hi:[0,1]
    v_pk_add_f32 v[228:229], v[228:229], v[14:15] op_sel_hi:[1,0] neg_lo:[0,1] neg_hi:[0,1]
    v_pk_add_f32 v[230:231], v[230:231], v[14:15] op_sel_hi:[1,0] neg_lo:[0,1] neg_hi:[0,1]
    v_cvt_pk_bf16_f32 v232, v160, v161
    v_cvt_pk_bf16_f32 v233, v162, v163
    v_exp_f32 v224, v224
    v_exp_f32 v225, v225
    v_mfma_f32_16x16x32_bf16 v[72:75], a[136:139], v[232:235], v[72:75]
    v_exp_f32 v226, v226
    v_exp_f32 v227, v227
    v_mfma_f32_16x16x32_bf16 v[76:79], a[140:143], v[232:235], v[76:79]
    v_exp_f32 v228, v228
    v_exp_f32 v229, v229
    v_mfma_f32_16x16x32_bf16 v[80:83], a[144:147], v[232:235], v[80:83]
    v_exp_f32 v230, v230
    v_exp_f32 v231, v231
    v_cvt_pk_bf16_f32 v224, v224, v225
    v_cvt_pk_bf16_f32 v225, v226, v227
    v_cvt_pk_bf16_f32 v226, v228, v229
    v_cvt_pk_bf16_f32 v227, v230, v231
    s_nop 1
    v_mfma_f32_16x16x32_bf16 v[84:87], a[136:139], v[224:227], v[84:87]
    v_mfma_f32_16x16x32_bf16 v[88:91], a[140:143], v[224:227], v[88:91]
    v_mfma_f32_16x16x32_bf16 v[92:95], a[144:147], v[224:227], v[92:95]
    v_add_u32 v5, 2048, v5
    s_add_u32 s63, s63, 1
    ds_read_b128 a[0:3], v5 offset:0
    ds_read_b128 a[4:7], v5 offset:1024
    ds_read_b128 a[8:11], v5 offset:2048
    ds_read_b128 a[12:15], v5 offset:3072
    ds_read_b128 a[16:19], v5 offset:4096
    ds_read_b128 a[20:23], v5 offset:5120
    ds_read_b128 a[24:27], v5 offset:6144
    ds_read_b128 a[28:31], v5 offset:7168
    v_rcp_f32 v12, v80
    v_rcp_f32 v14, v92
    v_mul_f32 v72, v72, v12
    v_mul_f32 v73, v73, v12
    v_mul_f32 v74, v74, v12
    v_mul_f32 v75, v75, v12
    v_cvt_pk_bf16_f32 v96, v72, v73
    v_cvt_pk_bf16_f32 v97, v74, v75
    v_mul_f32 v84, v84, v14
    v_mul_f32 v85, v85, v14
    v_mul_f32 v86, v86, v14
    v_mul_f32 v87, v87, v14
    v_cvt_pk_bf16_f32 v98, v84, v85
    v_cvt_pk_bf16_f32 v99, v86, v87
    v_lshlrev_b32 v72, 16, v96
    v_and_b32 v73, 0xffff0000, v96
    v_lshlrev_b32 v74, 16, v97
    v_and_b32 v75, 0xffff0000, v97
    v_lshlrev_b32 v84, 16, v98
    v_and_b32 v85, 0xffff0000, v98
    v_lshlrev_b32 v86, 16, v99
    v_and_b32 v87, 0xffff0000, v99
    v_permlane16_swap_b32 v96, v98
    v_permlane16_swap_b32 v97, v99
    buffer_store_dwordx4 v[96:99], v4, s[40:43], s55 offen offset:0 sc1
    v_mul_f32 v76, v76, v12
    v_mul_f32 v77, v77, v12
    v_mul_f32 v78, v78, v12
    v_mul_f32 v79, v79, v12
    v_cvt_pk_bf16_f32 v100, v76, v77
    v_cvt_pk_bf16_f32 v101, v78, v79
    v_mul_f32 v88, v88, v14
    v_mul_f32 v89, v89, v14
    v_mul_f32 v90, v90, v14
    v_mul_f32 v91, v91, v14
    v_cvt_pk_bf16_f32 v102, v88, v89
    v_cvt_pk_bf16_f32 v103, v90, v91
    v_lshlrev_b32 v76, 16, v100
    v_and_b32 v77, 0xffff0000, v100
    v_lshlrev_b32 v78, 16, v101
    v_and_b32 v79, 0xffff0000, v101
    v_lshlrev_b32 v88, 16, v102
    v_and_b32 v89, 0xffff0000, v102
    v_lshlrev_b32 v90, 16, v103
    v_and_b32 v91, 0xffff0000, v103
    v_permlane16_swap_b32 v100, v102
    v_permlane16_swap_b32 v101, v103
    buffer_store_dwordx4 v[100:103], v4, s[40:43], s55 offen offset:1024 sc1
    s_waitcnt vmcnt(10)
    v_mul_f32 v12, v72, v248
    v_mul_f32 v14, v84, v248
    v_fmac_f32 v12, v73, v249
    v_fmac_f32 v14, v85, v249
    v_fmac_f32 v12, v74, v250
    v_fmac_f32 v14, v86, v250
    v_fmac_f32 v12, v75, v251
    v_fmac_f32 v14, v87, v251
    v_fmac_f32 v12, v76, v252
    v_fmac_f32 v14, v88, v252
    v_fmac_f32 v12, v77, v253
    v_fmac_f32 v14, v89, v253
    v_fmac_f32 v12, v78, v254
    v_fmac_f32 v14, v90, v254
    v_fmac_f32 v12, v79, v255
    v_fmac_f32 v14, v91, v255
    s_nop 0
    s_nop 0
    v_permlane16_swap_b32 v12, v14
    v_add_f32 v12, v12, v14
    v_mov_b32 v13, v12
    s_nop 0
    s_nop 0
    v_permlane32_swap_b32 v13, v12
    v_add_f32 v12, v12, v13
    buffer_store_dword v12, v7, s[32:35], s54 offen sc1
    s_mov_b32 s54, 128
    s_mov_b32 s55, 65536
    s_add_u32 s68, s14, s60
    s_addc_u32 s69, s15, 0
    s_sub_u32 s51, s51, 1
    s_cmp_lg_u32 s51, 0
    s_cbranch_scc1 P2_loop
C_p3:
    s_waitcnt vmcnt(3)
    v_lshrrev_b32 v10, 3, v0
    v_and_b32 v11, 7, v0
    v_and_b32 v12, 2, v10
    s_and_b32 s52, s3, 1
    s_lshl_b32 s52, s52, 2
    v_or_b32 v12, s52, v12
    v_xor_b32 v11, v11, v12
    s_lshl_b32 s52, s3, 14
    v_lshlrev_b32 v4, 11, v10
    v_lshl_add_u32 v4, v11, 4, v4
    v_add_u32 v4, s52, v4
    v_lshrrev_b32 v10, 2, v1
    v_lshl_add_u32 v10, v2, 3, v10
    v_lshlrev_b32 v10, 7, v10
    v_and_b32 v11, 3, v0
    v_lshl_add_u32 v10, v11, 3, v10
    v_lshrrev_b32 v11, 3, v1
    v_and_b32 v12, 1, v2
    v_lshl_add_u32 v11, v12, 1, v11
    v_xor_b32 v12, 0, v11
    v_lshl_add_u32 v5, v12, 5, v10
    v_xor_b32 v12, 1, v11
    v_lshl_add_u32 v6, v12, 5, v10
    v_xor_b32 v12, 2, v11
    v_lshl_add_u32 v7, v12, 5, v10
    v_xor_b32 v12, 3, v11
    v_lshl_add_u32 v8, v12, 5, v10
    v_add_u32 v144, 65536, v5
    v_add_u32 v145, 65536, v6
    v_add_u32 v146, 65536, v7
    v_add_u32 v147, 65536, v8
    s_lshl_b32 s56, s26, 2
    s_add_u32 s56, s56, s3
    s_mov_b32 s52, s56
    s_mul_i32 s52, s52, 65536
    s_add_u32 s52, s52, 16777216
    s_add_u32 s36, s22, s52
    s_addc_u32 s37, s23, 0
    s_mov_b32 s38, 65536
    s_mov_b32 s39, 0x00020000
    v_lshlrev_b32 v3, 9, v2
    v_lshl_add_u32 v3, v1, 4, v3
    s_mov_b32 s50, 0
    v_lshlrev_b32 v9, 16, v2
    v_lshl_add_u32 v9, v1, 2, v9
    v_lshlrev_b32 v14, 4, v0
    s_mov_b32 s54, 0
    s_mov_b32 s55, 32768
    s_lshl_b32 s52, s56, 7
    s_sub_u32 s53, 262144, s52
    s_add_u32 s52, s52, 42098688
    s_add_u32 s32, s22, s52
    s_addc_u32 s33, s23, 0
    s_mov_b32 s34, s53
    s_mov_b32 s35, 0x00020000
    s_lshl_b32 s52, s56, 16
    s_lshl_b32 s53, s27, 12
    s_add_u32 s52, s52, s53
    s_add_u32 s52, s52, 20971520
    s_add_u32 s40, s22, s52
    s_addc_u32 s41, s23, 0
    s_mov_b32 s42, 4096
    s_mov_b32 s43, 0x00020000
    s_lshl_b32 s52, s56, 7
    s_lshl_b32 s53, s27, 13
    s_add_u32 s53, s52, s53
    s_add_u32 s53, s53, 41967616
    s_add_u32 s44, s22, s53
    s_addc_u32 s45, s23, 0
    s_mov_b32 s46, 128
    s_mov_b32 s47, 0x00020000
    v_lshrrev_b32 v10, 1, v1
    v_lshrrev_b32 v11, 1, v2
    v_xor_b32 v10, v10, v11
    v_lshlrev_b32 v10, 4, v10
    v_lshl_add_u32 v10, v1, 7, v10
    v_and_b32 v11, 1, v2
    v_lshl_add_u32 v10, v11, 3, v10
    s_lshl_b32 s52, s3, 12
    s_add_u32 s52, s52, 141312
    v_xor_b32 v11, 0, v10
    v_add_u32 v11, s52, v11
    ds_read_b64 v[72:73], v11 offset:0
    ds_read_b64 v[74:75], v11 offset:2048
    v_xor_b32 v11, 32, v10
    v_add_u32 v11, s52, v11
    ds_read_b64 v[76:77], v11 offset:0
    ds_read_b64 v[78:79], v11 offset:2048
    v_xor_b32 v11, 64, v10
    v_add_u32 v11, s52, v11
    ds_read_b64 v[80:81], v11 offset:0
    ds_read_b64 v[82:83], v11 offset:2048
    v_xor_b32 v11, 96, v10
    v_add_u32 v11, s52, v11
    ds_read_b64 v[84:85], v11 offset:0
    ds_read_b64 v[86:87], v11 offset:2048
    s_waitcnt lgkmcnt(0)
    v_lshlrev_b32 v32, 16, v72
    v_and_b32 v33, 0xffff0000, v72
    v_lshlrev_b32 v34, 16, v73
    v_and_b32 v35, 0xffff0000, v73
    v_lshlrev_b32 v36, 16, v74
    v_and_b32 v37, 0xffff0000, v74
    v_lshlrev_b32 v38, 16, v75
    v_and_b32 v39, 0xffff0000, v75
    v_lshlrev_b32 v40, 16, v76
    v_and_b32 v41, 0xffff0000, v76
    v_lshlrev_b32 v42, 16, v77
    v_and_b32 v43, 0xffff0000, v77
    v_lshlrev_b32 v44, 16, v78
    v_and_b32 v45, 0xffff0000, v78
    v_lshlrev_b32 v46, 16, v79
    v_and_b32 v47, 0xffff0000, v79
    v_lshlrev_b32 v48, 16, v80
    v_and_b32 v49, 0xffff0000, v80
    v_lshlrev_b32 v50, 16, v81
    v_and_b32 v51, 0xffff0000, v81
    v_lshlrev_b32 v52, 16, v82
    v_and_b32 v53, 0xffff0000, v82
    v_lshlrev_b32 v54, 16, v83
    v_and_b32 v55, 0xffff0000, v83
    v_lshlrev_b32 v56, 16, v84
    v_and_b32 v57, 0xffff0000, v84
    v_lshlrev_b32 v58, 16, v85
    v_and_b32 v59, 0xffff0000, v85
    v_lshlrev_b32 v60, 16, v86
    v_and_b32 v61, 0xffff0000, v86
    v_lshlrev_b32 v62, 16, v87
    v_and_b32 v63, 0xffff0000, v87
    v_accvgpr_read_b32 v22, a164
    v_accvgpr_read_b32 v24, a165
    s_waitcnt vmcnt(0) lgkmcnt(0)
    s_barrier
    s_cmp_lg_u32 s3, 0
    s_cbranch_scc1 SIG_5
    s_lshl_b32 s52, s26, 5
    s_add_u32 s52, s52, s27
    s_lshl_b32 s52, s52, 2
    s_add_u32 s52, s52, 2048
    v_lshrrev_b32 v16, 0, v0
    v_lshlrev_b32 v16, 20, v16
    v_lshl_add_u32 v16, v0, 13, v16
    s_add_u32 s52, s52, 40960
    v_mov_b32 v17, s10
    buffer_store_dword v17, v16, s[64:67], s52 offen sc1
SIG_5:
    s_cmp_eq_u32 s3, 0
    s_cbranch_scc1 S2_now
    s_mov_b32 s51, 1
    s_cmp_eq_u32 s3, 2
    s_cselect_b32 s51, 2, s51
S2_more:
    s_add_u32 s62, s48, 40960
    s_mov_b32 s63, s49
    s_mov_b32 m0, s62
    s_add_u32 s62, s62, 4096
    buffer_load_dwordx4 v4, s[28:31], s63 offen lds
    s_add_u32 s63, s63, 65536
    s_mov_b32 m0, s62
    s_add_u32 s62, s62, 4096
    buffer_load_dwordx4 v4, s[28:31], s63 offen lds
    s_add_u32 s63, s63, 65536
    s_mov_b32 m0, s62
    s_add_u32 s62, s62, 4096
    buffer_load_dwordx4 v4, s[28:31], s63 offen lds
    s_add_u32 s63, s63, 65536
    s_mov_b32 m0, s62
    s_add_u32 s62, s62, 4096
    buffer_load_dwordx4 v4, s[28:31], s63 offen lds
    s_add_u32 s63, s63, 65536
    s_mov_b32 m0, s62
    s_add_u32 s62, s62, 4096
    buffer_load_dwordx4 v4, s[28:31], s63 offen lds
    s_add_u32 s63, s63, 65536
    s_mov_b32 m0, s62
    s_add_u32 s62, s62, 4096
    buffer_load_dwordx4 v4, s[28:31], s63 offen lds
    s_add_u32 s63, s63, 65536
    s_mov_b32 m0, s62
    s_add_u32 s62, s62, 4096
    buffer_load_dwordx4 v4, s[28:31], s63 offen lds
    s_add_u32 s63, s63, 65536
    s_mov_b32 m0, s62
    s_add_u32 s62, s62, 4096
    buffer_load_dwordx4 v4, s[28:31], s63 offen lds
    s_add_u32 s63, s63, 65536
    s_mov_b32 m0, s62
    s_add_u32 s62, s62, 4096
    buffer_load_dwordx4 v4, s[28:31], s63 offen lds
    s_add_u32 s63, s63, 65536
    s_mov_b32 m0, s62
    s_add_u32 s62, s62, 4096
    buffer_load_dwordx4 v4, s[28:31], s63 offen lds
    s_add_u32 s63, s63, 65536
    s_mov_b32 m0, s62
    s_add_u32 s62, s62, 4096
    buffer_load_dwordx4 v4, s[28:31], s63 offen lds
    s_add_u32 s63, s63, 65536
    s_mov_b32 m0, s62
    s_add_u32 s62, s62, 4096
    buffer_load_dwordx4 v4, s[28:31], s63 offen lds
    s_add_u32 s63, s63, 65536
    s_mov_b32 m0, s62
    s_add_u32 s62, s62, 4096
    buffer_load_dwordx4 v4, s[28:31], s63 offen lds
    s_add_u32 s63, s63, 65536
    s_mov_b32 m0, s62
    s_add_u32 s62, s62, 4096
    buffer_load_dwordx4 v4, s[28:31], s63 offen lds
    s_add_u32 s63, s63, 65536
    s_mov_b32 m0, s62
    s_add_u32 s62, s62, 4096
    buffer_load_dwordx4 v4, s[28:31], s63 offen lds
    s_add_u32 s63, s63, 65536
    s_mov_b32 m0, s62
    s_add_u32 s62, s62, 4096
    buffer_load_dwordx4 v4, s[28:31], s63 offen lds
    s_add_u32 s63, s63, 65536
    s_mov_b32 m0, s62
    s_add_u32 s62, s62, 4096
    buffer_load_dwordx4 v4, s[28:31], s63 offen lds
    s_add_u32 s63, s63, 65536
    s_mov_b32 m0, s62
    s_add_u32 s62, s62, 4096
    buffer_load_dwordx4 v4, s[28:31], s63 offen lds
    s_add_u32 s63, s63, 65536
    s_mov_b32 m0, s62
    s_add_u32 s62, s62, 4096
    buffer_load_dwordx4 v4, s[28:31], s63 offen lds
    s_add_u32 s63, s63, 65536
    s_mov_b32 m0, s62
    s_add_u32 s62, s62, 4096
    buffer_load_dwordx4 v4, s[28:31], s63 offen lds
    s_add_u32 s63, s63, 65536
    s_mov_b32 m0, s62
    s_add_u32 s62, s62, 4096
    buffer_load_dwordx4 v4, s[28:31], s63 offen lds
    s_add_u32 s63, s63, 65536
    s_mov_b32 m0, s62
    s_add_u32 s62, s62, 4096
    buffer_load_dwordx4 v4, s[28:31], s63 offen lds
    s_add_u32 s63, s63, 65536
    s_sub_u32 s48, s48, 2048
    v_subrev_u32 v4, 32768, v4
    s_sub_u32 s51, s51, 1
    s_cmp_lg_u32 s51, 0
    s_cbranch_scc1 S2_more
S2_now:
    s_cmp_lg_u32 s3, 0
    s_cbranch_scc1 WT_6
    s_lshl_b32 s52, s26, 7
    s_add_u32 s52, s52, 2048
    v_and_b32 v12, 15, v0
    v_lshlrev_b32 v12, 2, v12
    v_add_u32 v12, s52, v12
    s_lshr_b32 s52, s2, 5
    s_and_b32 s52, s52, 0
    s_lshl_b32 s52, s52, 13
    s_add_u32 s52, s52, 40960
    v_add_u32 v12, s52, v12
    s_mov_b32 s52, 0x40000
    s_sleep 22
POLL_7:
    s_sleep 8
    buffer_load_dword v13, v12, s[64:67], 0 offen sc1
    s_waitcnt vmcnt(0)
    v_cmp_ne_u32 vcc, s10, v13
    s_sub_u32 s52, s52, 1
    s_cbranch_scc1 WT_6
    s_cbranch_vccnz POLL_7
WT_6:
    s_barrier
    buffer_load_dwordx4 a[0:3], v3, s[36:39], s50 offen offset:0 sc1
    buffer_load_dwordx4 a[4:7], v3, s[36:39], s50 offen offset:256 sc1
    s_add_u32 s50, s50, 2048
    buffer_load_dwordx4 a[8:11], v3, s[36:39], s50 offen offset:0 sc1
    buffer_load_dwordx4 a[12:15], v3, s[36:39], s50 offen offset:256 sc1
    s_add_u32 s50, s50, 2048
    buffer_load_dwordx4 a[16:19], v3, s[36:39], s50 offen offset:0 sc1
    buffer_load_dwordx4 a[20:23], v3, s[36:39], s50 offen offset:256 sc1
    s_add_u32 s50, s50, 2048
    buffer_load_dwordx4 a[24:27], v3, s[36:39], s50 offen offset:0 sc1
    buffer_load_dwordx4 a[28:31], v3, s[36:39], s50 offen offset:256 sc1
    s_add_u32 s50, s50, 2048
    buffer_load_dwordx4 a[32:35], v3, s[36:39], s50 offen offset:0 sc1
    buffer_load_dwordx4 a[36:39], v3, s[36:39], s50 offen offset:256 sc1
    s_add_u32 s50, s50, 2048
    buffer_load_dwordx4 a[40:43], v3, s[36:39], s50 offen offset:0 sc1
    buffer_load_dwordx4 a[44:47], v3, s[36:39], s50 offen offset:256 sc1
    s_add_u32 s50, s50, 2048
    s_waitcnt vmcnt(12)
    s_barrier
    ds_read_b64_tr_b16 a[64:65], v5 offset:0
    ds_read_b64_tr_b16 a[66:67], v5 offset:512
    ds_read_b64_tr_b16 a[68:69], v6 offset:0
    ds_read_b64_tr_b16 a[70:71], v6 offset:512
    ds_read_b64_tr_b16 a[72:73], v7 offset:0
    ds_read_b64_tr_b16 a[74:75], v7 offset:512
    ds_read_b64_tr_b16 a[76:77], v8 offset:0
    ds_read_b64_tr_b16 a[78:79], v8 offset:512
    ds_read_b64_tr_b16 a[80:81], v5 offset:4096
    ds_read_b64_tr_b16 a[82:83], v5 offset:4608
    ds_read_b64_tr_b16 a[84:85], v6 offset:4096
    ds_read_b64_tr_b16 a[86:87], v6 offset:4608
    s_waitcnt vmcnt(10) lgkmcnt(8)
    v_mfma_f32_16x16x32_bf16 v[32:35], a[64:67], a[0:3], v[32:35]
    ds_read_b64_tr_b16 a[88:89], v7 offset:4096
    v_mfma_f32_16x16x32_bf16 v[36:39], a[64:67], a[4:7], v[36:39]
    ds_read_b64_tr_b16 a[90:91], v7 offset:4608
    v_mfma_f32_16x16x32_bf16 v[44:47], a[68:71], a[4:7], v[44:47]
    ds_read_b64_tr_b16 a[92:93], v8 offset:4096
    buffer_load_dwordx4 a[48:51], v3, s[36:39], s50 offen offset:0 sc1
    v_mfma_f32_16x16x32_bf16 v[40:43], a[68:71], a[0:3], v[40:43]
    ds_read_b64_tr_b16 a[94:95], v8 offset:4608
    s_waitcnt lgkmcnt(8)
    v_mfma_f32_16x16x32_bf16 v[48:51], a[72:75], a[0:3], v[48:51]
    ds_read_b64_tr_b16 a[64:65], v5 offset:8192
    v_mfma_f32_16x16x32_bf16 v[52:55], a[72:75], a[4:7], v[52:55]
    ds_read_b64_tr_b16 a[66:67], v5 offset:8704
    v_mfma_f32_16x16x32_bf16 v[60:63], a[76:79], a[4:7], v[60:63]
    ds_read_b64_tr_b16 a[68:69], v6 offset:8192
    buffer_load_dwordx4 a[52:55], v3, s[36:39], s50 offen offset:256 sc1
    v_mfma_f32_16x16x32_bf16 v[56:59], a[76:79], a[0:3], v[56:59]
    ds_read_b64_tr_b16 a[70:71], v6 offset:8704
    s_add_u32 s50, s50, 2048
    s_waitcnt vmcnt(10) lgkmcnt(8)
    v_mfma_f32_16x16x32_bf16 v[32:35], a[80:83], a[8:11], v[32:35]
    ds_read_b64_tr_b16 a[72:73], v7 offset:8192
    v_mfma_f32_16x16x32_bf16 v[36:39], a[80:83], a[12:15], v[36:39]
    ds_read_b64_tr_b16 a[74:75], v7 offset:8704
    v_mfma_f32_16x16x32_bf16 v[44:47], a[84:87], a[12:15], v[44:47]
    ds_read_b64_tr_b16 a[76:77], v8 offset:8192
    buffer_load_dwordx4 a[56:59], v3, s[36:39], s50 offen offset:0 sc1
    v_mfma_f32_16x16x32_bf16 v[40:43], a[84:87], a[8:11], v[40:43]
    ds_read_b64_tr_b16 a[78:79], v8 offset:8704
    s_waitcnt lgkmcnt(8)
    v_mfma_f32_16x16x32_bf16 v[48:51], a[88:91], a[8:11], v[48:51]
    ds_read_b64_tr_b16 a[80:81], v5 offset:12288
    v_mfma_f32_16x16x32_bf16 v[52:55], a[88:91], a[12:15], v[52:55]
    ds_read_b64_tr_b16 a[82:83], v5 offset:12800
    v_mfma_f32_16x16x32_bf16 v[60:63], a[92:95], a[12:15], v[60:63]
    ds_read_b64_tr_b16 a[84:85], v6 offset:12288
    buffer_load_dwordx4 a[60:63], v3, s[36:39], s50 offen offset:256 sc1
    v_mfma_f32_16x16x32_bf16 v[56:59], a[92:95], a[8:11], v[56:59]
    ds_read_b64_tr_b16 a[86:87], v6 offset:12800
    s_add_u32 s50, s50, 2048
    s_waitcnt vmcnt(10) lgkmcnt(8)
    v_mfma_f32_16x16x32_bf16 v[32:35], a[64:67], a[16:19], v[32:35]
    ds_read_b64_tr_b16 a[88:89], v7 offset:12288
    v_mfma_f32_16x16x32_bf16 v[36:39], a[64:67], a[20:23], v[36:39]
    ds_read_b64_tr_b16 a[90:91], v7 offset:12800
    v_mfma_f32_16x16x32_bf16 v[44:47], a[68:71], a[20:23], v[44:47]
    ds_read_b64_tr_b16 a[92:93], v8 offset:12288
    buffer_load_dwordx4 a[0:3], v3, s[36:39], s50 offen offset:0 sc1
    v_mfma_f32_16x16x32_bf16 v[40:43], a[68:71], a[16:19], v[40:43]
    ds_read_b64_tr_b16 a[94:95], v8 offset:12800
    s_waitcnt lgkmcnt(8)
    v_mfma_f32_16x16x32_bf16 v[48:51], a[72:75], a[16:19], v[48:51]
    ds_read_b64_tr_b16 a[64:65], v5 offset:16384
    v_mfma_f32_16x16x32_bf16 v[52:55], a[72:75], a[20:23], v[52:55]
    ds_read_b64_tr_b16 a[66:67], v5 offset:16896
    v_mfma_f32_16x16x32_bf16 v[60:63], a[76:79], a[20:23], v[60:63]
    ds_read_b64_tr_b16 a[68:69], v6 offset:16384
    buffer_load_dwordx4 a[4:7], v3, s[36:39], s50 offen offset:256 sc1
    v_mfma_f32_16x16x32_bf16 v[56:59], a[76:79], a[16:19], v[56:59]
    ds_read_b64_tr_b16 a[70:71], v6 offset:16896
    s_add_u32 s50, s50, 2048
    s_waitcnt vmcnt(10) lgkmcnt(8)
    v_mfma_f32_16x16x32_bf16 v[32:35], a[80:83], a[24:27], v[32:35]
    ds_read_b64_tr_b16 a[72:73], v7 offset:16384
    v_mfma_f32_16x16x32_bf16 v[36:39], a[80:83], a[28:31], v[36:39]
    ds_read_b64_tr_b16 a[74:75], v7 offset:16896
    v_mfma_f32_16x16x32_bf16 v[44:47], a[84:87], a[28:31], v[44:47]
    ds_read_b64_tr_b16 a[76:77], v8 offset:16384
    buffer_load_dwordx4 a[8:11], v3, s[36:39], s50 offen offset:0 sc1
    v_mfma_f32_16x16x32_bf16 v[40:43], a[84:87], a[24:27], v[40:43]
    ds_read_b64_tr_b16 a[78:79], v8 offset:16896
    s_waitcnt lgkmcnt(8)
    v_mfma_f32_16x16x32_bf16 v[48:51], a[88:91], a[24:27], v[48:51]
    ds_read_b64_tr_b16 a[80:81], v5 offset:20480
    v_mfma_f32_16x16x32_bf16 v[52:55], a[88:91], a[28:31], v[52:55]
    ds_read_b64_tr_b16 a[82:83], v5 offset:20992
    v_mfma_f32_16x16x32_bf16 v[60:63], a[92:95], a[28:31], v[60:63]
    ds_read_b64_tr_b16 a[84:85], v6 offset:20480
    buffer_load_dwordx4 a[12:15], v3, s[36:39], s50 offen offset:256 sc1
    v_mfma_f32_16x16x32_bf16 v[56:59], a[92:95], a[24:27], v[56:59]
    ds_read_b64_tr_b16 a[86:87], v6 offset:20992
    s_add_u32 s50, s50, 2048
    s_waitcnt vmcnt(10) lgkmcnt(8)
    v_mfma_f32_16x16x32_bf16 v[32:35], a[64:67], a[32:35], v[32:35]
    ds_read_b64_tr_b16 a[88:89], v7 offset:20480
    v_mfma_f32_16x16x32_bf16 v[36:39], a[64:67], a[36:39], v[36:39]
    ds_read_b64_tr_b16 a[90:91], v7 offset:20992
    v_mfma_f32_16x16x32_bf16 v[44:47], a[68:71], a[36:39], v[44:47]
    ds_read_b64_tr_b16 a[92:93], v8 offset:20480
    buffer_load_dwordx4 a[16:19], v3, s[36:39], s50 offen offset:0 sc1
    v_mfma_f32_16x16x32_bf16 v[40:43], a[68:71], a[32:35], v[40:43]
    ds_read_b64_tr_b16 a[94:95], v8 offset:20992
    s_waitcnt lgkmcnt(8)
    v_mfma_f32_16x16x32_bf16 v[48:51], a[72:75], a[32:35], v[48:51]
    ds_read_b64_tr_b16 a[64:65], v5 offset:24576
    v_mfma_f32_16x16x32_bf16 v[52:55], a[72:75], a[36:39], v[52:55]
    ds_read_b64_tr_b16 a[66:67], v5 offset:25088
    v_mfma_f32_16x16x32_bf16 v[60:63], a[76:79], a[36:39], v[60:63]
    ds_read_b64_tr_b16 a[68:69], v6 offset:24576
    buffer_load_dwordx4 a[20:23], v3, s[36:39], s50 offen offset:256 sc1
    v_mfma_f32_16x16x32_bf16 v[56:59], a[76:79], a[32:35], v[56:59]
    ds_read_b64_tr_b16 a[70:71], v6 offset:25088
    s_add_u32 s50, s50, 2048
    s_waitcnt vmcnt(10) lgkmcnt(8)
    v_mfma_f32_16x16x32_bf16 v[32:35], a[80:83], a[40:43], v[32:35]
    ds_read_b64_tr_b16 a[72:73], v7 offset:24576
    v_mfma_f32_16x16x32_bf16 v[36:39], a[80:83], a[44:47], v[36:39]
    ds_read_b64_tr_b16 a[74:75], v7 offset:25088
    v_mfma_f32_16x16x32_bf16 v[44:47], a[84:87], a[44:47], v[44:47]
    ds_read_b64_tr_b16 a[76:77], v8 offset:24576
    buffer_load_dwordx4 a[24:27], v3, s[36:39], s50 offen offset:0 sc1
    v_mfma_f32_16x16x32_bf16 v[40:43], a[84:87], a[40:43], v[40:43]
    ds_read_b64_tr_b16 a[78:79], v8 offset:25088
    s_waitcnt lgkmcnt(8)
    v_mfma_f32_16x16x32_bf16 v[48:51], a[88:91], a[40:43], v[48:51]
    ds_read_b64_tr_b16 a[80:81], v5 offset:28672
    v_mfma_f32_16x16x32_bf16 v[52:55], a[88:91], a[44:47], v[52:55]
    ds_read_b64_tr_b16 a[82:83], v5 offset:29184
    v_mfma_f32_16x16x32_bf16 v[60:63], a[92:95], a[44:47], v[60:63]
    ds_read_b64_tr_b16 a[84:85], v6 offset:28672
    buffer_load_dwordx4 a[28:31], v3, s[36:39], s50 offen offset:256 sc1
    v_mfma_f32_16x16x32_bf16 v[56:59], a[92:95], a[40:43], v[56:59]
    ds_read_b64_tr_b16 a[86:87], v6 offset:29184
    s_add_u32 s50, s50, 2048
    s_waitcnt vmcnt(10) lgkmcnt(8)
    v_mfma_f32_16x16x32_bf16 v[32:35], a[64:67], a[48:51], v[32:35]
    ds_read_b64_tr_b16 a[88:89], v7 offset:28672
    v_mfma_f32_16x16x32_bf16 v[36:39], a[64:67], a[52:55], v[36:39]
    ds_read_b64_tr_b16 a[90:91], v7 offset:29184
    v_mfma_f32_16x16x32_bf16 v[44:47], a[68:71], a[52:55], v[44:47]
    ds_read_b64_tr_b16 a[92:93], v8 offset:28672
    buffer_load_dwordx4 a[32:35], v3, s[36:39], s50 offen offset:0 sc1
    v_mfma_f32_16x16x32_bf16 v[40:43], a[68:71], a[48:51], v[40:43]
    ds_read_b64_tr_b16 a[94:95], v8 offset:29184
    s_waitcnt lgkmcnt(8)
    v_mfma_f32_16x16x32_bf16 v[48:51], a[72:75], a[48:51], v[48:51]
    ds_read_b64_tr_b16 a[64:65], v5 offset:32768
    v_mfma_f32_16x16x32_bf16 v[52:55], a[72:75], a[52:55], v[52:55]
    ds_read_b64_tr_b16 a[66:67], v5 offset:33280
    v_mfma_f32_16x16x32_bf16 v[60:63], a[76:79], a[52:55], v[60:63]
    ds_read_b64_tr_b16 a[68:69], v6 offset:32768
    buffer_load_dwordx4 a[36:39], v3, s[36:39], s50 offen offset:256 sc1
    v_mfma_f32_16x16x32_bf16 v[56:59], a[76:79], a[48:51], v[56:59]
    ds_read_b64_tr_b16 a[70:71], v6 offset:33280
    s_add_u32 s50, s50, 2048
    s_waitcnt vmcnt(10) lgkmcnt(8)
    v_mfma_f32_16x16x32_bf16 v[32:35], a[80:83], a[56:59], v[32:35]
    ds_read_b64_tr_b16 a[72:73], v7 offset:32768
    v_mfma_f32_16x16x32_bf16 v[36:39], a[80:83], a[60:63], v[36:39]
    ds_read_b64_tr_b16 a[74:75], v7 offset:33280
    v_mfma_f32_16x16x32_bf16 v[44:47], a[84:87], a[60:63], v[44:47]
    ds_read_b64_tr_b16 a[76:77], v8 offset:32768
    buffer_load_dwordx4 a[40:43], v3, s[36:39], s50 offen offset:0 sc1
    v_mfma_f32_16x16x32_bf16 v[40:43], a[84:87], a[56:59], v[40:43]
    ds_read_b64_tr_b16 a[78:79], v8 offset:33280
    s_waitcnt lgkmcnt(8)
    v_mfma_f32_16x16x32_bf16 v[48:51], a[88:91], a[56:59], v[48:51]
    ds_read_b64_tr_b16 a[80:81], v5 offset:36864
    v_mfma_f32_16x16x32_bf16 v[52:55], a[88:91], a[60:63], v[52:55]
    ds_read_b64_tr_b16 a[82:83], v5 offset:37376
    v_mfma_f32_16x16x32_bf16 v[60:63], a[92:95], a[60:63], v[60:63]
    ds_read_b64_tr_b16 a[84:85], v6 offset:36864
    buffer_load_dwordx4 a[44:47], v3, s[36:39], s50 offen offset:256 sc1
    v_mfma_f32_16x16x32_bf16 v[56:59], a[92:95], a[56:59], v[56:59]
    ds_read_b64_tr_b16 a[86:87], v6 offset:37376
    s_add_u32 s50, s50, 2048
    s_waitcnt vmcnt(10) lgkmcnt(8)
    v_mfma_f32_16x16x32_bf16 v[32:35], a[64:67], a[0:3], v[32:35]
    ds_read_b64_tr_b16 a[88:89], v7 offset:36864
    v_mfma_f32_16x16x32_bf16 v[36:39], a[64:67], a[4:7], v[36:39]
    ds_read_b64_tr_b16 a[90:91], v7 offset:37376
    v_mfma_f32_16x16x32_bf16 v[44:47], a[68:71], a[4:7], v[44:47]
    ds_read_b64_tr_b16 a[92:93], v8 offset:36864
    buffer_load_dwordx4 a[48:51], v3, s[36:39], s50 offen offset:0 sc1
    v_mfma_f32_16x16x32_bf16 v[40:43], a[68:71], a[0:3], v[40:43]
    ds_read_b64_tr_b16 a[94:95], v8 offset:37376
    s_waitcnt lgkmcnt(8)
    v_mfma_f32_16x16x32_bf16 v[48:51], a[72:75], a[0:3], v[48:51]
    ds_read_b64_tr_b16 a[64:65], v5 offset:40960
    v_mfma_f32_16x16x32_bf16 v[52:55], a[72:75], a[4:7], v[52:55]
    ds_read_b64_tr_b16 a[66:67], v5 offset:41472
    v_mfma_f32_16x16x32_bf16 v[60:63], a[76:79], a[4:7], v[60:63]
    ds_read_b64_tr_b16 a[68:69], v6 offset:40960
    buffer_load_dwordx4 a[52:55], v3, s[36:39], s50 offen offset:256 sc1
    v_mfma_f32_16x16x32_bf16 v[56:59], a[76:79], a[0:3], v[56:59]
    ds_read_b64_tr_b16 a[70:71], v6 offset:41472
    s_add_u32 s50, s50, 2048
    s_waitcnt vmcnt(10) lgkmcnt(8)
    v_mfma_f32_16x16x32_bf16 v[32:35], a[80:83], a[8:11], v[32:35]
    ds_read_b64_tr_b16 a[72:73], v7 offset:40960
    v_mfma_f32_16x16x32_bf16 v[36:39], a[80:83], a[12:15], v[36:39]
    ds_read_b64_tr_b16 a[74:75], v7 offset:41472
    v_mfma_f32_16x16x32_bf16 v[44:47], a[84:87], a[12:15], v[44:47]
    ds_read_b64_tr_b16 a[76:77], v8 offset:40960
    buffer_load_dwordx4 a[56:59], v3, s[36:39], s50 offen offset:0 sc1
    v_mfma_f32_16x16x32_bf16 v[40:43], a[84:87], a[8:11], v[40:43]
    ds_read_b64_tr_b16 a[78:79], v8 offset:41472
    s_waitcnt lgkmcnt(8)
    v_mfma_f32_16x16x32_bf16 v[48:51], a[88:91], a[8:11], v[48:51]
    ds_read_b64_tr_b16 a[80:81], v5 offset:45056
    v_mfma_f32_16x16x32_bf16 v[52:55], a[88:91], a[12:15], v[52:55]
    ds_read_b64_tr_b16 a[82:83], v5 offset:45568
    v_mfma_f32_16x16x32_bf16 v[60:63], a[92:95], a[12:15], v[60:63]
    ds_read_b64_tr_b16 a[84:85], v6 offset:45056
    buffer_load_dwordx4 a[60:63], v3, s[36:39], s50 offen offset:256 sc1
    v_mfma_f32_16x16x32_bf16 v[56:59], a[92:95], a[8:11], v[56:59]
    ds_read_b64_tr_b16 a[86:87], v6 offset:45568
    s_add_u32 s50, s50, 2048
    s_waitcnt vmcnt(10) lgkmcnt(8)
    v_mfma_f32_16x16x32_bf16 v[32:35], a[64:67], a[16:19], v[32:35]
    ds_read_b64_tr_b16 a[88:89], v7 offset:45056
    v_mfma_f32_16x16x32_bf16 v[36:39], a[64:67], a[20:23], v[36:39]
    ds_read_b64_tr_b16 a[90:91], v7 offset:45568
    v_mfma_f32_16x16x32_bf16 v[44:47], a[68:71], a[20:23], v[44:47]
    ds_read_b64_tr_b16 a[92:93], v8 offset:45056
    buffer_load_dwordx4 a[0:3], v3, s[36:39], s50 offen offset:0 sc1
    v_mfma_f32_16x16x32_bf16 v[40:43], a[68:71], a[16:19], v[40:43]
    ds_read_b64_tr_b16 a[94:95], v8 offset:45568
    s_waitcnt lgkmcnt(8)
    v_mfma_f32_16x16x32_bf16 v[48:51], a[72:75], a[16:19], v[48:51]
    ds_read_b64_tr_b16 a[64:65], v5 offset:49152
    v_mfma_f32_16x16x32_bf16 v[52:55], a[72:75], a[20:23], v[52:55]
    ds_read_b64_tr_b16 a[66:67], v5 offset:49664
    v_mfma_f32_16x16x32_bf16 v[60:63], a[76:79], a[20:23], v[60:63]
    ds_read_b64_tr_b16 a[68:69], v6 offset:49152
    buffer_load_dwordx4 a[4:7], v3, s[36:39], s50 offen offset:256 sc1
    v_mfma_f32_16x16x32_bf16 v[56:59], a[76:79], a[16:19], v[56:59]
    ds_read_b64_tr_b16 a[70:71], v6 offset:49664
    s_add_u32 s50, s50, 2048
    s_waitcnt vmcnt(10) lgkmcnt(8)
    v_mfma_f32_16x16x32_bf16 v[32:35], a[80:83], a[24:27], v[32:35]
    ds_read_b64_tr_b16 a[72:73], v7 offset:49152
    v_mfma_f32_16x16x32_bf16 v[36:39], a[80:83], a[28:31], v[36:39]
    ds_read_b64_tr_b16 a[74:75], v7 offset:49664
    v_mfma_f32_16x16x32_bf16 v[44:47], a[84:87], a[28:31], v[44:47]
    ds_read_b64_tr_b16 a[76:77], v8 offset:49152
    buffer_load_dwordx4 a[8:11], v3, s[36:39], s50 offen offset:0 sc1
    v_mfma_f32_16x16x32_bf16 v[40:43], a[84:87], a[24:27], v[40:43]
    ds_read_b64_tr_b16 a[78:79], v8 offset:49664
    s_waitcnt lgkmcnt(8)
    v_mfma_f32_16x16x32_bf16 v[48:51], a[88:91], a[24:27], v[48:51]
    ds_read_b64_tr_b16 a[80:81], v5 offset:53248
    v_mfma_f32_16x16x32_bf16 v[52:55], a[88:91], a[28:31], v[52:55]
    ds_read_b64_tr_b16 a[82:83], v5 offset:53760
    v_mfma_f32_16x16x32_bf16 v[60:63], a[92:95], a[28:31], v[60:63]
    ds_read_b64_tr_b16 a[84:85], v6 offset:53248
    buffer_load_dwordx4 a[12:15], v3, s[36:39], s50 offen offset:256 sc1
    v_mfma_f32_16x16x32_bf16 v[56:59], a[92:95], a[24:27], v[56:59]
    ds_read_b64_tr_b16 a[86:87], v6 offset:53760
    s_add_u32 s50, s50, 2048
    s_waitcnt vmcnt(10) lgkmcnt(8)
    v_mfma_f32_16x16x32_bf16 v[32:35], a[64:67], a[32:35], v[32:35]
    ds_read_b64_tr_b16 a[88:89], v7 offset:53248
    v_mfma_f32_16x16x32_bf16 v[36:39], a[64:67], a[36:39], v[36:39]
    ds_read_b64_tr_b16 a[90:91], v7 offset:53760
    v_mfma_f32_16x16x32_bf16 v[44:47], a[68:71], a[36:39], v[44:47]
    ds_read_b64_tr_b16 a[92:93], v8 offset:53248
    buffer_load_dwordx4 a[16:19], v3, s[36:39], s50 offen offset:0 sc1
    v_mfma_f32_16x16x32_bf16 v[40:43], a[68:71], a[32:35], v[40:43]
    ds_read_b64_tr_b16 a[94:95], v8 offset:53760
    s_waitcnt lgkmcnt(8)
    v_mfma_f32_16x16x32_bf16 v[48:51], a[72:75], a[32:35], v[48:51]
    ds_read_b64_tr_b16 a[64:65], v5 offset:57344
    v_mfma_f32_16x16x32_bf16 v[52:55], a[72:75], a[36:39], v[52:55]
    ds_read_b64_tr_b16 a[66:67], v5 offset:57856
    v_mfma_f32_16x16x32_bf16 v[60:63], a[76:79], a[36:39], v[60:63]
    ds_read_b64_tr_b16 a[68:69], v6 offset:57344
    buffer_load_dwordx4 a[20:23], v3, s[36:39], s50 offen offset:256 sc1
    v_mfma_f32_16x16x32_bf16 v[56:59], a[76:79], a[32:35], v[56:59]
    ds_read_b64_tr_b16 a[70:71], v6 offset:57856
    s_add_u32 s50, s50, 2048
    s_waitcnt vmcnt(10) lgkmcnt(8)
    v_mfma_f32_16x16x32_bf16 v[32:35], a[80:83], a[40:43], v[32:35]
    ds_read_b64_tr_b16 a[72:73], v7 offset:57344
    v_mfma_f32_16x16x32_bf16 v[36:39], a[80:83], a[44:47], v[36:39]
    ds_read_b64_tr_b16 a[74:75], v7 offset:57856
    v_mfma_f32_16x16x32_bf16 v[44:47], a[84:87], a[44:47], v[44:47]
    ds_read_b64_tr_b16 a[76:77], v8 offset:57344
    buffer_load_dwordx4 a[24:27], v3, s[36:39], s50 offen offset:0 sc1
    v_mfma_f32_16x16x32_bf16 v[40:43], a[84:87], a[40:43], v[40:43]
    ds_read_b64_tr_b16 a[78:79], v8 offset:57856
    s_waitcnt lgkmcnt(8)
    v_mfma_f32_16x16x32_bf16 v[48:51], a[88:91], a[40:43], v[48:51]
    ds_read_b64_tr_b16 a[80:81], v5 offset:61440
    v_mfma_f32_16x16x32_bf16 v[52:55], a[88:91], a[44:47], v[52:55]
    ds_read_b64_tr_b16 a[82:83], v5 offset:61952
    v_mfma_f32_16x16x32_bf16 v[60:63], a[92:95], a[44:47], v[60:63]
    ds_read_b64_tr_b16 a[84:85], v6 offset:61440
    buffer_load_dwordx4 a[28:31], v3, s[36:39], s50 offen offset:256 sc1
    v_mfma_f32_16x16x32_bf16 v[56:59], a[92:95], a[40:43], v[56:59]
    ds_read_b64_tr_b16 a[86:87], v6 offset:61952
    s_add_u32 s50, s50, 2048
    s_waitcnt vmcnt(10) lgkmcnt(8)
    v_mfma_f32_16x16x32_bf16 v[32:35], a[64:67], a[48:51], v[32:35]
    ds_read_b64_tr_b16 a[88:89], v7 offset:61440
    v_mfma_f32_16x16x32_bf16 v[36:39], a[64:67], a[52:55], v[36:39]
    ds_read_b64_tr_b16 a[90:91], v7 offset:61952
    v_mfma_f32_16x16x32_bf16 v[44:47], a[68:71], a[52:55], v[44:47]
    ds_read_b64_tr_b16 a[92:93], v8 offset:61440
    buffer_load_dwordx4 a[32:35], v3, s[36:39], s50 offen offset:0 sc1
    v_mfma_f32_16x16x32_bf16 v[40:43], a[68:71], a[48:51], v[40:43]
    ds_read_b64_tr_b16 a[94:95], v8 offset:61952
    s_waitcnt lgkmcnt(8)
    v_mfma_f32_16x16x32_bf16 v[48:51], a[72:75], a[48:51], v[48:51]
    ds_read_b64_tr_b16 a[64:65], v144 offset:0
    v_mfma_f32_16x16x32_bf16 v[52:55], a[72:75], a[52:55], v[52:55]
    ds_read_b64_tr_b16 a[66:67], v144 offset:512
    v_mfma_f32_16x16x32_bf16 v[60:63], a[76:79], a[52:55], v[60:63]
    ds_read_b64_tr_b16 a[68:69], v145 offset:0
    buffer_load_dwordx4 a[36:39], v3, s[36:39], s50 offen offset:256 sc1
    v_mfma_f32_16x16x32_bf16 v[56:59], a[76:79], a[48:51], v[56:59]
    ds_read_b64_tr_b16 a[70:71], v145 offset:512
    s_add_u32 s50, s50, 2048
    s_waitcnt vmcnt(10) lgkmcnt(8)
    v_mfma_f32_16x16x32_bf16 v[32:35], a[80:83], a[56:59], v[32:35]
    ds_read_b64_tr_b16 a[72:73], v146 offset:0
    v_mfma_f32_16x16x32_bf16 v[36:39], a[80:83], a[60:63], v[36:39]
    ds_read_b64_tr_b16 a[74:75], v146 offset:512
    v_mfma_f32_16x16x32_bf16 v[44:47], a[84:87], a[60:63], v[44:47]
    ds_read_b64_tr_b16 a[76:77], v147 offset:0
    buffer_load_dwordx4 a[40:43], v3, s[36:39], s50 offen offset:0 sc1
    v_mfma_f32_16x16x32_bf16 v[40:43], a[84:87], a[56:59], v[40:43]
    ds_read_b64_tr_b16 a[78:79], v147 offset:512
    s_waitcnt lgkmcnt(8)
    v_mfma_f32_16x16x32_bf16 v[48:51], a[88:91], a[56:59], v[48:51]
    ds_read_b64_tr_b16 a[80:81], v144 offset:4096
    v_mfma_f32_16x16x32_bf16 v[52:55], a[88:91], a[60:63], v[52:55]
    ds_read_b64_tr_b16 a[82:83], v144 offset:4608
    v_mfma_f32_16x16x32_bf16 v[60:63], a[92:95], a[60:63], v[60:63]
    ds_read_b64_tr_b16 a[84:85], v145 offset:4096
    buffer_load_dwordx4 a[44:47], v3, s[36:39], s50 offen offset:256 sc1
    v_mfma_f32_16x16x32_bf16 v[56:59], a[92:95], a[56:59], v[56:59]
    ds_read_b64_tr_b16 a[86:87], v145 offset:4608
    s_add_u32 s50, s50, 2048
    s_waitcnt vmcnt(10) lgkmcnt(8)
    v_mfma_f32_16x16x32_bf16 v[32:35], a[64:67], a[0:3], v[32:35]
    ds_read_b64_tr_b16 a[88:89], v146 offset:4096
    v_mfma_f32_16x16x32_bf16 v[36:39], a[64:67], a[4:7], v[36:39]
    ds_read_b64_tr_b16 a[90:91], v146 offset:4608
    v_mfma_f32_16x16x32_bf16 v[44:47], a[68:71], a[4:7], v[44:47]
    ds_read_b64_tr_b16 a[92:93], v147 offset:4096
    buffer_load_dwordx4 a[48:51], v3, s[36:39], s50 offen offset:0 sc1
    v_mfma_f32_16x16x32_bf16 v[40:43], a[68:71], a[0:3], v[40:43]
    ds_read_b64_tr_b16 a[94:95], v147 offset:4608
    s_waitcnt lgkmcnt(8)
    v_mfma_f32_16x16x32_bf16 v[48:51], a[72:75], a[0:3], v[48:51]
    ds_read_b64_tr_b16 a[64:65], v144 offset:8192
    v_mfma_f32_16x16x32_bf16 v[52:55], a[72:75], a[4:7], v[52:55]
    ds_read_b64_tr_b16 a[66:67], v144 offset:8704
    v_mfma_f32_16x16x32_bf16 v[60:63], a[76:79], a[4:7], v[60:63]
    ds_read_b64_tr_b16 a[68:69], v145 offset:8192
    buffer_load_dwordx4 a[52:55], v3, s[36:39], s50 offen offset:256 sc1
    v_mfma_f32_16x16x32_bf16 v[56:59], a[76:79], a[0:3], v[56:59]
    ds_read_b64_tr_b16 a[70:71], v145 offset:8704
    s_add_u32 s50, s50, 2048
    s_waitcnt vmcnt(10) lgkmcnt(8)
    v_mfma_f32_16x16x32_bf16 v[32:35], a[80:83], a[8:11], v[32:35]
    ds_read_b64_tr_b16 a[72:73], v146 offset:8192
    v_mfma_f32_16x16x32_bf16 v[36:39], a[80:83], a[12:15], v[36:39]
    ds_read_b64_tr_b16 a[74:75], v146 offset:8704
    v_mfma_f32_16x16x32_bf16 v[44:47], a[84:87], a[12:15], v[44:47]
    ds_read_b64_tr_b16 a[76:77], v147 offset:8192
    buffer_load_dwordx4 a[56:59], v3, s[36:39], s50 offen offset:0 sc1
    v_mfma_f32_16x16x32_bf16 v[40:43], a[84:87], a[8:11], v[40:43]
    ds_read_b64_tr_b16 a[78:79], v147 offset:8704
    s_waitcnt lgkmcnt(8)
    v_mfma_f32_16x16x32_bf16 v[48:51], a[88:91], a[8:11], v[48:51]
    ds_read_b64_tr_b16 a[80:81], v144 offset:12288
    v_mfma_f32_16x16x32_bf16 v[52:55], a[88:91], a[12:15], v[52:55]
    ds_read_b64_tr_b16 a[82:83], v144 offset:12800
    v_mfma_f32_16x16x32_bf16 v[60:63], a[92:95], a[12:15], v[60:63]
    ds_read_b64_tr_b16 a[84:85], v145 offset:12288
    buffer_load_dwordx4 a[60:63], v3, s[36:39], s50 offen offset:256 sc1
    v_mfma_f32_16x16x32_bf16 v[56:59], a[92:95], a[8:11], v[56:59]
    ds_read_b64_tr_b16 a[86:87], v145 offset:12800
    s_add_u32 s50, s50, 2048
    s_waitcnt vmcnt(10) lgkmcnt(8)
    v_mfma_f32_16x16x32_bf16 v[32:35], a[64:67], a[16:19], v[32:35]
    ds_read_b64_tr_b16 a[88:89], v146 offset:12288
    v_mfma_f32_16x16x32_bf16 v[36:39], a[64:67], a[20:23], v[36:39]
    ds_read_b64_tr_b16 a[90:91], v146 offset:12800
    v_mfma_f32_16x16x32_bf16 v[44:47], a[68:71], a[20:23], v[44:47]
    ds_read_b64_tr_b16 a[92:93], v147 offset:12288
    buffer_load_dwordx4 a[0:3], v3, s[36:39], s50 offen offset:0 sc1
    v_mfma_f32_16x16x32_bf16 v[40:43], a[68:71], a[16:19], v[40:43]
    ds_read_b64_tr_b16 a[94:95], v147 offset:12800
    s_waitcnt lgkmcnt(8)
    v_mfma_f32_16x16x32_bf16 v[48:51], a[72:75], a[16:19], v[48:51]
    ds_read_b64_tr_b16 a[64:65], v144 offset:16384
    v_mfma_f32_16x16x32_bf16 v[52:55], a[72:75], a[20:23], v[52:55]
    ds_read_b64_tr_b16 a[66:67], v144 offset:16896
    v_mfma_f32_16x16x32_bf16 v[60:63], a[76:79], a[20:23], v[60:63]
    ds_read_b64_tr_b16 a[68:69], v145 offset:16384
    buffer_load_dwordx4 a[4:7], v3, s[36:39], s50 offen offset:256 sc1
    v_mfma_f32_16x16x32_bf16 v[56:59], a[76:79], a[16:19], v[56:59]
    ds_read_b64_tr_b16 a[70:71], v145 offset:16896
    s_add_u32 s50, s50, 2048
    s_waitcnt vmcnt(10) lgkmcnt(8)
    v_mfma_f32_16x16x32_bf16 v[32:35], a[80:83], a[24:27], v[32:35]
    ds_read_b64_tr_b16 a[72:73], v146 offset:16384
    v_mfma_f32_16x16x32_bf16 v[36:39], a[80:83], a[28:31], v[36:39]
    ds_read_b64_tr_b16 a[74:75], v146 offset:16896
    v_mfma_f32_16x16x32_bf16 v[44:47], a[84:87], a[28:31], v[44:47]
    ds_read_b64_tr_b16 a[76:77], v147 offset:16384
    buffer_load_dwordx4 a[8:11], v3, s[36:39], s50 offen offset:0 sc1
    v_mfma_f32_16x16x32_bf16 v[40:43], a[84:87], a[24:27], v[40:43]
    ds_read_b64_tr_b16 a[78:79], v147 offset:16896
    s_waitcnt lgkmcnt(8)
    v_mfma_f32_16x16x32_bf16 v[48:51], a[88:91], a[24:27], v[48:51]
    ds_read_b64_tr_b16 a[80:81], v144 offset:20480
    v_mfma_f32_16x16x32_bf16 v[52:55], a[88:91], a[28:31], v[52:55]
    ds_read_b64_tr_b16 a[82:83], v144 offset:20992
    v_mfma_f32_16x16x32_bf16 v[60:63], a[92:95], a[28:31], v[60:63]
    ds_read_b64_tr_b16 a[84:85], v145 offset:20480
    buffer_load_dwordx4 a[12:15], v3, s[36:39], s50 offen offset:256 sc1
    v_mfma_f32_16x16x32_bf16 v[56:59], a[92:95], a[24:27], v[56:59]
    ds_read_b64_tr_b16 a[86:87], v145 offset:20992
    s_add_u32 s50, s50, 2048
    s_waitcnt vmcnt(10) lgkmcnt(8)
    v_mfma_f32_16x16x32_bf16 v[32:35], a[64:67], a[32:35], v[32:35]
    ds_read_b64_tr_b16 a[88:89], v146 offset:20480
    v_mfma_f32_16x16x32_bf16 v[36:39], a[64:67], a[36:39], v[36:39]
    ds_read_b64_tr_b16 a[90:91], v146 offset:20992
    v_mfma_f32_16x16x32_bf16 v[44:47], a[68:71], a[36:39], v[44:47]
    ds_read_b64_tr_b16 a[92:93], v147 offset:20480
    buffer_load_dwordx4 a[16:19], v3, s[36:39], s50 offen offset:0 sc1
    v_mfma_f32_16x16x32_bf16 v[40:43], a[68:71], a[32:35], v[40:43]
    ds_read_b64_tr_b16 a[94:95], v147 offset:20992
    s_waitcnt lgkmcnt(8)
    v_mfma_f32_16x16x32_bf16 v[48:51], a[72:75], a[32:35], v[48:51]
    ds_read_b64_tr_b16 a[64:65], v144 offset:24576
    v_mfma_f32_16x16x32_bf16 v[52:55], a[72:75], a[36:39], v[52:55]
    ds_read_b64_tr_b16 a[66:67], v144 offset:25088
    v_mfma_f32_16x16x32_bf16 v[60:63], a[76:79], a[36:39], v[60:63]
    ds_read_b64_tr_b16 a[68:69], v145 offset:24576
    buffer_load_dwordx4 a[20:23], v3, s[36:39], s50 offen offset:256 sc1
    v_mfma_f32_16x16x32_bf16 v[56:59], a[76:79], a[32:35], v[56:59]
    ds_read_b64_tr_b16 a[70:71], v145 offset:25088
    s_add_u32 s50, s50, 2048
    s_waitcnt vmcnt(10) lgkmcnt(8)
    v_mfma_f32_16x16x32_bf16 v[32:35], a[80:83], a[40:43], v[32:35]
    ds_read_b64_tr_b16 a[72:73], v146 offset:24576
    v_mfma_f32_16x16x32_bf16 v[36:39], a[80:83], a[44:47], v[36:39]
    ds_read_b64_tr_b16 a[74:75], v146 offset:25088
    v_mfma_f32_16x16x32_bf16 v[44:47], a[84:87], a[44:47], v[44:47]
    ds_read_b64_tr_b16 a[76:77], v147 offset:24576
    buffer_load_dwordx4 a[24:27], v3, s[36:39], s50 offen offset:0 sc1
    v_mfma_f32_16x16x32_bf16 v[40:43], a[84:87], a[40:43], v[40:43]
    ds_read_b64_tr_b16 a[78:79], v147 offset:25088
    s_waitcnt lgkmcnt(8)
    v_mfma_f32_16x16x32_bf16 v[48:51], a[88:91], a[40:43], v[48:51]
    ds_read_b64_tr_b16 a[80:81], v144 offset:28672
    v_mfma_f32_16x16x32_bf16 v[52:55], a[88:91], a[44:47], v[52:55]
    ds_read_b64_tr_b16 a[82:83], v144 offset:29184
    v_mfma_f32_16x16x32_bf16 v[60:63], a[92:95], a[44:47], v[60:63]
    ds_read_b64_tr_b16 a[84:85], v145 offset:28672
    buffer_load_dwordx4 a[28:31], v3, s[36:39], s50 offen offset:256 sc1
    v_mfma_f32_16x16x32_bf16 v[56:59], a[92:95], a[40:43], v[56:59]
    ds_read_b64_tr_b16 a[86:87], v145 offset:29184
    s_add_u32 s50, s50, 2048
    s_waitcnt vmcnt(10) lgkmcnt(8)
    v_mfma_f32_16x16x32_bf16 v[32:35], a[64:67], a[48:51], v[32:35]
    ds_read_b64_tr_b16 a[88:89], v146 offset:28672
    v_mfma_f32_16x16x32_bf16 v[36:39], a[64:67], a[52:55], v[36:39]
    ds_read_b64_tr_b16 a[90:91], v146 offset:29184
    v_mfma_f32_16x16x32_bf16 v[44:47], a[68:71], a[52:55], v[44:47]
    ds_read_b64_tr_b16 a[92:93], v147 offset:28672
    buffer_load_dwordx4 a[32:35], v3, s[36:39], s50 offen offset:0 sc1
    v_mfma_f32_16x16x32_bf16 v[40:43], a[68:71], a[48:51], v[40:43]
    ds_read_b64_tr_b16 a[94:95], v147 offset:29184
    s_waitcnt lgkmcnt(8)
    v_mfma_f32_16x16x32_bf16 v[48:51], a[72:75], a[48:51], v[48:51]
    ds_read_b64_tr_b16 a[64:65], v144 offset:32768
    v_mfma_f32_16x16x32_bf16 v[52:55], a[72:75], a[52:55], v[52:55]
    ds_read_b64_tr_b16 a[66:67], v144 offset:33280
    v_mfma_f32_16x16x32_bf16 v[60:63], a[76:79], a[52:55], v[60:63]
    ds_read_b64_tr_b16 a[68:69], v145 offset:32768
    buffer_load_dwordx4 a[36:39], v3, s[36:39], s50 offen offset:256 sc1
    v_mfma_f32_16x16x32_bf16 v[56:59], a[76:79], a[48:51], v[56:59]
    ds_read_b64_tr_b16 a[70:71], v145 offset:33280
    s_add_u32 s50, s50, 2048
    s_waitcnt vmcnt(10) lgkmcnt(8)
    v_mfma_f32_16x16x32_bf16 v[32:35], a[80:83], a[56:59], v[32:35]
    ds_read_b64_tr_b16 a[72:73], v146 offset:32768
    v_mfma_f32_16x16x32_bf16 v[36:39], a[80:83], a[60:63], v[36:39]
    ds_read_b64_tr_b16 a[74:75], v146 offset:33280
    v_mfma_f32_16x16x32_bf16 v[44:47], a[84:87], a[60:63], v[44:47]
    ds_read_b64_tr_b16 a[76:77], v147 offset:32768
    buffer_load_dwordx4 a[40:43], v3, s[36:39], s50 offen offset:0 sc1
    v_mfma_f32_16x16x32_bf16 v[40:43], a[84:87], a[56:59], v[40:43]
    ds_read_b64_tr_b16 a[78:79], v147 offset:33280
    s_waitcnt lgkmcnt(8)
    v_mfma_f32_16x16x32_bf16 v[48:51], a[88:91], a[56:59], v[48:51]
    ds_read_b64_tr_b16 a[80:81], v144 offset:36864
    v_mfma_f32_16x16x32_bf16 v[52:55], a[88:91], a[60:63], v[52:55]
    ds_read_b64_tr_b16 a[82:83], v144 offset:37376
    v_mfma_f32_16x16x32_bf16 v[60:63], a[92:95], a[60:63], v[60:63]
    ds_read_b64_tr_b16 a[84:85], v145 offset:36864
    buffer_load_dwordx4 a[44:47], v3, s[36:39], s50 offen offset:256 sc1
    v_mfma_f32_16x16x32_bf16 v[56:59], a[92:95], a[56:59], v[56:59]
    ds_read_b64_tr_b16 a[86:87], v145 offset:37376
    s_add_u32 s50, s50, 2048
    s_waitcnt vmcnt(10) lgkmcnt(8)
    v_mfma_f32_16x16x32_bf16 v[32:35], a[64:67], a[0:3], v[32:35]
    ds_read_b64_tr_b16 a[88:89], v146 offset:36864
    buffer_load_dword v128, v9, s[32:35], s54 offen offset:0 sc1
    v_mfma_f32_16x16x32_bf16 v[36:39], a[64:67], a[4:7], v[36:39]
    ds_read_b64_tr_b16 a[90:91], v146 offset:37376
    s_add_u32 s54, s54, 8192
    v_mfma_f32_16x16x32_bf16 v[44:47], a[68:71], a[4:7], v[44:47]
    ds_read_b64_tr_b16 a[92:93], v147 offset:36864
    buffer_load_dwordx4 a[48:51], v3, s[36:39], s50 offen offset:0 sc1
    buffer_load_dword v129, v9, s[32:35], s54 offen offset:0 sc1
    v_mfma_f32_16x16x32_bf16 v[40:43], a[68:71], a[0:3], v[40:43]
    ds_read_b64_tr_b16 a[94:95], v147 offset:37376
    s_add_u32 s54, s54, 8192
    s_waitcnt lgkmcnt(8)
    v_mfma_f32_16x16x32_bf16 v[48:51], a[72:75], a[0:3], v[48:51]
    ds_read_b64_tr_b16 a[64:65], v144 offset:40960
    buffer_load_dword v130, v9, s[32:35], s54 offen offset:0 sc1
    v_mfma_f32_16x16x32_bf16 v[52:55], a[72:75], a[4:7], v[52:55]
    ds_read_b64_tr_b16 a[66:67], v144 offset:41472
    s_add_u32 s54, s54, 8192
    v_mfma_f32_16x16x32_bf16 v[60:63], a[76:79], a[4:7], v[60:63]
    ds_read_b64_tr_b16 a[68:69], v145 offset:40960
    buffer_load_dwordx4 a[52:55], v3, s[36:39], s50 offen offset:256 sc1
    buffer_load_dword v131, v9, s[32:35], s54 offen offset:0 sc1
    v_mfma_f32_16x16x32_bf16 v[56:59], a[76:79], a[0:3], v[56:59]
    ds_read_b64_tr_b16 a[70:71], v145 offset:41472
    s_add_u32 s50, s50, 2048
    s_add_u32 s54, s54, -24576
    s_waitcnt vmcnt(14) lgkmcnt(8)
    v_mfma_f32_16x16x32_bf16 v[32:35], a[80:83], a[8:11], v[32:35]
    ds_read_b64_tr_b16 a[72:73], v146 offset:40960
    buffer_load_dword v132, v9, s[32:35], s55 offen offset:0 sc1
    v_mfma_f32_16x16x32_bf16 v[36:39], a[80:83], a[12:15], v[36:39]
    ds_read_b64_tr_b16 a[74:75], v146 offset:41472
    s_add_u32 s55, s55, 8192
    v_mfma_f32_16x16x32_bf16 v[44:47], a[84:87], a[12:15], v[44:47]
    ds_read_b64_tr_b16 a[76:77], v147 offset:40960
    buffer_load_dwordx4 a[56:59], v3, s[36:39], s50 offen offset:0 sc1
    buffer_load_dword v133, v9, s[32:35], s55 offen offset:0 sc1
    v_mfma_f32_16x16x32_bf16 v[40:43], a[84:87], a[8:11], v[40:43]
    ds_read_b64_tr_b16 a[78:79], v147 offset:41472
    s_add_u32 s55, s55, 8192
    s_waitcnt lgkmcnt(8)
    v_mfma_f32_16x16x32_bf16 v[48:51], a[88:91], a[8:11], v[48:51]
    ds_read_b64_tr_b16 a[80:81], v144 offset:45056
    buffer_load_dword v134, v9, s[32:35], s55 offen offset:0 sc1
    v_mfma_f32_16x16x32_bf16 v[52:55], a[88:91], a[12:15], v[52:55]
    ds_read_b64_tr_b16 a[82:83], v144 offset:45568
    s_add_u32 s55, s55, 8192
    v_mfma_f32_16x16x32_bf16 v[60:63], a[92:95], a[12:15], v[60:63]
    ds_read_b64_tr_b16 a[84:85], v145 offset:45056
    buffer_load_dwordx4 a[60:63], v3, s[36:39], s50 offen offset:256 sc1
    buffer_load_dword v135, v9, s[32:35], s55 offen offset:0 sc1
    v_mfma_f32_16x16x32_bf16 v[56:59], a[92:95], a[8:11], v[56:59]
    ds_read_b64_tr_b16 a[86:87], v145 offset:45568
    s_add_u32 s50, s50, 2048
    s_add_u32 s55, s55, -24576
    s_waitcnt vmcnt(18) lgkmcnt(8)
    v_mfma_f32_16x16x32_bf16 v[32:35], a[64:67], a[16:19], v[32:35]
    ds_read_b64_tr_b16 a[88:89], v146 offset:45056
    buffer_load_dword v136, v9, s[32:35], s54 offen offset:64 sc1
    v_mfma_f32_16x16x32_bf16 v[36:39], a[64:67], a[20:23], v[36:39]
    ds_read_b64_tr_b16 a[90:91], v146 offset:45568
    s_add_u32 s54, s54, 8192
    v_mfma_f32_16x16x32_bf16 v[44:47], a[68:71], a[20:23], v[44:47]
    ds_read_b64_tr_b16 a[92:93], v147 offset:45056
    buffer_load_dword v137, v9, s[32:35], s54 offen offset:64 sc1
    v_mfma_f32_16x16x32_bf16 v[40:43], a[68:71], a[16:19], v[40:43]
    ds_read_b64_tr_b16 a[94:95], v147 offset:45568
    s_add_u32 s54, s54, 8192
    s_waitcnt lgkmcnt(8)
    v_mfma_f32_16x16x32_bf16 v[48:51], a[72:75], a[16:19], v[48:51]
    ds_read_b64_tr_b16 a[64:65], v144 offset:49152
    buffer_load_dword v138, v9, s[32:35], s54 offen offset:64 sc1
    v_mfma_f32_16x16x32_bf16 v[52:55], a[72:75], a[20:23], v[52:55]
    ds_read_b64_tr_b16 a[66:67], v144 offset:49664
    s_add_u32 s54, s54, 8192
    v_mfma_f32_16x16x32_bf16 v[60:63], a[76:79], a[20:23], v[60:63]
    ds_read_b64_tr_b16 a[68:69], v145 offset:49152
    buffer_load_dword v139, v9, s[32:35], s54 offen offset:64 sc1
    v_mfma_f32_16x16x32_bf16 v[56:59], a[76:79], a[16:19], v[56:59]
    ds_read_b64_tr_b16 a[70:71], v145 offset:49664
    s_add_u32 s54, s54, -24576
    s_waitcnt vmcnt(20) lgkmcnt(8)
    v_mfma_f32_16x16x32_bf16 v[32:35], a[80:83], a[24:27], v[32:35]
    ds_read_b64_tr_b16 a[72:73], v146 offset:49152
    buffer_load_dword v140, v9, s[32:35], s55 offen offset:64 sc1
    v_mfma_f32_16x16x32_bf16 v[36:39], a[80:83], a[28:31], v[36:39]
    ds_read_b64_tr_b16 a[74:75], v146 offset:49664
    s_add_u32 s55, s55, 8192
    v_mfma_f32_16x16x32_bf16 v[44:47], a[84:87], a[28:31], v[44:47]
    ds_read_b64_tr_b16 a[76:77], v147 offset:49152
    buffer_load_dword v141, v9, s[32:35], s55 offen offset:64 sc1
    v_mfma_f32_16x16x32_bf16 v[40:43], a[84:87], a[24:27], v[40:43]
    ds_read_b64_tr_b16 a[78:79], v147 offset:49664
    s_add_u32 s55, s55, 8192
    s_waitcnt lgkmcnt(8)
    v_mfma_f32_16x16x32_bf16 v[48:51], a[88:91], a[24:27], v[48:51]
    ds_read_b64_tr_b16 a[80:81], v144 offset:53248
    buffer_load_dword v142, v9, s[32:35], s55 offen offset:64 sc1
    v_mfma_f32_16x16x32_bf16 v[52:55], a[88:91], a[28:31], v[52:55]
    ds_read_b64_tr_b16 a[82:83], v144 offset:53760
    s_add_u32 s55, s55, 8192
    v_mfma_f32_16x16x32_bf16 v[60:63], a[92:95], a[28:31], v[60:63]
    ds_read_b64_tr_b16 a[84:85], v145 offset:53248
    buffer_load_dword v143, v9, s[32:35], s55 offen offset:64 sc1
    v_mfma_f32_16x16x32_bf16 v[56:59], a[92:95], a[24:27], v[56:59]
    ds_read_b64_tr_b16 a[86:87], v145 offset:53760
    s_add_u32 s55, s55, -24576
    s_waitcnt vmcnt(22) lgkmcnt(8)
    v_mfma_f32_16x16x32_bf16 v[32:35], a[64:67], a[32:35], v[32:35]
    ds_read_b64_tr_b16 a[88:89], v146 offset:53248
    v_mfma_f32_16x16x32_bf16 v[36:39], a[64:67], a[36:39], v[36:39]
    ds_read_b64_tr_b16 a[90:91], v146 offset:53760
    v_mfma_f32_16x16x32_bf16 v[44:47], a[68:71], a[36:39], v[44:47]
    ds_read_b64_tr_b16 a[92:93], v147 offset:53248
    v_mfma_f32_16x16x32_bf16 v[40:43], a[68:71], a[32:35], v[40:43]
    ds_read_b64_tr_b16 a[94:95], v147 offset:53760
    s_waitcnt lgkmcnt(8)
    v_mfma_f32_16x16x32_bf16 v[48:51], a[72:75], a[32:35], v[48:51]
    ds_read_b64_tr_b16 a[64:65], v144 offset:57344
    v_mfma_f32_16x16x32_bf16 v[52:55], a[72:75], a[36:39], v[52:55]
    ds_read_b64_tr_b16 a[66:67], v144 offset:57856
    v_mfma_f32_16x16x32_bf16 v[60:63], a[76:79], a[36:39], v[60:63]
    ds_read_b64_tr_b16 a[68:69], v145 offset:57344
    v_mfma_f32_16x16x32_bf16 v[56:59], a[76:79], a[32:35], v[56:59]
    ds_read_b64_tr_b16 a[70:71], v145 offset:57856
    s_waitcnt vmcnt(20) lgkmcnt(8)
    v_mfma_f32_16x16x32_bf16 v[32:35], a[80:83], a[40:43], v[32:35]
    ds_read_b64_tr_b16 a[72:73], v146 offset:57344
    v_mfma_f32_16x16x32_bf16 v[36:39], a[80:83], a[44:47], v[36:39]
    ds_read_b64_tr_b16 a[74:75], v146 offset:57856
    v_mfma_f32_16x16x32_bf16 v[44:47], a[84:87], a[44:47], v[44:47]
    ds_read_b64_tr_b16 a[76:77], v147 offset:57344
    v_mfma_f32_16x16x32_bf16 v[40:43], a[84:87], a[40:43], v[40:43]
    ds_read_b64_tr_b16 a[78:79], v147 offset:57856
    s_waitcnt lgkmcnt(8)
    v_mfma_f32_16x16x32_bf16 v[48:51], a[88:91], a[40:43], v[48:51]
    ds_read_b64_tr_b16 a[80:81], v144 offset:61440
    v_mfma_f32_16x16x32_bf16 v[52:55], a[88:91], a[44:47], v[52:55]
    ds_read_b64_tr_b16 a[82:83], v144 offset:61952
    v_mfma_f32_16x16x32_bf16 v[60:63], a[92:95], a[44:47], v[60:63]
    ds_read_b64_tr_b16 a[84:85], v145 offset:61440
    v_mfma_f32_16x16x32_bf16 v[56:59], a[92:95], a[40:43], v[56:59]
    ds_read_b64_tr_b16 a[86:87], v145 offset:61952
    s_waitcnt vmcnt(15) lgkmcnt(8)
    v_mfma_f32_16x16x32_bf16 v[32:35], a[64:67], a[48:51], v[32:35]
    ds_read_b64_tr_b16 a[88:89], v146 offset:61440
    v_mfma_f32_16x16x32_bf16 v[36:39], a[64:67], a[52:55], v[36:39]
    ds_read_b64_tr_b16 a[90:91], v146 offset:61952
    v_mfma_f32_16x16x32_bf16 v[44:47], a[68:71], a[52:55], v[44:47]
    ds_read_b64_tr_b16 a[92:93], v147 offset:61440
    v_mfma_f32_16x16x32_bf16 v[40:43], a[68:71], a[48:51], v[40:43]
    ds_read_b64_tr_b16 a[94:95], v147 offset:61952
    s_waitcnt lgkmcnt(8)
    v_mfma_f32_16x16x32_bf16 v[48:51], a[72:75], a[48:51], v[48:51]
    v_mfma_f32_16x16x32_bf16 v[52:55], a[72:75], a[52:55], v[52:55]
    v_mfma_f32_16x16x32_bf16 v[60:63], a[76:79], a[52:55], v[60:63]
    v_mfma_f32_16x16x32_bf16 v[56:59], a[76:79], a[48:51], v[56:59]
    s_waitcnt vmcnt(9) lgkmcnt(4)
    v_mfma_f32_16x16x32_bf16 v[32:35], a[80:83], a[56:59], v[32:35]
    v_mfma_f32_16x16x32_bf16 v[36:39], a[80:83], a[60:63], v[36:39]
    v_mfma_f32_16x16x32_bf16 v[44:47], a[84:87], a[60:63], v[44:47]
    v_mfma_f32_16x16x32_bf16 v[40:43], a[84:87], a[56:59], v[40:43]
    s_waitcnt lgkmcnt(0)
    v_mfma_f32_16x16x32_bf16 v[48:51], a[88:91], a[56:59], v[48:51]
    v_mfma_f32_16x16x32_bf16 v[52:55], a[88:91], a[60:63], v[52:55]
    v_mfma_f32_16x16x32_bf16 v[60:63], a[92:95], a[60:63], v[60:63]
    v_mfma_f32_16x16x32_bf16 v[56:59], a[92:95], a[56:59], v[56:59]
    s_waitcnt vmcnt(0)
    v_add_f32 v128, v128, v132
    v_add_f32 v129, v129, v133
    v_add_f32 v130, v130, v134
    v_add_f32 v131, v131, v135
    v_add_f32 v128, v128, v130
    v_add_f32 v129, v129, v131
    v_add_f32 v128, v128, v129
    v_add_f32 v136, v136, v140
    v_add_f32 v137, v137, v141
    v_add_f32 v138, v138, v142
    v_add_f32 v139, v139, v143
    v_add_f32 v136, v136, v138
    v_add_f32 v137, v137, v139
    v_add_f32 v136, v136, v137
    v_mov_b32 v129, v128
    v_mov_b32 v137, v136
    s_nop 0
    v_permlane16_swap_b32 v129, v128
    v_permlane16_swap_b32 v137, v136
    v_add_f32 v128, v129, v128
    v_add_f32 v136, v137, v136
    v_mov_b32 v129, v128
    v_mov_b32 v137, v136
    s_nop 0
    v_permlane32_swap_b32 v129, v128
    v_permlane32_swap_b32 v137, v136
    v_add_f32 v128, v129, v128
    v_add_f32 v136, v137, v136
    v_add_f32 v22, v22, v128
    v_add_f32 v24, v24, v136
    v_pk_add_f32 v[96:97], v[32:33], v[22:23] op_sel_hi:[1,0] neg_lo:[0,1] neg_hi:[0,1]
    v_pk_add_f32 v[98:99], v[34:35], v[22:23] op_sel_hi:[1,0] neg_lo:[0,1] neg_hi:[0,1]
    v_cvt_pk_bf16_f32 v72, v96, v97
    v_cvt_pk_bf16_f32 v73, v98, v99
    v_pk_add_f32 v[100:101], v[36:37], v[24:25] op_sel_hi:[1,0] neg_lo:[0,1] neg_hi:[0,1]
    v_pk_add_f32 v[102:103], v[38:39], v[24:25] op_sel_hi:[1,0] neg_lo:[0,1] neg_hi:[0,1]
    v_cvt_pk_bf16_f32 v74, v100, v101
    v_cvt_pk_bf16_f32 v75, v102, v103
    s_nop 0
    v_permlane16_swap_b32 v72, v74
    v_permlane16_swap_b32 v73, v75
    buffer_store_dwordx4 v[72:75], v14, s[40:43], 0 offen offset:0 sc1
    v_pk_add_f32 v[104:105], v[40:41], v[22:23] op_sel_hi:[1,0] neg_lo:[0,1] neg_hi:[0,1]
    v_pk_add_f32 v[106:107], v[42:43], v[22:23] op_sel_hi:[1,0] neg_lo:[0,1] neg_hi:[0,1]
    v_cvt_pk_bf16_f32 v76, v104, v105
    v_cvt_pk_bf16_f32 v77, v106, v107
    v_pk_add_f32 v[108:109], v[44:45], v[24:25] op_sel_hi:[1,0] neg_lo:[0,1] neg_hi:[0,1]
    v_pk_add_f32 v[110:111], v[46:47], v[24:25] op_sel_hi:[1,0] neg_lo:[0,1] neg_hi:[0,1]
    v_cvt_pk_bf16_f32 v78, v108, v109
    v_cvt_pk_bf16_f32 v79, v110, v111
    s_nop 0
    v_permlane16_swap_b32 v76, v78
    v_permlane16_swap_b32 v77, v79
    buffer_store_dwordx4 v[76:79], v14, s[40:43], 0 offen offset:1024 sc1
    v_pk_add_f32 v[112:113], v[48:49], v[22:23] op_sel_hi:[1,0] neg_lo:[0,1] neg_hi:[0,1]
    v_pk_add_f32 v[114:115], v[50:51], v[22:23] op_sel_hi:[1,0] neg_lo:[0,1] neg_hi:[0,1]
    v_cvt_pk_bf16_f32 v80, v112, v113
    v_cvt_pk_bf16_f32 v81, v114, v115
    v_pk_add_f32 v[116:117], v[52:53], v[24:25] op_sel_hi:[1,0] neg_lo:[0,1] neg_hi:[0,1]
    v_pk_add_f32 v[118:119], v[54:55], v[24:25] op_sel_hi:[1,0] neg_lo:[0,1] neg_hi:[0,1]
    v_cvt_pk_bf16_f32 v82, v116, v117
    v_cvt_pk_bf16_f32 v83, v118, v119
    s_nop 0
    v_permlane16_swap_b32 v80, v82
    v_permlane16_swap_b32 v81, v83
    buffer_store_dwordx4 v[80:83], v14, s[40:43], 0 offen offset:2048 sc1
    v_pk_add_f32 v[120:121], v[56:57], v[22:23] op_sel_hi:[1,0] neg_lo:[0,1] neg_hi:[0,1]
    v_pk_add_f32 v[122:123], v[58:59], v[22:23] op_sel_hi:[1,0] neg_lo:[0,1] neg_hi:[0,1]
    v_cvt_pk_bf16_f32 v84, v120, v121
    v_cvt_pk_bf16_f32 v85, v122, v123
    v_pk_add_f32 v[124:125], v[60:61], v[24:25] op_sel_hi:[1,0] neg_lo:[0,1] neg_hi:[0,1]
    v_pk_add_f32 v[126:127], v[62:63], v[24:25] op_sel_hi:[1,0] neg_lo:[0,1] neg_hi:[0,1]
    v_cvt_pk_bf16_f32 v86, v124, v125
    v_cvt_pk_bf16_f32 v87, v126, v127
    s_nop 0
    v_permlane16_swap_b32 v84, v86
    v_permlane16_swap_b32 v85, v87
    buffer_store_dwordx4 v[84:87], v14, s[40:43], 0 offen offset:3072 sc1
    v_mul_f32 v26, v96, v96
    v_fmac_f32 v26, v97, v97
    v_fmac_f32 v26, v98, v98
    v_fmac_f32 v26, v99, v99
    v_fmac_f32 v26, v104, v104
    v_fmac_f32 v26, v105, v105
    v_fmac_f32 v26, v106, v106
    v_fmac_f32 v26, v107, v107
    v_fmac_f32 v26, v112, v112
    v_fmac_f32 v26, v113, v113
    v_fmac_f32 v26, v114, v114
    v_fmac_f32 v26, v115, v115
    v_fmac_f32 v26, v120, v120
    v_fmac_f32 v26, v121, v121
    v_fmac_f32 v26, v122, v122
    v_fmac_f32 v26, v123, v123
    v_mov_b32 v28, v26
    s_nop 1
    v_permlane16_swap_b32 v28, v26
    v_add_f32 v26, v28, v26
    v_mov_b32 v28, v26
    s_nop 1
    v_permlane32_swap_b32 v28, v26
    v_add_f32 v26, v28, v26
    v_mul_f32 v27, v100, v100
    v_fmac_f32 v27, v101, v101
    v_fmac_f32 v27, v102, v102
    v_fmac_f32 v27, v103, v103
    v_fmac_f32 v27, v108, v108
    v_fmac_f32 v27, v109, v109
    v_fmac_f32 v27, v110, v110
    v_fmac_f32 v27, v111, v111
    v_fmac_f32 v27, v116, v116
    v_fmac_f32 v27, v117, v117
    v_fmac_f32 v27, v118, v118
    v_fmac_f32 v27, v119, v119
    v_fmac_f32 v27, v124, v124
    v_fmac_f32 v27, v125, v125
    v_fmac_f32 v27, v126, v126
    v_fmac_f32 v27, v127, v127
    v_mov_b32 v28, v27
    s_nop 1
    v_permlane16_swap_b32 v28, v27
    v_add_f32 v27, v28, v27
    v_mov_b32 v28, v27
    s_nop 1
    v_permlane32_swap_b32 v28, v27
    v_add_f32 v27, v28, v27
    v_and_b32 v28, 1, v2
    v_cmp_eq_u32 vcc, 1, v28
    s_nop 1
    v_cndmask_b32 v26, v26, v27, vcc
    v_lshlrev_b32 v28, 2, v0
    buffer_store_dword v26, v28, s[44:47], 0 offen sc1
    v_accvgpr_write_b32 a192, v32
    v_accvgpr_write_b32 a193, v33
    v_accvgpr_write_b32 a194, v34
    v_accvgpr_write_b32 a195, v35
    v_accvgpr_write_b32 a196, v36
    v_accvgpr_write_b32 a197, v37
    v_accvgpr_write_b32 a198, v38
    v_accvgpr_write_b32 a199, v39
    v_accvgpr_write_b32 a200, v40
    v_accvgpr_write_b32 a201, v41
    v_accvgpr_write_b32 a202, v42
    v_accvgpr_write_b32 a203, v43
    v_accvgpr_write_b32 a204, v44
    v_accvgpr_write_b32 a205, v45
    v_accvgpr_write_b32 a206, v46
    v_accvgpr_write_b32 a207, v47
    v_accvgpr_write_b32 a208, v48
    v_accvgpr_write_b32 a209, v49
    v_accvgpr_write_b32 a210, v50
    v_accvgpr_write_b32 a211, v51
    v_accvgpr_write_b32 a212, v52
    v_accvgpr_write_b32 a213, v53
    v_accvgpr_write_b32 a214, v54
    v_accvgpr_write_b32 a215, v55
    v_accvgpr_write_b32 a216, v56
    v_accvgpr_write_b32 a217, v57
    v_accvgpr_write_b32 a218, v58
    v_accvgpr_write_b32 a219, v59
    v_accvgpr_write_b32 a220, v60
    v_accvgpr_write_b32 a221, v61
    v_accvgpr_write_b32 a222, v62
    v_accvgpr_write_b32 a223, v63
    s_mul_i32 s52, s25, 224
    s_sub_u32 s53, 7340032, s52
    s_add_u32 s28, s12, s52
    s_addc_u32 s29, s13, 0
    s_mov_b32 s30, s53
    s_mov_b32 s31, 0x00020000
    s_add_u32 s32, s14, s52
    s_addc_u32 s33, s15, 0
    s_sub_u32 s32, s32, 2048
    s_subb_u32 s33, s33, 0
    s_add_u32 s34, s53, 2048
    s_mov_b32 s35, 0x00020000
    s_mul_i32 s52, s3, 57344
    v_add_u32 v10, 0, v0
    v_mul_u32_u24 v11, 4682, v10
    v_lshrrev_b32 v11, 16, v11
    v_mul_u32_u24 v12, 14, v11
    v_sub_u32 v12, v10, v12
    v_mul_u32_u24 v5, 7168, v11
    v_lshl_add_u32 v5, v12, 4, v5
    v_add_u32 v5, s52, v5
    v_add_u32 v10, 64, v0
    v_mul_u32_u24 v11, 4682, v10
    v_lshrrev_b32 v11, 16, v11
    v_mul_u32_u24 v12, 14, v11
    v_sub_u32 v12, v10, v12
    v_mul_u32_u24 v6, 7168, v11
    v_lshl_add_u32 v6, v12, 4, v6
    v_add_u32 v6, s52, v6
    v_subrev_u32 v6, 1024, v6
    v_mov_b32 v10, 0x7f000000
    v_cmp_gt_u32 vcc, 48, v0
    s_nop 1
    v_cndmask_b32 v6, v10, v6, vcc
    s_mul_i32 s48, s3, 4224
    s_add_u32 s48, s48, 28672
    s_mov_b32 s49, 0
    s_lshl_b32 s52, s2, 2
    s_add_u32 s52, s52, s3
    s_mul_i32 s53, s52, 7168
    s_mul_i32 s52, s52, 3584
    s_add_u32 s52, s52, 3670016
    v_lshlrev_b32 v13, 7, v0
    s_mov_b32 s63, -1
    s_and_b32 s21, s3, 1
    s_add_u32 s68, s12, s52
    s_addc_u32 s69, s13, 0
    s_mov_b32 s70, 3584
    s_add_u32 s72, s14, s52
    s_addc_u32 s73, s15, 0
    s_mov_b32 s74, 3584
    s_add_u32 s60, s16, s53
    s_addc_u32 s61, s17, 0
    s_mov_b32 s62, 7168
    s_mov_b32 s71, 0x00020000
    s_lshl_b32 s52, s24, 2
    s_add_u32 s52, s52, s3
    s_lshl_b32 s52, s52, 1
    s_mul_i32 s52, s52, 65536
    s_add_u32 s52, s52, 20971520
    s_add_u32 s36, s22, s52
    s_addc_u32 s37, s23, 0
    s_mov_b32 s38, 131072
    s_mov_b32 s39, 0x00020000
    v_lshlrev_b32 v3, 9, v2
    v_lshl_add_u32 v3, v1, 4, v3
    s_mov_b32 s50, 0
    v_add_u32 v4, 65536, v3
    v_mul_u32_u24 v7, 4224, v2
    v_lshrrev_b32 v10, 2, v1
    v_mul_u32_u24 v10, 224, v10
    v_add_u32 v7, v7, v10
    v_and_b32 v10, 3, v0
    v_lshl_add_u32 v7, v10, 3, v7
    v_add_u32 v7, 28672, v7
    v_add_u32 v8, 50688, v7
    v_add_u32 v9, 101376, v7
    s_lshl_b32 s52, s24, 2
    s_add_u32 s52, s52, s3
    s_mul_i32 s52, s52, 458752
    s_mul_i32 s53, s25, 7168
    s_add_u32 s52, s52, s53
    s_add_u32 s52, s52, 25165824
    s_add_u32 s40, s22, s52
    s_addc_u32 s41, s23, 0
    s_mov_b32 s42, 236544
    s_mov_b32 s43, 0x00020000
    s_lshl_b32 s52, s24, 2
    s_add_u32 s52, s52, s3
    s_lshl_b32 s52, s52, 8
    s_sub_u32 s53, 131072, s52
    s_add_u32 s52, s52, 41967616
    s_add_u32 s44, s22, s52
    s_addc_u32 s45, s23, 0
    s_mov_b32 s46, s53
    s_mov_b32 s47, 0x00020000
    v_lshlrev_b32 v30, 13, v2
    v_lshl_add_u32 v30, v1, 4, v30
    s_mov_b32 s53, 32768
    s_mov_b32 s54, 65536
    s_mov_b32 s55, 98304
    s_waitcnt vmcnt(0) lgkmcnt(0)
    s_barrier
    s_cmp_lg_u32 s3, 0
    s_cbranch_scc1 SIG_8
    s_lshr_b32 s52, s26, 1
    s_lshl_b32 s52, s52, 2
    s_and_b32 s57, s26, 1
    s_add_u32 s52, s52, s57
    s_lshl_b32 s52, s52, 4
    s_add_u32 s52, s52, s27
    s_lshl_b32 s52, s52, 2
    s_add_u32 s52, s52, 4096
    v_lshrrev_b32 v10, 0, v0
    v_lshlrev_b32 v10, 20, v10
    v_lshl_add_u32 v10, v0, 13, v10
    s_add_u32 s52, s52, 40960
    v_mov_b32 v11, s10
    buffer_store_dword v11, v10, s[64:67], s52 offen sc1
SIG_8:
    s_cmp_lg_u32 s3, 3
    s_cbranch_scc1 CT_9
    s_getpc_b64 s[0:1]
CTH_10:
    s_add_u32 s0, s0, P4_loop-CTH_10
    s_addc_u32 s1, s1, (P4_loop-CTH_10)>>32
    s_lshr_b32 s52, s2, 3
    s_mul_i32 s52, s52, ((C_p4t-P4_loop)/4096+1)
    v_min_u32 v10, ((C_p4t-P4_loop)/4096), v0
    v_add_u32 v10, s52, v10
    v_min_u32 v10, ((C_p4t-P4_loop)/128), v10
    v_lshlrev_b32 v10, 7, v10
    v_mov_b32 v11, s1
    v_add_co_u32 v10, vcc, s0, v10
    s_nop 1
    v_addc_co_u32 v11, vcc, 0, v11, vcc
    global_load_dword v12, v[10:11], off
CT_9:
    s_mov_b32 s57, s49
    s_cmp_eq_u32 s3, 0
    s_cbranch_scc1 S3_skip
    s_add_u32 m0, s48, 50688
    s_nop 0
    buffer_load_dwordx4 v5, s[28:31], s49 offen lds
    buffer_load_dwordx4 v6, s[28:31], s49 offen offset:1024 lds
    buffer_load_dwordx4 v5, s[32:35], s49 offen offset:2048 lds
    buffer_load_dwordx4 v6, s[32:35], s49 offen offset:3072 lds
    s_add_u32 s49, s49, 229376
    s_add_u32 m0, s48, 67584
    s_nop 0
    buffer_load_dwordx4 v5, s[28:31], s49 offen lds
    buffer_load_dwordx4 v6, s[28:31], s49 offen offset:1024 lds
    buffer_load_dwordx4 v5, s[32:35], s49 offen offset:2048 lds
    buffer_load_dwordx4 v6, s[32:35], s49 offen offset:3072 lds
    s_add_u32 s49, s49, 229376
    s_add_u32 m0, s48, 84480
    s_nop 0
    buffer_load_dwordx4 v5, s[28:31], s49 offen lds
    buffer_load_dwordx4 v6, s[28:31], s49 offen offset:1024 lds
    buffer_load_dwordx4 v5, s[32:35], s49 offen offset:2048 lds
    buffer_load_dwordx4 v6, s[32:35], s49 offen offset:3072 lds
    s_add_u32 s49, s49, 229376
    s_add_u32 m0, s48, 101376
    s_nop 0
    buffer_load_dwordx4 v5, s[28:31], s49 offen lds
    buffer_load_dwordx4 v6, s[28:31], s49 offen offset:1024 lds
    buffer_load_dwordx4 v5, s[32:35], s49 offen offset:2048 lds
    buffer_load_dwordx4 v6, s[32:35], s49 offen offset:3072 lds
    s_add_u32 s49, s49, 229376
    s_cmp_eq_u32 s3, 2
    s_cbranch_scc0 S3_done
    s_mov_b32 s49, s57
    s_sub_u32 s48, s48, 8448
    v_subrev_u32 v5, 114688, v5
    v_subrev_u32 v6, 114688, v6
    s_add_u32 m0, s48, 50688
    s_nop 0
    buffer_load_dwordx4 v5, s[28:31], s49 offen lds
    buffer_load_dwordx4 v6, s[28:31], s49 offen offset:1024 lds
    buffer_load_dwordx4 v5, s[32:35], s49 offen offset:2048 lds
    buffer_load_dwordx4 v6, s[32:35], s49 offen offset:3072 lds
    s_add_u32 s49, s49, 229376
    s_add_u32 m0, s48, 67584
    s_nop 0
    buffer_load_dwordx4 v5, s[28:31], s49 offen lds
    buffer_load_dwordx4 v6, s[28:31], s49 offen offset:1024 lds
    buffer_load_dwordx4 v5, s[32:35], s49 offen offset:2048 lds
    buffer_load_dwordx4 v6, s[32:35], s49 offen offset:3072 lds
    s_add_u32 s49, s49, 229376
    s_add_u32 m0, s48, 84480
    s_nop 0
    buffer_load_dwordx4 v5, s[28:31], s49 offen lds
    buffer_load_dwordx4 v6, s[28:31], s49 offen offset:1024 lds
    buffer_load_dwordx4 v5, s[32:35], s49 offen offset:2048 lds
    buffer_load_dwordx4 v6, s[32:35], s49 offen offset:3072 lds
    s_add_u32 s49, s49, 229376
    s_add_u32 m0, s48, 101376
    s_nop 0
    buffer_load_dwordx4 v5, s[28:31], s49 offen lds
    buffer_load_dwordx4 v6, s[28:31], s49 offen offset:1024 lds
    buffer_load_dwordx4 v5, s[32:35], s49 offen offset:2048 lds
    buffer_load_dwordx4 v6, s[32:35], s49 offen offset:3072 lds
    s_add_u32 s49, s49, 229376
    s_add_u32 s48, s48, 8448
    v_add_u32 v5, 114688, v5
    v_add_u32 v6, 114688, v6
    s_branch S3_done
S3_skip:
    s_add_u32 s49, s49, 917504
S3_done:
    v_mov_b32 v32, 0
    v_mov_b32 v33, 0
    v_mov_b32 v34, 0
    v_mov_b32 v35, 0
    v_mov_b32 v36, 0
    v_mov_b32 v37, 0
    v_mov_b32 v38, 0
    v_mov_b32 v39, 0
    v_mov_b32 v40, 0
    v_mov_b32 v41, 0
    v_mov_b32 v42, 0
    v_mov_b32 v43, 0
    v_mov_b32 v44, 0
    v_mov_b32 v45, 0
    v_mov_b32 v46, 0
    v_mov_b32 v47, 0
    v_mov_b32 v48, 0
    v_mov_b32 v49, 0
    v_mov_b32 v50, 0
    v_mov_b32 v51, 0
    v_mov_b32 v52, 0
    v_mov_b32 v53, 0
    v_mov_b32 v54, 0
    v_mov_b32 v55, 0
    v_mov_b32 v56, 0
    v_mov_b32 v57, 0
    v_mov_b32 v58, 0
    v_mov_b32 v59, 0
    v_mov_b32 v60, 0
    v_mov_b32 v61, 0
    v_mov_b32 v62, 0
    v_mov_b32 v63, 0
    v_mov_b32 v64, 0
    v_mov_b32 v65, 0
    v_mov_b32 v66, 0
    v_mov_b32 v67, 0
    v_mov_b32 v68, 0
    v_mov_b32 v69, 0
    v_mov_b32 v70, 0
    v_mov_b32 v71, 0
    v_mov_b32 v72, 0
    v_mov_b32 v73, 0
    v_mov_b32 v74, 0
    v_mov_b32 v75, 0
    v_mov_b32 v76, 0
    v_mov_b32 v77, 0
    v_mov_b32 v78, 0
    v_mov_b32 v79, 0
    v_mov_b32 v80, 0
    v_mov_b32 v81, 0
    v_mov_b32 v82, 0
    v_mov_b32 v83, 0
    v_mov_b32 v84, 0
    v_mov_b32 v85, 0
    v_mov_b32 v86, 0
    v_mov_b32 v87, 0
    v_mov_b32 v88, 0
    v_mov_b32 v89, 0
    v_mov_b32 v90, 0
    v_mov_b32 v91, 0
    v_mov_b32 v92, 0
    v_mov_b32 v93, 0
    v_mov_b32 v94, 0
    v_mov_b32 v95, 0
    v_mov_b32 v96, 0
    v_mov_b32 v97, 0
    v_mov_b32 v98, 0
    v_mov_b32 v99, 0
    v_mov_b32 v100, 0
    v_mov_b32 v101, 0
    v_mov_b32 v102, 0
    v_mov_b32 v103, 0
    v_mov_b32 v104, 0
    v_mov_b32 v105, 0
    v_mov_b32 v106, 0
    v_mov_b32 v107, 0
    v_mov_b32 v108, 0
    v_mov_b32 v109, 0
    v_mov_b32 v110, 0
    v_mov_b32 v111, 0
    v_mov_b32 v112, 0
    v_mov_b32 v113, 0
    v_mov_b32 v114, 0
    v_mov_b32 v115, 0
    v_mov_b32 v116, 0
    v_mov_b32 v117, 0
    v_mov_b32 v118, 0
    v_mov_b32 v119, 0
    v_mov_b32 v120, 0
    v_mov_b32 v121, 0
    v_mov_b32 v122, 0
    v_mov_b32 v123, 0
    v_mov_b32 v124, 0
    v_mov_b32 v125, 0
    v_mov_b32 v126, 0
    v_mov_b32 v127, 0
    v_mov_b32 v128, 0
    v_mov_b32 v129, 0
    v_mov_b32 v130, 0
    v_mov_b32 v131, 0
    v_mov_b32 v132, 0
    v_mov_b32 v133, 0
    v_mov_b32 v134, 0
    v_mov_b32 v135, 0
    v_mov_b32 v136, 0
    v_mov_b32 v137, 0
    v_mov_b32 v138, 0
    v_mov_b32 v139, 0
    v_mov_b32 v140, 0
    v_mov_b32 v141, 0
    v_mov_b32 v142, 0
    v_mov_b32 v143, 0
    v_mov_b32 v144, 0
    v_mov_b32 v145, 0
    v_mov_b32 v146, 0
    v_mov_b32 v147, 0
    v_mov_b32 v148, 0
    v_mov_b32 v149, 0
    v_mov_b32 v150, 0
    v_mov_b32 v151, 0
    v_mov_b32 v152, 0
    v_mov_b32 v153, 0
    v_mov_b32 v154, 0
    v_mov_b32 v155, 0
    v_mov_b32 v156, 0
    v_mov_b32 v157, 0
    v_mov_b32 v158, 0
    v_mov_b32 v159, 0
    v_mov_b32 v160, 0
    v_mov_b32 v161, 0
    v_mov_b32 v162, 0
    v_mov_b32 v163, 0
    v_mov_b32 v164, 0
    v_mov_b32 v165, 0
    v_mov_b32 v166, 0
    v_mov_b32 v167, 0
    v_mov_b32 v168, 0
    v_mov_b32 v169, 0
    v_mov_b32 v170, 0
    v_mov_b32 v171, 0
    v_mov_b32 v172, 0
    v_mov_b32 v173, 0
    v_mov_b32 v174, 0
    v_mov_b32 v175, 0
    v_mov_b32 v176, 0
    v_mov_b32 v177, 0
    v_mov_b32 v178, 0
    v_mov_b32 v179, 0
    v_mov_b32 v180, 0
    v_mov_b32 v181, 0
    v_mov_b32 v182, 0
    v_mov_b32 v183, 0
    v_mov_b32 v184, 0
    v_mov_b32 v185, 0
    v_mov_b32 v186, 0
    v_mov_b32 v187, 0
    v_mov_b32 v188, 0
    v_mov_b32 v189, 0
    v_mov_b32 v190, 0
    v_mov_b32 v191, 0
    v_mov_b32 v192, 0
    v_mov_b32 v193, 0
    v_mov_b32 v194, 0
    v_mov_b32 v195, 0
    v_mov_b32 v196, 0
    v_mov_b32 v197, 0
    v_mov_b32 v198, 0
    v_mov_b32 v199, 0
    v_mov_b32 v200, 0
    v_mov_b32 v201, 0
    v_mov_b32 v202, 0
    v_mov_b32 v203, 0
    v_mov_b32 v204, 0
    v_mov_b32 v205, 0
    v_mov_b32 v206, 0
    v_mov_b32 v207, 0
    v_mov_b32 v208, 0
    v_mov_b32 v209, 0
    v_mov_b32 v210, 0
    v_mov_b32 v211, 0
    v_mov_b32 v212, 0
    v_mov_b32 v213, 0
    v_mov_b32 v214, 0
    v_mov_b32 v215, 0
    v_mov_b32 v216, 0
    v_mov_b32 v217, 0
    v_mov_b32 v218, 0
    v_mov_b32 v219, 0
    v_mov_b32 v220, 0
    v_mov_b32 v221, 0
    v_mov_b32 v222, 0
    v_mov_b32 v223, 0
    v_mov_b32 v224, 0
    v_mov_b32 v225, 0
    v_mov_b32 v226, 0
    v_mov_b32 v227, 0
    v_mov_b32 v228, 0
    v_mov_b32 v229, 0
    v_mov_b32 v230, 0
    v_mov_b32 v231, 0
    v_mov_b32 v232, 0
    v_mov_b32 v233, 0
    v_mov_b32 v234, 0
    v_mov_b32 v235, 0
    v_mov_b32 v236, 0
    v_mov_b32 v237, 0
    v_mov_b32 v238, 0
    v_mov_b32 v239, 0
    v_mov_b32 v240, 0
    v_mov_b32 v241, 0
    v_mov_b32 v242, 0
    v_mov_b32 v243, 0
    v_mov_b32 v244, 0
    v_mov_b32 v245, 0
    v_mov_b32 v246, 0
    v_mov_b32 v247, 0
    v_mov_b32 v248, 0
    v_mov_b32 v249, 0
    v_mov_b32 v250, 0
    v_mov_b32 v251, 0
    v_mov_b32 v252, 0
    v_mov_b32 v253, 0
    v_mov_b32 v254, 0
    v_mov_b32 v255, 0
    s_cmp_lg_u32 s3, 0
    s_cbranch_scc1 WT_11
    s_lshl_b32 s52, s24, 8
    s_add_u32 s52, s52, 4096
    v_and_b32 v10, 31, v0
    v_lshlrev_b32 v10, 2, v10
    v_add_u32 v10, s52, v10
    s_lshr_b32 s52, s2, 5
    s_and_b32 s52, s52, 0
    s_lshl_b32 s52, s52, 13
    s_add_u32 s52, s52, 40960
    v_add_u32 v10, s52, v10
    s_mov_b32 s52, 0x40000
    s_sleep 6
POLL_12:
    s_sleep 8
    buffer_load_dword v11, v10, s[64:67], 0 offen sc1
    s_waitcnt vmcnt(0)
    v_cmp_ne_u32 vcc, s10, v11
    s_sub_u32 s52, s52, 1
    s_cbranch_scc1 WT_11
    s_cbranch_vccnz POLL_12
WT_11:
    s_waitcnt vmcnt(8)
    s_barrier
    buffer_load_dwordx4 a[0:3], v3, s[36:39], s50 offen offset:0 sc1
    buffer_load_dwordx4 a[4:7], v3, s[36:39], s50 offen offset:256 sc1
    buffer_load_dwordx4 a[8:11], v4, s[36:39], s50 offen offset:0 sc1
    buffer_load_dwordx4 a[12:15], v4, s[36:39], s50 offen offset:256 sc1
    s_add_u32 s50, s50, 2048
    buffer_load_dwordx4 a[16:19], v3, s[36:39], s50 offen offset:0 sc1
    buffer_load_dwordx4 a[20:23], v3, s[36:39], s50 offen offset:256 sc1
    buffer_load_dwordx4 a[24:27], v4, s[36:39], s50 offen offset:0 sc1
    buffer_load_dwordx4 a[28:31], v4, s[36:39], s50 offen offset:256 sc1
    s_add_u32 s50, s50, 2048
    buffer_load_dwordx4 a[32:35], v3, s[36:39], s50 offen offset:0 sc1
    buffer_load_dwordx4 a[36:39], v3, s[36:39], s50 offen offset:256 sc1
    buffer_load_dwordx4 a[40:43], v4, s[36:39], s50 offen offset:0 sc1
    buffer_load_dwordx4 a[44:47], v4, s[36:39], s50 offen offset:256 sc1
    s_add_u32 s50, s50, 2048
    buffer_load_dwordx4 v[14:17], v30, s[44:47], 0 offen sc1
    buffer_load_dwordx4 v[18:21], v30, s[44:47], s53 offen sc1
    buffer_load_dwordx4 v[22:25], v30, s[44:47], s54 offen sc1
    buffer_load_dwordx4 v[26:29], v30, s[44:47], s55 offen sc1
    ds_read_b64_tr_b16 a[128:129], v8 offset:0
    ds_read_b64_tr_b16 a[130:131], v8 offset:896
    ds_read_b64_tr_b16 a[132:133], v8 offset:32
    ds_read_b64_tr_b16 a[134:135], v8 offset:928
    ds_read_b64_tr_b16 a[136:137], v8 offset:64
    ds_read_b64_tr_b16 a[138:139], v8 offset:960
    ds_read_b64_tr_b16 a[140:141], v8 offset:96
    ds_read_b64_tr_b16 a[142:143], v8 offset:992
    s_mov_b32 s51, 3
P4_loop:
    s_waitcnt vmcnt(12) lgkmcnt(4)
    v_mfma_f32_16x16x32_bf16 v[32:35], a[128:131], a[0:3], v[32:35]
    ds_read_b64_tr_b16 a[144:145], v8 offset:128
    v_mfma_f32_16x16x32_bf16 v[36:39], a[128:131], a[4:7], v[36:39]
    ds_read_b64_tr_b16 a[146:147], v8 offset:1024
    v_mfma_f32_16x16x32_bf16 v[40:43], a[128:131], a[8:11], v[40:43]
    v_mfma_f32_16x16x32_bf16 v[44:47], a[128:131], a[12:15], v[44:47]
    buffer_load_dwordx4 a[48:51], v3, s[36:39], s50 offen offset:0 sc1
    v_mfma_f32_16x16x32_bf16 v[60:63], a[132:135], a[12:15], v[60:63]
    ds_read_b64_tr_b16 a[148:149], v8 offset:160
    v_mfma_f32_16x16x32_bf16 v[56:59], a[132:135], a[8:11], v[56:59]
    ds_read_b64_tr_b16 a[150:151], v8 offset:1056
    v_mfma_f32_16x16x32_bf16 v[52:55], a[132:135], a[4:7], v[52:55]
    v_mfma_f32_16x16x32_bf16 v[48:51], a[132:135], a[0:3], v[48:51]
    s_waitcnt lgkmcnt(4)
    v_mfma_f32_16x16x32_bf16 v[64:67], a[136:139], a[0:3], v[64:67]
    ds_read_b64_tr_b16 a[152:153], v8 offset:192
    v_mfma_f32_16x16x32_bf16 v[68:71], a[136:139], a[4:7], v[68:71]
    s_add_u32 m0, s48, 118272
    v_mfma_f32_16x16x32_bf16 v[72:75], a[136:139], a[8:11], v[72:75]
    buffer_load_dwordx4 v5, s[28:31], s49 offen lds
    v_mfma_f32_16x16x32_bf16 v[76:79], a[136:139], a[12:15], v[76:79]
    ds_read_b64_tr_b16 a[154:155], v8 offset:1088
    v_mfma_f32_16x16x32_bf16 v[92:95], a[140:143], a[12:15], v[92:95]
    ds_read_b64_tr_b16 a[128:129], v8 offset:2048
    v_mfma_f32_16x16x32_bf16 v[88:91], a[140:143], a[8:11], v[88:91]
    ds_read_b64_tr_b16 a[130:131], v8 offset:2944
    v_mfma_f32_16x16x32_bf16 v[84:87], a[140:143], a[4:7], v[84:87]
    v_mfma_f32_16x16x32_bf16 v[80:83], a[140:143], a[0:3], v[80:83]
    s_waitcnt lgkmcnt(4)
    v_mfma_f32_16x16x32_bf16 v[96:99], a[144:147], a[0:3], v[96:99]
    ds_read_b64_tr_b16 a[132:133], v8 offset:2080
    v_mfma_f32_16x16x32_bf16 v[100:103], a[144:147], a[4:7], v[100:103]
    buffer_load_dwordx4 a[52:55], v3, s[36:39], s50 offen offset:256 sc1
    v_mfma_f32_16x16x32_bf16 v[104:107], a[144:147], a[8:11], v[104:107]
    ds_read_b64_tr_b16 a[134:135], v8 offset:2976
    v_mfma_f32_16x16x32_bf16 v[108:111], a[144:147], a[12:15], v[108:111]
    v_mfma_f32_16x16x32_bf16 v[124:127], a[148:151], a[12:15], v[124:127]
    ds_read_b64_tr_b16 a[136:137], v8 offset:2112
    v_mfma_f32_16x16x32_bf16 v[120:123], a[148:151], a[8:11], v[120:123]
    ds_read_b64_tr_b16 a[138:139], v8 offset:3008
    v_mfma_f32_16x16x32_bf16 v[116:119], a[148:151], a[4:7], v[116:119]
    v_mfma_f32_16x16x32_bf16 v[112:115], a[148:151], a[0:3], v[112:115]
    s_waitcnt lgkmcnt(4)
    v_mfma_f32_16x16x32_bf16 v[128:131], a[152:155], a[0:3], v[128:131]
    buffer_load_dwordx4 v6, s[28:31], s49 offen offset:1024 lds
    v_mfma_f32_16x16x32_bf16 v[132:135], a[152:155], a[4:7], v[132:135]
    ds_read_b64_tr_b16 a[140:141], v8 offset:2144
    v_mfma_f32_16x16x32_bf16 v[136:139], a[152:155], a[8:11], v[136:139]
    ds_read_b64_tr_b16 a[142:143], v8 offset:3040
    v_mfma_f32_16x16x32_bf16 v[140:143], a[152:155], a[12:15], v[140:143]
    v_mfma_f32_16x16x32_bf16 v[156:159], a[128:131], a[12:15], v[156:159]
    ds_read_b64_tr_b16 a[144:145], v8 offset:2176
    v_mfma_f32_16x16x32_bf16 v[152:155], a[128:131], a[8:11], v[152:155]
    ds_read_b64_tr_b16 a[146:147], v8 offset:3072
    v_mfma_f32_16x16x32_bf16 v[148:151], a[128:131], a[4:7], v[148:151]
    v_mfma_f32_16x16x32_bf16 v[144:147], a[128:131], a[0:3], v[144:147]
    buffer_load_dwordx4 a[56:59], v4, s[36:39], s50 offen offset:0 sc1
    s_waitcnt lgkmcnt(4)
    v_mfma_f32_16x16x32_bf16 v[160:163], a[132:135], a[0:3], v[160:163]
    ds_read_b64_tr_b16 a[148:149], v8 offset:2208
    v_mfma_f32_16x16x32_bf16 v[164:167], a[132:135], a[4:7], v[164:167]
    ds_read_b64_tr_b16 a[150:151], v8 offset:3104
    v_mfma_f32_16x16x32_bf16 v[168:171], a[132:135], a[8:11], v[168:171]
    v_mfma_f32_16x16x32_bf16 v[172:175], a[132:135], a[12:15], v[172:175]
    v_mfma_f32_16x16x32_bf16 v[188:191], a[136:139], a[12:15], v[188:191]
    ds_read_b64_tr_b16 a[152:153], v8 offset:2240
    v_mfma_f32_16x16x32_bf16 v[184:187], a[136:139], a[8:11], v[184:187]
    ds_read_b64_tr_b16 a[154:155], v8 offset:3136
    v_mfma_f32_16x16x32_bf16 v[180:183], a[136:139], a[4:7], v[180:183]
    buffer_load_dwordx4 v5, s[32:35], s49 offen offset:2048 lds
    v_mfma_f32_16x16x32_bf16 v[176:179], a[136:139], a[0:3], v[176:179]
    s_waitcnt lgkmcnt(4)
    v_mfma_f32_16x16x32_bf16 v[192:195], a[140:143], a[0:3], v[192:195]
    ds_read_b64_tr_b16 a[128:129], v8 offset:16896
    v_mfma_f32_16x16x32_bf16 v[196:199], a[140:143], a[4:7], v[196:199]
    ds_read_b64_tr_b16 a[130:131], v8 offset:17792
    v_mfma_f32_16x16x32_bf16 v[200:203], a[140:143], a[8:11], v[200:203]
    v_mfma_f32_16x16x32_bf16 v[204:207], a[140:143], a[12:15], v[204:207]
    v_mfma_f32_16x16x32_bf16 v[220:223], a[144:147], a[12:15], v[220:223]
    ds_read_b64_tr_b16 a[132:133], v8 offset:16928
    v_mfma_f32_16x16x32_bf16 v[216:219], a[144:147], a[8:11], v[216:219]
    buffer_load_dwordx4 a[60:63], v4, s[36:39], s50 offen offset:256 sc1
    v_mfma_f32_16x16x32_bf16 v[212:215], a[144:147], a[4:7], v[212:215]
    s_add_u32 s50, s50, 2048
    v_mfma_f32_16x16x32_bf16 v[208:211], a[144:147], a[0:3], v[208:211]
    ds_read_b64_tr_b16 a[134:135], v8 offset:17824
    s_waitcnt lgkmcnt(4)
    v_mfma_f32_16x16x32_bf16 v[224:227], a[148:151], a[0:3], v[224:227]
    ds_read_b64_tr_b16 a[136:137], v8 offset:16960
    v_mfma_f32_16x16x32_bf16 v[228:231], a[148:151], a[4:7], v[228:231]
    ds_read_b64_tr_b16 a[138:139], v8 offset:17856
    v_mfma_f32_16x16x32_bf16 v[232:235], a[148:151], a[8:11], v[232:235]
    v_mfma_f32_16x16x32_bf16 v[236:239], a[148:151], a[12:15], v[236:239]
    v_mfma_f32_16x16x32_bf16 v[252:255], a[152:155], a[12:15], v[252:255]
    buffer_load_dwordx4 v6, s[32:35], s49 offen offset:3072 lds
    v_mfma_f32_16x16x32_bf16 v[248:251], a[152:155], a[8:11], v[248:251]
    s_add_u32 s49, s49, 229376
    v_mfma_f32_16x16x32_bf16 v[244:247], a[152:155], a[4:7], v[244:247]
    ds_read_b64_tr_b16 a[140:141], v8 offset:16992
    v_mfma_f32_16x16x32_bf16 v[240:243], a[152:155], a[0:3], v[240:243]
    ds_read_b64_tr_b16 a[142:143], v8 offset:17888
    s_waitcnt vmcnt(16) lgkmcnt(4)
    v_mfma_f32_16x16x32_bf16 v[32:35], a[128:131], a[16:19], v[32:35]
    ds_read_b64_tr_b16 a[144:145], v8 offset:17024
    v_mfma_f32_16x16x32_bf16 v[36:39], a[128:131], a[20:23], v[36:39]
    ds_read_b64_tr_b16 a[146:147], v8 offset:17920
    v_mfma_f32_16x16x32_bf16 v[40:43], a[128:131], a[24:27], v[40:43]
    v_mfma_f32_16x16x32_bf16 v[44:47], a[128:131], a[28:31], v[44:47]
    buffer_load_dwordx4 a[64:67], v3, s[36:39], s50 offen offset:0 sc1
    v_mfma_f32_16x16x32_bf16 v[60:63], a[132:135], a[28:31], v[60:63]
    ds_read_b64_tr_b16 a[148:149], v8 offset:17056
    v_mfma_f32_16x16x32_bf16 v[56:59], a[132:135], a[24:27], v[56:59]
    ds_read_b64_tr_b16 a[150:151], v8 offset:17952
    v_mfma_f32_16x16x32_bf16 v[52:55], a[132:135], a[20:23], v[52:55]
    v_mfma_f32_16x16x32_bf16 v[48:51], a[132:135], a[16:19], v[48:51]
    s_waitcnt lgkmcnt(4)
    v_mfma_f32_16x16x32_bf16 v[64:67], a[136:139], a[16:19], v[64:67]
    ds_read_b64_tr_b16 a[152:153], v8 offset:17088
    v_mfma_f32_16x16x32_bf16 v[68:71], a[136:139], a[20:23], v[68:71]
    s_add_u32 m0, s48, 0
    s_add_u32 s63, s63, 1
    v_mfma_f32_16x16x32_bf16 v[72:75], a[136:139], a[24:27], v[72:75]
    buffer_load_dwordx4 v5, s[28:31], s49 offen lds
    s_and_b32 s57, s63, 1
    v_mfma_f32_16x16x32_bf16 v[76:79], a[136:139], a[28:31], v[76:79]
    ds_read_b64_tr_b16 a[154:155], v8 offset:17984
    s_cmp_eq_u32 s57, s21
    s_cbranch_scc0 P4_t1
    buffer_load_dword v31, v13, s[68:71], 0 offen
    s_mov_b32 s68, s72
    s_mov_b32 s69, s73
    s_mov_b32 s70, s74
    s_mov_b32 s72, s60
    s_mov_b32 s73, s61
    s_mov_b32 s74, s62
    s_mov_b32 s62, 0
P4_t1:
    v_mfma_f32_16x16x32_bf16 v[92:95], a[140:143], a[28:31], v[92:95]
    ds_read_b64_tr_b16 a[128:129], v8 offset:18944
    v_mfma_f32_16x16x32_bf16 v[88:91], a[140:143], a[24:27], v[88:91]
    ds_read_b64_tr_b16 a[130:131], v8 offset:19840
    v_mfma_f32_16x16x32_bf16 v[84:87], a[140:143], a[20:23], v[84:87]
    v_mfma_f32_16x16x32_bf16 v[80:83], a[140:143], a[16:19], v[80:83]
    s_waitcnt lgkmcnt(4)
    v_mfma_f32_16x16x32_bf16 v[96:99], a[144:147], a[16:19], v[96:99]
    ds_read_b64_tr_b16 a[132:133], v8 offset:18976
    v_mfma_f32_16x16x32_bf16 v[100:103], a[144:147], a[20:23], v[100:103]
    buffer_load_dwordx4 a[68:71], v3, s[36:39], s50 offen offset:256 sc1
    v_mfma_f32_16x16x32_bf16 v[104:107], a[144:147], a[24:27], v[104:107]
    ds_read_b64_tr_b16 a[134:135], v8 offset:19872
    v_mfma_f32_16x16x32_bf16 v[108:111], a[144:147], a[28:31], v[108:111]
    v_mfma_f32_16x16x32_bf16 v[124:127], a[148:151], a[28:31], v[124:127]
    ds_read_b64_tr_b16 a[136:137], v8 offset:19008
    v_mfma_f32_16x16x32_bf16 v[120:123], a[148:151], a[24:27], v[120:123]
    ds_read_b64_tr_b16 a[138:139], v8 offset:19904
    v_mfma_f32_16x16x32_bf16 v[116:119], a[148:151], a[20:23], v[116:119]
    v_mfma_f32_16x16x32_bf16 v[112:115], a[148:151], a[16:19], v[112:115]
    s_waitcnt lgkmcnt(4)
    v_mfma_f32_16x16x32_bf16 v[128:131], a[152:155], a[16:19], v[128:131]
    buffer_load_dwordx4 v6, s[28:31], s49 offen offset:1024 lds
    v_mfma_f32_16x16x32_bf16 v[132:135], a[152:155], a[20:23], v[132:135]
    ds_read_b64_tr_b16 a[140:141], v8 offset:19040
    v_mfma_f32_16x16x32_bf16 v[136:139], a[152:155], a[24:27], v[136:139]
    ds_read_b64_tr_b16 a[142:143], v8 offset:19936
    v_mfma_f32_16x16x32_bf16 v[140:143], a[152:155], a[28:31], v[140:143]
    v_mfma_f32_16x16x32_bf16 v[156:159], a[128:131], a[28:31], v[156:159]
    ds_read_b64_tr_b16 a[144:145], v8 offset:19072
    v_mfma_f32_16x16x32_bf16 v[152:155], a[128:131], a[24:27], v[152:155]
    ds_read_b64_tr_b16 a[146:147], v8 offset:19968
    v_mfma_f32_16x16x32_bf16 v[148:151], a[128:131], a[20:23], v[148:151]
    v_mfma_f32_16x16x32_bf16 v[144:147], a[128:131], a[16:19], v[144:147]
    buffer_load_dwordx4 a[72:75], v4, s[36:39], s50 offen offset:0 sc1
    s_waitcnt lgkmcnt(4)
    v_mfma_f32_16x16x32_bf16 v[160:163], a[132:135], a[16:19], v[160:163]
    ds_read_b64_tr_b16 a[148:149], v8 offset:19104
    v_mfma_f32_16x16x32_bf16 v[164:167], a[132:135], a[20:23], v[164:167]
    ds_read_b64_tr_b16 a[150:151], v8 offset:20000
    v_mfma_f32_16x16x32_bf16 v[168:171], a[132:135], a[24:27], v[168:171]
    v_mfma_f32_16x16x32_bf16 v[172:175], a[132:135], a[28:31], v[172:175]
    v_mfma_f32_16x16x32_bf16 v[188:191], a[136:139], a[28:31], v[188:191]
    ds_read_b64_tr_b16 a[152:153], v8 offset:19136
    v_mfma_f32_16x16x32_bf16 v[184:187], a[136:139], a[24:27], v[184:187]
    ds_read_b64_tr_b16 a[154:155], v8 offset:20032
    v_mfma_f32_16x16x32_bf16 v[180:183], a[136:139], a[20:23], v[180:183]
    buffer_load_dwordx4 v5, s[32:35], s49 offen offset:2048 lds
    v_mfma_f32_16x16x32_bf16 v[176:179], a[136:139], a[16:19], v[176:179]
    s_waitcnt vmcnt(14)
    s_barrier
    s_waitcnt lgkmcnt(4)
    v_mfma_f32_16x16x32_bf16 v[192:195], a[140:143], a[16:19], v[192:195]
    ds_read_b64_tr_b16 a[128:129], v8 offset:33792
    v_mfma_f32_16x16x32_bf16 v[196:199], a[140:143], a[20:23], v[196:199]
    ds_read_b64_tr_b16 a[130:131], v8 offset:34688
    v_mfma_f32_16x16x32_bf16 v[200:203], a[140:143], a[24:27], v[200:203]
    v_mfma_f32_16x16x32_bf16 v[204:207], a[140:143], a[28:31], v[204:207]
    v_mfma_f32_16x16x32_bf16 v[220:223], a[144:147], a[28:31], v[220:223]
    ds_read_b64_tr_b16 a[132:133], v8 offset:33824
    v_mfma_f32_16x16x32_bf16 v[216:219], a[144:147], a[24:27], v[216:219]
    buffer_load_dwordx4 a[76:79], v4, s[36:39], s50 offen offset:256 sc1
    v_mfma_f32_16x16x32_bf16 v[212:215], a[144:147], a[20:23], v[212:215]
    s_add_u32 s50, s50, 2048
    v_mfma_f32_16x16x32_bf16 v[208:211], a[144:147], a[16:19], v[208:211]
    ds_read_b64_tr_b16 a[134:135], v8 offset:34720
    s_waitcnt lgkmcnt(4)
    v_mfma_f32_16x16x32_bf16 v[224:227], a[148:151], a[16:19], v[224:227]
    ds_read_b64_tr_b16 a[136:137], v8 offset:33856
    v_mfma_f32_16x16x32_bf16 v[228:231], a[148:151], a[20:23], v[228:231]
    ds_read_b64_tr_b16 a[138:139], v8 offset:34752
    v_mfma_f32_16x16x32_bf16 v[232:235], a[148:151], a[24:27], v[232:235]
    v_mfma_f32_16x16x32_bf16 v[236:239], a[148:151], a[28:31], v[236:239]
    v_mfma_f32_16x16x32_bf16 v[252:255], a[152:155], a[28:31], v[252:255]
    buffer_load_dwordx4 v6, s[32:35], s49 offen offset:3072 lds
    v_mfma_f32_16x16x32_bf16 v[248:251], a[152:155], a[24:27], v[248:251]
    s_add_u32 s49, s49, 229376
    v_mfma_f32_16x16x32_bf16 v[244:247], a[152:155], a[20:23], v[244:247]
    ds_read_b64_tr_b16 a[140:141], v8 offset:33888
    v_mfma_f32_16x16x32_bf16 v[240:243], a[152:155], a[16:19], v[240:243]
    ds_read_b64_tr_b16 a[142:143], v8 offset:34784
    s_waitcnt vmcnt(17) lgkmcnt(4)
    v_mfma_f32_16x16x32_bf16 v[32:35], a[128:131], a[32:35], v[32:35]
    ds_read_b64_tr_b16 a[144:145], v8 offset:33920
    v_mfma_f32_16x16x32_bf16 v[36:39], a[128:131], a[36:39], v[36:39]
    ds_read_b64_tr_b16 a[146:147], v8 offset:34816
    v_mfma_f32_16x16x32_bf16 v[40:43], a[128:131], a[40:43], v[40:43]
    v_mfma_f32_16x16x32_bf16 v[44:47], a[128:131], a[44:47], v[44:47]
    buffer_load_dwordx4 a[80:83], v3, s[36:39], s50 offen offset:0 sc1
    v_mfma_f32_16x16x32_bf16 v[60:63], a[132:135], a[44:47], v[60:63]
    ds_read_b64_tr_b16 a[148:149], v8 offset:33952
    v_mfma_f32_16x16x32_bf16 v[56:59], a[132:135], a[40:43], v[56:59]
    ds_read_b64_tr_b16 a[150:151], v8 offset:34848
    v_mfma_f32_16x16x32_bf16 v[52:55], a[132:135], a[36:39], v[52:55]
    v_mfma_f32_16x16x32_bf16 v[48:51], a[132:135], a[32:35], v[48:51]
    s_waitcnt lgkmcnt(4)
    v_mfma_f32_16x16x32_bf16 v[64:67], a[136:139], a[32:35], v[64:67]
    ds_read_b64_tr_b16 a[152:153], v8 offset:33984
    v_mfma_f32_16x16x32_bf16 v[68:71], a[136:139], a[36:39], v[68:71]
    s_add_u32 m0, s48, 16896
    v_mfma_f32_16x16x32_bf16 v[72:75], a[136:139], a[40:43], v[72:75]
    buffer_load_dwordx4 v5, s[28:31], s49 offen lds
    v_mfma_f32_16x16x32_bf16 v[76:79], a[136:139], a[44:47], v[76:79]
    ds_read_b64_tr_b16 a[154:155], v8 offset:34880
    v_mfma_f32_16x16x32_bf16 v[92:95], a[140:143], a[44:47], v[92:95]
    ds_read_b64_tr_b16 a[128:129], v8 offset:35840
    v_mfma_f32_16x16x32_bf16 v[88:91], a[140:143], a[40:43], v[88:91]
    ds_read_b64_tr_b16 a[130:131], v8 offset:36736
    v_mfma_f32_16x16x32_bf16 v[84:87], a[140:143], a[36:39], v[84:87]
    v_mfma_f32_16x16x32_bf16 v[80:83], a[140:143], a[32:35], v[80:83]
    s_waitcnt lgkmcnt(4)
    v_mfma_f32_16x16x32_bf16 v[96:99], a[144:147], a[32:35], v[96:99]
    ds_read_b64_tr_b16 a[132:133], v8 offset:35872
    v_mfma_f32_16x16x32_bf16 v[100:103], a[144:147], a[36:39], v[100:103]
    buffer_load_dwordx4 a[84:87], v3, s[36:39], s50 offen offset:256 sc1
    v_mfma_f32_16x16x32_bf16 v[104:107], a[144:147], a[40:43], v[104:107]
    ds_read_b64_tr_b16 a[134:135], v8 offset:36768
    v_mfma_f32_16x16x32_bf16 v[108:111], a[144:147], a[44:47], v[108:111]
    v_mfma_f32_16x16x32_bf16 v[124:127], a[148:151], a[44:47], v[124:127]
    ds_read_b64_tr_b16 a[136:137], v8 offset:35904
    v_mfma_f32_16x16x32_bf16 v[120:123], a[148:151], a[40:43], v[120:123]
    ds_read_b64_tr_b16 a[138:139], v8 offset:36800
    v_mfma_f32_16x16x32_bf16 v[116:119], a[148:151], a[36:39], v[116:119]
    v_mfma_f32_16x16x32_bf16 v[112:115], a[148:151], a[32:35], v[112:115]
    s_waitcnt lgkmcnt(4)
    v_mfma_f32_16x16x32_bf16 v[128:131], a[152:155], a[32:35], v[128:131]
    buffer_load_dwordx4 v6, s[28:31], s49 offen offset:1024 lds
    v_mfma_f32_16x16x32_bf16 v[132:135], a[152:155], a[36:39], v[132:135]
    ds_read_b64_tr_b16 a[140:141], v8 offset:35936
    v_mfma_f32_16x16x32_bf16 v[136:139], a[152:155], a[40:43], v[136:139]
    ds_read_b64_tr_b16 a[142:143], v8 offset:36832
    v_mfma_f32_16x16x32_bf16 v[140:143], a[152:155], a[44:47], v[140:143]
    v_mfma_f32_16x16x32_bf16 v[156:159], a[128:131], a[44:47], v[156:159]
    ds_read_b64_tr_b16 a[144:145], v8 offset:35968
    v_mfma_f32_16x16x32_bf16 v[152:155], a[128:131], a[40:43], v[152:155]
    ds_read_b64_tr_b16 a[146:147], v8 offset:36864
    v_mfma_f32_16x16x32_bf16 v[148:151], a[128:131], a[36:39], v[148:151]
    v_mfma_f32_16x16x32_bf16 v[144:147], a[128:131], a[32:35], v[144:147]
    buffer_load_dwordx4 a[88:91], v4, s[36:39], s50 offen offset:0 sc1
    s_waitcnt lgkmcnt(4)
    v_mfma_f32_16x16x32_bf16 v[160:163], a[132:135], a[32:35], v[160:163]
    ds_read_b64_tr_b16 a[148:149], v8 offset:36000
    v_mfma_f32_16x16x32_bf16 v[164:167], a[132:135], a[36:39], v[164:167]
    ds_read_b64_tr_b16 a[150:151], v8 offset:36896
    v_mfma_f32_16x16x32_bf16 v[168:171], a[132:135], a[40:43], v[168:171]
    v_mfma_f32_16x16x32_bf16 v[172:175], a[132:135], a[44:47], v[172:175]
    v_mfma_f32_16x16x32_bf16 v[188:191], a[136:139], a[44:47], v[188:191]
    ds_read_b64_tr_b16 a[152:153], v8 offset:36032
    v_mfma_f32_16x16x32_bf16 v[184:187], a[136:139], a[40:43], v[184:187]
    ds_read_b64_tr_b16 a[154:155], v8 offset:36928
    v_mfma_f32_16x16x32_bf16 v[180:183], a[136:139], a[36:39], v[180:183]
    buffer_load_dwordx4 v5, s[32:35], s49 offen offset:2048 lds
    v_mfma_f32_16x16x32_bf16 v[176:179], a[136:139], a[32:35], v[176:179]
    s_waitcnt lgkmcnt(4)
    v_mfma_f32_16x16x32_bf16 v[192:195], a[140:143], a[32:35], v[192:195]
    ds_read_b64_tr_b16 a[128:129], v9 offset:0
    v_mfma_f32_16x16x32_bf16 v[196:199], a[140:143], a[36:39], v[196:199]
    ds_read_b64_tr_b16 a[130:131], v9 offset:896
    v_mfma_f32_16x16x32_bf16 v[200:203], a[140:143], a[40:43], v[200:203]
    v_mfma_f32_16x16x32_bf16 v[204:207], a[140:143], a[44:47], v[204:207]
    v_mfma_f32_16x16x32_bf16 v[220:223], a[144:147], a[44:47], v[220:223]
    ds_read_b64_tr_b16 a[132:133], v9 offset:32
    v_mfma_f32_16x16x32_bf16 v[216:219], a[144:147], a[40:43], v[216:219]
    buffer_load_dwordx4 a[92:95], v4, s[36:39], s50 offen offset:256 sc1
    v_mfma_f32_16x16x32_bf16 v[212:215], a[144:147], a[36:39], v[212:215]
    s_add_u32 s50, s50, 2048
    v_mfma_f32_16x16x32_bf16 v[208:211], a[144:147], a[32:35], v[208:211]
    ds_read_b64_tr_b16 a[134:135], v9 offset:928
    s_waitcnt lgkmcnt(4)
    v_mfma_f32_16x16x32_bf16 v[224:227], a[148:151], a[32:35], v[224:227]
    ds_read_b64_tr_b16 a[136:137], v9 offset:64
    v_mfma_f32_16x16x32_bf16 v[228:231], a[148:151], a[36:39], v[228:231]
    ds_read_b64_tr_b16 a[138:139], v9 offset:960
    v_mfma_f32_16x16x32_bf16 v[232:235], a[148:151], a[40:43], v[232:235]
    v_mfma_f32_16x16x32_bf16 v[236:239], a[148:151], a[44:47], v[236:239]
    v_mfma_f32_16x16x32_bf16 v[252:255], a[152:155], a[44:47], v[252:255]
    buffer_load_dwordx4 v6, s[32:35], s49 offen offset:3072 lds
    v_mfma_f32_16x16x32_bf16 v[248:251], a[152:155], a[40:43], v[248:251]
    s_add_u32 s49, s49, 229376
    v_mfma_f32_16x16x32_bf16 v[244:247], a[152:155], a[36:39], v[244:247]
    ds_read_b64_tr_b16 a[140:141], v9 offset:96
    v_mfma_f32_16x16x32_bf16 v[240:243], a[152:155], a[32:35], v[240:243]
    ds_read_b64_tr_b16 a[142:143], v9 offset:992
    s_waitcnt vmcnt(17) lgkmcnt(4)
    v_mfma_f32_16x16x32_bf16 v[32:35], a[128:131], a[48:51], v[32:35]
    ds_read_b64_tr_b16 a[144:145], v9 offset:128
    v_mfma_f32_16x16x32_bf16 v[36:39], a[128:131], a[52:55], v[36:39]
    ds_read_b64_tr_b16 a[146:147], v9 offset:1024
    v_mfma_f32_16x16x32_bf16 v[40:43], a[128:131], a[56:59], v[40:43]
    v_mfma_f32_16x16x32_bf16 v[44:47], a[128:131], a[60:63], v[44:47]
    buffer_load_dwordx4 a[96:99], v3, s[36:39], s50 offen offset:0 sc1
    v_mfma_f32_16x16x32_bf16 v[60:63], a[132:135], a[60:63], v[60:63]
    ds_read_b64_tr_b16 a[148:149], v9 offset:160
    v_mfma_f32_16x16x32_bf16 v[56:59], a[132:135], a[56:59], v[56:59]
    ds_read_b64_tr_b16 a[150:151], v9 offset:1056
    v_mfma_f32_16x16x32_bf16 v[52:55], a[132:135], a[52:55], v[52:55]
    v_mfma_f32_16x16x32_bf16 v[48:51], a[132:135], a[48:51], v[48:51]
    s_waitcnt lgkmcnt(4)
    v_mfma_f32_16x16x32_bf16 v[64:67], a[136:139], a[48:51], v[64:67]
    ds_read_b64_tr_b16 a[152:153], v9 offset:192
    v_mfma_f32_16x16x32_bf16 v[68:71], a[136:139], a[52:55], v[68:71]
    s_add_u32 m0, s48, 33792
    v_mfma_f32_16x16x32_bf16 v[72:75], a[136:139], a[56:59], v[72:75]
    buffer_load_dwordx4 v5, s[28:31], s49 offen lds
    v_mfma_f32_16x16x32_bf16 v[76:79], a[136:139], a[60:63], v[76:79]
    ds_read_b64_tr_b16 a[154:155], v9 offset:1088
    v_mfma_f32_16x16x32_bf16 v[92:95], a[140:143], a[60:63], v[92:95]
    ds_read_b64_tr_b16 a[128:129], v9 offset:2048
    v_mfma_f32_16x16x32_bf16 v[88:91], a[140:143], a[56:59], v[88:91]
    ds_read_b64_tr_b16 a[130:131], v9 offset:2944
    v_mfma_f32_16x16x32_bf16 v[84:87], a[140:143], a[52:55], v[84:87]
    v_mfma_f32_16x16x32_bf16 v[80:83], a[140:143], a[48:51], v[80:83]
    s_waitcnt lgkmcnt(4)
    v_mfma_f32_16x16x32_bf16 v[96:99], a[144:147], a[48:51], v[96:99]
    ds_read_b64_tr_b16 a[132:133], v9 offset:2080
    v_mfma_f32_16x16x32_bf16 v[100:103], a[144:147], a[52:55], v[100:103]
    buffer_load_dwordx4 a[100:103], v3, s[36:39], s50 offen offset:256 sc1
    v_mfma_f32_16x16x32_bf16 v[104:107], a[144:147], a[56:59], v[104:107]
    ds_read_b64_tr_b16 a[134:135], v9 offset:2976
    v_mfma_f32_16x16x32_bf16 v[108:111], a[144:147], a[60:63], v[108:111]
    v_mfma_f32_16x16x32_bf16 v[124:127], a[148:151], a[60:63], v[124:127]
    ds_read_b64_tr_b16 a[136:137], v9 offset:2112
    v_mfma_f32_16x16x32_bf16 v[120:123], a[148:151], a[56:59], v[120:123]
    ds_read_b64_tr_b16 a[138:139], v9 offset:3008
    v_mfma_f32_16x16x32_bf16 v[116:119], a[148:151], a[52:55], v[116:119]
    v_mfma_f32_16x16x32_bf16 v[112:115], a[148:151], a[48:51], v[112:115]
    s_waitcnt lgkmcnt(4)
    v_mfma_f32_16x16x32_bf16 v[128:131], a[152:155], a[48:51], v[128:131]
    buffer_load_dwordx4 v6, s[28:31], s49 offen offset:1024 lds
    v_mfma_f32_16x16x32_bf16 v[132:135], a[152:155], a[52:55], v[132:135]
    ds_read_b64_tr_b16 a[140:141], v9 offset:2144
    v_mfma_f32_16x16x32_bf16 v[136:139], a[152:155], a[56:59], v[136:139]
    ds_read_b64_tr_b16 a[142:143], v9 offset:3040
    v_mfma_f32_16x16x32_bf16 v[140:143], a[152:155], a[60:63], v[140:143]
    v_mfma_f32_16x16x32_bf16 v[156:159], a[128:131], a[60:63], v[156:159]
    ds_read_b64_tr_b16 a[144:145], v9 offset:2176
    v_mfma_f32_16x16x32_bf16 v[152:155], a[128:131], a[56:59], v[152:155]
    ds_read_b64_tr_b16 a[146:147], v9 offset:3072
    v_mfma_f32_16x16x32_bf16 v[148:151], a[128:131], a[52:55], v[148:151]
    v_mfma_f32_16x16x32_bf16 v[144:147], a[128:131], a[48:51], v[144:147]
    buffer_load_dwordx4 a[104:107], v4, s[36:39], s50 offen offset:0 sc1
    s_waitcnt lgkmcnt(4)
    v_mfma_f32_16x16x32_bf16 v[160:163], a[132:135], a[48:51], v[160:163]
    ds_read_b64_tr_b16 a[148:149], v9 offset:2208
    v_mfma_f32_16x16x32_bf16 v[164:167], a[132:135], a[52:55], v[164:167]
    ds_read_b64_tr_b16 a[150:151], v9 offset:3104
    v_mfma_f32_16x16x32_bf16 v[168:171], a[132:135], a[56:59], v[168:171]
    v_mfma_f32_16x16x32_bf16 v[172:175], a[132:135], a[60:63], v[172:175]
    v_mfma_f32_16x16x32_bf16 v[188:191], a[136:139], a[60:63], v[188:191]
    ds_read_b64_tr_b16 a[152:153], v9 offset:2240
    v_mfma_f32_16x16x32_bf16 v[184:187], a[136:139], a[56:59], v[184:187]
    ds_read_b64_tr_b16 a[154:155], v9 offset:3136
    v_mfma_f32_16x16x32_bf16 v[180:183], a[136:139], a[52:55], v[180:183]
    buffer_load_dwordx4 v5, s[32:35], s49 offen offset:2048 lds
    v_mfma_f32_16x16x32_bf16 v[176:179], a[136:139], a[48:51], v[176:179]
    s_waitcnt vmcnt(14)
    s_barrier
    s_waitcnt lgkmcnt(4)
    v_mfma_f32_16x16x32_bf16 v[192:195], a[140:143], a[48:51], v[192:195]
    ds_read_b64_tr_b16 a[128:129], v9 offset:16896
    v_mfma_f32_16x16x32_bf16 v[196:199], a[140:143], a[52:55], v[196:199]
    ds_read_b64_tr_b16 a[130:131], v9 offset:17792
    v_mfma_f32_16x16x32_bf16 v[200:203], a[140:143], a[56:59], v[200:203]
    v_mfma_f32_16x16x32_bf16 v[204:207], a[140:143], a[60:63], v[204:207]
    v_mfma_f32_16x16x32_bf16 v[220:223], a[144:147], a[60:63], v[220:223]
    ds_read_b64_tr_b16 a[132:133], v9 offset:16928
    v_mfma_f32_16x16x32_bf16 v[216:219], a[144:147], a[56:59], v[216:219]
    buffer_load_dwordx4 a[108:111], v4, s[36:39], s50 offen offset:256 sc1
    v_mfma_f32_16x16x32_bf16 v[212:215], a[144:147], a[52:55], v[212:215]
    s_add_u32 s50, s50, 2048
    v_mfma_f32_16x16x32_bf16 v[208:211], a[144:147], a[48:51], v[208:211]
    ds_read_b64_tr_b16 a[134:135], v9 offset:17824
    s_waitcnt lgkmcnt(4)
    v_mfma_f32_16x16x32_bf16 v[224:227], a[148:151], a[48:51], v[224:227]
    ds_read_b64_tr_b16 a[136:137], v9 offset:16960
    v_mfma_f32_16x16x32_bf16 v[228:231], a[148:151], a[52:55], v[228:231]
    ds_read_b64_tr_b16 a[138:139], v9 offset:17856
    v_mfma_f32_16x16x32_bf16 v[232:235], a[148:151], a[56:59], v[232:235]
    v_mfma_f32_16x16x32_bf16 v[236:239], a[148:151], a[60:63], v[236:239]
    v_mfma_f32_16x16x32_bf16 v[252:255], a[152:155], a[60:63], v[252:255]
    buffer_load_dwordx4 v6, s[32:35], s49 offen offset:3072 lds
    v_mfma_f32_16x16x32_bf16 v[248:251], a[152:155], a[56:59], v[248:251]
    s_add_u32 s49, s49, 229376
    v_mfma_f32_16x16x32_bf16 v[244:247], a[152:155], a[52:55], v[244:247]
    ds_read_b64_tr_b16 a[140:141], v9 offset:16992
    v_mfma_f32_16x16x32_bf16 v[240:243], a[152:155], a[48:51], v[240:243]
    ds_read_b64_tr_b16 a[142:143], v9 offset:17888
    s_waitcnt vmcnt(17) lgkmcnt(4)
    v_mfma_f32_16x16x32_bf16 v[32:35], a[128:131], a[64:67], v[32:35]
    ds_read_b64_tr_b16 a[144:145], v9 offset:17024
    v_mfma_f32_16x16x32_bf16 v[36:39], a[128:131], a[68:71], v[36:39]
    ds_read_b64_tr_b16 a[146:147], v9 offset:17920
    v_mfma_f32_16x16x32_bf16 v[40:43], a[128:131], a[72:75], v[40:43]
    v_mfma_f32_16x16x32_bf16 v[44:47], a[128:131], a[76:79], v[44:47]
    buffer_load_dwordx4 a[112:115], v3, s[36:39], s50 offen offset:0 sc1
    v_mfma_f32_16x16x32_bf16 v[60:63], a[132:135], a[76:79], v[60:63]
    ds_read_b64_tr_b16 a[148:149], v9 offset:17056
    v_mfma_f32_16x16x32_bf16 v[56:59], a[132:135], a[72:75], v[56:59]
    ds_read_b64_tr_b16 a[150:151], v9 offset:17952
    v_mfma_f32_16x16x32_bf16 v[52:55], a[132:135], a[68:71], v[52:55]
    v_mfma_f32_16x16x32_bf16 v[48:51], a[132:135], a[64:67], v[48:51]
    s_waitcnt lgkmcnt(4)
    v_mfma_f32_16x16x32_bf16 v[64:67], a[136:139], a[64:67], v[64:67]
    ds_read_b64_tr_b16 a[152:153], v9 offset:17088
    v_mfma_f32_16x16x32_bf16 v[68:71], a[136:139], a[68:71], v[68:71]
    s_add_u32 m0, s48, 50688
    v_mfma_f32_16x16x32_bf16 v[72:75], a[136:139], a[72:75], v[72:75]
    buffer_load_dwordx4 v5, s[28:31], s49 offen lds
    v_mfma_f32_16x16x32_bf16 v[76:79], a[136:139], a[76:79], v[76:79]
    ds_read_b64_tr_b16 a[154:155], v9 offset:17984
    v_mfma_f32_16x16x32_bf16 v[92:95], a[140:143], a[76:79], v[92:95]
    ds_read_b64_tr_b16 a[128:129], v9 offset:18944
    v_mfma_f32_16x16x32_bf16 v[88:91], a[140:143], a[72:75], v[88:91]
    ds_read_b64_tr_b16 a[130:131], v9 offset:19840
    v_mfma_f32_16x16x32_bf16 v[84:87], a[140:143], a[68:71], v[84:87]
    v_mfma_f32_16x16x32_bf16 v[80:83], a[140:143], a[64:67], v[80:83]
    s_waitcnt lgkmcnt(4)
    v_mfma_f32_16x16x32_bf16 v[96:99], a[144:147], a[64:67], v[96:99]
    ds_read_b64_tr_b16 a[132:133], v9 offset:18976
    v_mfma_f32_16x16x32_bf16 v[100:103], a[144:147], a[68:71], v[100:103]
    buffer_load_dwordx4 a[116:119], v3, s[36:39], s50 offen offset:256 sc1
    v_mfma_f32_16x16x32_bf16 v[104:107], a[144:147], a[72:75], v[104:107]
    ds_read_b64_tr_b16 a[134:135], v9 offset:19872
    v_mfma_f32_16x16x32_bf16 v[108:111], a[144:147], a[76:79], v[108:111]
    v_mfma_f32_16x16x32_bf16 v[124:127], a[148:151], a[76:79], v[124:127]
    ds_read_b64_tr_b16 a[136:137], v9 offset:19008
    v_mfma_f32_16x16x32_bf16 v[120:123], a[148:151], a[72:75], v[120:123]
    ds_read_b64_tr_b16 a[138:139], v9 offset:19904
    v_mfma_f32_16x16x32_bf16 v[116:119], a[148:151], a[68:71], v[116:119]
    v_mfma_f32_16x16x32_bf16 v[112:115], a[148:151], a[64:67], v[112:115]
    s_waitcnt lgkmcnt(4)
    v_mfma_f32_16x16x32_bf16 v[128:131], a[152:155], a[64:67], v[128:131]
    buffer_load_dwordx4 v6, s[28:31], s49 offen offset:1024 lds
    v_mfma_f32_16x16x32_bf16 v[132:135], a[152:155], a[68:71], v[132:135]
    ds_read_b64_tr_b16 a[140:141], v9 offset:19040
    v_mfma_f32_16x16x32_bf16 v[136:139], a[152:155], a[72:75], v[136:139]
    ds_read_b64_tr_b16 a[142:143], v9 offset:19936
    v_mfma_f32_16x16x32_bf16 v[140:143], a[152:155], a[76:79], v[140:143]
    v_mfma_f32_16x16x32_bf16 v[156:159], a[128:131], a[76:79], v[156:159]
    ds_read_b64_tr_b16 a[144:145], v9 offset:19072
    v_mfma_f32_16x16x32_bf16 v[152:155], a[128:131], a[72:75], v[152:155]
    ds_read_b64_tr_b16 a[146:147], v9 offset:19968
    v_mfma_f32_16x16x32_bf16 v[148:151], a[128:131], a[68:71], v[148:151]
    v_mfma_f32_16x16x32_bf16 v[144:147], a[128:131], a[64:67], v[144:147]
    buffer_load_dwordx4 a[120:123], v4, s[36:39], s50 offen offset:0 sc1
    s_waitcnt lgkmcnt(4)
    v_mfma_f32_16x16x32_bf16 v[160:163], a[132:135], a[64:67], v[160:163]
    ds_read_b64_tr_b16 a[148:149], v9 offset:19104
    v_mfma_f32_16x16x32_bf16 v[164:167], a[132:135], a[68:71], v[164:167]
    ds_read_b64_tr_b16 a[150:151], v9 offset:20000
    v_mfma_f32_16x16x32_bf16 v[168:171], a[132:135], a[72:75], v[168:171]
    v_mfma_f32_16x16x32_bf16 v[172:175], a[132:135], a[76:79], v[172:175]
    v_mfma_f32_16x16x32_bf16 v[188:191], a[136:139], a[76:79], v[188:191]
    ds_read_b64_tr_b16 a[152:153], v9 offset:19136
    v_mfma_f32_16x16x32_bf16 v[184:187], a[136:139], a[72:75], v[184:187]
    ds_read_b64_tr_b16 a[154:155], v9 offset:20032
    v_mfma_f32_16x16x32_bf16 v[180:183], a[136:139], a[68:71], v[180:183]
    buffer_load_dwordx4 v5, s[32:35], s49 offen offset:2048 lds
    v_mfma_f32_16x16x32_bf16 v[176:179], a[136:139], a[64:67], v[176:179]
    s_waitcnt lgkmcnt(4)
    v_mfma_f32_16x16x32_bf16 v[192:195], a[140:143], a[64:67], v[192:195]
    ds_read_b64_tr_b16 a[128:129], v7 offset:0
    v_mfma_f32_16x16x32_bf16 v[196:199], a[140:143], a[68:71], v[196:199]
    ds_read_b64_tr_b16 a[130:131], v7 offset:896
    v_mfma_f32_16x16x32_bf16 v[200:203], a[140:143], a[72:75], v[200:203]
    v_mfma_f32_16x16x32_bf16 v[204:207], a[140:143], a[76:79], v[204:207]
    v_mfma_f32_16x16x32_bf16 v[220:223], a[144:147], a[76:79], v[220:223]
    ds_read_b64_tr_b16 a[132:133], v7 offset:32
    v_mfma_f32_16x16x32_bf16 v[216:219], a[144:147], a[72:75], v[216:219]
    buffer_load_dwordx4 a[124:127], v4, s[36:39], s50 offen offset:256 sc1
    v_mfma_f32_16x16x32_bf16 v[212:215], a[144:147], a[68:71], v[212:215]
    s_add_u32 s50, s50, 2048
    v_mfma_f32_16x16x32_bf16 v[208:211], a[144:147], a[64:67], v[208:211]
    ds_read_b64_tr_b16 a[134:135], v7 offset:928
    s_waitcnt lgkmcnt(4)
    v_mfma_f32_16x16x32_bf16 v[224:227], a[148:151], a[64:67], v[224:227]
    ds_read_b64_tr_b16 a[136:137], v7 offset:64
    v_mfma_f32_16x16x32_bf16 v[228:231], a[148:151], a[68:71], v[228:231]
    ds_read_b64_tr_b16 a[138:139], v7 offset:960
    v_mfma_f32_16x16x32_bf16 v[232:235], a[148:151], a[72:75], v[232:235]
    v_mfma_f32_16x16x32_bf16 v[236:239], a[148:151], a[76:79], v[236:239]
    v_mfma_f32_16x16x32_bf16 v[252:255], a[152:155], a[76:79], v[252:255]
    buffer_load_dwordx4 v6, s[32:35], s49 offen offset:3072 lds
    v_mfma_f32_16x16x32_bf16 v[248:251], a[152:155], a[72:75], v[248:251]
    s_add_u32 s49, s49, 229376
    v_mfma_f32_16x16x32_bf16 v[244:247], a[152:155], a[68:71], v[244:247]
    ds_read_b64_tr_b16 a[140:141], v7 offset:96
    v_mfma_f32_16x16x32_bf16 v[240:243], a[152:155], a[64:67], v[240:243]
    ds_read_b64_tr_b16 a[142:143], v7 offset:992
    s_waitcnt vmcnt(17) lgkmcnt(4)
    v_mfma_f32_16x16x32_bf16 v[32:35], a[128:131], a[80:83], v[32:35]
    ds_read_b64_tr_b16 a[144:145], v7 offset:128
    v_mfma_f32_16x16x32_bf16 v[36:39], a[128:131], a[84:87], v[36:39]
    ds_read_b64_tr_b16 a[146:147], v7 offset:1024
    v_mfma_f32_16x16x32_bf16 v[40:43], a[128:131], a[88:91], v[40:43]
    v_mfma_f32_16x16x32_bf16 v[44:47], a[128:131], a[92:95], v[44:47]
    buffer_load_dwordx4 a[0:3], v3, s[36:39], s50 offen offset:0 sc1
    v_mfma_f32_16x16x32_bf16 v[60:63], a[132:135], a[92:95], v[60:63]
    ds_read_b64_tr_b16 a[148:149], v7 offset:160
    v_mfma_f32_16x16x32_bf16 v[56:59], a[132:135], a[88:91], v[56:59]
    ds_read_b64_tr_b16 a[150:151], v7 offset:1056
    v_mfma_f32_16x16x32_bf16 v[52:55], a[132:135], a[84:87], v[52:55]
    v_mfma_f32_16x16x32_bf16 v[48:51], a[132:135], a[80:83], v[48:51]
    s_waitcnt lgkmcnt(4)
    v_mfma_f32_16x16x32_bf16 v[64:67], a[136:139], a[80:83], v[64:67]
    ds_read_b64_tr_b16 a[152:153], v7 offset:192
    v_mfma_f32_16x16x32_bf16 v[68:71], a[136:139], a[84:87], v[68:71]
    s_add_u32 m0, s48, 67584
    s_add_u32 s63, s63, 1
    v_mfma_f32_16x16x32_bf16 v[72:75], a[136:139], a[88:91], v[72:75]
    buffer_load_dwordx4 v5, s[28:31], s49 offen lds
    s_and_b32 s57, s63, 1
    v_mfma_f32_16x16x32_bf16 v[76:79], a[136:139], a[92:95], v[76:79]
    ds_read_b64_tr_b16 a[154:155], v7 offset:1088
    s_cmp_eq_u32 s57, s21
    s_cbranch_scc0 P4_t5
    buffer_load_dword v31, v13, s[68:71], 0 offen
    s_mov_b32 s68, s72
    s_mov_b32 s69, s73
    s_mov_b32 s70, s74
    s_mov_b32 s72, s60
    s_mov_b32 s73, s61
    s_mov_b32 s74, s62
    s_mov_b32 s62, 0
P4_t5:
    v_mfma_f32_16x16x32_bf16 v[92:95], a[140:143], a[92:95], v[92:95]
    ds_read_b64_tr_b16 a[128:129], v7 offset:2048
    v_mfma_f32_16x16x32_bf16 v[88:91], a[140:143], a[88:91], v[88:91]
    ds_read_b64_tr_b16 a[130:131], v7 offset:2944
    v_mfma_f32_16x16x32_bf16 v[84:87], a[140:143], a[84:87], v[84:87]
    v_mfma_f32_16x16x32_bf16 v[80:83], a[140:143], a[80:83], v[80:83]
    s_waitcnt lgkmcnt(4)
    v_mfma_f32_16x16x32_bf16 v[96:99], a[144:147], a[80:83], v[96:99]
    ds_read_b64_tr_b16 a[132:133], v7 offset:2080
    v_mfma_f32_16x16x32_bf16 v[100:103], a[144:147], a[84:87], v[100:103]
    buffer_load_dwordx4 a[4:7], v3, s[36:39], s50 offen offset:256 sc1
    v_mfma_f32_16x16x32_bf16 v[104:107], a[144:147], a[88:91], v[104:107]
    ds_read_b64_tr_b16 a[134:135], v7 offset:2976
    v_mfma_f32_16x16x32_bf16 v[108:111], a[144:147], a[92:95], v[108:111]
    v_mfma_f32_16x16x32_bf16 v[124:127], a[148:151], a[92:95], v[124:127]
    ds_read_b64_tr_b16 a[136:137], v7 offset:2112
    v_mfma_f32_16x16x32_bf16 v[120:123], a[148:151], a[88:91], v[120:123]
    ds_read_b64_tr_b16 a[138:139], v7 offset:3008
    v_mfma_f32_16x16x32_bf16 v[116:119], a[148:151], a[84:87], v[116:119]
    v_mfma_f32_16x16x32_bf16 v[112:115], a[148:151], a[80:83], v[112:115]
    s_waitcnt lgkmcnt(4)
    v_mfma_f32_16x16x32_bf16 v[128:131], a[152:155], a[80:83], v[128:131]
    buffer_load_dwordx4 v6, s[28:31], s49 offen offset:1024 lds
    v_mfma_f32_16x16x32_bf16 v[132:135], a[152:155], a[84:87], v[132:135]
    ds_read_b64_tr_b16 a[140:141], v7 offset:2144
    v_mfma_f32_16x16x32_bf16 v[136:139], a[152:155], a[88:91], v[136:139]
    ds_read_b64_tr_b16 a[142:143], v7 offset:3040
    v_mfma_f32_16x16x32_bf16 v[140:143], a[152:155], a[92:95], v[140:143]
    v_mfma_f32_16x16x32_bf16 v[156:159], a[128:131], a[92:95], v[156:159]
    ds_read_b64_tr_b16 a[144:145], v7 offset:2176
    v_mfma_f32_16x16x32_bf16 v[152:155], a[128:131], a[88:91], v[152:155]
    ds_read_b64_tr_b16 a[146:147], v7 offset:3072
    v_mfma_f32_16x16x32_bf16 v[148:151], a[128:131], a[84:87], v[148:151]
    v_mfma_f32_16x16x32_bf16 v[144:147], a[128:131], a[80:83], v[144:147]
    buffer_load_dwordx4 a[8:11], v4, s[36:39], s50 offen offset:0 sc1
    s_waitcnt lgkmcnt(4)
    v_mfma_f32_16x16x32_bf16 v[160:163], a[132:135], a[80:83], v[160:163]
    ds_read_b64_tr_b16 a[148:149], v7 offset:2208
    v_mfma_f32_16x16x32_bf16 v[164:167], a[132:135], a[84:87], v[164:167]
    ds_read_b64_tr_b16 a[150:151], v7 offset:3104
    v_mfma_f32_16x16x32_bf16 v[168:171], a[132:135], a[88:91], v[168:171]
    v_mfma_f32_16x16x32_bf16 v[172:175], a[132:135], a[92:95], v[172:175]
    v_mfma_f32_16x16x32_bf16 v[188:191], a[136:139], a[92:95], v[188:191]
    ds_read_b64_tr_b16 a[152:153], v7 offset:2240
    v_mfma_f32_16x16x32_bf16 v[184:187], a[136:139], a[88:91], v[184:187]
    ds_read_b64_tr_b16 a[154:155], v7 offset:3136
    v_mfma_f32_16x16x32_bf16 v[180:183], a[136:139], a[84:87], v[180:183]
    buffer_load_dwordx4 v5, s[32:35], s49 offen offset:2048 lds
    v_mfma_f32_16x16x32_bf16 v[176:179], a[136:139], a[80:83], v[176:179]
    s_waitcnt vmcnt(14)
    s_barrier
    s_waitcnt lgkmcnt(4)
    v_mfma_f32_16x16x32_bf16 v[192:195], a[140:143], a[80:83], v[192:195]
    ds_read_b64_tr_b16 a[128:129], v7 offset:16896
    v_mfma_f32_16x16x32_bf16 v[196:199], a[140:143], a[84:87], v[196:199]
    ds_read_b64_tr_b16 a[130:131], v7 offset:17792
    v_mfma_f32_16x16x32_bf16 v[200:203], a[140:143], a[88:91], v[200:203]
    v_mfma_f32_16x16x32_bf16 v[204:207], a[140:143], a[92:95], v[204:207]
    v_mfma_f32_16x16x32_bf16 v[220:223], a[144:147], a[92:95], v[220:223]
    ds_read_b64_tr_b16 a[132:133], v7 offset:16928
    v_mfma_f32_16x16x32_bf16 v[216:219], a[144:147], a[88:91], v[216:219]
    buffer_load_dwordx4 a[12:15], v4, s[36:39], s50 offen offset:256 sc1
    v_mfma_f32_16x16x32_bf16 v[212:215], a[144:147], a[84:87], v[212:215]
    s_add_u32 s50, s50, 2048
    v_mfma_f32_16x16x32_bf16 v[208:211], a[144:147], a[80:83], v[208:211]
    ds_read_b64_tr_b16 a[134:135], v7 offset:17824
    s_waitcnt lgkmcnt(4)
    v_mfma_f32_16x16x32_bf16 v[224:227], a[148:151], a[80:83], v[224:227]
    ds_read_b64_tr_b16 a[136:137], v7 offset:16960
    v_mfma_f32_16x16x32_bf16 v[228:231], a[148:151], a[84:87], v[228:231]
    ds_read_b64_tr_b16 a[138:139], v7 offset:17856
    v_mfma_f32_16x16x32_bf16 v[232:235], a[148:151], a[88:91], v[232:235]
    v_mfma_f32_16x16x32_bf16 v[236:239], a[148:151], a[92:95], v[236:239]
    v_mfma_f32_16x16x32_bf16 v[252:255], a[152:155], a[92:95], v[252:255]
    buffer_load_dwordx4 v6, s[32:35], s49 offen offset:3072 lds
    v_mfma_f32_16x16x32_bf16 v[248:251], a[152:155], a[88:91], v[248:251]
    s_add_u32 s49, s49, 229376
    v_mfma_f32_16x16x32_bf16 v[244:247], a[152:155], a[84:87], v[244:247]
    ds_read_b64_tr_b16 a[140:141], v7 offset:16992
    v_mfma_f32_16x16x32_bf16 v[240:243], a[152:155], a[80:83], v[240:243]
    ds_read_b64_tr_b16 a[142:143], v7 offset:17888
    s_waitcnt vmcnt(17) lgkmcnt(4)
    v_mfma_f32_16x16x32_bf16 v[32:35], a[128:131], a[96:99], v[32:35]
    ds_read_b64_tr_b16 a[144:145], v7 offset:17024
    v_mfma_f32_16x16x32_bf16 v[36:39], a[128:131], a[100:103], v[36:39]
    ds_read_b64_tr_b16 a[146:147], v7 offset:17920
    v_mfma_f32_16x16x32_bf16 v[40:43], a[128:131], a[104:107], v[40:43]
    v_mfma_f32_16x16x32_bf16 v[44:47], a[128:131], a[108:111], v[44:47]
    buffer_load_dwordx4 a[16:19], v3, s[36:39], s50 offen offset:0 sc1
    v_mfma_f32_16x16x32_bf16 v[60:63], a[132:135], a[108:111], v[60:63]
    ds_read_b64_tr_b16 a[148:149], v7 offset:17056
    v_mfma_f32_16x16x32_bf16 v[56:59], a[132:135], a[104:107], v[56:59]
    ds_read_b64_tr_b16 a[150:151], v7 offset:17952
    v_mfma_f32_16x16x32_bf16 v[52:55], a[132:135], a[100:103], v[52:55]
    v_mfma_f32_16x16x32_bf16 v[48:51], a[132:135], a[96:99], v[48:51]
    s_waitcnt lgkmcnt(4)
    v_mfma_f32_16x16x32_bf16 v[64:67], a[136:139], a[96:99], v[64:67]
    ds_read_b64_tr_b16 a[152:153], v7 offset:17088
    v_mfma_f32_16x16x32_bf16 v[68:71], a[136:139], a[100:103], v[68:71]
    s_add_u32 m0, s48, 84480
    v_mfma_f32_16x16x32_bf16 v[72:75], a[136:139], a[104:107], v[72:75]
    buffer_load_dwordx4 v5, s[28:31], s49 offen lds
    v_mfma_f32_16x16x32_bf16 v[76:79], a[136:139], a[108:111], v[76:79]
    ds_read_b64_tr_b16 a[154:155], v7 offset:17984
    v_mfma_f32_16x16x32_bf16 v[92:95], a[140:143], a[108:111], v[92:95]
    ds_read_b64_tr_b16 a[128:129], v7 offset:18944
    v_mfma_f32_16x16x32_bf16 v[88:91], a[140:143], a[104:107], v[88:91]
    ds_read_b64_tr_b16 a[130:131], v7 offset:19840
    v_mfma_f32_16x16x32_bf16 v[84:87], a[140:143], a[100:103], v[84:87]
    v_mfma_f32_16x16x32_bf16 v[80:83], a[140:143], a[96:99], v[80:83]
    s_waitcnt lgkmcnt(4)
    v_mfma_f32_16x16x32_bf16 v[96:99], a[144:147], a[96:99], v[96:99]
    ds_read_b64_tr_b16 a[132:133], v7 offset:18976
    v_mfma_f32_16x16x32_bf16 v[100:103], a[144:147], a[100:103], v[100:103]
    buffer_load_dwordx4 a[20:23], v3, s[36:39], s50 offen offset:256 sc1
    v_mfma_f32_16x16x32_bf16 v[104:107], a[144:147], a[104:107], v[104:107]
    ds_read_b64_tr_b16 a[134:135], v7 offset:19872
    v_mfma_f32_16x16x32_bf16 v[108:111], a[144:147], a[108:111], v[108:111]
    v_mfma_f32_16x16x32_bf16 v[124:127], a[148:151], a[108:111], v[124:127]
    ds_read_b64_tr_b16 a[136:137], v7 offset:19008
    v_mfma_f32_16x16x32_bf16 v[120:123], a[148:151], a[104:107], v[120:123]
    ds_read_b64_tr_b16 a[138:139], v7 offset:19904
    v_mfma_f32_16x16x32_bf16 v[116:119], a[148:151], a[100:103], v[116:119]
    v_mfma_f32_16x16x32_bf16 v[112:115], a[148:151], a[96:99], v[112:115]
    s_waitcnt lgkmcnt(4)
    v_mfma_f32_16x16x32_bf16 v[128:131], a[152:155], a[96:99], v[128:131]
    buffer_load_dwordx4 v6, s[28:31], s49 offen offset:1024 lds
    v_mfma_f32_16x16x32_bf16 v[132:135], a[152:155], a[100:103], v[132:135]
    ds_read_b64_tr_b16 a[140:141], v7 offset:19040
    v_mfma_f32_16x16x32_bf16 v[136:139], a[152:155], a[104:107], v[136:139]
    ds_read_b64_tr_b16 a[142:143], v7 offset:19936
    v_mfma_f32_16x16x32_bf16 v[140:143], a[152:155], a[108:111], v[140:143]
    v_mfma_f32_16x16x32_bf16 v[156:159], a[128:131], a[108:111], v[156:159]
    ds_read_b64_tr_b16 a[144:145], v7 offset:19072
    v_mfma_f32_16x16x32_bf16 v[152:155], a[128:131], a[104:107], v[152:155]
    ds_read_b64_tr_b16 a[146:147], v7 offset:19968
    v_mfma_f32_16x16x32_bf16 v[148:151], a[128:131], a[100:103], v[148:151]
    v_mfma_f32_16x16x32_bf16 v[144:147], a[128:131], a[96:99], v[144:147]
    buffer_load_dwordx4 a[24:27], v4, s[36:39], s50 offen offset:0 sc1
    s_waitcnt lgkmcnt(4)
    v_mfma_f32_16x16x32_bf16 v[160:163], a[132:135], a[96:99], v[160:163]
    ds_read_b64_tr_b16 a[148:149], v7 offset:19104
    v_mfma_f32_16x16x32_bf16 v[164:167], a[132:135], a[100:103], v[164:167]
    ds_read_b64_tr_b16 a[150:151], v7 offset:20000
    v_mfma_f32_16x16x32_bf16 v[168:171], a[132:135], a[104:107], v[168:171]
    v_mfma_f32_16x16x32_bf16 v[172:175], a[132:135], a[108:111], v[172:175]
    v_mfma_f32_16x16x32_bf16 v[188:191], a[136:139], a[108:111], v[188:191]
    ds_read_b64_tr_b16 a[152:153], v7 offset:19136
    v_mfma_f32_16x16x32_bf16 v[184:187], a[136:139], a[104:107], v[184:187]
    ds_read_b64_tr_b16 a[154:155], v7 offset:20032
    v_mfma_f32_16x16x32_bf16 v[180:183], a[136:139], a[100:103], v[180:183]
    buffer_load_dwordx4 v5, s[32:35], s49 offen offset:2048 lds
    v_mfma_f32_16x16x32_bf16 v[176:179], a[136:139], a[96:99], v[176:179]
    s_waitcnt lgkmcnt(4)
    v_mfma_f32_16x16x32_bf16 v[192:195], a[140:143], a[96:99], v[192:195]
    ds_read_b64_tr_b16 a[128:129], v7 offset:33792
    v_mfma_f32_16x16x32_bf16 v[196:199], a[140:143], a[100:103], v[196:199]
    ds_read_b64_tr_b16 a[130:131], v7 offset:34688
    v_mfma_f32_16x16x32_bf16 v[200:203], a[140:143], a[104:107], v[200:203]
    v_mfma_f32_16x16x32_bf16 v[204:207], a[140:143], a[108:111], v[204:207]
    v_mfma_f32_16x16x32_bf16 v[220:223], a[144:147], a[108:111], v[220:223]
    ds_read_b64_tr_b16 a[132:133], v7 offset:33824
    v_mfma_f32_16x16x32_bf16 v[216:219], a[144:147], a[104:107], v[216:219]
    buffer_load_dwordx4 a[28:31], v4, s[36:39], s50 offen offset:256 sc1
    v_mfma_f32_16x16x32_bf16 v[212:215], a[144:147], a[100:103], v[212:215]
    s_add_u32 s50, s50, 2048
    v_mfma_f32_16x16x32_bf16 v[208:211], a[144:147], a[96:99], v[208:211]
    ds_read_b64_tr_b16 a[134:135], v7 offset:34720
    s_waitcnt lgkmcnt(4)
    v_mfma_f32_16x16x32_bf16 v[224:227], a[148:151], a[96:99], v[224:227]
    ds_read_b64_tr_b16 a[136:137], v7 offset:33856
    v_mfma_f32_16x16x32_bf16 v[228:231], a[148:151], a[100:103], v[228:231]
    ds_read_b64_tr_b16 a[138:139], v7 offset:34752
    v_mfma_f32_16x16x32_bf16 v[232:235], a[148:151], a[104:107], v[232:235]
    v_mfma_f32_16x16x32_bf16 v[236:239], a[148:151], a[108:111], v[236:239]
    v_mfma_f32_16x16x32_bf16 v[252:255], a[152:155], a[108:111], v[252:255]
    buffer_load_dwordx4 v6, s[32:35], s49 offen offset:3072 lds
    v_mfma_f32_16x16x32_bf16 v[248:251], a[152:155], a[104:107], v[248:251]
    s_add_u32 s49, s49, 229376
    v_mfma_f32_16x16x32_bf16 v[244:247], a[152:155], a[100:103], v[244:247]
    ds_read_b64_tr_b16 a[140:141], v7 offset:33888
    v_mfma_f32_16x16x32_bf16 v[240:243], a[152:155], a[96:99], v[240:243]
    ds_read_b64_tr_b16 a[142:143], v7 offset:34784
    s_waitcnt vmcnt(17) lgkmcnt(4)
    v_mfma_f32_16x16x32_bf16 v[32:35], a[128:131], a[112:115], v[32:35]
    ds_read_b64_tr_b16 a[144:145], v7 offset:33920
    v_mfma_f32_16x16x32_bf16 v[36:39], a[128:131], a[116:119], v[36:39]
    ds_read_b64_tr_b16 a[146:147], v7 offset:34816
    v_mfma_f32_16x16x32_bf16 v[40:43], a[128:131], a[120:123], v[40:43]
    v_mfma_f32_16x16x32_bf16 v[44:47], a[128:131], a[124:127], v[44:47]
    buffer_load_dwordx4 a[32:35], v3, s[36:39], s50 offen offset:0 sc1
    v_mfma_f32_16x16x32_bf16 v[60:63], a[132:135], a[124:127], v[60:63]
    ds_read_b64_tr_b16 a[148:149], v7 offset:33952
    v_mfma_f32_16x16x32_bf16 v[56:59], a[132:135], a[120:123], v[56:59]
    ds_read_b64_tr_b16 a[150:151], v7 offset:34848
    v_mfma_f32_16x16x32_bf16 v[52:55], a[132:135], a[116:119], v[52:55]
    v_mfma_f32_16x16x32_bf16 v[48:51], a[132:135], a[112:115], v[48:51]
    s_waitcnt lgkmcnt(4)
    v_mfma_f32_16x16x32_bf16 v[64:67], a[136:139], a[112:115], v[64:67]
    ds_read_b64_tr_b16 a[152:153], v7 offset:33984
    v_mfma_f32_16x16x32_bf16 v[68:71], a[136:139], a[116:119], v[68:71]
    s_add_u32 m0, s48, 101376
    v_mfma_f32_16x16x32_bf16 v[72:75], a[136:139], a[120:123], v[72:75]
    buffer_load_dwordx4 v5, s[28:31], s49 offen lds
    v_mfma_f32_16x16x32_bf16 v[76:79], a[136:139], a[124:127], v[76:79]
    ds_read_b64_tr_b16 a[154:155], v7 offset:34880
    v_mfma_f32_16x16x32_bf16 v[92:95], a[140:143], a[124:127], v[92:95]
    ds_read_b64_tr_b16 a[128:129], v7 offset:35840
    v_mfma_f32_16x16x32_bf16 v[88:91], a[140:143], a[120:123], v[88:91]
    ds_read_b64_tr_b16 a[130:131], v7 offset:36736
    v_mfma_f32_16x16x32_bf16 v[84:87], a[140:143], a[116:119], v[84:87]
    v_mfma_f32_16x16x32_bf16 v[80:83], a[140:143], a[112:115], v[80:83]
    s_waitcnt lgkmcnt(4)
    v_mfma_f32_16x16x32_bf16 v[96:99], a[144:147], a[112:115], v[96:99]
    ds_read_b64_tr_b16 a[132:133], v7 offset:35872
    v_mfma_f32_16x16x32_bf16 v[100:103], a[144:147], a[116:119], v[100:103]
    buffer_load_dwordx4 a[36:39], v3, s[36:39], s50 offen offset:256 sc1
    v_mfma_f32_16x16x32_bf16 v[104:107], a[144:147], a[120:123], v[104:107]
    ds_read_b64_tr_b16 a[134:135], v7 offset:36768
    v_mfma_f32_16x16x32_bf16 v[108:111], a[144:147], a[124:127], v[108:111]
    v_mfma_f32_16x16x32_bf16 v[124:127], a[148:151], a[124:127], v[124:127]
    ds_read_b64_tr_b16 a[136:137], v7 offset:35904
    v_mfma_f32_16x16x32_bf16 v[120:123], a[148:151], a[120:123], v[120:123]
    ds_read_b64_tr_b16 a[138:139], v7 offset:36800
    v_mfma_f32_16x16x32_bf16 v[116:119], a[148:151], a[116:119], v[116:119]
    v_mfma_f32_16x16x32_bf16 v[112:115], a[148:151], a[112:115], v[112:115]
    s_waitcnt lgkmcnt(4)
    v_mfma_f32_16x16x32_bf16 v[128:131], a[152:155], a[112:115], v[128:131]
    buffer_load_dwordx4 v6, s[28:31], s49 offen offset:1024 lds
    v_mfma_f32_16x16x32_bf16 v[132:135], a[152:155], a[116:119], v[132:135]
    ds_read_b64_tr_b16 a[140:141], v7 offset:35936
    v_mfma_f32_16x16x32_bf16 v[136:139], a[152:155], a[120:123], v[136:139]
    ds_read_b64_tr_b16 a[142:143], v7 offset:36832
    v_mfma_f32_16x16x32_bf16 v[140:143], a[152:155], a[124:127], v[140:143]
    v_mfma_f32_16x16x32_bf16 v[156:159], a[128:131], a[124:127], v[156:159]
    ds_read_b64_tr_b16 a[144:145], v7 offset:35968
    v_mfma_f32_16x16x32_bf16 v[152:155], a[128:131], a[120:123], v[152:155]
    ds_read_b64_tr_b16 a[146:147], v7 offset:36864
    v_mfma_f32_16x16x32_bf16 v[148:151], a[128:131], a[116:119], v[148:151]
    v_mfma_f32_16x16x32_bf16 v[144:147], a[128:131], a[112:115], v[144:147]
    buffer_load_dwordx4 a[40:43], v4, s[36:39], s50 offen offset:0 sc1
    s_waitcnt lgkmcnt(4)
    v_mfma_f32_16x16x32_bf16 v[160:163], a[132:135], a[112:115], v[160:163]
    ds_read_b64_tr_b16 a[148:149], v7 offset:36000
    v_mfma_f32_16x16x32_bf16 v[164:167], a[132:135], a[116:119], v[164:167]
    ds_read_b64_tr_b16 a[150:151], v7 offset:36896
    v_mfma_f32_16x16x32_bf16 v[168:171], a[132:135], a[120:123], v[168:171]
    v_mfma_f32_16x16x32_bf16 v[172:175], a[132:135], a[124:127], v[172:175]
    v_mfma_f32_16x16x32_bf16 v[188:191], a[136:139], a[124:127], v[188:191]
    ds_read_b64_tr_b16 a[152:153], v7 offset:36032
    v_mfma_f32_16x16x32_bf16 v[184:187], a[136:139], a[120:123], v[184:187]
    ds_read_b64_tr_b16 a[154:155], v7 offset:36928
    v_mfma_f32_16x16x32_bf16 v[180:183], a[136:139], a[116:119], v[180:183]
    buffer_load_dwordx4 v5, s[32:35], s49 offen offset:2048 lds
    v_mfma_f32_16x16x32_bf16 v[176:179], a[136:139], a[112:115], v[176:179]
    s_waitcnt vmcnt(14)
    s_barrier
    s_waitcnt lgkmcnt(4)
    v_mfma_f32_16x16x32_bf16 v[192:195], a[140:143], a[112:115], v[192:195]
    ds_read_b64_tr_b16 a[128:129], v8 offset:0
    v_mfma_f32_16x16x32_bf16 v[196:199], a[140:143], a[116:119], v[196:199]
    ds_read_b64_tr_b16 a[130:131], v8 offset:896
    v_mfma_f32_16x16x32_bf16 v[200:203], a[140:143], a[120:123], v[200:203]
    v_mfma_f32_16x16x32_bf16 v[204:207], a[140:143], a[124:127], v[204:207]
    v_mfma_f32_16x16x32_bf16 v[220:223], a[144:147], a[124:127], v[220:223]
    ds_read_b64_tr_b16 a[132:133], v8 offset:32
    v_mfma_f32_16x16x32_bf16 v[216:219], a[144:147], a[120:123], v[216:219]
    buffer_load_dwordx4 a[44:47], v4, s[36:39], s50 offen offset:256 sc1
    v_mfma_f32_16x16x32_bf16 v[212:215], a[144:147], a[116:119], v[212:215]
    s_add_u32 s50, s50, 2048
    v_mfma_f32_16x16x32_bf16 v[208:211], a[144:147], a[112:115], v[208:211]
    ds_read_b64_tr_b16 a[134:135], v8 offset:928
    s_waitcnt lgkmcnt(4)
    v_mfma_f32_16x16x32_bf16 v[224:227], a[148:151], a[112:115], v[224:227]
    ds_read_b64_tr_b16 a[136:137], v8 offset:64
    v_mfma_f32_16x16x32_bf16 v[228:231], a[148:151], a[116:119], v[228:231]
    ds_read_b64_tr_b16 a[138:139], v8 offset:960
    v_mfma_f32_16x16x32_bf16 v[232:235], a[148:151], a[120:123], v[232:235]
    v_mfma_f32_16x16x32_bf16 v[236:239], a[148:151], a[124:127], v[236:239]
    v_mfma_f32_16x16x32_bf16 v[252:255], a[152:155], a[124:127], v[252:255]
    buffer_load_dwordx4 v6, s[32:35], s49 offen offset:3072 lds
    v_mfma_f32_16x16x32_bf16 v[248:251], a[152:155], a[120:123], v[248:251]
    s_add_u32 s49, s49, 229376
    v_mfma_f32_16x16x32_bf16 v[244:247], a[152:155], a[116:119], v[244:247]
    ds_read_b64_tr_b16 a[140:141], v8 offset:96
    v_mfma_f32_16x16x32_bf16 v[240:243], a[152:155], a[112:115], v[240:243]
    ds_read_b64_tr_b16 a[142:143], v8 offset:992
    s_sub_u32 s51, s51, 1
    s_cmp_lg_u32 s51, 0
    s_cbranch_scc1 P4_loop
    s_waitcnt vmcnt(17) lgkmcnt(4)
    v_mfma_f32_16x16x32_bf16 v[32:35], a[128:131], a[0:3], v[32:35]
    ds_read_b64_tr_b16 a[144:145], v8 offset:128
    v_mfma_f32_16x16x32_bf16 v[36:39], a[128:131], a[4:7], v[36:39]
    s_cmp_lg_u32 s3, 1
    s_cbranch_scc1 CT_13
    s_getpc_b64 s[0:1]
CTH_14:
    s_add_u32 s0, s0, C_p4t-CTH_14
    s_addc_u32 s1, s1, (C_p4t-CTH_14)>>32
    s_lshr_b32 s52, s2, 3
    s_mul_i32 s52, s52, ((C_p5t-C_p4t)/4096+1)
    v_min_u32 v10, ((C_p5t-C_p4t)/4096), v0
    v_add_u32 v10, s52, v10
    v_min_u32 v10, ((C_p5t-C_p4t)/128), v10
    v_lshlrev_b32 v10, 7, v10
    v_mov_b32 v11, s1
    v_add_co_u32 v10, vcc, s0, v10
    s_nop 1
    v_addc_co_u32 v11, vcc, 0, v11, vcc
    global_load_dword v12, v[10:11], off
CT_13:
    v_mfma_f32_16x16x32_bf16 v[40:43], a[128:131], a[8:11], v[40:43]
    v_add_f32 v14, v14, v18
    v_mfma_f32_16x16x32_bf16 v[44:47], a[128:131], a[12:15], v[44:47]
    ds_read_b64_tr_b16 a[146:147], v8 offset:1024
    buffer_load_dwordx4 a[48:51], v3, s[36:39], s50 offen offset:0 sc1
    v_mfma_f32_16x16x32_bf16 v[60:63], a[132:135], a[12:15], v[60:63]
    v_add_f32 v15, v15, v19
    v_mfma_f32_16x16x32_bf16 v[56:59], a[132:135], a[8:11], v[56:59]
    ds_read_b64_tr_b16 a[148:149], v8 offset:160
    v_mfma_f32_16x16x32_bf16 v[52:55], a[132:135], a[4:7], v[52:55]
    ds_read_b64_tr_b16 a[150:151], v8 offset:1056
    v_mfma_f32_16x16x32_bf16 v[48:51], a[132:135], a[0:3], v[48:51]
    v_add_f32 v16, v16, v20
    s_waitcnt lgkmcnt(4)
    v_mfma_f32_16x16x32_bf16 v[64:67], a[136:139], a[0:3], v[64:67]
    ds_read_b64_tr_b16 a[152:153], v8 offset:192
    v_mfma_f32_16x16x32_bf16 v[68:71], a[136:139], a[4:7], v[68:71]
    s_add_u32 m0, s48, 118272
    v_add_f32 v17, v17, v21
    v_mfma_f32_16x16x32_bf16 v[72:75], a[136:139], a[8:11], v[72:75]
    buffer_load_dwordx4 v5, s[28:31], s49 offen lds
    v_mfma_f32_16x16x32_bf16 v[76:79], a[136:139], a[12:15], v[76:79]
    ds_read_b64_tr_b16 a[154:155], v8 offset:1088
    v_mfma_f32_16x16x32_bf16 v[92:95], a[140:143], a[12:15], v[92:95]
    v_add_f32 v22, v22, v26
    v_mfma_f32_16x16x32_bf16 v[88:91], a[140:143], a[8:11], v[88:91]
    ds_read_b64_tr_b16 a[128:129], v8 offset:2048
    v_mfma_f32_16x16x32_bf16 v[84:87], a[140:143], a[4:7], v[84:87]
    ds_read_b64_tr_b16 a[130:131], v8 offset:2944
    v_mfma_f32_16x16x32_bf16 v[80:83], a[140:143], a[0:3], v[80:83]
    v_add_f32 v23, v23, v27
    s_waitcnt lgkmcnt(4)
    v_mfma_f32_16x16x32_bf16 v[96:99], a[144:147], a[0:3], v[96:99]
    ds_read_b64_tr_b16 a[132:133], v8 offset:2080
    v_mfma_f32_16x16x32_bf16 v[100:103], a[144:147], a[4:7], v[100:103]
    buffer_load_dwordx4 a[52:55], v3, s[36:39], s50 offen offset:256 sc1
    v_add_f32 v24, v24, v28
    v_mfma_f32_16x16x32_bf16 v[104:107], a[144:147], a[8:11], v[104:107]
    ds_read_b64_tr_b16 a[134:135], v8 offset:2976
    v_mfma_f32_16x16x32_bf16 v[108:111], a[144:147], a[12:15], v[108:111]
    v_mfma_f32_16x16x32_bf16 v[124:127], a[148:151], a[12:15], v[124:127]
    v_add_f32 v25, v25, v29
    v_mfma_f32_16x16x32_bf16 v[120:123], a[148:151], a[8:11], v[120:123]
    ds_read_b64_tr_b16 a[136:137], v8 offset:2112
    v_mfma_f32_16x16x32_bf16 v[116:119], a[148:151], a[4:7], v[116:119]
    v_add_f32 v14, v14, v22
    v_mfma_f32_16x16x32_bf16 v[112:115], a[148:151], a[0:3], v[112:115]
    ds_read_b64_tr_b16 a[138:139], v8 offset:3008
    s_waitcnt lgkmcnt(4)
    v_mfma_f32_16x16x32_bf16 v[128:131], a[152:155], a[0:3], v[128:131]
    buffer_load_dwordx4 v6, s[28:31], s49 offen offset:1024 lds
    v_mfma_f32_16x16x32_bf16 v[132:135], a[152:155], a[4:7], v[132:135]
    v_add_f32 v15, v15, v23
    v_mfma_f32_16x16x32_bf16 v[136:139], a[152:155], a[8:11], v[136:139]
    ds_read_b64_tr_b16 a[140:141], v8 offset:2144
    v_mfma_f32_16x16x32_bf16 v[140:143], a[152:155], a[12:15], v[140:143]
    ds_read_b64_tr_b16 a[142:143], v8 offset:3040
    v_mfma_f32_16x16x32_bf16 v[156:159], a[128:131], a[12:15], v[156:159]
    v_add_f32 v16, v16, v24
    v_mfma_f32_16x16x32_bf16 v[152:155], a[128:131], a[8:11], v[152:155]
    ds_read_b64_tr_b16 a[144:145], v8 offset:2176
    v_mfma_f32_16x16x32_bf16 v[148:151], a[128:131], a[4:7], v[148:151]
    v_add_f32 v17, v17, v25
    v_mfma_f32_16x16x32_bf16 v[144:147], a[128:131], a[0:3], v[144:147]
    ds_read_b64_tr_b16 a[146:147], v8 offset:3072
    buffer_load_dwordx4 a[56:59], v4, s[36:39], s50 offen offset:0 sc1
    s_waitcnt lgkmcnt(4)
    v_mfma_f32_16x16x32_bf16 v[160:163], a[132:135], a[0:3], v[160:163]
    ds_read_b64_tr_b16 a[148:149], v8 offset:2208
    v_mfma_f32_16x16x32_bf16 v[164:167], a[132:135], a[4:7], v[164:167]
    v_mov_b32 v18, v14
    v_mfma_f32_16x16x32_bf16 v[168:171], a[132:135], a[8:11], v[168:171]
    ds_read_b64_tr_b16 a[150:151], v8 offset:3104
    v_mfma_f32_16x16x32_bf16 v[172:175], a[132:135], a[12:15], v[172:175]
    v_mov_b32 v19, v15
    v_mfma_f32_16x16x32_bf16 v[188:191], a[136:139], a[12:15], v[188:191]
    ds_read_b64_tr_b16 a[152:153], v8 offset:2240
    v_mfma_f32_16x16x32_bf16 v[184:187], a[136:139], a[8:11], v[184:187]
    ds_read_b64_tr_b16 a[154:155], v8 offset:3136
    v_mfma_f32_16x16x32_bf16 v[180:183], a[136:139], a[4:7], v[180:183]
    buffer_load_dwordx4 v5, s[32:35], s49 offen offset:2048 lds
    v_mov_b32 v20, v16
    v_mfma_f32_16x16x32_bf16 v[176:179], a[136:139], a[0:3], v[176:179]
    s_waitcnt lgkmcnt(4)
    v_mfma_f32_16x16x32_bf16 v[192:195], a[140:143], a[0:3], v[192:195]
    ds_read_b64_tr_b16 a[128:129], v8 offset:16896
    v_mfma_f32_16x16x32_bf16 v[196:199], a[140:143], a[4:7], v[196:199]
    v_mov_b32 v21, v17
    v_mfma_f32_16x16x32_bf16 v[200:203], a[140:143], a[8:11], v[200:203]
    ds_read_b64_tr_b16 a[130:131], v8 offset:17792
    v_mfma_f32_16x16x32_bf16 v[204:207], a[140:143], a[12:15], v[204:207]
    v_permlane16_swap_b32 v18, v14
    v_mfma_f32_16x16x32_bf16 v[220:223], a[144:147], a[12:15], v[220:223]
    ds_read_b64_tr_b16 a[132:133], v8 offset:16928
    v_mfma_f32_16x16x32_bf16 v[216:219], a[144:147], a[8:11], v[216:219]
    buffer_load_dwordx4 a[60:63], v4, s[36:39], s50 offen offset:256 sc1
    v_mfma_f32_16x16x32_bf16 v[212:215], a[144:147], a[4:7], v[212:215]
    s_add_u32 s50, s50, 2048
    v_permlane16_swap_b32 v19, v15
    v_mfma_f32_16x16x32_bf16 v[208:211], a[144:147], a[0:3], v[208:211]
    ds_read_b64_tr_b16 a[134:135], v8 offset:17824
    s_waitcnt lgkmcnt(4)
    v_mfma_f32_16x16x32_bf16 v[224:227], a[148:151], a[0:3], v[224:227]
    v_permlane16_swap_b32 v20, v16
    v_mfma_f32_16x16x32_bf16 v[228:231], a[148:151], a[4:7], v[228:231]
    ds_read_b64_tr_b16 a[136:137], v8 offset:16960
    v_mfma_f32_16x16x32_bf16 v[232:235], a[148:151], a[8:11], v[232:235]
    ds_read_b64_tr_b16 a[138:139], v8 offset:17856
    v_mfma_f32_16x16x32_bf16 v[236:239], a[148:151], a[12:15], v[236:239]
    v_permlane16_swap_b32 v21, v17
    v_mfma_f32_16x16x32_bf16 v[252:255], a[152:155], a[12:15], v[252:255]
    buffer_load_dwordx4 v6, s[32:35], s49 offen offset:3072 lds
    v_mfma_f32_16x16x32_bf16 v[248:251], a[152:155], a[8:11], v[248:251]
    s_add_u32 s49, s49, 229376
    v_mfma_f32_16x16x32_bf16 v[244:247], a[152:155], a[4:7], v[244:247]
    ds_read_b64_tr_b16 a[140:141], v8 offset:16992
    v_mfma_f32_16x16x32_bf16 v[240:243], a[152:155], a[0:3], v[240:243]
    ds_read_b64_tr_b16 a[142:143], v8 offset:17888
    s_waitcnt vmcnt(17) lgkmcnt(4)
    v_mfma_f32_16x16x32_bf16 v[32:35], a[128:131], a[16:19], v[32:35]
    ds_read_b64_tr_b16 a[144:145], v8 offset:17024
    v_mfma_f32_16x16x32_bf16 v[36:39], a[128:131], a[20:23], v[36:39]
    ds_read_b64_tr_b16 a[146:147], v8 offset:17920
    v_mfma_f32_16x16x32_bf16 v[40:43], a[128:131], a[24:27], v[40:43]
    v_add_f32 v14, v14, v18
    v_mfma_f32_16x16x32_bf16 v[44:47], a[128:131], a[28:31], v[44:47]
    buffer_load_dwordx4 a[64:67], v3, s[36:39], s50 offen offset:0 sc1
    v_mfma_f32_16x16x32_bf16 v[60:63], a[132:135], a[28:31], v[60:63]
    v_add_f32 v15, v15, v19
    v_mfma_f32_16x16x32_bf16 v[56:59], a[132:135], a[24:27], v[56:59]
    ds_read_b64_tr_b16 a[148:149], v8 offset:17056
    v_mfma_f32_16x16x32_bf16 v[52:55], a[132:135], a[20:23], v[52:55]
    ds_read_b64_tr_b16 a[150:151], v8 offset:17952
    v_mfma_f32_16x16x32_bf16 v[48:51], a[132:135], a[16:19], v[48:51]
    v_add_f32 v16, v16, v20
    s_waitcnt lgkmcnt(4)
    v_mfma_f32_16x16x32_bf16 v[64:67], a[136:139], a[16:19], v[64:67]
    ds_read_b64_tr_b16 a[152:153], v8 offset:17088
    v_mfma_f32_16x16x32_bf16 v[68:71], a[136:139], a[20:23], v[68:71]
    s_add_u32 m0, s48, 0
    v_add_f32 v17, v17, v21
    v_mfma_f32_16x16x32_bf16 v[72:75], a[136:139], a[24:27], v[72:75]
    buffer_load_dwordx4 v5, s[28:31], s49 offen lds
    v_mfma_f32_16x16x32_bf16 v[76:79], a[136:139], a[28:31], v[76:79]
    ds_read_b64_tr_b16 a[154:155], v8 offset:17984
    v_mfma_f32_16x16x32_bf16 v[92:95], a[140:143], a[28:31], v[92:95]
    v_mov_b32 v18, v14
    v_mfma_f32_16x16x32_bf16 v[88:91], a[140:143], a[24:27], v[88:91]
    ds_read_b64_tr_b16 a[128:129], v8 offset:18944
    v_mfma_f32_16x16x32_bf16 v[84:87], a[140:143], a[20:23], v[84:87]
    ds_read_b64_tr_b16 a[130:131], v8 offset:19840
    v_mfma_f32_16x16x32_bf16 v[80:83], a[140:143], a[16:19], v[80:83]
    v_mov_b32 v19, v15
    s_waitcnt lgkmcnt(4)
    v_mfma_f32_16x16x32_bf16 v[96:99], a[144:147], a[16:19], v[96:99]
    ds_read_b64_tr_b16 a[132:133], v8 offset:18976
    v_mfma_f32_16x16x32_bf16 v[100:103], a[144:147], a[20:23], v[100:103]
    buffer_load_dwordx4 a[68:71], v3, s[36:39], s50 offen offset:256 sc1
    v_mov_b32 v20, v16
    v_mfma_f32_16x16x32_bf16 v[104:107], a[144:147], a[24:27], v[104:107]
    ds_read_b64_tr_b16 a[134:135], v8 offset:19872
    v_mfma_f32_16x16x32_bf16 v[108:111], a[144:147], a[28:31], v[108:111]
    v_mfma_f32_16x16x32_bf16 v[124:127], a[148:151], a[28:31], v[124:127]
    v_mov_b32 v21, v17
    v_mfma_f32_16x16x32_bf16 v[120:123], a[148:151], a[24:27], v[120:123]
    ds_read_b64_tr_b16 a[136:137], v8 offset:19008
    v_mfma_f32_16x16x32_bf16 v[116:119], a[148:151], a[20:23], v[116:119]
    v_permlane32_swap_b32 v18, v14
    v_mfma_f32_16x16x32_bf16 v[112:115], a[148:151], a[16:19], v[112:115]
    ds_read_b64_tr_b16 a[138:139], v8 offset:19904
    s_waitcnt lgkmcnt(4)
    v_mfma_f32_16x16x32_bf16 v[128:131], a[152:155], a[16:19], v[128:131]
    buffer_load_dwordx4 v6, s[28:31], s49 offen offset:1024 lds
    v_mfma_f32_16x16x32_bf16 v[132:135], a[152:155], a[20:23], v[132:135]
    v_permlane32_swap_b32 v19, v15
    v_mfma_f32_16x16x32_bf16 v[136:139], a[152:155], a[24:27], v[136:139]
    ds_read_b64_tr_b16 a[140:141], v8 offset:19040
    v_mfma_f32_16x16x32_bf16 v[140:143], a[152:155], a[28:31], v[140:143]
    ds_read_b64_tr_b16 a[142:143], v8 offset:19936
    v_mfma_f32_16x16x32_bf16 v[156:159], a[128:131], a[28:31], v[156:159]
    v_permlane32_swap_b32 v20, v16
    v_mfma_f32_16x16x32_bf16 v[152:155], a[128:131], a[24:27], v[152:155]
    ds_read_b64_tr_b16 a[144:145], v8 offset:19072
    v_mfma_f32_16x16x32_bf16 v[148:151], a[128:131], a[20:23], v[148:151]
    v_permlane32_swap_b32 v21, v17
    v_mfma_f32_16x16x32_bf16 v[144:147], a[128:131], a[16:19], v[144:147]
    ds_read_b64_tr_b16 a[146:147], v8 offset:19968
    buffer_load_dwordx4 a[72:75], v4, s[36:39], s50 offen offset:0 sc1
    s_waitcnt lgkmcnt(4)
    v_mfma_f32_16x16x32_bf16 v[160:163], a[132:135], a[16:19], v[160:163]
    ds_read_b64_tr_b16 a[148:149], v8 offset:19104
    v_mfma_f32_16x16x32_bf16 v[164:167], a[132:135], a[20:23], v[164:167]
    v_add_f32 v14, v14, v18
    v_mfma_f32_16x16x32_bf16 v[168:171], a[132:135], a[24:27], v[168:171]
    ds_read_b64_tr_b16 a[150:151], v8 offset:20000
    v_mfma_f32_16x16x32_bf16 v[172:175], a[132:135], a[28:31], v[172:175]
    v_add_f32 v15, v15, v19
    v_mfma_f32_16x16x32_bf16 v[188:191], a[136:139], a[28:31], v[188:191]
    ds_read_b64_tr_b16 a[152:153], v8 offset:19136
    v_mfma_f32_16x16x32_bf16 v[184:187], a[136:139], a[24:27], v[184:187]
    ds_read_b64_tr_b16 a[154:155], v8 offset:20032
    v_mfma_f32_16x16x32_bf16 v[180:183], a[136:139], a[20:23], v[180:183]
    buffer_load_dwordx4 v5, s[32:35], s49 offen offset:2048 lds
    v_add_f32 v16, v16, v20
    v_mfma_f32_16x16x32_bf16 v[176:179], a[136:139], a[16:19], v[176:179]
    s_waitcnt vmcnt(14)
    s_barrier
    s_waitcnt lgkmcnt(4)
    v_mfma_f32_16x16x32_bf16 v[192:195], a[140:143], a[16:19], v[192:195]
    ds_read_b64_tr_b16 a[128:129], v8 offset:33792
    v_mfma_f32_16x16x32_bf16 v[196:199], a[140:143], a[20:23], v[196:199]
    v_add_f32 v17, v17, v21
    v_mfma_f32_16x16x32_bf16 v[200:203], a[140:143], a[24:27], v[200:203]
    ds_read_b64_tr_b16 a[130:131], v8 offset:34688
    v_mfma_f32_16x16x32_bf16 v[204:207], a[140:143], a[28:31], v[204:207]
    s_lshl_b32 s52, s3, 8
    v_mfma_f32_16x16x32_bf16 v[220:223], a[144:147], a[28:31], v[220:223]
    ds_read_b64_tr_b16 a[132:133], v8 offset:33824
    v_mfma_f32_16x16x32_bf16 v[216:219], a[144:147], a[24:27], v[216:219]
    buffer_load_dwordx4 a[76:79], v4, s[36:39], s50 offen offset:256 sc1
    v_mfma_f32_16x16x32_bf16 v[212:215], a[144:147], a[20:23], v[212:215]
    s_add_u32 s50, s50, 2048
    v_lshl_add_u32 v22, v1, 4, s52
    v_mfma_f32_16x16x32_bf16 v[208:211], a[144:147], a[16:19], v[208:211]
    ds_read_b64_tr_b16 a[134:135], v8 offset:34720
    s_waitcnt lgkmcnt(4)
    v_mfma_f32_16x16x32_bf16 v[224:227], a[148:151], a[16:19], v[224:227]
    v_lshl_add_u32 v23, v1, 2, s52
    v_mfma_f32_16x16x32_bf16 v[228:231], a[148:151], a[20:23], v[228:231]
    ds_read_b64_tr_b16 a[136:137], v8 offset:33856
    v_mfma_f32_16x16x32_bf16 v[232:235], a[148:151], a[24:27], v[232:235]
    ds_read_b64_tr_b16 a[138:139], v8 offset:34752
    v_mfma_f32_16x16x32_bf16 v[236:239], a[148:151], a[28:31], v[236:239]
    v_mov_b32 v18, 0x3727c5ac
    v_mfma_f32_16x16x32_bf16 v[252:255], a[152:155], a[28:31], v[252:255]
    buffer_load_dwordx4 v6, s[32:35], s49 offen offset:3072 lds
    v_mfma_f32_16x16x32_bf16 v[248:251], a[152:155], a[24:27], v[248:251]
    s_add_u32 s49, s49, 229376
    v_mfma_f32_16x16x32_bf16 v[244:247], a[152:155], a[20:23], v[244:247]
    ds_read_b64_tr_b16 a[140:141], v8 offset:33888
    v_mfma_f32_16x16x32_bf16 v[240:243], a[152:155], a[16:19], v[240:243]
    ds_read_b64_tr_b16 a[142:143], v8 offset:34784
    s_waitcnt vmcnt(17) lgkmcnt(4)
    v_mfma_f32_16x16x32_bf16 v[32:35], a[128:131], a[32:35], v[32:35]
    ds_read_b64_tr_b16 a[144:145], v8 offset:33920
    v_mfma_f32_16x16x32_bf16 v[36:39], a[128:131], a[36:39], v[36:39]
    s_add_u32 m0, s48, 16896
    v_mfma_f32_16x16x32_bf16 v[40:43], a[128:131], a[40:43], v[40:43]
    buffer_load_dwordx4 v5, s[28:31], s49 offen lds
    v_fmac_f32 v18, 0x3a800000, v14
    v_mfma_f32_16x16x32_bf16 v[44:47], a[128:131], a[44:47], v[44:47]
    ds_read_b64_tr_b16 a[146:147], v8 offset:34816
    v_mfma_f32_16x16x32_bf16 v[60:63], a[132:135], a[44:47], v[60:63]
    v_mov_b32 v19, 0x3727c5ac
    v_mfma_f32_16x16x32_bf16 v[56:59], a[132:135], a[40:43], v[56:59]
    ds_read_b64_tr_b16 a[148:149], v8 offset:33952
    v_mfma_f32_16x16x32_bf16 v[52:55], a[132:135], a[36:39], v[52:55]
    ds_read_b64_tr_b16 a[150:151], v8 offset:34848
    v_mfma_f32_16x16x32_bf16 v[48:51], a[132:135], a[32:35], v[48:51]
    buffer_load_dwordx4 v6, s[28:31], s49 offen offset:1024 lds
    v_fmac_f32 v19, 0x3a800000, v15
    s_waitcnt lgkmcnt(4)
    v_mfma_f32_16x16x32_bf16 v[64:67], a[136:139], a[32:35], v[64:67]
    ds_read_b64_tr_b16 a[152:153], v8 offset:33984
    v_mfma_f32_16x16x32_bf16 v[68:71], a[136:139], a[36:39], v[68:71]
    v_mov_b32 v20, 0x3727c5ac
    v_mfma_f32_16x16x32_bf16 v[72:75], a[136:139], a[40:43], v[72:75]
    ds_read_b64_tr_b16 a[154:155], v8 offset:34880
    v_mfma_f32_16x16x32_bf16 v[76:79], a[136:139], a[44:47], v[76:79]
    buffer_load_dwordx4 v5, s[32:35], s49 offen offset:2048 lds
    v_mfma_f32_16x16x32_bf16 v[92:95], a[140:143], a[44:47], v[92:95]
    v_fmac_f32 v20, 0x3a800000, v16
    v_mfma_f32_16x16x32_bf16 v[88:91], a[140:143], a[40:43], v[88:91]
    ds_read_b64_tr_b16 a[128:129], v8 offset:35840
    v_mfma_f32_16x16x32_bf16 v[84:87], a[140:143], a[36:39], v[84:87]
    ds_read_b64_tr_b16 a[130:131], v8 offset:36736
    v_mfma_f32_16x16x32_bf16 v[80:83], a[140:143], a[32:35], v[80:83]
    v_mov_b32 v21, 0x3727c5ac
    s_waitcnt lgkmcnt(4)
    v_mfma_f32_16x16x32_bf16 v[96:99], a[144:147], a[32:35], v[96:99]
    buffer_load_dwordx4 v6, s[32:35], s49 offen offset:3072 lds
    v_mfma_f32_16x16x32_bf16 v[100:103], a[144:147], a[36:39], v[100:103]
    s_add_u32 s49, s49, 229376
    v_fmac_f32 v21, 0x3a800000, v17
    v_mfma_f32_16x16x32_bf16 v[104:107], a[144:147], a[40:43], v[104:107]
    ds_read_b64_tr_b16 a[132:133], v8 offset:35872
    v_mfma_f32_16x16x32_bf16 v[108:111], a[144:147], a[44:47], v[108:111]
    ds_read_b64_tr_b16 a[134:135], v8 offset:36768
    v_mfma_f32_16x16x32_bf16 v[124:127], a[148:151], a[44:47], v[124:127]
    v_rsq_f32 v18, v18
    v_mfma_f32_16x16x32_bf16 v[120:123], a[148:151], a[40:43], v[120:123]
    buffer_load_dwordx4 a[80:83], v3, s[36:39], s50 offen offset:0 sc1
    v_mfma_f32_16x16x32_bf16 v[116:119], a[148:151], a[36:39], v[116:119]
    ds_read_b64_tr_b16 a[136:137], v8 offset:35904
    v_rsq_f32 v19, v19
    v_mfma_f32_16x16x32_bf16 v[112:115], a[148:151], a[32:35], v[112:115]
    ds_read_b64_tr_b16 a[138:139], v8 offset:36800
    s_waitcnt lgkmcnt(4)
    v_mfma_f32_16x16x32_bf16 v[128:131], a[152:155], a[32:35], v[128:131]
    s_add_u32 m0, s48, 33792
    v_mfma_f32_16x16x32_bf16 v[132:135], a[152:155], a[36:39], v[132:135]
    buffer_load_dwordx4 v5, s[28:31], s49 offen lds
    v_rsq_f32 v20, v20
    v_mfma_f32_16x16x32_bf16 v[136:139], a[152:155], a[40:43], v[136:139]
    ds_read_b64_tr_b16 a[140:141], v8 offset:35936
    v_mfma_f32_16x16x32_bf16 v[140:143], a[152:155], a[44:47], v[140:143]
    ds_read_b64_tr_b16 a[142:143], v8 offset:36832
    v_mfma_f32_16x16x32_bf16 v[156:159], a[128:131], a[44:47], v[156:159]
    v_rsq_f32 v21, v21
    v_mfma_f32_16x16x32_bf16 v[152:155], a[128:131], a[40:43], v[152:155]
    ds_read_b64_tr_b16 a[144:145], v8 offset:35968
    v_mfma_f32_16x16x32_bf16 v[148:151], a[128:131], a[36:39], v[148:151]
    buffer_load_dwordx4 a[84:87], v3, s[36:39], s50 offen offset:256 sc1
    v_mul_f32 v18, 0xbfb8aa3b, v18
    v_mfma_f32_16x16x32_bf16 v[144:147], a[128:131], a[32:35], v[144:147]
    ds_read_b64_tr_b16 a[146:147], v8 offset:36864
    s_waitcnt lgkmcnt(4)
    v_mfma_f32_16x16x32_bf16 v[160:163], a[132:135], a[32:35], v[160:163]
    ds_read_b64_tr_b16 a[148:149], v8 offset:36000
    v_mfma_f32_16x16x32_bf16 v[164:167], a[132:135], a[36:39], v[164:167]
    v_mul_f32 v19, 0xbfb8aa3b, v19
    v_mfma_f32_16x16x32_bf16 v[168:171], a[132:135], a[40:43], v[168:171]
    ds_read_b64_tr_b16 a[150:151], v8 offset:36896
    v_mfma_f32_16x16x32_bf16 v[172:175], a[132:135], a[44:47], v[172:175]
    buffer_load_dwordx4 v6, s[28:31], s49 offen offset:1024 lds
    v_mul_f32 v20, 0xbfb8aa3b, v20
    v_mfma_f32_16x16x32_bf16 v[188:191], a[136:139], a[44:47], v[188:191]
    ds_read_b64_tr_b16 a[152:153], v8 offset:36032
    v_mfma_f32_16x16x32_bf16 v[184:187], a[136:139], a[40:43], v[184:187]
    ds_read_b64_tr_b16 a[154:155], v8 offset:36928
    v_mfma_f32_16x16x32_bf16 v[180:183], a[136:139], a[36:39], v[180:183]
    v_mul_f32 v21, 0xbfb8aa3b, v21
    v_mfma_f32_16x16x32_bf16 v[176:179], a[136:139], a[32:35], v[176:179]
    buffer_load_dwordx4 a[88:91], v4, s[36:39], s50 offen offset:0 sc1
    s_waitcnt lgkmcnt(4)
    v_mfma_f32_16x16x32_bf16 v[192:195], a[140:143], a[32:35], v[192:195]
    ds_read_b64_tr_b16 a[128:129], v9 offset:0
    v_mfma_f32_16x16x32_bf16 v[196:199], a[140:143], a[36:39], v[196:199]
    ds_write_b128 v22, v[18:21]
    v_mfma_f32_16x16x32_bf16 v[200:203], a[140:143], a[40:43], v[200:203]
    ds_read_b64_tr_b16 a[130:131], v9 offset:896
    v_mfma_f32_16x16x32_bf16 v[204:207], a[140:143], a[44:47], v[204:207]
    ds_read_b32 v24, v23 offset:0
    v_mfma_f32_16x16x32_bf16 v[220:223], a[144:147], a[44:47], v[220:223]
    buffer_load_dwordx4 v5, s[32:35], s49 offen offset:2048 lds
    v_mfma_f32_16x16x32_bf16 v[216:219], a[144:147], a[40:43], v[216:219]
    ds_read_b64_tr_b16 a[132:133], v9 offset:32
    v_mfma_f32_16x16x32_bf16 v[212:215], a[144:147], a[36:39], v[212:215]
    ds_read_b32 v25, v23 offset:64
    v_mfma_f32_16x16x32_bf16 v[208:211], a[144:147], a[32:35], v[208:211]
    ds_read_b64_tr_b16 a[134:135], v9 offset:928
    s_waitcnt lgkmcnt(4)
    v_mfma_f32_16x16x32_bf16 v[224:227], a[148:151], a[32:35], v[224:227]
    ds_read_b32 v26, v23 offset:128
    v_mfma_f32_16x16x32_bf16 v[228:231], a[148:151], a[36:39], v[228:231]
    buffer_load_dwordx4 a[92:95], v4, s[36:39], s50 offen offset:256 sc1
    v_mfma_f32_16x16x32_bf16 v[232:235], a[148:151], a[40:43], v[232:235]
    ds_read_b64_tr_b16 a[136:137], v9 offset:64
    s_add_u32 s50, s50, 2048
    v_mfma_f32_16x16x32_bf16 v[236:239], a[148:151], a[44:47], v[236:239]
    ds_read_b64_tr_b16 a[138:139], v9 offset:960
    ds_read_b32 v27, v23 offset:192
    v_mfma_f32_16x16x32_bf16 v[252:255], a[152:155], a[44:47], v[252:255]
    ds_read_b64_tr_b16 a[140:141], v9 offset:96
    v_mfma_f32_16x16x32_bf16 v[248:251], a[152:155], a[40:43], v[248:251]
    buffer_load_dwordx4 v6, s[32:35], s49 offen offset:3072 lds
    v_mfma_f32_16x16x32_bf16 v[244:247], a[152:155], a[36:39], v[244:247]
    s_add_u32 s49, s49, 229376
    v_mfma_f32_16x16x32_bf16 v[240:243], a[152:155], a[32:35], v[240:243]
    ds_read_b64_tr_b16 a[142:143], v9 offset:992
    s_waitcnt vmcnt(21) lgkmcnt(4)
    v_mfma_f32_16x16x32_bf16 v[32:35], a[128:131], a[48:51], v[32:35]
    ds_read_b64_tr_b16 a[144:145], v9 offset:128
    v_mfma_f32_16x16x32_bf16 v[36:39], a[128:131], a[52:55], v[36:39]
    ds_read_b64_tr_b16 a[146:147], v9 offset:1024
    v_mfma_f32_16x16x32_bf16 v[40:43], a[128:131], a[56:59], v[40:43]
    v_mfma_f32_16x16x32_bf16 v[44:47], a[128:131], a[60:63], v[44:47]
    buffer_load_dwordx4 a[96:99], v3, s[36:39], s50 offen offset:0 sc1
    v_mfma_f32_16x16x32_bf16 v[60:63], a[132:135], a[60:63], v[60:63]
    ds_read_b64_tr_b16 a[148:149], v9 offset:160
    v_mfma_f32_16x16x32_bf16 v[56:59], a[132:135], a[56:59], v[56:59]
    ds_read_b64_tr_b16 a[150:151], v9 offset:1056
    v_mfma_f32_16x16x32_bf16 v[52:55], a[132:135], a[52:55], v[52:55]
    v_mfma_f32_16x16x32_bf16 v[48:51], a[132:135], a[48:51], v[48:51]
    s_waitcnt lgkmcnt(4)
    v_mfma_f32_16x16x32_bf16 v[64:67], a[136:139], a[48:51], v[64:67]
    ds_read_b64_tr_b16 a[152:153], v9 offset:192
    v_mfma_f32_16x16x32_bf16 v[68:71], a[136:139], a[52:55], v[68:71]
    ds_read_b64_tr_b16 a[154:155], v9 offset:1088
    v_mfma_f32_16x16x32_bf16 v[72:75], a[136:139], a[56:59], v[72:75]
    buffer_load_dwordx4 a[100:103], v3, s[36:39], s50 offen offset:256 sc1
    v_mfma_f32_16x16x32_bf16 v[76:79], a[136:139], a[60:63], v[76:79]
    v_mfma_f32_16x16x32_bf16 v[92:95], a[140:143], a[60:63], v[92:95]
    ds_read_b64_tr_b16 a[128:129], v9 offset:2048
    v_mfma_f32_16x16x32_bf16 v[88:91], a[140:143], a[56:59], v[88:91]
    ds_read_b64_tr_b16 a[130:131], v9 offset:2944
    v_mfma_f32_16x16x32_bf16 v[84:87], a[140:143], a[52:55], v[84:87]
    v_mfma_f32_16x16x32_bf16 v[80:83], a[140:143], a[48:51], v[80:83]
    s_waitcnt lgkmcnt(4)
    v_mfma_f32_16x16x32_bf16 v[96:99], a[144:147], a[48:51], v[96:99]
    ds_read_b64_tr_b16 a[132:133], v9 offset:2080
    v_mfma_f32_16x16x32_bf16 v[100:103], a[144:147], a[52:55], v[100:103]
    buffer_load_dwordx4 a[104:107], v4, s[36:39], s50 offen offset:0 sc1
    v_mfma_f32_16x16x32_bf16 v[104:107], a[144:147], a[56:59], v[104:107]
    ds_read_b64_tr_b16 a[134:135], v9 offset:2976
    v_mfma_f32_16x16x32_bf16 v[108:111], a[144:147], a[60:63], v[108:111]
    v_mfma_f32_16x16x32_bf16 v[124:127], a[148:151], a[60:63], v[124:127]
    ds_read_b64_tr_b16 a[136:137], v9 offset:2112
    v_mfma_f32_16x16x32_bf16 v[120:123], a[148:151], a[56:59], v[120:123]
    ds_read_b64_tr_b16 a[138:139], v9 offset:3008
    v_mfma_f32_16x16x32_bf16 v[116:119], a[148:151], a[52:55], v[116:119]
    v_mfma_f32_16x16x32_bf16 v[112:115], a[148:151], a[48:51], v[112:115]
    s_waitcnt lgkmcnt(4)
    v_mfma_f32_16x16x32_bf16 v[128:131], a[152:155], a[48:51], v[128:131]
    buffer_load_dwordx4 a[108:111], v4, s[36:39], s50 offen offset:256 sc1
    v_mfma_f32_16x16x32_bf16 v[132:135], a[152:155], a[52:55], v[132:135]
    s_add_u32 s50, s50, 2048
    v_mfma_f32_16x16x32_bf16 v[136:139], a[152:155], a[56:59], v[136:139]
    ds_read_b64_tr_b16 a[140:141], v9 offset:2144
    v_mfma_f32_16x16x32_bf16 v[140:143], a[152:155], a[60:63], v[140:143]
    ds_read_b64_tr_b16 a[142:143], v9 offset:3040
    v_mfma_f32_16x16x32_bf16 v[156:159], a[128:131], a[60:63], v[156:159]
    ds_read_b64_tr_b16 a[144:145], v9 offset:2176
    v_mfma_f32_16x16x32_bf16 v[152:155], a[128:131], a[56:59], v[152:155]
    ds_read_b64_tr_b16 a[146:147], v9 offset:3072
    v_mfma_f32_16x16x32_bf16 v[148:151], a[128:131], a[52:55], v[148:151]
    v_mfma_f32_16x16x32_bf16 v[144:147], a[128:131], a[48:51], v[144:147]
    buffer_load_dwordx4 a[112:115], v3, s[36:39], s50 offen offset:0 sc1
    s_waitcnt lgkmcnt(4)
    v_mfma_f32_16x16x32_bf16 v[160:163], a[132:135], a[48:51], v[160:163]
    ds_read_b64_tr_b16 a[148:149], v9 offset:2208
    v_mfma_f32_16x16x32_bf16 v[164:167], a[132:135], a[52:55], v[164:167]
    ds_read_b64_tr_b16 a[150:151], v9 offset:3104
    v_mfma_f32_16x16x32_bf16 v[168:171], a[132:135], a[56:59], v[168:171]
    v_mfma_f32_16x16x32_bf16 v[172:175], a[132:135], a[60:63], v[172:175]
    v_mfma_f32_16x16x32_bf16 v[188:191], a[136:139], a[60:63], v[188:191]
    ds_read_b64_tr_b16 a[152:153], v9 offset:2240
    v_mfma_f32_16x16x32_bf16 v[184:187], a[136:139], a[56:59], v[184:187]
    ds_read_b64_tr_b16 a[154:155], v9 offset:3136
    v_mfma_f32_16x16x32_bf16 v[180:183], a[136:139], a[52:55], v[180:183]
    buffer_load_dwordx4 a[116:119], v3, s[36:39], s50 offen offset:256 sc1
    v_mfma_f32_16x16x32_bf16 v[176:179], a[136:139], a[48:51], v[176:179]
    s_waitcnt lgkmcnt(4)
    v_mfma_f32_16x16x32_bf16 v[192:195], a[140:143], a[48:51], v[192:195]
    v_mfma_f32_16x16x32_bf16 v[196:199], a[140:143], a[52:55], v[196:199]
    v_mfma_f32_16x16x32_bf16 v[200:203], a[140:143], a[56:59], v[200:203]
    v_mfma_f32_16x16x32_bf16 v[204:207], a[140:143], a[60:63], v[204:207]
    v_mfma_f32_16x16x32_bf16 v[220:223], a[144:147], a[60:63], v[220:223]
    v_mfma_f32_16x16x32_bf16 v[216:219], a[144:147], a[56:59], v[216:219]
    buffer_load_dwordx4 a[120:123], v4, s[36:39], s50 offen offset:0 sc1
    v_mfma_f32_16x16x32_bf16 v[212:215], a[144:147], a[52:55], v[212:215]
    v_mfma_f32_16x16x32_bf16 v[208:211], a[144:147], a[48:51], v[208:211]
    s_waitcnt lgkmcnt(0)
    v_mfma_f32_16x16x32_bf16 v[224:227], a[148:151], a[48:51], v[224:227]
    v_mfma_f32_16x16x32_bf16 v[228:231], a[148:151], a[52:55], v[228:231]
    v_mfma_f32_16x16x32_bf16 v[232:235], a[148:151], a[56:59], v[232:235]
    v_mfma_f32_16x16x32_bf16 v[236:239], a[148:151], a[60:63], v[236:239]
    v_mfma_f32_16x16x32_bf16 v[252:255], a[152:155], a[60:63], v[252:255]
    buffer_load_dwordx4 a[124:127], v4, s[36:39], s50 offen offset:256 sc1
    v_mfma_f32_16x16x32_bf16 v[248:251], a[152:155], a[56:59], v[248:251]
    s_add_u32 s50, s50, 2048
    v_mfma_f32_16x16x32_bf16 v[244:247], a[152:155], a[52:55], v[244:247]
    v_mfma_f32_16x16x32_bf16 v[240:243], a[152:155], a[48:51], v[240:243]
C_p4t:
    s_waitcnt vmcnt(8) lgkmcnt(0)
    s_barrier
    ds_read_b64_tr_b16 a[128:129], v9 offset:16896
    ds_read_b64_tr_b16 a[130:131], v9 offset:17792
    ds_read_b64_tr_b16 a[132:133], v7 offset:0
    ds_read_b64_tr_b16 a[134:135], v7 offset:896
    ds_read_b64_tr_b16 a[136:137], v7 offset:16896
    ds_read_b64_tr_b16 a[138:139], v7 offset:17792
    ds_read_b64_tr_b16 a[140:141], v7 offset:33792
    ds_read_b64_tr_b16 a[142:143], v7 offset:34688
    v_lshlrev_b32 v14, 4, v0
    s_mov_b32 s53, 4096
    s_mov_b32 s54, 229376
    s_mov_b32 s55, 233472
    s_waitcnt vmcnt(21) lgkmcnt(4)
    v_mfma_f32_16x16x32_bf16 v[32:35], a[128:131], a[64:67], v[32:35]
    ds_read_b64_tr_b16 a[144:145], v9 offset:18944
    v_mfma_f32_16x16x32_bf16 v[36:39], a[128:131], a[68:71], v[36:39]
    v_mfma_f32_16x16x32_bf16 v[40:43], a[128:131], a[72:75], v[40:43]
    ds_read_b64_tr_b16 a[146:147], v9 offset:19840
    v_mfma_f32_16x16x32_bf16 v[44:47], a[128:131], a[76:79], v[44:47]
    s_waitcnt vmcnt(9)
    v_mfma_f32_16x16x32_bf16 v[32:35], a[132:135], a[80:83], v[32:35]
    ds_read_b64_tr_b16 a[148:149], v7 offset:2048
    v_mfma_f32_16x16x32_bf16 v[36:39], a[132:135], a[84:87], v[36:39]
    v_mfma_f32_16x16x32_bf16 v[40:43], a[132:135], a[88:91], v[40:43]
    ds_read_b64_tr_b16 a[150:151], v7 offset:2944
    v_mfma_f32_16x16x32_bf16 v[44:47], a[132:135], a[92:95], v[44:47]
    s_waitcnt vmcnt(4) lgkmcnt(4)
    v_mfma_f32_16x16x32_bf16 v[32:35], a[136:139], a[96:99], v[32:35]
    ds_read_b64_tr_b16 a[152:153], v7 offset:18944
    v_mfma_f32_16x16x32_bf16 v[36:39], a[136:139], a[100:103], v[36:39]
    v_mfma_f32_16x16x32_bf16 v[40:43], a[136:139], a[104:107], v[40:43]
    ds_read_b64_tr_b16 a[154:155], v7 offset:19840
    v_mfma_f32_16x16x32_bf16 v[44:47], a[136:139], a[108:111], v[44:47]
    s_waitcnt vmcnt(0)
    v_mfma_f32_16x16x32_bf16 v[32:35], a[140:143], a[112:115], v[32:35]
    ds_read_b64_tr_b16 a[128:129], v7 offset:35840
    v_mfma_f32_16x16x32_bf16 v[36:39], a[140:143], a[116:119], v[36:39]
    v_mfma_f32_16x16x32_bf16 v[40:43], a[140:143], a[120:123], v[40:43]
    ds_read_b64_tr_b16 a[130:131], v7 offset:36736
    v_mfma_f32_16x16x32_bf16 v[44:47], a[140:143], a[124:127], v[44:47]
    s_waitcnt lgkmcnt(4)
    v_mfma_f32_16x16x32_bf16 v[144:147], a[144:147], a[64:67], v[144:147]
    ds_read_b64_tr_b16 a[132:133], v9 offset:16928
    v_mfma_f32_16x16x32_bf16 v[148:151], a[144:147], a[68:71], v[148:151]
    v_mfma_f32_16x16x32_bf16 v[152:155], a[144:147], a[72:75], v[152:155]
    ds_read_b64_tr_b16 a[134:135], v9 offset:17824
    v_mfma_f32_16x16x32_bf16 v[156:159], a[144:147], a[76:79], v[156:159]
    v_mfma_f32_16x16x32_bf16 v[144:147], a[148:151], a[80:83], v[144:147]
    ds_read_b64_tr_b16 a[136:137], v7 offset:32
    v_mfma_f32_16x16x32_bf16 v[148:151], a[148:151], a[84:87], v[148:151]
    v_mfma_f32_16x16x32_bf16 v[152:155], a[148:151], a[88:91], v[152:155]
    ds_read_b64_tr_b16 a[138:139], v7 offset:928
    v_mfma_f32_16x16x32_bf16 v[156:159], a[148:151], a[92:95], v[156:159]
    s_waitcnt lgkmcnt(4)
    v_mfma_f32_16x16x32_bf16 v[144:147], a[152:155], a[96:99], v[144:147]
    ds_read_b64_tr_b16 a[140:141], v7 offset:16928
    v_mfma_f32_16x16x32_bf16 v[148:151], a[152:155], a[100:103], v[148:151]
    v_mfma_f32_16x16x32_bf16 v[152:155], a[152:155], a[104:107], v[152:155]
    ds_read_b64_tr_b16 a[142:143], v7 offset:17824
    v_mfma_f32_16x16x32_bf16 v[156:159], a[152:155], a[108:111], v[156:159]
    v_mfma_f32_16x16x32_bf16 v[144:147], a[128:131], a[112:115], v[144:147]
    ds_read_b64_tr_b16 a[144:145], v7 offset:33824
    v_mfma_f32_16x16x32_bf16 v[148:151], a[128:131], a[116:119], v[148:151]
    v_mfma_f32_16x16x32_bf16 v[152:155], a[128:131], a[120:123], v[152:155]
    ds_read_b64_tr_b16 a[146:147], v7 offset:34720
    v_mfma_f32_16x16x32_bf16 v[156:159], a[128:131], a[124:127], v[156:159]
    s_waitcnt lgkmcnt(4)
    v_mfma_f32_16x16x32_bf16 v[48:51], a[132:135], a[64:67], v[48:51]
    ds_read_b64_tr_b16 a[148:149], v9 offset:18976
    v_mfma_f32_16x16x32_bf16 v[52:55], a[132:135], a[68:71], v[52:55]
    v_mfma_f32_16x16x32_bf16 v[56:59], a[132:135], a[72:75], v[56:59]
    ds_read_b64_tr_b16 a[150:151], v9 offset:19872
    v_mfma_f32_16x16x32_bf16 v[60:63], a[132:135], a[76:79], v[60:63]
    v_mfma_f32_16x16x32_bf16 v[48:51], a[136:139], a[80:83], v[48:51]
    ds_read_b64_tr_b16 a[152:153], v7 offset:2080
    v_mul_f32 v32, v32, v24
    v_mul_f32 v33, v33, v24
    v_mul_f32 v34, v34, v24
    v_mfma_f32_16x16x32_bf16 v[52:55], a[136:139], a[84:87], v[52:55]
    v_exp_f32 v32, v32
    v_mul_f32 v35, v35, v24
    v_exp_f32 v33, v33
    v_mfma_f32_16x16x32_bf16 v[56:59], a[136:139], a[88:91], v[56:59]
    ds_read_b64_tr_b16 a[154:155], v7 offset:2976
    v_mul_f32 v36, v36, v25
    v_exp_f32 v34, v34
    v_add_f32 v32, 1.0, v32
    v_mul_f32 v37, v37, v25
    v_mfma_f32_16x16x32_bf16 v[60:63], a[136:139], a[92:95], v[60:63]
    v_exp_f32 v35, v35
    v_add_f32 v33, 1.0, v33
    v_mul_f32 v38, v38, v25
    s_waitcnt lgkmcnt(4)
    v_mfma_f32_16x16x32_bf16 v[48:51], a[140:143], a[96:99], v[48:51]
    ds_read_b64_tr_b16 a[128:129], v7 offset:18976
    v_exp_f32 v36, v36
    v_add_f32 v34, 1.0, v34
    v_rcp_f32 v32, v32
    v_mfma_f32_16x16x32_bf16 v[52:55], a[140:143], a[100:103], v[52:55]
    v_mul_f32 v39, v39, v25
    v_exp_f32 v37, v37
    v_add_f32 v35, 1.0, v35
    v_rcp_f32 v33, v33
    v_mfma_f32_16x16x32_bf16 v[56:59], a[140:143], a[104:107], v[56:59]
    ds_read_b64_tr_b16 a[130:131], v7 offset:19872
    v_exp_f32 v38, v38
    v_add_f32 v36, 1.0, v36
    v_rcp_f32 v34, v34
    v_mfma_f32_16x16x32_bf16 v[60:63], a[140:143], a[108:111], v[60:63]
    v_mul_f32 v144, v144, v32
    v_exp_f32 v39, v39
    v_add_f32 v37, 1.0, v37
    v_mfma_f32_16x16x32_bf16 v[48:51], a[144:147], a[112:115], v[48:51]
    ds_read_b64_tr_b16 a[132:133], v7 offset:35872
    v_rcp_f32 v35, v35
    v_mul_f32 v145, v145, v33
    v_add_f32 v38, 1.0, v38
    v_rcp_f32 v36, v36
    v_mfma_f32_16x16x32_bf16 v[52:55], a[144:147], a[116:119], v[52:55]
    v_mul_f32 v146, v146, v34
    v_add_f32 v39, 1.0, v39
    v_rcp_f32 v37, v37
    v_mfma_f32_16x16x32_bf16 v[56:59], a[144:147], a[120:123], v[56:59]
    ds_read_b64_tr_b16 a[134:135], v7 offset:36768
    v_mul_f32 v147, v147, v35
    v_rcp_f32 v38, v38
    v_mul_f32 v148, v148, v36
    v_mfma_f32_16x16x32_bf16 v[60:63], a[144:147], a[124:127], v[60:63]
    v_rcp_f32 v39, v39
    v_mul_f32 v149, v149, v37
    v_mul_f32 v150, v150, v38
    v_mul_f32 v151, v151, v39
    s_waitcnt lgkmcnt(4)
    v_mfma_f32_16x16x32_bf16 v[160:163], a[148:151], a[64:67], v[160:163]
    ds_read_b64_tr_b16 a[136:137], v9 offset:16960
    v_cvt_pk_bf16_f32 v16, v144, v145
    v_cvt_pk_bf16_f32 v18, v148, v149
    v_cvt_pk_bf16_f32 v17, v146, v147
    v_mfma_f32_16x16x32_bf16 v[164:167], a[148:151], a[68:71], v[164:167]
    v_cvt_pk_bf16_f32 v19, v150, v151
    v_permlane16_swap_b32 v16, v18
    s_nop 0
    v_permlane16_swap_b32 v17, v19
    v_mfma_f32_16x16x32_bf16 v[168:171], a[148:151], a[72:75], v[168:171]
    ds_read_b64_tr_b16 a[138:139], v9 offset:17856
    buffer_store_dwordx4 v[16:19], v14, s[40:43], 0 offen offset:0 sc1
    v_mul_f32 v40, v40, v26
    v_mul_f32 v41, v41, v26
    v_mul_f32 v42, v42, v26
    v_mfma_f32_16x16x32_bf16 v[172:175], a[148:151], a[76:79], v[172:175]
    v_exp_f32 v40, v40
    v_mul_f32 v43, v43, v26
    v_exp_f32 v41, v41
    v_mfma_f32_16x16x32_bf16 v[160:163], a[152:155], a[80:83], v[160:163]
    ds_read_b64_tr_b16 a[140:141], v7 offset:64
    v_mul_f32 v44, v44, v27
    v_exp_f32 v42, v42
    v_add_f32 v40, 1.0, v40
    v_mul_f32 v45, v45, v27
    v_mfma_f32_16x16x32_bf16 v[164:167], a[152:155], a[84:87], v[164:167]
    v_exp_f32 v43, v43
    v_add_f32 v41, 1.0, v41
    v_mul_f32 v46, v46, v27
    v_mfma_f32_16x16x32_bf16 v[168:171], a[152:155], a[88:91], v[168:171]
    ds_read_b64_tr_b16 a[142:143], v7 offset:960
    v_exp_f32 v44, v44
    v_add_f32 v42, 1.0, v42
    v_rcp_f32 v40, v40
    v_mfma_f32_16x16x32_bf16 v[172:175], a[152:155], a[92:95], v[172:175]
    v_mul_f32 v47, v47, v27
    v_exp_f32 v45, v45
    v_add_f32 v43, 1.0, v43
    v_rcp_f32 v41, v41
    s_waitcnt lgkmcnt(4)
    v_mfma_f32_16x16x32_bf16 v[160:163], a[128:131], a[96:99], v[160:163]
    ds_read_b64_tr_b16 a[144:145], v7 offset:16960
    v_exp_f32 v46, v46
    v_add_f32 v44, 1.0, v44
    v_rcp_f32 v42, v42
    v_mfma_f32_16x16x32_bf16 v[164:167], a[128:131], a[100:103], v[164:167]
    v_mul_f32 v152, v152, v40
    v_exp_f32 v47, v47
    v_add_f32 v45, 1.0, v45
    v_mfma_f32_16x16x32_bf16 v[168:171], a[128:131], a[104:107], v[168:171]
    ds_read_b64_tr_b16 a[146:147], v7 offset:17856
    v_rcp_f32 v43, v43
    v_mul_f32 v153, v153, v41
    v_add_f32 v46, 1.0, v46
    v_rcp_f32 v44, v44
    v_mfma_f32_16x16x32_bf16 v[172:175], a[128:131], a[108:111], v[172:175]
    v_mul_f32 v154, v154, v42
    v_add_f32 v47, 1.0, v47
    v_rcp_f32 v45, v45
    v_mfma_f32_16x16x32_bf16 v[160:163], a[132:135], a[112:115], v[160:163]
    ds_read_b64_tr_b16 a[148:149], v7 offset:33856
    v_mul_f32 v155, v155, v43
    v_rcp_f32 v46, v46
    v_mul_f32 v156, v156, v44
    v_mfma_f32_16x16x32_bf16 v[164:167], a[132:135], a[116:119], v[164:167]
    v_rcp_f32 v47, v47
    v_mul_f32 v157, v157, v45
    v_mul_f32 v158, v158, v46
    v_mul_f32 v159, v159, v47
    v_mfma_f32_16x16x32_bf16 v[168:171], a[132:135], a[120:123], v[168:171]
    ds_read_b64_tr_b16 a[150:151], v7 offset:34752
    v_cvt_pk_bf16_f32 v20, v152, v153
    v_cvt_pk_bf16_f32 v22, v156, v157
    v_cvt_pk_bf16_f32 v21, v154, v155
    v_mfma_f32_16x16x32_bf16 v[172:175], a[132:135], a[124:127], v[172:175]
    v_cvt_pk_bf16_f32 v23, v158, v159
    v_permlane16_swap_b32 v20, v22
    s_nop 0
    v_permlane16_swap_b32 v21, v23
    s_waitcnt lgkmcnt(4)
    v_mfma_f32_16x16x32_bf16 v[64:67], a[136:139], a[64:67], v[64:67]
    ds_read_b64_tr_b16 a[152:153], v9 offset:19008
    buffer_store_dwordx4 v[20:23], v14, s[40:43], s54 offen offset:0 sc1
    v_mfma_f32_16x16x32_bf16 v[68:71], a[136:139], a[68:71], v[68:71]
    v_mfma_f32_16x16x32_bf16 v[72:75], a[136:139], a[72:75], v[72:75]
    ds_read_b64_tr_b16 a[154:155], v9 offset:19904
    v_mfma_f32_16x16x32_bf16 v[76:79], a[136:139], a[76:79], v[76:79]
    v_mfma_f32_16x16x32_bf16 v[64:67], a[140:143], a[80:83], v[64:67]
    ds_read_b64_tr_b16 a[128:129], v7 offset:2112
    v_mul_f32 v48, v48, v24
    v_mul_f32 v49, v49, v24
    v_mul_f32 v50, v50, v24
    v_mfma_f32_16x16x32_bf16 v[68:71], a[140:143], a[84:87], v[68:71]
    v_exp_f32 v48, v48
    v_mul_f32 v51, v51, v24
    v_exp_f32 v49, v49
    v_mfma_f32_16x16x32_bf16 v[72:75], a[140:143], a[88:91], v[72:75]
    ds_read_b64_tr_b16 a[130:131], v7 offset:3008
    v_mul_f32 v52, v52, v25
    v_exp_f32 v50, v50
    v_add_f32 v48, 1.0, v48
    v_mul_f32 v53, v53, v25
    v_mfma_f32_16x16x32_bf16 v[76:79], a[140:143], a[92:95], v[76:79]
    v_exp_f32 v51, v51
    v_add_f32 v49, 1.0, v49
    v_mul_f32 v54, v54, v25
    s_waitcnt lgkmcnt(4)
    v_mfma_f32_16x16x32_bf16 v[64:67], a[144:147], a[96:99], v[64:67]
    ds_read_b64_tr_b16 a[132:133], v7 offset:19008
    v_exp_f32 v52, v52
    v_add_f32 v50, 1.0, v50
    v_rcp_f32 v48, v48
    v_mfma_f32_16x16x32_bf16 v[68:71], a[144:147], a[100:103], v[68:71]
    v_mul_f32 v55, v55, v25
    v_exp_f32 v53, v53
    v_add_f32 v51, 1.0, v51
    v_rcp_f32 v49, v49
    v_mfma_f32_16x16x32_bf16 v[72:75], a[144:147], a[104:107], v[72:75]
    ds_read_b64_tr_b16 a[134:135], v7 offset:19904
    v_exp_f32 v54, v54
    v_add_f32 v52, 1.0, v52
    v_rcp_f32 v50, v50
    v_mfma_f32_16x16x32_bf16 v[76:79], a[144:147], a[108:111], v[76:79]
    v_mul_f32 v160, v160, v48
    v_exp_f32 v55, v55
    v_add_f32 v53, 1.0, v53
    v_mfma_f32_16x16x32_bf16 v[64:67], a[148:151], a[112:115], v[64:67]
    ds_read_b64_tr_b16 a[136:137], v7 offset:35904
    v_rcp_f32 v51, v51
    v_mul_f32 v161, v161, v49
    v_add_f32 v54, 1.0, v54
    v_rcp_f32 v52, v52
    v_mfma_f32_16x16x32_bf16 v[68:71], a[148:151], a[116:119], v[68:71]
    v_mul_f32 v162, v162, v50
    v_add_f32 v55, 1.0, v55
    v_rcp_f32 v53, v53
    v_mfma_f32_16x16x32_bf16 v[72:75], a[148:151], a[120:123], v[72:75]
    ds_read_b64_tr_b16 a[138:139], v7 offset:36800
    v_mul_f32 v163, v163, v51
    v_rcp_f32 v54, v54
    v_mul_f32 v164, v164, v52
    v_mfma_f32_16x16x32_bf16 v[76:79], a[148:151], a[124:127], v[76:79]
    v_rcp_f32 v55, v55
    v_mul_f32 v165, v165, v53
    v_mul_f32 v166, v166, v54
    v_mul_f32 v167, v167, v55
    s_waitcnt lgkmcnt(4)
    v_mfma_f32_16x16x32_bf16 v[176:179], a[152:155], a[64:67], v[176:179]
    ds_read_b64_tr_b16 a[140:141], v9 offset:16992
    v_cvt_pk_bf16_f32 v16, v160, v161
    v_cvt_pk_bf16_f32 v18, v164, v165
    v_cvt_pk_bf16_f32 v17, v162, v163
    v_mfma_f32_16x16x32_bf16 v[180:183], a[152:155], a[68:71], v[180:183]
    v_cvt_pk_bf16_f32 v19, v166, v167
    v_permlane16_swap_b32 v16, v18
    s_nop 0
    v_permlane16_swap_b32 v17, v19
    v_mfma_f32_16x16x32_bf16 v[184:187], a[152:155], a[72:75], v[184:187]
    ds_read_b64_tr_b16 a[142:143], v9 offset:17888
    buffer_store_dwordx4 v[16:19], v14, s[40:43], 0 offen offset:1024 sc1
    v_mul_f32 v56, v56, v26
    v_mul_f32 v57, v57, v26
    v_mul_f32 v58, v58, v26
    v_mfma_f32_16x16x32_bf16 v[188:191], a[152:155], a[76:79], v[188:191]
    v_exp_f32 v56, v56
    v_mul_f32 v59, v59, v26
    v_exp_f32 v57, v57
    v_mfma_f32_16x16x32_bf16 v[176:179], a[128:131], a[80:83], v[176:179]
    ds_read_b64_tr_b16 a[144:145], v7 offset:96
    v_mul_f32 v60, v60, v27
    v_exp_f32 v58, v58
    v_add_f32 v56, 1.0, v56
    v_mul_f32 v61, v61, v27
    v_mfma_f32_16x16x32_bf16 v[180:183], a[128:131], a[84:87], v[180:183]
    v_exp_f32 v59, v59
    v_add_f32 v57, 1.0, v57
    v_mul_f32 v62, v62, v27
    v_mfma_f32_16x16x32_bf16 v[184:187], a[128:131], a[88:91], v[184:187]
    ds_read_b64_tr_b16 a[146:147], v7 offset:992
    v_exp_f32 v60, v60
    v_add_f32 v58, 1.0, v58
    v_rcp_f32 v56, v56
    v_mfma_f32_16x16x32_bf16 v[188:191], a[128:131], a[92:95], v[188:191]
    v_mul_f32 v63, v63, v27
    v_exp_f32 v61, v61
    v_add_f32 v59, 1.0, v59
    v_rcp_f32 v57, v57
    s_waitcnt lgkmcnt(4)
    v_mfma_f32_16x16x32_bf16 v[176:179], a[132:135], a[96:99], v[176:179]
    ds_read_b64_tr_b16 a[148:149], v7 offset:16992
    v_exp_f32 v62, v62
    v_add_f32 v60, 1.0, v60
    v_rcp_f32 v58, v58
    v_mfma_f32_16x16x32_bf16 v[180:183], a[132:135], a[100:103], v[180:183]
    v_mul_f32 v168, v168, v56
    v_exp_f32 v63, v63
    v_add_f32 v61, 1.0, v61
    v_mfma_f32_16x16x32_bf16 v[184:187], a[132:135], a[104:107], v[184:187]
    ds_read_b64_tr_b16 a[150:151], v7 offset:17888
    v_rcp_f32 v59, v59
    v_mul_f32 v169, v169, v57
    v_add_f32 v62, 1.0, v62
    v_rcp_f32 v60, v60
    v_mfma_f32_16x16x32_bf16 v[188:191], a[132:135], a[108:111], v[188:191]
    v_mul_f32 v170, v170, v58
    v_add_f32 v63, 1.0, v63
    v_rcp_f32 v61, v61
    v_mfma_f32_16x16x32_bf16 v[176:179], a[136:139], a[112:115], v[176:179]
    ds_read_b64_tr_b16 a[152:153], v7 offset:33888
    v_mul_f32 v171, v171, v59
    v_rcp_f32 v62, v62
    v_mul_f32 v172, v172, v60
    v_mfma_f32_16x16x32_bf16 v[180:183], a[136:139], a[116:119], v[180:183]
    v_rcp_f32 v63, v63
    v_mul_f32 v173, v173, v61
    v_mul_f32 v174, v174, v62
    v_mul_f32 v175, v175, v63
    v_mfma_f32_16x16x32_bf16 v[184:187], a[136:139], a[120:123], v[184:187]
    ds_read_b64_tr_b16 a[154:155], v7 offset:34784
    v_cvt_pk_bf16_f32 v20, v168, v169
    v_cvt_pk_bf16_f32 v22, v172, v173
    v_cvt_pk_bf16_f32 v21, v170, v171
    v_mfma_f32_16x16x32_bf16 v[188:191], a[136:139], a[124:127], v[188:191]
    v_cvt_pk_bf16_f32 v23, v174, v175
    v_permlane16_swap_b32 v20, v22
    s_nop 0
    v_permlane16_swap_b32 v21, v23
    s_waitcnt lgkmcnt(4)
    v_mfma_f32_16x16x32_bf16 v[80:83], a[140:143], a[64:67], v[80:83]
    ds_read_b64_tr_b16 a[128:129], v9 offset:19040
    buffer_store_dwordx4 v[20:23], v14, s[40:43], s54 offen offset:1024 sc1
    v_mfma_f32_16x16x32_bf16 v[84:87], a[140:143], a[68:71], v[84:87]
    v_mfma_f32_16x16x32_bf16 v[88:91], a[140:143], a[72:75], v[88:91]
    ds_read_b64_tr_b16 a[130:131], v9 offset:19936
    v_mfma_f32_16x16x32_bf16 v[92:95], a[140:143], a[76:79], v[92:95]
    v_mfma_f32_16x16x32_bf16 v[80:83], a[144:147], a[80:83], v[80:83]
    ds_read_b64_tr_b16 a[132:133], v7 offset:2144
    v_mul_f32 v64, v64, v24
    v_mul_f32 v65, v65, v24
    v_mul_f32 v66, v66, v24
    v_mfma_f32_16x16x32_bf16 v[84:87], a[144:147], a[84:87], v[84:87]
    v_exp_f32 v64, v64
    v_mul_f32 v67, v67, v24
    v_exp_f32 v65, v65
    v_mfma_f32_16x16x32_bf16 v[88:91], a[144:147], a[88:91], v[88:91]
    ds_read_b64_tr_b16 a[134:135], v7 offset:3040
    v_mul_f32 v68, v68, v25
    v_exp_f32 v66, v66
    v_add_f32 v64, 1.0, v64
    v_mul_f32 v69, v69, v25
    v_mfma_f32_16x16x32_bf16 v[92:95], a[144:147], a[92:95], v[92:95]
    v_exp_f32 v67, v67
    v_add_f32 v65, 1.0, v65
    v_mul_f32 v70, v70, v25
    s_waitcnt lgkmcnt(4)
    v_mfma_f32_16x16x32_bf16 v[80:83], a[148:151], a[96:99], v[80:83]
    ds_read_b64_tr_b16 a[136:137], v7 offset:19040
    v_exp_f32 v68, v68
    v_add_f32 v66, 1.0, v66
    v_rcp_f32 v64, v64
    v_mfma_f32_16x16x32_bf16 v[84:87], a[148:151], a[100:103], v[84:87]
    v_mul_f32 v71, v71, v25
    v_exp_f32 v69, v69
    v_add_f32 v67, 1.0, v67
    v_rcp_f32 v65, v65
    v_mfma_f32_16x16x32_bf16 v[88:91], a[148:151], a[104:107], v[88:91]
    ds_read_b64_tr_b16 a[138:139], v7 offset:19936
    v_exp_f32 v70, v70
    v_add_f32 v68, 1.0, v68
    v_rcp_f32 v66, v66
    v_mfma_f32_16x16x32_bf16 v[92:95], a[148:151], a[108:111], v[92:95]
    v_mul_f32 v176, v176, v64
    v_exp_f32 v71, v71
    v_add_f32 v69, 1.0, v69
    v_mfma_f32_16x16x32_bf16 v[80:83], a[152:155], a[112:115], v[80:83]
    ds_read_b64_tr_b16 a[140:141], v7 offset:35936
    v_rcp_f32 v67, v67
    v_mul_f32 v177, v177, v65
    v_add_f32 v70, 1.0, v70
    v_rcp_f32 v68, v68
    v_mfma_f32_16x16x32_bf16 v[84:87], a[152:155], a[116:119], v[84:87]
    v_mul_f32 v178, v178, v66
    v_add_f32 v71, 1.0, v71
    v_rcp_f32 v69, v69
    v_mfma_f32_16x16x32_bf16 v[88:91], a[152:155], a[120:123], v[88:91]
    ds_read_b64_tr_b16 a[142:143], v7 offset:36832
    v_mul_f32 v179, v179, v67
    v_rcp_f32 v70, v70
    v_mul_f32 v180, v180, v68
    v_mfma_f32_16x16x32_bf16 v[92:95], a[152:155], a[124:127], v[92:95]
    v_rcp_f32 v71, v71
    v_mul_f32 v181, v181, v69
    v_mul_f32 v182, v182, v70
    v_mul_f32 v183, v183, v71
    s_waitcnt lgkmcnt(4)
    v_mfma_f32_16x16x32_bf16 v[192:195], a[128:131], a[64:67], v[192:195]
    ds_read_b64_tr_b16 a[144:145], v9 offset:17024
    v_cvt_pk_bf16_f32 v16, v176, v177
    v_cvt_pk_bf16_f32 v18, v180, v181
    v_cvt_pk_bf16_f32 v17, v178, v179
    v_mfma_f32_16x16x32_bf16 v[196:199], a[128:131], a[68:71], v[196:199]
    v_cvt_pk_bf16_f32 v19, v182, v183
    v_permlane16_swap_b32 v16, v18
    s_nop 0
    v_permlane16_swap_b32 v17, v19
    v_mfma_f32_16x16x32_bf16 v[200:203], a[128:131], a[72:75], v[200:203]
    ds_read_b64_tr_b16 a[146:147], v9 offset:17920
    buffer_store_dwordx4 v[16:19], v14, s[40:43], 0 offen offset:2048 sc1
    v_mul_f32 v72, v72, v26
    v_mul_f32 v73, v73, v26
    v_mul_f32 v74, v74, v26
    v_mfma_f32_16x16x32_bf16 v[204:207], a[128:131], a[76:79], v[204:207]
    v_exp_f32 v72, v72
    v_mul_f32 v75, v75, v26
    v_exp_f32 v73, v73
    v_mfma_f32_16x16x32_bf16 v[192:195], a[132:135], a[80:83], v[192:195]
    ds_read_b64_tr_b16 a[148:149], v7 offset:128
    v_mul_f32 v76, v76, v27
    v_exp_f32 v74, v74
    v_add_f32 v72, 1.0, v72
    v_mul_f32 v77, v77, v27
    v_mfma_f32_16x16x32_bf16 v[196:199], a[132:135], a[84:87], v[196:199]
    v_exp_f32 v75, v75
    v_add_f32 v73, 1.0, v73
    v_mul_f32 v78, v78, v27
    v_mfma_f32_16x16x32_bf16 v[200:203], a[132:135], a[88:91], v[200:203]
    ds_read_b64_tr_b16 a[150:151], v7 offset:1024
    v_exp_f32 v76, v76
    v_add_f32 v74, 1.0, v74
    v_rcp_f32 v72, v72
    v_mfma_f32_16x16x32_bf16 v[204:207], a[132:135], a[92:95], v[204:207]
    v_mul_f32 v79, v79, v27
    v_exp_f32 v77, v77
    v_add_f32 v75, 1.0, v75
    v_rcp_f32 v73, v73
    s_waitcnt lgkmcnt(4)
    v_mfma_f32_16x16x32_bf16 v[192:195], a[136:139], a[96:99], v[192:195]
    ds_read_b64_tr_b16 a[152:153], v7 offset:17024
    v_exp_f32 v78, v78
    v_add_f32 v76, 1.0, v76
    v_rcp_f32 v74, v74
    v_mfma_f32_16x16x32_bf16 v[196:199], a[136:139], a[100:103], v[196:199]
    v_mul_f32 v184, v184, v72
    v_exp_f32 v79, v79
    v_add_f32 v77, 1.0, v77
    v_mfma_f32_16x16x32_bf16 v[200:203], a[136:139], a[104:107], v[200:203]
    ds_read_b64_tr_b16 a[154:155], v7 offset:17920
    v_rcp_f32 v75, v75
    v_mul_f32 v185, v185, v73
    v_add_f32 v78, 1.0, v78
    v_rcp_f32 v76, v76
    v_mfma_f32_16x16x32_bf16 v[204:207], a[136:139], a[108:111], v[204:207]
    v_mul_f32 v186, v186, v74
    v_add_f32 v79, 1.0, v79
    v_rcp_f32 v77, v77
    v_mfma_f32_16x16x32_bf16 v[192:195], a[140:143], a[112:115], v[192:195]
    ds_read_b64_tr_b16 a[128:129], v7 offset:33920
    v_mul_f32 v187, v187, v75
    v_rcp_f32 v78, v78
    v_mul_f32 v188, v188, v76
    v_mfma_f32_16x16x32_bf16 v[196:199], a[140:143], a[116:119], v[196:199]
    v_rcp_f32 v79, v79
    v_mul_f32 v189, v189, v77
    v_mul_f32 v190, v190, v78
    v_mul_f32 v191, v191, v79
    v_mfma_f32_16x16x32_bf16 v[200:203], a[140:143], a[120:123], v[200:203]
    ds_read_b64_tr_b16 a[130:131], v7 offset:34816
    v_cvt_pk_bf16_f32 v20, v184, v185
    v_cvt_pk_bf16_f32 v22, v188, v189
    v_cvt_pk_bf16_f32 v21, v186, v187
    v_mfma_f32_16x16x32_bf16 v[204:207], a[140:143], a[124:127], v[204:207]
    v_cvt_pk_bf16_f32 v23, v190, v191
    v_permlane16_swap_b32 v20, v22
    s_nop 0
    v_permlane16_swap_b32 v21, v23
    s_waitcnt lgkmcnt(4)
    v_mfma_f32_16x16x32_bf16 v[96:99], a[144:147], a[64:67], v[96:99]
    ds_read_b64_tr_b16 a[132:133], v9 offset:19072
    buffer_store_dwordx4 v[20:23], v14, s[40:43], s54 offen offset:2048 sc1
    v_mfma_f32_16x16x32_bf16 v[100:103], a[144:147], a[68:71], v[100:103]
    v_mfma_f32_16x16x32_bf16 v[104:107], a[144:147], a[72:75], v[104:107]
    ds_read_b64_tr_b16 a[134:135], v9 offset:19968
    v_mfma_f32_16x16x32_bf16 v[108:111], a[144:147], a[76:79], v[108:111]
    v_mfma_f32_16x16x32_bf16 v[96:99], a[148:151], a[80:83], v[96:99]
    ds_read_b64_tr_b16 a[136:137], v7 offset:2176
    v_mul_f32 v80, v80, v24
    v_mul_f32 v81, v81, v24
    v_mul_f32 v82, v82, v24
    v_mfma_f32_16x16x32_bf16 v[100:103], a[148:151], a[84:87], v[100:103]
    v_exp_f32 v80, v80
    v_mul_f32 v83, v83, v24
    v_exp_f32 v81, v81
    v_mfma_f32_16x16x32_bf16 v[104:107], a[148:151], a[88:91], v[104:107]
    ds_read_b64_tr_b16 a[138:139], v7 offset:3072
    v_mul_f32 v84, v84, v25
    v_exp_f32 v82, v82
    v_add_f32 v80, 1.0, v80
    v_mul_f32 v85, v85, v25
    v_mfma_f32_16x16x32_bf16 v[108:111], a[148:151], a[92:95], v[108:111]
    v_exp_f32 v83, v83
    v_add_f32 v81, 1.0, v81
    v_mul_f32 v86, v86, v25
    s_waitcnt lgkmcnt(4)
    v_mfma_f32_16x16x32_bf16 v[96:99], a[152:155], a[96:99], v[96:99]
    ds_read_b64_tr_b16 a[140:141], v7 offset:19072
    v_exp_f32 v84, v84
    v_add_f32 v82, 1.0, v82
    v_rcp_f32 v80, v80
    v_mfma_f32_16x16x32_bf16 v[100:103], a[152:155], a[100:103], v[100:103]
    v_mul_f32 v87, v87, v25
    v_exp_f32 v85, v85
    v_add_f32 v83, 1.0, v83
    v_rcp_f32 v81, v81
    v_mfma_f32_16x16x32_bf16 v[104:107], a[152:155], a[104:107], v[104:107]
    ds_read_b64_tr_b16 a[142:143], v7 offset:19968
    v_exp_f32 v86, v86
    v_add_f32 v84, 1.0, v84
    v_rcp_f32 v82, v82
    v_mfma_f32_16x16x32_bf16 v[108:111], a[152:155], a[108:111], v[108:111]
    v_mul_f32 v192, v192, v80
    v_exp_f32 v87, v87
    v_add_f32 v85, 1.0, v85
    v_mfma_f32_16x16x32_bf16 v[96:99], a[128:131], a[112:115], v[96:99]
    ds_read_b64_tr_b16 a[144:145], v7 offset:35968
    v_rcp_f32 v83, v83
    v_mul_f32 v193, v193, v81
    v_add_f32 v86, 1.0, v86
    v_rcp_f32 v84, v84
    v_mfma_f32_16x16x32_bf16 v[100:103], a[128:131], a[116:119], v[100:103]
    v_mul_f32 v194, v194, v82
    v_add_f32 v87, 1.0, v87
    v_rcp_f32 v85, v85
    v_mfma_f32_16x16x32_bf16 v[104:107], a[128:131], a[120:123], v[104:107]
    ds_read_b64_tr_b16 a[146:147], v7 offset:36864
    v_mul_f32 v195, v195, v83
    v_rcp_f32 v86, v86
    v_mul_f32 v196, v196, v84
    v_mfma_f32_16x16x32_bf16 v[108:111], a[128:131], a[124:127], v[108:111]
    v_rcp_f32 v87, v87
    v_mul_f32 v197, v197, v85
    v_mul_f32 v198, v198, v86
    v_mul_f32 v199, v199, v87
    s_waitcnt lgkmcnt(4)
    v_mfma_f32_16x16x32_bf16 v[208:211], a[132:135], a[64:67], v[208:211]
    ds_read_b64_tr_b16 a[148:149], v9 offset:17056
    v_cvt_pk_bf16_f32 v16, v192, v193
    v_cvt_pk_bf16_f32 v18, v196, v197
    v_cvt_pk_bf16_f32 v17, v194, v195
    v_mfma_f32_16x16x32_bf16 v[212:215], a[132:135], a[68:71], v[212:215]
    v_cvt_pk_bf16_f32 v19, v198, v199
    v_permlane16_swap_b32 v16, v18
    s_nop 0
    v_permlane16_swap_b32 v17, v19
    v_mfma_f32_16x16x32_bf16 v[216:219], a[132:135], a[72:75], v[216:219]
    ds_read_b64_tr_b16 a[150:151], v9 offset:17952
    buffer_store_dwordx4 v[16:19], v14, s[40:43], 0 offen offset:3072 sc1
    v_mul_f32 v88, v88, v26
    v_mul_f32 v89, v89, v26
    v_mul_f32 v90, v90, v26
    v_mfma_f32_16x16x32_bf16 v[220:223], a[132:135], a[76:79], v[220:223]
    v_exp_f32 v88, v88
    v_mul_f32 v91, v91, v26
    v_exp_f32 v89, v89
    v_mfma_f32_16x16x32_bf16 v[208:211], a[136:139], a[80:83], v[208:211]
    ds_read_b64_tr_b16 a[152:153], v7 offset:160
    v_mul_f32 v92, v92, v27
    v_exp_f32 v90, v90
    v_add_f32 v88, 1.0, v88
    v_mul_f32 v93, v93, v27
    v_mfma_f32_16x16x32_bf16 v[212:215], a[136:139], a[84:87], v[212:215]
    v_exp_f32 v91, v91
    v_add_f32 v89, 1.0, v89
    v_mul_f32 v94, v94, v27
    v_mfma_f32_16x16x32_bf16 v[216:219], a[136:139], a[88:91], v[216:219]
    ds_read_b64_tr_b16 a[154:155], v7 offset:1056
    v_exp_f32 v92, v92
    v_add_f32 v90, 1.0, v90
    v_rcp_f32 v88, v88
    v_mfma_f32_16x16x32_bf16 v[220:223], a[136:139], a[92:95], v[220:223]
    v_mul_f32 v95, v95, v27
    v_exp_f32 v93, v93
    v_add_f32 v91, 1.0, v91
    v_rcp_f32 v89, v89
    s_waitcnt lgkmcnt(4)
    v_mfma_f32_16x16x32_bf16 v[208:211], a[140:143], a[96:99], v[208:211]
    ds_read_b64_tr_b16 a[128:129], v7 offset:17056
    v_exp_f32 v94, v94
    v_add_f32 v92, 1.0, v92
    v_rcp_f32 v90, v90
    v_mfma_f32_16x16x32_bf16 v[212:215], a[140:143], a[100:103], v[212:215]
    v_mul_f32 v200, v200, v88
    v_exp_f32 v95, v95
    v_add_f32 v93, 1.0, v93
    v_mfma_f32_16x16x32_bf16 v[216:219], a[140:143], a[104:107], v[216:219]
    ds_read_b64_tr_b16 a[130:131], v7 offset:17952
    v_rcp_f32 v91, v91
    v_mul_f32 v201, v201, v89
    v_add_f32 v94, 1.0, v94
    v_rcp_f32 v92, v92
    v_mfma_f32_16x16x32_bf16 v[220:223], a[140:143], a[108:111], v[220:223]
    v_mul_f32 v202, v202, v90
    v_add_f32 v95, 1.0, v95
    v_rcp_f32 v93, v93
    v_mfma_f32_16x16x32_bf16 v[208:211], a[144:147], a[112:115], v[208:211]
    ds_read_b64_tr_b16 a[132:133], v7 offset:33952
    v_mul_f32 v203, v203, v91
    v_rcp_f32 v94, v94
    v_mul_f32 v204, v204, v92
    v_mfma_f32_16x16x32_bf16 v[212:215], a[144:147], a[116:119], v[212:215]
    v_rcp_f32 v95, v95
    v_mul_f32 v205, v205, v93
    v_mul_f32 v206, v206, v94
    v_mul_f32 v207, v207, v95
    v_mfma_f32_16x16x32_bf16 v[216:219], a[144:147], a[120:123], v[216:219]
    ds_read_b64_tr_b16 a[134:135], v7 offset:34848
    v_cvt_pk_bf16_f32 v20, v200, v201
    v_cvt_pk_bf16_f32 v22, v204, v205
    v_cvt_pk_bf16_f32 v21, v202, v203
    v_mfma_f32_16x16x32_bf16 v[220:223], a[144:147], a[124:127], v[220:223]
    v_cvt_pk_bf16_f32 v23, v206, v207
    v_permlane16_swap_b32 v20, v22
    s_nop 0
    v_permlane16_swap_b32 v21, v23
    s_waitcnt lgkmcnt(4)
    v_mfma_f32_16x16x32_bf16 v[112:115], a[148:151], a[64:67], v[112:115]
    ds_read_b64_tr_b16 a[136:137], v9 offset:19104
    buffer_store_dwordx4 v[20:23], v14, s[40:43], s54 offen offset:3072 sc1
    v_mfma_f32_16x16x32_bf16 v[116:119], a[148:151], a[68:71], v[116:119]
    v_mfma_f32_16x16x32_bf16 v[120:123], a[148:151], a[72:75], v[120:123]
    ds_read_b64_tr_b16 a[138:139], v9 offset:20000
    v_mfma_f32_16x16x32_bf16 v[124:127], a[148:151], a[76:79], v[124:127]
    v_mfma_f32_16x16x32_bf16 v[112:115], a[152:155], a[80:83], v[112:115]
    ds_read_b64_tr_b16 a[140:141], v7 offset:2208
    v_mul_f32 v96, v96, v24
    v_mul_f32 v97, v97, v24
    v_mul_f32 v98, v98, v24
    v_mfma_f32_16x16x32_bf16 v[116:119], a[152:155], a[84:87], v[116:119]
    v_exp_f32 v96, v96
    v_mul_f32 v99, v99, v24
    v_exp_f32 v97, v97
    v_mfma_f32_16x16x32_bf16 v[120:123], a[152:155], a[88:91], v[120:123]
    ds_read_b64_tr_b16 a[142:143], v7 offset:3104
    v_mul_f32 v100, v100, v25
    v_exp_f32 v98, v98
    v_add_f32 v96, 1.0, v96
    v_mul_f32 v101, v101, v25
    v_mfma_f32_16x16x32_bf16 v[124:127], a[152:155], a[92:95], v[124:127]
    v_exp_f32 v99, v99
    v_add_f32 v97, 1.0, v97
    v_mul_f32 v102, v102, v25
    s_waitcnt lgkmcnt(4)
    v_mfma_f32_16x16x32_bf16 v[112:115], a[128:131], a[96:99], v[112:115]
    ds_read_b64_tr_b16 a[144:145], v7 offset:19104
    v_exp_f32 v100, v100
    v_add_f32 v98, 1.0, v98
    v_rcp_f32 v96, v96
    v_mfma_f32_16x16x32_bf16 v[116:119], a[128:131], a[100:103], v[116:119]
    v_mul_f32 v103, v103, v25
    v_exp_f32 v101, v101
    v_add_f32 v99, 1.0, v99
    v_rcp_f32 v97, v97
    v_mfma_f32_16x16x32_bf16 v[120:123], a[128:131], a[104:107], v[120:123]
    ds_read_b64_tr_b16 a[146:147], v7 offset:20000
    v_exp_f32 v102, v102
    v_add_f32 v100, 1.0, v100
    v_rcp_f32 v98, v98
    v_mfma_f32_16x16x32_bf16 v[124:127], a[128:131], a[108:111], v[124:127]
    v_mul_f32 v208, v208, v96
    v_exp_f32 v103, v103
    v_add_f32 v101, 1.0, v101
    v_mfma_f32_16x16x32_bf16 v[112:115], a[132:135], a[112:115], v[112:115]
    ds_read_b64_tr_b16 a[148:149], v7 offset:36000
    v_rcp_f32 v99, v99
    v_mul_f32 v209, v209, v97
    v_add_f32 v102, 1.0, v102
    v_rcp_f32 v100, v100
    v_mfma_f32_16x16x32_bf16 v[116:119], a[132:135], a[116:119], v[116:119]
    v_mul_f32 v210, v210, v98
    v_add_f32 v103, 1.0, v103
    v_rcp_f32 v101, v101
    v_mfma_f32_16x16x32_bf16 v[120:123], a[132:135], a[120:123], v[120:123]
    ds_read_b64_tr_b16 a[150:151], v7 offset:36896
    v_mul_f32 v211, v211, v99
    v_rcp_f32 v102, v102
    v_mul_f32 v212, v212, v100
    v_mfma_f32_16x16x32_bf16 v[124:127], a[132:135], a[124:127], v[124:127]
    v_rcp_f32 v103, v103
    v_mul_f32 v213, v213, v101
    v_mul_f32 v214, v214, v102
    v_mul_f32 v215, v215, v103
    s_waitcnt lgkmcnt(4)
    v_mfma_f32_16x16x32_bf16 v[224:227], a[136:139], a[64:67], v[224:227]
    ds_read_b64_tr_b16 a[152:153], v9 offset:17088
    v_cvt_pk_bf16_f32 v16, v208, v209
    v_cvt_pk_bf16_f32 v18, v212, v213
    v_cvt_pk_bf16_f32 v17, v210, v211
    v_mfma_f32_16x16x32_bf16 v[228:231], a[136:139], a[68:71], v[228:231]
    v_cvt_pk_bf16_f32 v19, v214, v215
    v_permlane16_swap_b32 v16, v18
    s_nop 0
    v_permlane16_swap_b32 v17, v19
    v_mfma_f32_16x16x32_bf16 v[232:235], a[136:139], a[72:75], v[232:235]
    ds_read_b64_tr_b16 a[154:155], v9 offset:17984
    buffer_store_dwordx4 v[16:19], v14, s[40:43], s53 offen offset:0 sc1
    v_mul_f32 v104, v104, v26
    v_mul_f32 v105, v105, v26
    v_mul_f32 v106, v106, v26
    v_mfma_f32_16x16x32_bf16 v[236:239], a[136:139], a[76:79], v[236:239]
    v_exp_f32 v104, v104
    v_mul_f32 v107, v107, v26
    v_exp_f32 v105, v105
    v_mfma_f32_16x16x32_bf16 v[224:227], a[140:143], a[80:83], v[224:227]
    ds_read_b64_tr_b16 a[128:129], v7 offset:192
    v_mul_f32 v108, v108, v27
    v_exp_f32 v106, v106
    v_add_f32 v104, 1.0, v104
    v_mul_f32 v109, v109, v27
    v_mfma_f32_16x16x32_bf16 v[228:231], a[140:143], a[84:87], v[228:231]
    v_exp_f32 v107, v107
    v_add_f32 v105, 1.0, v105
    v_mul_f32 v110, v110, v27
    v_mfma_f32_16x16x32_bf16 v[232:235], a[140:143], a[88:91], v[232:235]
    ds_read_b64_tr_b16 a[130:131], v7 offset:1088
    v_exp_f32 v108, v108
    v_add_f32 v106, 1.0, v106
    v_rcp_f32 v104, v104
    v_mfma_f32_16x16x32_bf16 v[236:239], a[140:143], a[92:95], v[236:239]
    v_mul_f32 v111, v111, v27
    v_exp_f32 v109, v109
    v_add_f32 v107, 1.0, v107
    v_rcp_f32 v105, v105
    s_waitcnt lgkmcnt(4)
    v_mfma_f32_16x16x32_bf16 v[224:227], a[144:147], a[96:99], v[224:227]
    ds_read_b64_tr_b16 a[132:133], v7 offset:17088
    v_exp_f32 v110, v110
    v_add_f32 v108, 1.0, v108
    v_rcp_f32 v106, v106
    v_mfma_f32_16x16x32_bf16 v[228:231], a[144:147], a[100:103], v[228:231]
    v_mul_f32 v216, v216, v104
    v_exp_f32 v111, v111
    v_add_f32 v109, 1.0, v109
    v_mfma_f32_16x16x32_bf16 v[232:235], a[144:147], a[104:107], v[232:235]
    ds_read_b64_tr_b16 a[134:135], v7 offset:17984
    v_rcp_f32 v107, v107
    v_mul_f32 v217, v217, v105
    v_add_f32 v110, 1.0, v110
    v_rcp_f32 v108, v108
    v_mfma_f32_16x16x32_bf16 v[236:239], a[144:147], a[108:111], v[236:239]
    v_mul_f32 v218, v218, v106
    v_add_f32 v111, 1.0, v111
    v_rcp_f32 v109, v109
    v_mfma_f32_16x16x32_bf16 v[224:227], a[148:151], a[112:115], v[224:227]
    ds_read_b64_tr_b16 a[136:137], v7 offset:33984
    v_mul_f32 v219, v219, v107
    v_rcp_f32 v110, v110
    v_mul_f32 v220, v220, v108
    v_mfma_f32_16x16x32_bf16 v[228:231], a[148:151], a[116:119], v[228:231]
    v_rcp_f32 v111, v111
    v_mul_f32 v221, v221, v109
    v_mul_f32 v222, v222, v110
    v_mul_f32 v223, v223, v111
    v_mfma_f32_16x16x32_bf16 v[232:235], a[148:151], a[120:123], v[232:235]
    ds_read_b64_tr_b16 a[138:139], v7 offset:34880
    v_cvt_pk_bf16_f32 v20, v216, v217
    v_cvt_pk_bf16_f32 v22, v220, v221
    v_cvt_pk_bf16_f32 v21, v218, v219
    v_mfma_f32_16x16x32_bf16 v[236:239], a[148:151], a[124:127], v[236:239]
    v_cvt_pk_bf16_f32 v23, v222, v223
    v_permlane16_swap_b32 v20, v22
    s_nop 0
    v_permlane16_swap_b32 v21, v23
    s_waitcnt lgkmcnt(4)
    v_mfma_f32_16x16x32_bf16 v[128:131], a[152:155], a[64:67], v[128:131]
    ds_read_b64_tr_b16 a[140:141], v9 offset:19136
    buffer_store_dwordx4 v[20:23], v14, s[40:43], s55 offen offset:0 sc1
    v_mfma_f32_16x16x32_bf16 v[132:135], a[152:155], a[68:71], v[132:135]
    v_mfma_f32_16x16x32_bf16 v[136:139], a[152:155], a[72:75], v[136:139]
    ds_read_b64_tr_b16 a[142:143], v9 offset:20032
    v_mfma_f32_16x16x32_bf16 v[140:143], a[152:155], a[76:79], v[140:143]
    v_mfma_f32_16x16x32_bf16 v[128:131], a[128:131], a[80:83], v[128:131]
    ds_read_b64_tr_b16 a[144:145], v7 offset:2240
    v_mul_f32 v112, v112, v24
    v_mul_f32 v113, v113, v24
    v_mul_f32 v114, v114, v24
    v_mfma_f32_16x16x32_bf16 v[132:135], a[128:131], a[84:87], v[132:135]
    v_exp_f32 v112, v112
    v_mul_f32 v115, v115, v24
    v_exp_f32 v113, v113
    v_mfma_f32_16x16x32_bf16 v[136:139], a[128:131], a[88:91], v[136:139]
    ds_read_b64_tr_b16 a[146:147], v7 offset:3136
    v_mul_f32 v116, v116, v25
    v_exp_f32 v114, v114
    v_add_f32 v112, 1.0, v112
    v_mul_f32 v117, v117, v25
    v_mfma_f32_16x16x32_bf16 v[140:143], a[128:131], a[92:95], v[140:143]
    v_exp_f32 v115, v115
    v_add_f32 v113, 1.0, v113
    v_mul_f32 v118, v118, v25
    s_waitcnt lgkmcnt(4)
    v_mfma_f32_16x16x32_bf16 v[128:131], a[132:135], a[96:99], v[128:131]
    ds_read_b64_tr_b16 a[148:149], v7 offset:19136
    v_exp_f32 v116, v116
    v_add_f32 v114, 1.0, v114
    v_rcp_f32 v112, v112
    v_mfma_f32_16x16x32_bf16 v[132:135], a[132:135], a[100:103], v[132:135]
    v_mul_f32 v119, v119, v25
    v_exp_f32 v117, v117
    v_add_f32 v115, 1.0, v115
    v_rcp_f32 v113, v113
    v_mfma_f32_16x16x32_bf16 v[136:139], a[132:135], a[104:107], v[136:139]
    ds_read_b64_tr_b16 a[150:151], v7 offset:20032
    v_exp_f32 v118, v118
    v_add_f32 v116, 1.0, v116
    v_rcp_f32 v114, v114
    v_mfma_f32_16x16x32_bf16 v[140:143], a[132:135], a[108:111], v[140:143]
    v_mul_f32 v224, v224, v112
    v_exp_f32 v119, v119
    v_add_f32 v117, 1.0, v117
    v_mfma_f32_16x16x32_bf16 v[128:131], a[136:139], a[112:115], v[128:131]
    ds_read_b64_tr_b16 a[152:153], v7 offset:36032
    v_rcp_f32 v115, v115
    v_mul_f32 v225, v225, v113
    v_add_f32 v118, 1.0, v118
    v_rcp_f32 v116, v116
    v_mfma_f32_16x16x32_bf16 v[132:135], a[136:139], a[116:119], v[132:135]
    v_mul_f32 v226, v226, v114
    v_add_f32 v119, 1.0, v119
    v_rcp_f32 v117, v117
    v_mfma_f32_16x16x32_bf16 v[136:139], a[136:139], a[120:123], v[136:139]
    ds_read_b64_tr_b16 a[154:155], v7 offset:36928
    v_mul_f32 v227, v227, v115
    v_rcp_f32 v118, v118
    v_mul_f32 v228, v228, v116
    v_mfma_f32_16x16x32_bf16 v[140:143], a[136:139], a[124:127], v[140:143]
    v_rcp_f32 v119, v119
    v_mul_f32 v229, v229, v117
    v_mul_f32 v230, v230, v118
    v_mul_f32 v231, v231, v119
    s_waitcnt lgkmcnt(4)
    v_mfma_f32_16x16x32_bf16 v[240:243], a[140:143], a[64:67], v[240:243]
    v_cvt_pk_bf16_f32 v16, v224, v225
    v_cvt_pk_bf16_f32 v18, v228, v229
    v_cvt_pk_bf16_f32 v17, v226, v227
    v_mfma_f32_16x16x32_bf16 v[244:247], a[140:143], a[68:71], v[244:247]
    v_cvt_pk_bf16_f32 v19, v230, v231
    v_permlane16_swap_b32 v16, v18
    s_nop 0
    v_permlane16_swap_b32 v17, v19
    v_mfma_f32_16x16x32_bf16 v[248:251], a[140:143], a[72:75], v[248:251]
    buffer_store_dwordx4 v[16:19], v14, s[40:43], s53 offen offset:1024 sc1
    v_mul_f32 v120, v120, v26
    v_mul_f32 v121, v121, v26
    v_mul_f32 v122, v122, v26
    v_mfma_f32_16x16x32_bf16 v[252:255], a[140:143], a[76:79], v[252:255]
    v_exp_f32 v120, v120
    v_mul_f32 v123, v123, v26
    v_exp_f32 v121, v121
    v_mfma_f32_16x16x32_bf16 v[240:243], a[144:147], a[80:83], v[240:243]
    v_mul_f32 v124, v124, v27
    v_exp_f32 v122, v122
    v_add_f32 v120, 1.0, v120
    v_mul_f32 v125, v125, v27
    v_mfma_f32_16x16x32_bf16 v[244:247], a[144:147], a[84:87], v[244:247]
    v_exp_f32 v123, v123
    v_add_f32 v121, 1.0, v121
    v_mul_f32 v126, v126, v27
    v_mfma_f32_16x16x32_bf16 v[248:251], a[144:147], a[88:91], v[248:251]
    v_exp_f32 v124, v124
    v_add_f32 v122, 1.0, v122
    v_rcp_f32 v120, v120
    v_mfma_f32_16x16x32_bf16 v[252:255], a[144:147], a[92:95], v[252:255]
    v_mul_f32 v127, v127, v27
    v_exp_f32 v125, v125
    v_add_f32 v123, 1.0, v123
    v_rcp_f32 v121, v121
    s_waitcnt lgkmcnt(0)
    v_mfma_f32_16x16x32_bf16 v[240:243], a[148:151], a[96:99], v[240:243]
    v_exp_f32 v126, v126
    v_add_f32 v124, 1.0, v124
    v_rcp_f32 v122, v122
    v_mfma_f32_16x16x32_bf16 v[244:247], a[148:151], a[100:103], v[244:247]
    v_mul_f32 v232, v232, v120
    v_exp_f32 v127, v127
    v_add_f32 v125, 1.0, v125
    v_mfma_f32_16x16x32_bf16 v[248:251], a[148:151], a[104:107], v[248:251]
    v_rcp_f32 v123, v123
    v_mul_f32 v233, v233, v121
    v_add_f32 v126, 1.0, v126
    v_rcp_f32 v124, v124
    v_mfma_f32_16x16x32_bf16 v[252:255], a[148:151], a[108:111], v[252:255]
    v_mul_f32 v234, v234, v122
    v_add_f32 v127, 1.0, v127
    v_rcp_f32 v125, v125
    v_mfma_f32_16x16x32_bf16 v[240:243], a[152:155], a[112:115], v[240:243]
    v_mul_f32 v235, v235, v123
    v_rcp_f32 v126, v126
    v_mul_f32 v236, v236, v124
    v_mfma_f32_16x16x32_bf16 v[244:247], a[152:155], a[116:119], v[244:247]
    v_rcp_f32 v127, v127
    v_mul_f32 v237, v237, v125
    v_mul_f32 v238, v238, v126
    v_mul_f32 v239, v239, v127
    v_mfma_f32_16x16x32_bf16 v[248:251], a[152:155], a[120:123], v[248:251]
    v_cvt_pk_bf16_f32 v20, v232, v233
    v_cvt_pk_bf16_f32 v22, v236, v237
    v_cvt_pk_bf16_f32 v21, v234, v235
    v_mfma_f32_16x16x32_bf16 v[252:255], a[152:155], a[124:127], v[252:255]
    v_cvt_pk_bf16_f32 v23, v238, v239
    v_permlane16_swap_b32 v20, v22
    s_nop 0
    v_permlane16_swap_b32 v21, v23
    buffer_store_dwordx4 v[20:23], v14, s[40:43], s55 offen offset:1024 sc1
    v_mov_b32 v6, v24
    v_mov_b32 v8, v25
    v_mov_b32 v10, v26
    v_mov_b32 v12, v27
    s_bfe_u32 s11, s27, 65536
    s_mul_i32 s52, s11, 3670016
    s_andn2_b32 s53, s27, 1
    s_lshl_b32 s53, s53, 7
    s_add_u32 s52, s52, s53
    s_sub_u32 s53, 3670016, s53
    s_add_u32 s28, s16, s52
    s_addc_u32 s29, s17, 0
    s_mov_b32 s30, s53
    s_mov_b32 s31, 0x00020000
    s_lshl_b32 s48, s3, 11
    s_and_b32 s52, s3, 1
    s_lshl_b32 s52, s52, 3
    v_lshlrev_b32 v4, 1, v2
    v_or_b32 v4, s52, v4
    v_xor_b32 v4, v4, v1
    v_lshrrev_b32 v5, 3, v4
    v_and_b32 v4, 7, v4
    v_lshlrev_b32 v4, 4, v4
    v_lshl_add_u32 v4, v5, 7, v4
    v_lshl_add_u32 v4, v2, 11, v4
    s_lshl_b32 s52, s3, 14
    v_add_u32 v4, s52, v4
    v_add_u32 v5, 7168, v4
    s_mov_b32 s49, 0
    v_lshlrev_b32 v14, 4, v0
    s_mov_b32 s53, 4096
    s_mov_b32 s54, 229376
    s_mov_b32 s55, 233472
    v_pk_mul_f32 v[128:129], v[128:129], v[6:7] op_sel_hi:[1,0]
    v_pk_mul_f32 v[130:131], v[130:131], v[6:7] op_sel_hi:[1,0]
    v_pk_mul_f32 v[132:133], v[132:133], v[8:9] op_sel_hi:[1,0]
    v_pk_mul_f32 v[134:135], v[134:135], v[8:9] op_sel_hi:[1,0]
    v_exp_f32 v128, v128
    v_exp_f32 v129, v129
    v_exp_f32 v130, v130
    v_exp_f32 v131, v131
    v_exp_f32 v132, v132
    v_exp_f32 v133, v133
    v_exp_f32 v134, v134
    v_exp_f32 v135, v135
    v_pk_add_f32 v[128:129], v[128:129], 1.0 op_sel_hi:[1,0]
    v_pk_add_f32 v[130:131], v[130:131], 1.0 op_sel_hi:[1,0]
    v_pk_add_f32 v[132:133], v[132:133], 1.0 op_sel_hi:[1,0]
    v_pk_add_f32 v[134:135], v[134:135], 1.0 op_sel_hi:[1,0]
    v_rcp_f32 v128, v128
    v_rcp_f32 v129, v129
    v_rcp_f32 v130, v130
    v_rcp_f32 v131, v131
    v_rcp_f32 v132, v132
    v_rcp_f32 v133, v133
    v_rcp_f32 v134, v134
    v_rcp_f32 v135, v135
    v_pk_mul_f32 v[240:241], v[240:241], v[128:129]
    v_pk_mul_f32 v[242:243], v[242:243], v[130:131]
    v_pk_mul_f32 v[244:245], v[244:245], v[132:133]
    v_pk_mul_f32 v[246:247], v[246:247], v[134:135]
    v_cvt_pk_bf16_f32 v16, v240, v241
    v_cvt_pk_bf16_f32 v17, v242, v243
    v_cvt_pk_bf16_f32 v18, v244, v245
    v_cvt_pk_bf16_f32 v19, v246, v247
    s_nop 0
    v_permlane16_swap_b32 v16, v18
    v_permlane16_swap_b32 v17, v19
    buffer_store_dwordx4 v[16:19], v14, s[40:43], s53 offen offset:2048 sc1
    v_pk_mul_f32 v[136:137], v[136:137], v[10:11] op_sel_hi:[1,0]
    v_pk_mul_f32 v[138:139], v[138:139], v[10:11] op_sel_hi:[1,0]
    v_pk_mul_f32 v[140:141], v[140:141], v[12:13] op_sel_hi:[1,0]
    v_pk_mul_f32 v[142:143], v[142:143], v[12:13] op_sel_hi:[1,0]
    v_exp_f32 v136, v136
    v_exp_f32 v137, v137
    v_exp_f32 v138, v138
    v_exp_f32 v139, v139
    v_exp_f32 v140, v140
    v_exp_f32 v141, v141
    v_exp_f32 v142, v142
    v_exp_f32 v143, v143
    v_pk_add_f32 v[136:137], v[136:137], 1.0 op_sel_hi:[1,0]
    v_pk_add_f32 v[138:139], v[138:139], 1.0 op_sel_hi:[1,0]
    v_pk_add_f32 v[140:141], v[140:141], 1.0 op_sel_hi:[1,0]
    v_pk_add_f32 v[142:143], v[142:143], 1.0 op_sel_hi:[1,0]
    v_rcp_f32 v136, v136
    v_rcp_f32 v137, v137
    v_rcp_f32 v138, v138
    v_rcp_f32 v139, v139
    v_rcp_f32 v140, v140
    v_rcp_f32 v141, v141
    v_rcp_f32 v142, v142
    v_rcp_f32 v143, v143
    v_pk_mul_f32 v[248:249], v[248:249], v[136:137]
    v_pk_mul_f32 v[250:251], v[250:251], v[138:139]
    v_pk_mul_f32 v[252:253], v[252:253], v[140:141]
    v_pk_mul_f32 v[254:255], v[254:255], v[142:143]
    v_cvt_pk_bf16_f32 v20, v248, v249
    v_cvt_pk_bf16_f32 v21, v250, v251
    v_cvt_pk_bf16_f32 v22, v252, v253
    v_cvt_pk_bf16_f32 v23, v254, v255
    s_nop 0
    v_permlane16_swap_b32 v20, v22
    v_permlane16_swap_b32 v21, v23
    buffer_store_dwordx4 v[20:23], v14, s[40:43], s55 offen offset:2048 sc1
    v_lshrrev_b32 v14, 2, v1
    v_lshl_add_u32 v15, v2, 3, v14
    v_lshlrev_b32 v15, 8, v15
    v_and_b32 v13, 3, v0
    v_lshl_add_u32 v15, v13, 3, v15
    v_xor_b32 v13, s11, v2
    v_and_b32 v13, 1, v13
    v_lshl_add_u32 v14, v13, 2, v14
    v_lshl_add_u32 v6, v14, 5, v15
    v_xor_b32 v7, 32, v6
    v_xor_b32 v8, 64, v6
    v_xor_b32 v9, 96, v6
    v_xor_b32 v10, 128, v6
    v_xor_b32 v11, 160, v6
    v_xor_b32 v12, 192, v6
    v_xor_b32 v13, 224, v6
    v_add_u32 v160, 65536, v6
    v_add_u32 v161, 65536, v7
    v_add_u32 v162, 65536, v8
    v_add_u32 v163, 65536, v9
    v_add_u32 v164, 65536, v10
    v_add_u32 v165, 65536, v11
    v_add_u32 v166, 65536, v12
    v_add_u32 v167, 65536, v13
    s_lshl_b32 s56, s26, 2
    s_add_u32 s56, s56, s3
    s_mul_i32 s52, s56, 229376
    s_mul_i32 s53, s11, 114688
    s_add_u32 s52, s52, s53
    s_add_u32 s52, s52, 25165824
    s_add_u32 s36, s22, s52
    s_addc_u32 s37, s23, 0
    s_mov_b32 s38, 114688
    s_mov_b32 s39, 0x00020000
    v_lshlrev_b32 v3, 9, v2
    v_lshl_add_u32 v3, v1, 4, v3
    s_mov_b32 s50, 0
    v_lshrrev_b32 v14, 1, v2
    v_and_b32 v15, 1, v2
    v_lshlrev_b32 v139, 11, v1
    v_lshl_add_u32 v139, v15, 5, v139
    v_lshl_add_u32 v139, v14, 4, v139
    s_lshl_b32 s52, s56, 16
    s_lshl_b32 s53, s27, 7
    s_add_u32 s52, s52, s53
    s_sub_u32 s53, 65536, s53
    s_add_u32 s40, s18, s52
    s_addc_u32 s41, s19, 0
    s_mov_b32 s42, s53
    s_mov_b32 s43, 0x00020000
    s_lshl_b32 s52, s26, 4
    s_add_u32 s52, s52, s27
    s_lshl_b32 s57, s52, 7
    s_lshl_b32 s53, s3, 2
    s_add_u32 s57, s57, s53
    s_add_u32 s57, s57, 8208
    s_lshl_b32 s52, s26, 19
    s_add_u32 s32, s22, s52
    s_addc_u32 s33, s23, 0
    s_mov_b32 s34, 524288
    s_mov_b32 s35, 0x00020000
    s_lshl_b32 s52, s27, 2
    s_add_u32 s52, s52, s3
    s_lshl_b32 s52, s52, 13
    v_lshlrev_b32 v137, 4, v0
    v_add_u32 v137, s52, v137
    v_xor_b32 v138, 32768, v137
    s_lshl_b32 s52, s56, 5
    s_lshl_b32 s52, s52, 2
    s_sub_u32 s53, 131072, s52
    s_add_u32 s52, s52, 41967616
    s_add_u32 s44, s22, s52
    s_addc_u32 s45, s23, 0
    s_mov_b32 s46, s53
    s_mov_b32 s47, 0x00020000
    v_lshlrev_b32 v14, 15, v2
    v_lshl_add_u32 v14, v1, 2, v14
    s_mov_b32 s53, 8192
    s_mov_b32 s54, 16384
    s_mov_b32 s55, 24576
    v_mov_b32 v32, 0
    v_mov_b32 v33, 0
    v_mov_b32 v34, 0
    v_mov_b32 v35, 0
    v_mov_b32 v36, 0
    v_mov_b32 v37, 0
    v_mov_b32 v38, 0
    v_mov_b32 v39, 0
    v_mov_b32 v40, 0
    v_mov_b32 v41, 0
    v_mov_b32 v42, 0
    v_mov_b32 v43, 0
    v_mov_b32 v44, 0
    v_mov_b32 v45, 0
    v_mov_b32 v46, 0
    v_mov_b32 v47, 0
    v_mov_b32 v48, 0
    v_mov_b32 v49, 0
    v_mov_b32 v50, 0
    v_mov_b32 v51, 0
    v_mov_b32 v52, 0
    v_mov_b32 v53, 0
    v_mov_b32 v54, 0
    v_mov_b32 v55, 0
    v_mov_b32 v56, 0
    v_mov_b32 v57, 0
    v_mov_b32 v58, 0
    v_mov_b32 v59, 0
    v_mov_b32 v60, 0
    v_mov_b32 v61, 0
    v_mov_b32 v62, 0
    v_mov_b32 v63, 0
    v_mov_b32 v64, 0
    v_mov_b32 v65, 0
    v_mov_b32 v66, 0
    v_mov_b32 v67, 0
    v_mov_b32 v68, 0
    v_mov_b32 v69, 0
    v_mov_b32 v70, 0
    v_mov_b32 v71, 0
    v_mov_b32 v72, 0
    v_mov_b32 v73, 0
    v_mov_b32 v74, 0
    v_mov_b32 v75, 0
    v_mov_b32 v76, 0
    v_mov_b32 v77, 0
    v_mov_b32 v78, 0
    v_mov_b32 v79, 0
    v_mov_b32 v80, 0
    v_mov_b32 v81, 0
    v_mov_b32 v82, 0
    v_mov_b32 v83, 0
    v_mov_b32 v84, 0
    v_mov_b32 v85, 0
    v_mov_b32 v86, 0
    v_mov_b32 v87, 0
    v_mov_b32 v88, 0
    v_mov_b32 v89, 0
    v_mov_b32 v90, 0
    v_mov_b32 v91, 0
    v_mov_b32 v92, 0
    v_mov_b32 v93, 0
    v_mov_b32 v94, 0
    v_mov_b32 v95, 0
    v_accvgpr_read_b32 v96, a192
    v_accvgpr_read_b32 v97, a193
    v_accvgpr_read_b32 v98, a194
    v_accvgpr_read_b32 v99, a195
    v_accvgpr_read_b32 v100, a196
    v_accvgpr_read_b32 v101, a197
    v_accvgpr_read_b32 v102, a198
    v_accvgpr_read_b32 v103, a199
    v_accvgpr_read_b32 v104, a200
    v_accvgpr_read_b32 v105, a201
    v_accvgpr_read_b32 v106, a202
    v_accvgpr_read_b32 v107, a203
    v_accvgpr_read_b32 v108, a204
    v_accvgpr_read_b32 v109, a205
    v_accvgpr_read_b32 v110, a206
    v_accvgpr_read_b32 v111, a207
    v_accvgpr_read_b32 v112, a208
    v_accvgpr_read_b32 v113, a209
    v_accvgpr_read_b32 v114, a210
    v_accvgpr_read_b32 v115, a211
    v_accvgpr_read_b32 v116, a212
    v_accvgpr_read_b32 v117, a213
    v_accvgpr_read_b32 v118, a214
    v_accvgpr_read_b32 v119, a215
    v_accvgpr_read_b32 v120, a216
    v_accvgpr_read_b32 v121, a217
    v_accvgpr_read_b32 v122, a218
    v_accvgpr_read_b32 v123, a219
    v_accvgpr_read_b32 v124, a220
    v_accvgpr_read_b32 v125, a221
    v_accvgpr_read_b32 v126, a222
    v_accvgpr_read_b32 v127, a223
    s_waitcnt vmcnt(0) lgkmcnt(0)
    s_barrier
    s_cmp_lg_u32 s3, 0
    s_cbranch_scc1 SIG_15
    s_lshl_b32 s52, s24, 6
    s_add_u32 s52, s52, s25
    s_lshl_b32 s52, s52, 2
    s_add_u32 s52, s52, 6144
    v_lshrrev_b32 v16, 0, v0
    v_lshlrev_b32 v16, 20, v16
    v_lshl_add_u32 v16, v0, 13, v16
    s_add_u32 s52, s52, 40960
    v_mov_b32 v17, s10
    buffer_store_dword v17, v16, s[64:67], s52 offen sc1
SIG_15:
    s_cmp_lg_u32 s3, 3
    s_cbranch_scc1 CT_16
    s_getpc_b64 s[0:1]
CTH_17:
    s_add_u32 s0, s0, P5_loop-CTH_17
    s_addc_u32 s1, s1, (P5_loop-CTH_17)>>32
    s_lshr_b32 s52, s2, 3
    s_mul_i32 s52, s52, ((C_end-P5_loop)/4096+1)
    v_min_u32 v18, ((C_end-P5_loop)/4096), v0
    v_add_u32 v18, s52, v18
    v_min_u32 v18, ((C_end-P5_loop)/128), v18
    v_lshlrev_b32 v18, 7, v18
    v_mov_b32 v19, s1
    v_add_co_u32 v18, vcc, s0, v18
    s_nop 1
    v_addc_co_u32 v19, vcc, 0, v19, vcc
    global_load_dword v20, v[18:19], off
CT_16:
    s_mov_b32 s20, s49
    s_cmp_eq_u32 s3, 0
    s_cbranch_scc1 S4_skip
    s_add_u32 m0, s48, 0
    s_nop 0
    buffer_load_dwordx4 v4, s[28:31], s49 offen lds
    buffer_load_dwordx4 v5, s[28:31], s49 offen offset:1024 lds
    s_add_u32 s49, s49, 65536
    s_add_u32 m0, s48, 8192
    s_nop 0
    buffer_load_dwordx4 v4, s[28:31], s49 offen lds
    buffer_load_dwordx4 v5, s[28:31], s49 offen offset:1024 lds
    s_add_u32 s49, s49, 65536
    s_add_u32 m0, s48, 16384
    s_nop 0
    buffer_load_dwordx4 v4, s[28:31], s49 offen lds
    buffer_load_dwordx4 v5, s[28:31], s49 offen offset:1024 lds
    s_add_u32 s49, s49, 65536
    s_add_u32 m0, s48, 24576
    s_nop 0
    buffer_load_dwordx4 v4, s[28:31], s49 offen lds
    buffer_load_dwordx4 v5, s[28:31], s49 offen offset:1024 lds
    s_add_u32 s49, s49, 65536
    s_add_u32 m0, s48, 32768
    s_nop 0
    buffer_load_dwordx4 v4, s[28:31], s49 offen lds
    buffer_load_dwordx4 v5, s[28:31], s49 offen offset:1024 lds
    s_add_u32 s49, s49, 65536
    s_add_u32 m0, s48, 40960
    s_nop 0
    buffer_load_dwordx4 v4, s[28:31], s49 offen lds
    buffer_load_dwordx4 v5, s[28:31], s49 offen offset:1024 lds
    s_add_u32 s49, s49, 65536
    s_add_u32 m0, s48, 49152
    s_nop 0
    buffer_load_dwordx4 v4, s[28:31], s49 offen lds
    buffer_load_dwordx4 v5, s[28:31], s49 offen offset:1024 lds
    s_add_u32 s49, s49, 65536
    s_add_u32 m0, s48, 57344
    s_nop 0
    buffer_load_dwordx4 v4, s[28:31], s49 offen lds
    buffer_load_dwordx4 v5, s[28:31], s49 offen offset:1024 lds
    s_add_u32 s49, s49, 65536
    s_add_u32 m0, s48, 65536
    s_nop 0
    buffer_load_dwordx4 v4, s[28:31], s49 offen lds
    buffer_load_dwordx4 v5, s[28:31], s49 offen offset:1024 lds
    s_add_u32 s49, s49, 65536
    s_add_u32 m0, s48, 73728
    s_nop 0
    buffer_load_dwordx4 v4, s[28:31], s49 offen lds
    buffer_load_dwordx4 v5, s[28:31], s49 offen offset:1024 lds
    s_add_u32 s49, s49, 65536
    s_add_u32 m0, s48, 81920
    s_nop 0
    buffer_load_dwordx4 v4, s[28:31], s49 offen lds
    buffer_load_dwordx4 v5, s[28:31], s49 offen offset:1024 lds
    s_add_u32 s49, s49, 65536
    s_cmp_eq_u32 s3, 2
    s_cbranch_scc0 S4_done
    s_mov_b32 s49, s20
    s_sub_u32 s48, s48, 4096
    v_subrev_u32 v4, 32768, v4
    v_subrev_u32 v5, 32768, v5
    s_add_u32 m0, s48, 0
    s_nop 0
    buffer_load_dwordx4 v4, s[28:31], s49 offen lds
    buffer_load_dwordx4 v5, s[28:31], s49 offen offset:1024 lds
    s_add_u32 s49, s49, 65536
    s_add_u32 m0, s48, 8192
    s_nop 0
    buffer_load_dwordx4 v4, s[28:31], s49 offen lds
    buffer_load_dwordx4 v5, s[28:31], s49 offen offset:1024 lds
    s_add_u32 s49, s49, 65536
    s_add_u32 m0, s48, 16384
    s_nop 0
    buffer_load_dwordx4 v4, s[28:31], s49 offen lds
    buffer_load_dwordx4 v5, s[28:31], s49 offen offset:1024 lds
    s_add_u32 s49, s49, 65536
    s_add_u32 m0, s48, 24576
    s_nop 0
    buffer_load_dwordx4 v4, s[28:31], s49 offen lds
    buffer_load_dwordx4 v5, s[28:31], s49 offen offset:1024 lds
    s_add_u32 s49, s49, 65536
    s_add_u32 m0, s48, 32768
    s_nop 0
    buffer_load_dwordx4 v4, s[28:31], s49 offen lds
    buffer_load_dwordx4 v5, s[28:31], s49 offen offset:1024 lds
    s_add_u32 s49, s49, 65536
    s_add_u32 m0, s48, 40960
    s_nop 0
    buffer_load_dwordx4 v4, s[28:31], s49 offen lds
    buffer_load_dwordx4 v5, s[28:31], s49 offen offset:1024 lds
    s_add_u32 s49, s49, 65536
    s_add_u32 m0, s48, 49152
    s_nop 0
    buffer_load_dwordx4 v4, s[28:31], s49 offen lds
    buffer_load_dwordx4 v5, s[28:31], s49 offen offset:1024 lds
    s_add_u32 s49, s49, 65536
    s_add_u32 m0, s48, 57344
    s_nop 0
    buffer_load_dwordx4 v4, s[28:31], s49 offen lds
    buffer_load_dwordx4 v5, s[28:31], s49 offen offset:1024 lds
    s_add_u32 s49, s49, 65536
    s_add_u32 m0, s48, 65536
    s_nop 0
    buffer_load_dwordx4 v4, s[28:31], s49 offen lds
    buffer_load_dwordx4 v5, s[28:31], s49 offen offset:1024 lds
    s_add_u32 s49, s49, 65536
    s_add_u32 m0, s48, 73728
    s_nop 0
    buffer_load_dwordx4 v4, s[28:31], s49 offen lds
    buffer_load_dwordx4 v5, s[28:31], s49 offen offset:1024 lds
    s_add_u32 s49, s49, 65536
    s_add_u32 m0, s48, 81920
    s_nop 0
    buffer_load_dwordx4 v4, s[28:31], s49 offen lds
    buffer_load_dwordx4 v5, s[28:31], s49 offen offset:1024 lds
    s_add_u32 s49, s49, 65536
    s_add_u32 s48, s48, 4096
    v_add_u32 v4, 32768, v4
    v_add_u32 v5, 32768, v5
    s_branch S4_done
S4_skip:
    s_add_u32 s49, s49, 720896
S4_done:
    s_cmp_lg_u32 s3, 0
    s_cbranch_scc1 WT_18
    s_lshr_b32 s52, s26, 1
    s_lshl_b32 s52, s52, 2
    s_add_u32 s52, s52, s11
    s_lshl_b32 s52, s52, 6
    s_add_u32 s52, s52, 6144
    v_and_b32 v16, 15, v0
    v_lshlrev_b32 v16, 2, v16
    v_add_u32 v16, s52, v16
    s_lshr_b32 s52, s2, 5
    s_and_b32 s52, s52, 0
    s_lshl_b32 s52, s52, 13
    s_add_u32 s52, s52, 40960
    v_add_u32 v16, s52, v16
    s_mov_b32 s52, 0x40000
    s_sleep 16
POLL_19:
    s_sleep 8
    buffer_load_dword v17, v16, s[64:67], 0 offen sc1
    s_waitcnt vmcnt(0)
    v_cmp_ne_u32 vcc, s10, v17
    s_sub_u32 s52, s52, 1
    s_cbranch_scc1 WT_18
    s_cbranch_vccnz POLL_19
WT_18:
    s_waitcnt vmcnt(18)
    s_barrier
    buffer_load_dwordx4 a[0:3], v3, s[36:39], s50 offen offset:0 sc1
    buffer_load_dwordx4 a[4:7], v3, s[36:39], s50 offen offset:256 sc1
    s_add_u32 s50, s50, 2048
    buffer_load_dwordx4 a[8:11], v3, s[36:39], s50 offen offset:0 sc1
    buffer_load_dwordx4 a[12:15], v3, s[36:39], s50 offen offset:256 sc1
    s_add_u32 s50, s50, 2048
    buffer_load_dwordx4 a[16:19], v3, s[36:39], s50 offen offset:0 sc1
    buffer_load_dwordx4 a[20:23], v3, s[36:39], s50 offen offset:256 sc1
    s_add_u32 s50, s50, 2048
    buffer_load_dwordx4 a[24:27], v3, s[36:39], s50 offen offset:0 sc1
    buffer_load_dwordx4 a[28:31], v3, s[36:39], s50 offen offset:256 sc1
    s_add_u32 s50, s50, 2048
    buffer_load_dwordx4 a[32:35], v3, s[36:39], s50 offen offset:0 sc1
    buffer_load_dwordx4 a[36:39], v3, s[36:39], s50 offen offset:256 sc1
    s_add_u32 s50, s50, 2048
    buffer_load_dwordx4 a[40:43], v3, s[36:39], s50 offen offset:0 sc1
    buffer_load_dwordx4 a[44:47], v3, s[36:39], s50 offen offset:256 sc1
    s_add_u32 s50, s50, 2048
    buffer_load_dword v128, v14, s[44:47], 0 offen offset:0 sc1
    buffer_load_dword v129, v14, s[44:47], s53 offen offset:0 sc1
    buffer_load_dword v130, v14, s[44:47], s54 offen offset:0 sc1
    buffer_load_dword v131, v14, s[44:47], s55 offen offset:0 sc1
    buffer_load_dword v132, v14, s[44:47], 0 offen offset:64 sc1
    buffer_load_dword v133, v14, s[44:47], s53 offen offset:64 sc1
    buffer_load_dword v134, v14, s[44:47], s54 offen offset:64 sc1
    buffer_load_dword v135, v14, s[44:47], s55 offen offset:64 sc1
    s_mov_b32 s53, 32768
    s_mov_b32 s54, 4096
    ds_read_b64_tr_b16 a[112:113], v6 offset:0
    ds_read_b64_tr_b16 a[114:115], v6 offset:1024
    ds_read_b64_tr_b16 a[116:117], v7 offset:0
    ds_read_b64_tr_b16 a[118:119], v7 offset:1024
    ds_read_b64_tr_b16 a[120:121], v8 offset:0
    ds_read_b64_tr_b16 a[122:123], v8 offset:1024
    ds_read_b64_tr_b16 a[124:125], v9 offset:0
    ds_read_b64_tr_b16 a[126:127], v9 offset:1024
    ds_read_b64_tr_b16 a[128:129], v10 offset:0
    ds_read_b64_tr_b16 a[130:131], v10 offset:1024
    ds_read_b64_tr_b16 a[132:133], v11 offset:0
    ds_read_b64_tr_b16 a[134:135], v11 offset:1024
    s_mov_b32 s51, 3
P5_loop:
    s_waitcnt vmcnt(18) lgkmcnt(8)
    v_mfma_f32_16x16x32_bf16 v[32:35], a[112:115], a[0:3], v[32:35]
    ds_read_b64_tr_b16 a[136:137], v12 offset:0
    v_mfma_f32_16x16x32_bf16 v[36:39], a[112:115], a[4:7], v[36:39]
    ds_read_b64_tr_b16 a[138:139], v12 offset:1024
    v_mfma_f32_16x16x32_bf16 v[44:47], a[116:119], a[4:7], v[44:47]
    ds_read_b64_tr_b16 a[140:141], v13 offset:0
    buffer_load_dwordx4 a[48:51], v3, s[36:39], s50 offen offset:0 sc1
    v_mfma_f32_16x16x32_bf16 v[40:43], a[116:119], a[0:3], v[40:43]
    ds_read_b64_tr_b16 a[142:143], v13 offset:1024
    s_waitcnt lgkmcnt(8)
    v_mfma_f32_16x16x32_bf16 v[48:51], a[120:123], a[0:3], v[48:51]
    ds_read_b64_tr_b16 a[112:113], v6 offset:8192
    v_mfma_f32_16x16x32_bf16 v[52:55], a[120:123], a[4:7], v[52:55]
    ds_read_b64_tr_b16 a[114:115], v6 offset:9216
    s_add_u32 m0, s48, 90112
    v_mfma_f32_16x16x32_bf16 v[60:63], a[124:127], a[4:7], v[60:63]
    ds_read_b64_tr_b16 a[116:117], v7 offset:8192
    buffer_load_dwordx4 v4, s[28:31], s49 offen lds
    v_mfma_f32_16x16x32_bf16 v[56:59], a[124:127], a[0:3], v[56:59]
    ds_read_b64_tr_b16 a[118:119], v7 offset:9216
    s_waitcnt lgkmcnt(8)
    v_mfma_f32_16x16x32_bf16 v[64:67], a[128:131], a[0:3], v[64:67]
    ds_read_b64_tr_b16 a[120:121], v8 offset:8192
    v_mfma_f32_16x16x32_bf16 v[68:71], a[128:131], a[4:7], v[68:71]
    ds_read_b64_tr_b16 a[122:123], v8 offset:9216
    v_mfma_f32_16x16x32_bf16 v[76:79], a[132:135], a[4:7], v[76:79]
    ds_read_b64_tr_b16 a[124:125], v9 offset:8192
    buffer_load_dwordx4 a[52:55], v3, s[36:39], s50 offen offset:256 sc1
    v_mfma_f32_16x16x32_bf16 v[72:75], a[132:135], a[0:3], v[72:75]
    ds_read_b64_tr_b16 a[126:127], v9 offset:9216
    s_add_u32 s50, s50, 2048
    s_waitcnt lgkmcnt(8)
    v_mfma_f32_16x16x32_bf16 v[80:83], a[136:139], a[0:3], v[80:83]
    ds_read_b64_tr_b16 a[128:129], v10 offset:8192
    v_mfma_f32_16x16x32_bf16 v[84:87], a[136:139], a[4:7], v[84:87]
    ds_read_b64_tr_b16 a[130:131], v10 offset:9216
    v_mfma_f32_16x16x32_bf16 v[92:95], a[140:143], a[4:7], v[92:95]
    ds_read_b64_tr_b16 a[132:133], v11 offset:8192
    buffer_load_dwordx4 v5, s[28:31], s49 offen offset:1024 lds
    v_mfma_f32_16x16x32_bf16 v[88:91], a[140:143], a[0:3], v[88:91]
    ds_read_b64_tr_b16 a[134:135], v11 offset:9216
    s_add_u32 s49, s49, 65536
    s_waitcnt vmcnt(20) lgkmcnt(8)
    v_mfma_f32_16x16x32_bf16 v[32:35], a[112:115], a[8:11], v[32:35]
    ds_read_b64_tr_b16 a[136:137], v12 offset:8192
    v_mfma_f32_16x16x32_bf16 v[36:39], a[112:115], a[12:15], v[36:39]
    ds_read_b64_tr_b16 a[138:139], v12 offset:9216
    v_mfma_f32_16x16x32_bf16 v[44:47], a[116:119], a[12:15], v[44:47]
    ds_read_b64_tr_b16 a[140:141], v13 offset:8192
    buffer_load_dwordx4 a[56:59], v3, s[36:39], s50 offen offset:0 sc1
    v_mfma_f32_16x16x32_bf16 v[40:43], a[116:119], a[8:11], v[40:43]
    ds_read_b64_tr_b16 a[142:143], v13 offset:9216
    s_waitcnt vmcnt(33)
    s_barrier
    s_waitcnt lgkmcnt(8)
    v_mfma_f32_16x16x32_bf16 v[48:51], a[120:123], a[8:11], v[48:51]
    ds_read_b64_tr_b16 a[112:113], v6 offset:16384
    v_mfma_f32_16x16x32_bf16 v[52:55], a[120:123], a[12:15], v[52:55]
    ds_read_b64_tr_b16 a[114:115], v6 offset:17408
    s_add_u32 m0, s48, 98304
    v_mfma_f32_16x16x32_bf16 v[60:63], a[124:127], a[12:15], v[60:63]
    ds_read_b64_tr_b16 a[116:117], v7 offset:16384
    buffer_load_dwordx4 v4, s[28:31], s49 offen lds
    v_mfma_f32_16x16x32_bf16 v[56:59], a[124:127], a[8:11], v[56:59]
    ds_read_b64_tr_b16 a[118:119], v7 offset:17408
    s_waitcnt lgkmcnt(8)
    v_mfma_f32_16x16x32_bf16 v[64:67], a[128:131], a[8:11], v[64:67]
    ds_read_b64_tr_b16 a[120:121], v8 offset:16384
    v_mfma_f32_16x16x32_bf16 v[68:71], a[128:131], a[12:15], v[68:71]
    ds_read_b64_tr_b16 a[122:123], v8 offset:17408
    v_mfma_f32_16x16x32_bf16 v[76:79], a[132:135], a[12:15], v[76:79]
    ds_read_b64_tr_b16 a[124:125], v9 offset:16384
    buffer_load_dwordx4 a[60:63], v3, s[36:39], s50 offen offset:256 sc1
    v_mfma_f32_16x16x32_bf16 v[72:75], a[132:135], a[8:11], v[72:75]
    ds_read_b64_tr_b16 a[126:127], v9 offset:17408
    s_add_u32 s50, s50, 2048
    s_waitcnt lgkmcnt(8)
    v_mfma_f32_16x16x32_bf16 v[80:83], a[136:139], a[8:11], v[80:83]
    ds_read_b64_tr_b16 a[128:129], v10 offset:16384
    v_mfma_f32_16x16x32_bf16 v[84:87], a[136:139], a[12:15], v[84:87]
    ds_read_b64_tr_b16 a[130:131], v10 offset:17408
    v_mfma_f32_16x16x32_bf16 v[92:95], a[140:143], a[12:15], v[92:95]
    ds_read_b64_tr_b16 a[132:133], v11 offset:16384
    buffer_load_dwordx4 v5, s[28:31], s49 offen offset:1024 lds
    v_mfma_f32_16x16x32_bf16 v[88:91], a[140:143], a[8:11], v[88:91]
    ds_read_b64_tr_b16 a[134:135], v11 offset:17408
    s_add_u32 s49, s49, 65536
    s_waitcnt vmcnt(21) lgkmcnt(8)
    v_mfma_f32_16x16x32_bf16 v[32:35], a[112:115], a[16:19], v[32:35]
    ds_read_b64_tr_b16 a[136:137], v12 offset:16384
    v_mfma_f32_16x16x32_bf16 v[36:39], a[112:115], a[20:23], v[36:39]
    ds_read_b64_tr_b16 a[138:139], v12 offset:17408
    v_mfma_f32_16x16x32_bf16 v[44:47], a[116:119], a[20:23], v[44:47]
    ds_read_b64_tr_b16 a[140:141], v13 offset:16384
    buffer_load_dwordx4 a[64:67], v3, s[36:39], s50 offen offset:0 sc1
    v_mfma_f32_16x16x32_bf16 v[40:43], a[116:119], a[16:19], v[40:43]
    ds_read_b64_tr_b16 a[142:143], v13 offset:17408
    s_waitcnt lgkmcnt(8)
    v_mfma_f32_16x16x32_bf16 v[48:51], a[120:123], a[16:19], v[48:51]
    ds_read_b64_tr_b16 a[112:113], v6 offset:24576
    v_mfma_f32_16x16x32_bf16 v[52:55], a[120:123], a[20:23], v[52:55]
    ds_read_b64_tr_b16 a[114:115], v6 offset:25600
    s_add_u32 m0, s48, 106496
    v_mfma_f32_16x16x32_bf16 v[60:63], a[124:127], a[20:23], v[60:63]
    ds_read_b64_tr_b16 a[116:117], v7 offset:24576
    buffer_load_dwordx4 v4, s[28:31], s49 offen lds
    v_mfma_f32_16x16x32_bf16 v[56:59], a[124:127], a[16:19], v[56:59]
    ds_read_b64_tr_b16 a[118:119], v7 offset:25600
    s_waitcnt lgkmcnt(8)
    v_mfma_f32_16x16x32_bf16 v[64:67], a[128:131], a[16:19], v[64:67]
    ds_read_b64_tr_b16 a[120:121], v8 offset:24576
    v_mfma_f32_16x16x32_bf16 v[68:71], a[128:131], a[20:23], v[68:71]
    ds_read_b64_tr_b16 a[122:123], v8 offset:25600
    v_mfma_f32_16x16x32_bf16 v[76:79], a[132:135], a[20:23], v[76:79]
    ds_read_b64_tr_b16 a[124:125], v9 offset:24576
    buffer_load_dwordx4 a[68:71], v3, s[36:39], s50 offen offset:256 sc1
    v_mfma_f32_16x16x32_bf16 v[72:75], a[132:135], a[16:19], v[72:75]
    ds_read_b64_tr_b16 a[126:127], v9 offset:25600
    s_add_u32 s50, s50, 2048
    s_waitcnt lgkmcnt(8)
    v_mfma_f32_16x16x32_bf16 v[80:83], a[136:139], a[16:19], v[80:83]
    ds_read_b64_tr_b16 a[128:129], v10 offset:24576
    v_mfma_f32_16x16x32_bf16 v[84:87], a[136:139], a[20:23], v[84:87]
    ds_read_b64_tr_b16 a[130:131], v10 offset:25600
    v_mfma_f32_16x16x32_bf16 v[92:95], a[140:143], a[20:23], v[92:95]
    ds_read_b64_tr_b16 a[132:133], v11 offset:24576
    buffer_load_dwordx4 v5, s[28:31], s49 offen offset:1024 lds
    v_mfma_f32_16x16x32_bf16 v[88:91], a[140:143], a[16:19], v[88:91]
    ds_read_b64_tr_b16 a[134:135], v11 offset:25600
    s_add_u32 s49, s49, 65536
    s_waitcnt vmcnt(21) lgkmcnt(8)
    v_mfma_f32_16x16x32_bf16 v[32:35], a[112:115], a[24:27], v[32:35]
    ds_read_b64_tr_b16 a[136:137], v12 offset:24576
    v_mfma_f32_16x16x32_bf16 v[36:39], a[112:115], a[28:31], v[36:39]
    ds_read_b64_tr_b16 a[138:139], v12 offset:25600
    v_mfma_f32_16x16x32_bf16 v[44:47], a[116:119], a[28:31], v[44:47]
    ds_read_b64_tr_b16 a[140:141], v13 offset:24576
    buffer_load_dwordx4 a[72:75], v3, s[36:39], s50 offen offset:0 sc1
    v_mfma_f32_16x16x32_bf16 v[40:43], a[116:119], a[24:27], v[40:43]
    ds_read_b64_tr_b16 a[142:143], v13 offset:25600
    s_waitcnt vmcnt(33)
    s_barrier
    s_waitcnt lgkmcnt(8)
    v_mfma_f32_16x16x32_bf16 v[48:51], a[120:123], a[24:27], v[48:51]
    ds_read_b64_tr_b16 a[112:113], v6 offset:32768
    v_mfma_f32_16x16x32_bf16 v[52:55], a[120:123], a[28:31], v[52:55]
    ds_read_b64_tr_b16 a[114:115], v6 offset:33792
    s_add_u32 m0, s48, 0
    v_mfma_f32_16x16x32_bf16 v[60:63], a[124:127], a[28:31], v[60:63]
    ds_read_b64_tr_b16 a[116:117], v7 offset:32768
    buffer_load_dwordx4 v4, s[28:31], s49 offen lds
    v_mfma_f32_16x16x32_bf16 v[56:59], a[124:127], a[24:27], v[56:59]
    ds_read_b64_tr_b16 a[118:119], v7 offset:33792
    s_waitcnt lgkmcnt(8)
    v_mfma_f32_16x16x32_bf16 v[64:67], a[128:131], a[24:27], v[64:67]
    ds_read_b64_tr_b16 a[120:121], v8 offset:32768
    v_mfma_f32_16x16x32_bf16 v[68:71], a[128:131], a[28:31], v[68:71]
    ds_read_b64_tr_b16 a[122:123], v8 offset:33792
    v_mfma_f32_16x16x32_bf16 v[76:79], a[132:135], a[28:31], v[76:79]
    ds_read_b64_tr_b16 a[124:125], v9 offset:32768
    buffer_load_dwordx4 a[76:79], v3, s[36:39], s50 offen offset:256 sc1
    v_mfma_f32_16x16x32_bf16 v[72:75], a[132:135], a[24:27], v[72:75]
    ds_read_b64_tr_b16 a[126:127], v9 offset:33792
    s_add_u32 s50, s50, 2048
    s_waitcnt lgkmcnt(8)
    v_mfma_f32_16x16x32_bf16 v[80:83], a[136:139], a[24:27], v[80:83]
    ds_read_b64_tr_b16 a[128:129], v10 offset:32768
    v_mfma_f32_16x16x32_bf16 v[84:87], a[136:139], a[28:31], v[84:87]
    ds_read_b64_tr_b16 a[130:131], v10 offset:33792
    v_mfma_f32_16x16x32_bf16 v[92:95], a[140:143], a[28:31], v[92:95]
    ds_read_b64_tr_b16 a[132:133], v11 offset:32768
    buffer_load_dwordx4 v5, s[28:31], s49 offen offset:1024 lds
    v_mfma_f32_16x16x32_bf16 v[88:91], a[140:143], a[24:27], v[88:91]
    ds_read_b64_tr_b16 a[134:135], v11 offset:33792
    s_add_u32 s49, s49, 65536
    s_waitcnt vmcnt(21) lgkmcnt(8)
    v_mfma_f32_16x16x32_bf16 v[32:35], a[112:115], a[32:35], v[32:35]
    ds_read_b64_tr_b16 a[136:137], v12 offset:32768
    v_mfma_f32_16x16x32_bf16 v[36:39], a[112:115], a[36:39], v[36:39]
    ds_read_b64_tr_b16 a[138:139], v12 offset:33792
    v_mfma_f32_16x16x32_bf16 v[44:47], a[116:119], a[36:39], v[44:47]
    ds_read_b64_tr_b16 a[140:141], v13 offset:32768
    buffer_load_dwordx4 a[80:83], v3, s[36:39], s50 offen offset:0 sc1
    v_mfma_f32_16x16x32_bf16 v[40:43], a[116:119], a[32:35], v[40:43]
    ds_read_b64_tr_b16 a[142:143], v13 offset:33792
    s_waitcnt lgkmcnt(8)
    v_mfma_f32_16x16x32_bf16 v[48:51], a[120:123], a[32:35], v[48:51]
    ds_read_b64_tr_b16 a[112:113], v6 offset:40960
    v_mfma_f32_16x16x32_bf16 v[52:55], a[120:123], a[36:39], v[52:55]
    ds_read_b64_tr_b16 a[114:115], v6 offset:41984
    s_add_u32 m0, s48, 8192
    v_mfma_f32_16x16x32_bf16 v[60:63], a[124:127], a[36:39], v[60:63]
    ds_read_b64_tr_b16 a[116:117], v7 offset:40960
    buffer_load_dwordx4 v4, s[28:31], s49 offen lds
    v_mfma_f32_16x16x32_bf16 v[56:59], a[124:127], a[32:35], v[56:59]
    ds_read_b64_tr_b16 a[118:119], v7 offset:41984
    s_waitcnt lgkmcnt(8)
    v_mfma_f32_16x16x32_bf16 v[64:67], a[128:131], a[32:35], v[64:67]
    ds_read_b64_tr_b16 a[120:121], v8 offset:40960
    v_mfma_f32_16x16x32_bf16 v[68:71], a[128:131], a[36:39], v[68:71]
    ds_read_b64_tr_b16 a[122:123], v8 offset:41984
    v_mfma_f32_16x16x32_bf16 v[76:79], a[132:135], a[36:39], v[76:79]
    ds_read_b64_tr_b16 a[124:125], v9 offset:40960
    buffer_load_dwordx4 a[84:87], v3, s[36:39], s50 offen offset:256 sc1
    v_mfma_f32_16x16x32_bf16 v[72:75], a[132:135], a[32:35], v[72:75]
    ds_read_b64_tr_b16 a[126:127], v9 offset:41984
    s_add_u32 s50, s50, 2048
    s_waitcnt lgkmcnt(8)
    v_mfma_f32_16x16x32_bf16 v[80:83], a[136:139], a[32:35], v[80:83]
    ds_read_b64_tr_b16 a[128:129], v10 offset:40960
    v_mfma_f32_16x16x32_bf16 v[84:87], a[136:139], a[36:39], v[84:87]
    ds_read_b64_tr_b16 a[130:131], v10 offset:41984
    v_mfma_f32_16x16x32_bf16 v[92:95], a[140:143], a[36:39], v[92:95]
    ds_read_b64_tr_b16 a[132:133], v11 offset:40960
    buffer_load_dwordx4 v5, s[28:31], s49 offen offset:1024 lds
    v_mfma_f32_16x16x32_bf16 v[88:91], a[140:143], a[32:35], v[88:91]
    ds_read_b64_tr_b16 a[134:135], v11 offset:41984
    s_add_u32 s49, s49, 65536
    s_waitcnt vmcnt(21) lgkmcnt(8)
    v_mfma_f32_16x16x32_bf16 v[32:35], a[112:115], a[40:43], v[32:35]
    ds_read_b64_tr_b16 a[136:137], v12 offset:40960
    v_mfma_f32_16x16x32_bf16 v[36:39], a[112:115], a[44:47], v[36:39]
    ds_read_b64_tr_b16 a[138:139], v12 offset:41984
    v_mfma_f32_16x16x32_bf16 v[44:47], a[116:119], a[44:47], v[44:47]
    ds_read_b64_tr_b16 a[140:141], v13 offset:40960
    buffer_load_dwordx4 a[88:91], v3, s[36:39], s50 offen offset:0 sc1
    v_mfma_f32_16x16x32_bf16 v[40:43], a[116:119], a[40:43], v[40:43]
    ds_read_b64_tr_b16 a[142:143], v13 offset:41984
    s_waitcnt vmcnt(33)
    s_barrier
    s_waitcnt lgkmcnt(8)
    v_mfma_f32_16x16x32_bf16 v[48:51], a[120:123], a[40:43], v[48:51]
    ds_read_b64_tr_b16 a[112:113], v6 offset:49152
    v_mfma_f32_16x16x32_bf16 v[52:55], a[120:123], a[44:47], v[52:55]
    ds_read_b64_tr_b16 a[114:115], v6 offset:50176
    s_add_u32 m0, s48, 16384
    v_mfma_f32_16x16x32_bf16 v[60:63], a[124:127], a[44:47], v[60:63]
    ds_read_b64_tr_b16 a[116:117], v7 offset:49152
    buffer_load_dwordx4 v4, s[28:31], s49 offen lds
    v_mfma_f32_16x16x32_bf16 v[56:59], a[124:127], a[40:43], v[56:59]
    ds_read_b64_tr_b16 a[118:119], v7 offset:50176
    s_waitcnt lgkmcnt(8)
    v_mfma_f32_16x16x32_bf16 v[64:67], a[128:131], a[40:43], v[64:67]
    ds_read_b64_tr_b16 a[120:121], v8 offset:49152
    v_mfma_f32_16x16x32_bf16 v[68:71], a[128:131], a[44:47], v[68:71]
    ds_read_b64_tr_b16 a[122:123], v8 offset:50176
    v_mfma_f32_16x16x32_bf16 v[76:79], a[132:135], a[44:47], v[76:79]
    ds_read_b64_tr_b16 a[124:125], v9 offset:49152
    buffer_load_dwordx4 a[92:95], v3, s[36:39], s50 offen offset:256 sc1
    v_mfma_f32_16x16x32_bf16 v[72:75], a[132:135], a[40:43], v[72:75]
    ds_read_b64_tr_b16 a[126:127], v9 offset:50176
    s_add_u32 s50, s50, 2048
    s_waitcnt lgkmcnt(8)
    v_mfma_f32_16x16x32_bf16 v[80:83], a[136:139], a[40:43], v[80:83]
    ds_read_b64_tr_b16 a[128:129], v10 offset:49152
    v_mfma_f32_16x16x32_bf16 v[84:87], a[136:139], a[44:47], v[84:87]
    ds_read_b64_tr_b16 a[130:131], v10 offset:50176
    v_mfma_f32_16x16x32_bf16 v[92:95], a[140:143], a[44:47], v[92:95]
    ds_read_b64_tr_b16 a[132:133], v11 offset:49152
    buffer_load_dwordx4 v5, s[28:31], s49 offen offset:1024 lds
    v_mfma_f32_16x16x32_bf16 v[88:91], a[140:143], a[40:43], v[88:91]
    ds_read_b64_tr_b16 a[134:135], v11 offset:50176
    s_add_u32 s49, s49, 65536
    s_waitcnt vmcnt(21) lgkmcnt(8)
    v_mfma_f32_16x16x32_bf16 v[32:35], a[112:115], a[48:51], v[32:35]
    ds_read_b64_tr_b16 a[136:137], v12 offset:49152
    v_mfma_f32_16x16x32_bf16 v[36:39], a[112:115], a[52:55], v[36:39]
    ds_read_b64_tr_b16 a[138:139], v12 offset:50176
    v_mfma_f32_16x16x32_bf16 v[44:47], a[116:119], a[52:55], v[44:47]
    ds_read_b64_tr_b16 a[140:141], v13 offset:49152
    buffer_load_dwordx4 a[96:99], v3, s[36:39], s50 offen offset:0 sc1
    v_mfma_f32_16x16x32_bf16 v[40:43], a[116:119], a[48:51], v[40:43]
    ds_read_b64_tr_b16 a[142:143], v13 offset:50176
    s_waitcnt lgkmcnt(8)
    v_mfma_f32_16x16x32_bf16 v[48:51], a[120:123], a[48:51], v[48:51]
    ds_read_b64_tr_b16 a[112:113], v6 offset:57344
    v_mfma_f32_16x16x32_bf16 v[52:55], a[120:123], a[52:55], v[52:55]
    ds_read_b64_tr_b16 a[114:115], v6 offset:58368
    s_add_u32 m0, s48, 24576
    v_mfma_f32_16x16x32_bf16 v[60:63], a[124:127], a[52:55], v[60:63]
    ds_read_b64_tr_b16 a[116:117], v7 offset:57344
    buffer_load_dwordx4 v4, s[28:31], s49 offen lds
    v_mfma_f32_16x16x32_bf16 v[56:59], a[124:127], a[48:51], v[56:59]
    ds_read_b64_tr_b16 a[118:119], v7 offset:58368
    s_waitcnt lgkmcnt(8)
    v_mfma_f32_16x16x32_bf16 v[64:67], a[128:131], a[48:51], v[64:67]
    ds_read_b64_tr_b16 a[120:121], v8 offset:57344
    v_mfma_f32_16x16x32_bf16 v[68:71], a[128:131], a[52:55], v[68:71]
    ds_read_b64_tr_b16 a[122:123], v8 offset:58368
    v_mfma_f32_16x16x32_bf16 v[76:79], a[132:135], a[52:55], v[76:79]
    ds_read_b64_tr_b16 a[124:125], v9 offset:57344
    buffer_load_dwordx4 a[100:103], v3, s[36:39], s50 offen offset:256 sc1
    v_mfma_f32_16x16x32_bf16 v[72:75], a[132:135], a[48:51], v[72:75]
    ds_read_b64_tr_b16 a[126:127], v9 offset:58368
    s_add_u32 s50, s50, 2048
    s_waitcnt lgkmcnt(8)
    v_mfma_f32_16x16x32_bf16 v[80:83], a[136:139], a[48:51], v[80:83]
    ds_read_b64_tr_b16 a[128:129], v10 offset:57344
    v_mfma_f32_16x16x32_bf16 v[84:87], a[136:139], a[52:55], v[84:87]
    ds_read_b64_tr_b16 a[130:131], v10 offset:58368
    v_mfma_f32_16x16x32_bf16 v[92:95], a[140:143], a[52:55], v[92:95]
    ds_read_b64_tr_b16 a[132:133], v11 offset:57344
    buffer_load_dwordx4 v5, s[28:31], s49 offen offset:1024 lds
    v_mfma_f32_16x16x32_bf16 v[88:91], a[140:143], a[48:51], v[88:91]
    ds_read_b64_tr_b16 a[134:135], v11 offset:58368
    s_add_u32 s49, s49, 65536
    s_waitcnt vmcnt(21) lgkmcnt(8)
    v_mfma_f32_16x16x32_bf16 v[32:35], a[112:115], a[56:59], v[32:35]
    ds_read_b64_tr_b16 a[136:137], v12 offset:57344
    v_mfma_f32_16x16x32_bf16 v[36:39], a[112:115], a[60:63], v[36:39]
    ds_read_b64_tr_b16 a[138:139], v12 offset:58368
    v_mfma_f32_16x16x32_bf16 v[44:47], a[116:119], a[60:63], v[44:47]
    ds_read_b64_tr_b16 a[140:141], v13 offset:57344
    buffer_load_dwordx4 a[104:107], v3, s[36:39], s50 offen offset:0 sc1
    v_mfma_f32_16x16x32_bf16 v[40:43], a[116:119], a[56:59], v[40:43]
    ds_read_b64_tr_b16 a[142:143], v13 offset:58368
    s_waitcnt vmcnt(33)
    s_barrier
    s_waitcnt lgkmcnt(8)
    v_mfma_f32_16x16x32_bf16 v[48:51], a[120:123], a[56:59], v[48:51]
    ds_read_b64_tr_b16 a[112:113], v160 offset:0
    v_mfma_f32_16x16x32_bf16 v[52:55], a[120:123], a[60:63], v[52:55]
    ds_read_b64_tr_b16 a[114:115], v160 offset:1024
    s_add_u32 m0, s48, 32768
    v_mfma_f32_16x16x32_bf16 v[60:63], a[124:127], a[60:63], v[60:63]
    ds_read_b64_tr_b16 a[116:117], v161 offset:0
    buffer_load_dwordx4 v4, s[28:31], s49 offen lds
    v_mfma_f32_16x16x32_bf16 v[56:59], a[124:127], a[56:59], v[56:59]
    ds_read_b64_tr_b16 a[118:119], v161 offset:1024
    s_waitcnt lgkmcnt(8)
    v_mfma_f32_16x16x32_bf16 v[64:67], a[128:131], a[56:59], v[64:67]
    ds_read_b64_tr_b16 a[120:121], v162 offset:0
    v_mfma_f32_16x16x32_bf16 v[68:71], a[128:131], a[60:63], v[68:71]
    ds_read_b64_tr_b16 a[122:123], v162 offset:1024
    v_mfma_f32_16x16x32_bf16 v[76:79], a[132:135], a[60:63], v[76:79]
    ds_read_b64_tr_b16 a[124:125], v163 offset:0
    buffer_load_dwordx4 a[108:111], v3, s[36:39], s50 offen offset:256 sc1
    v_mfma_f32_16x16x32_bf16 v[72:75], a[132:135], a[56:59], v[72:75]
    ds_read_b64_tr_b16 a[126:127], v163 offset:1024
    s_add_u32 s50, s50, 2048
    s_waitcnt lgkmcnt(8)
    v_mfma_f32_16x16x32_bf16 v[80:83], a[136:139], a[56:59], v[80:83]
    ds_read_b64_tr_b16 a[128:129], v164 offset:0
    v_mfma_f32_16x16x32_bf16 v[84:87], a[136:139], a[60:63], v[84:87]
    ds_read_b64_tr_b16 a[130:131], v164 offset:1024
    v_mfma_f32_16x16x32_bf16 v[92:95], a[140:143], a[60:63], v[92:95]
    ds_read_b64_tr_b16 a[132:133], v165 offset:0
    buffer_load_dwordx4 v5, s[28:31], s49 offen offset:1024 lds
    v_mfma_f32_16x16x32_bf16 v[88:91], a[140:143], a[56:59], v[88:91]
    ds_read_b64_tr_b16 a[134:135], v165 offset:1024
    s_add_u32 s49, s49, 65536
    s_waitcnt vmcnt(21) lgkmcnt(8)
    v_mfma_f32_16x16x32_bf16 v[32:35], a[112:115], a[64:67], v[32:35]
    ds_read_b64_tr_b16 a[136:137], v166 offset:0
    v_mfma_f32_16x16x32_bf16 v[36:39], a[112:115], a[68:71], v[36:39]
    ds_read_b64_tr_b16 a[138:139], v166 offset:1024
    v_mfma_f32_16x16x32_bf16 v[44:47], a[116:119], a[68:71], v[44:47]
    ds_read_b64_tr_b16 a[140:141], v167 offset:0
    buffer_load_dwordx4 a[0:3], v3, s[36:39], s50 offen offset:0 sc1
    v_mfma_f32_16x16x32_bf16 v[40:43], a[116:119], a[64:67], v[40:43]
    ds_read_b64_tr_b16 a[142:143], v167 offset:1024
    s_waitcnt lgkmcnt(8)
    v_mfma_f32_16x16x32_bf16 v[48:51], a[120:123], a[64:67], v[48:51]
    ds_read_b64_tr_b16 a[112:113], v160 offset:8192
    v_mfma_f32_16x16x32_bf16 v[52:55], a[120:123], a[68:71], v[52:55]
    ds_read_b64_tr_b16 a[114:115], v160 offset:9216
    s_add_u32 m0, s48, 40960
    v_mfma_f32_16x16x32_bf16 v[60:63], a[124:127], a[68:71], v[60:63]
    ds_read_b64_tr_b16 a[116:117], v161 offset:8192
    buffer_load_dwordx4 v4, s[28:31], s49 offen lds
    v_mfma_f32_16x16x32_bf16 v[56:59], a[124:127], a[64:67], v[56:59]
    ds_read_b64_tr_b16 a[118:119], v161 offset:9216
    s_waitcnt lgkmcnt(8)
    v_mfma_f32_16x16x32_bf16 v[64:67], a[128:131], a[64:67], v[64:67]
    ds_read_b64_tr_b16 a[120:121], v162 offset:8192
    v_mfma_f32_16x16x32_bf16 v[68:71], a[128:131], a[68:71], v[68:71]
    ds_read_b64_tr_b16 a[122:123], v162 offset:9216
    v_mfma_f32_16x16x32_bf16 v[76:79], a[132:135], a[68:71], v[76:79]
    ds_read_b64_tr_b16 a[124:125], v163 offset:8192
    buffer_load_dwordx4 a[4:7], v3, s[36:39], s50 offen offset:256 sc1
    v_mfma_f32_16x16x32_bf16 v[72:75], a[132:135], a[64:67], v[72:75]
    ds_read_b64_tr_b16 a[126:127], v163 offset:9216
    s_add_u32 s50, s50, 2048
    s_waitcnt lgkmcnt(8)
    v_mfma_f32_16x16x32_bf16 v[80:83], a[136:139], a[64:67], v[80:83]
    ds_read_b64_tr_b16 a[128:129], v164 offset:8192
    v_mfma_f32_16x16x32_bf16 v[84:87], a[136:139], a[68:71], v[84:87]
    ds_read_b64_tr_b16 a[130:131], v164 offset:9216
    v_mfma_f32_16x16x32_bf16 v[92:95], a[140:143], a[68:71], v[92:95]
    ds_read_b64_tr_b16 a[132:133], v165 offset:8192
    buffer_load_dwordx4 v5, s[28:31], s49 offen offset:1024 lds
    v_mfma_f32_16x16x32_bf16 v[88:91], a[140:143], a[64:67], v[88:91]
    ds_read_b64_tr_b16 a[134:135], v165 offset:9216
    s_add_u32 s49, s49, 65536
    s_waitcnt vmcnt(21) lgkmcnt(8)
    v_mfma_f32_16x16x32_bf16 v[32:35], a[112:115], a[72:75], v[32:35]
    ds_read_b64_tr_b16 a[136:137], v166 offset:8192
    v_mfma_f32_16x16x32_bf16 v[36:39], a[112:115], a[76:79], v[36:39]
    ds_read_b64_tr_b16 a[138:139], v166 offset:9216
    v_mfma_f32_16x16x32_bf16 v[44:47], a[116:119], a[76:79], v[44:47]
    ds_read_b64_tr_b16 a[140:141], v167 offset:8192
    buffer_load_dwordx4 a[8:11], v3, s[36:39], s50 offen offset:0 sc1
    v_mfma_f32_16x16x32_bf16 v[40:43], a[116:119], a[72:75], v[40:43]
    ds_read_b64_tr_b16 a[142:143], v167 offset:9216
    s_waitcnt vmcnt(33)
    s_barrier
    s_waitcnt lgkmcnt(8)
    v_mfma_f32_16x16x32_bf16 v[48:51], a[120:123], a[72:75], v[48:51]
    ds_read_b64_tr_b16 a[112:113], v160 offset:16384
    v_mfma_f32_16x16x32_bf16 v[52:55], a[120:123], a[76:79], v[52:55]
    ds_read_b64_tr_b16 a[114:115], v160 offset:17408
    s_add_u32 m0, s48, 49152
    v_mfma_f32_16x16x32_bf16 v[60:63], a[124:127], a[76:79], v[60:63]
    ds_read_b64_tr_b16 a[116:117], v161 offset:16384
    buffer_load_dwordx4 v4, s[28:31], s49 offen lds
    v_mfma_f32_16x16x32_bf16 v[56:59], a[124:127], a[72:75], v[56:59]
    ds_read_b64_tr_b16 a[118:119], v161 offset:17408
    s_waitcnt lgkmcnt(8)
    v_mfma_f32_16x16x32_bf16 v[64:67], a[128:131], a[72:75], v[64:67]
    ds_read_b64_tr_b16 a[120:121], v162 offset:16384
    v_mfma_f32_16x16x32_bf16 v[68:71], a[128:131], a[76:79], v[68:71]
    ds_read_b64_tr_b16 a[122:123], v162 offset:17408
    v_mfma_f32_16x16x32_bf16 v[76:79], a[132:135], a[76:79], v[76:79]
    ds_read_b64_tr_b16 a[124:125], v163 offset:16384
    buffer_load_dwordx4 a[12:15], v3, s[36:39], s50 offen offset:256 sc1
    v_mfma_f32_16x16x32_bf16 v[72:75], a[132:135], a[72:75], v[72:75]
    ds_read_b64_tr_b16 a[126:127], v163 offset:17408
    s_add_u32 s50, s50, 2048
    s_waitcnt lgkmcnt(8)
    v_mfma_f32_16x16x32_bf16 v[80:83], a[136:139], a[72:75], v[80:83]
    ds_read_b64_tr_b16 a[128:129], v164 offset:16384
    v_mfma_f32_16x16x32_bf16 v[84:87], a[136:139], a[76:79], v[84:87]
    ds_read_b64_tr_b16 a[130:131], v164 offset:17408
    v_mfma_f32_16x16x32_bf16 v[92:95], a[140:143], a[76:79], v[92:95]
    ds_read_b64_tr_b16 a[132:133], v165 offset:16384
    buffer_load_dwordx4 v5, s[28:31], s49 offen offset:1024 lds
    v_mfma_f32_16x16x32_bf16 v[88:91], a[140:143], a[72:75], v[88:91]
    ds_read_b64_tr_b16 a[134:135], v165 offset:17408
    s_add_u32 s49, s49, 65536
    s_waitcnt vmcnt(21) lgkmcnt(8)
    v_mfma_f32_16x16x32_bf16 v[32:35], a[112:115], a[80:83], v[32:35]
    ds_read_b64_tr_b16 a[136:137], v166 offset:16384
    v_mfma_f32_16x16x32_bf16 v[36:39], a[112:115], a[84:87], v[36:39]
    ds_read_b64_tr_b16 a[138:139], v166 offset:17408
    v_mfma_f32_16x16x32_bf16 v[44:47], a[116:119], a[84:87], v[44:47]
    ds_read_b64_tr_b16 a[140:141], v167 offset:16384
    buffer_load_dwordx4 a[16:19], v3, s[36:39], s50 offen offset:0 sc1
    v_mfma_f32_16x16x32_bf16 v[40:43], a[116:119], a[80:83], v[40:43]
    ds_read_b64_tr_b16 a[142:143], v167 offset:17408
    s_waitcnt lgkmcnt(8)
    v_mfma_f32_16x16x32_bf16 v[48:51], a[120:123], a[80:83], v[48:51]
    ds_read_b64_tr_b16 a[112:113], v160 offset:24576
    v_mfma_f32_16x16x32_bf16 v[52:55], a[120:123], a[84:87], v[52:55]
    ds_read_b64_tr_b16 a[114:115], v160 offset:25600
    s_add_u32 m0, s48, 57344
    v_mfma_f32_16x16x32_bf16 v[60:63], a[124:127], a[84:87], v[60:63]
    ds_read_b64_tr_b16 a[116:117], v161 offset:24576
    buffer_load_dwordx4 v4, s[28:31], s49 offen lds
    v_mfma_f32_16x16x32_bf16 v[56:59], a[124:127], a[80:83], v[56:59]
    ds_read_b64_tr_b16 a[118:119], v161 offset:25600
    s_waitcnt lgkmcnt(8)
    v_mfma_f32_16x16x32_bf16 v[64:67], a[128:131], a[80:83], v[64:67]
    ds_read_b64_tr_b16 a[120:121], v162 offset:24576
    v_mfma_f32_16x16x32_bf16 v[68:71], a[128:131], a[84:87], v[68:71]
    ds_read_b64_tr_b16 a[122:123], v162 offset:25600
    v_mfma_f32_16x16x32_bf16 v[76:79], a[132:135], a[84:87], v[76:79]
    ds_read_b64_tr_b16 a[124:125], v163 offset:24576
    buffer_load_dwordx4 a[20:23], v3, s[36:39], s50 offen offset:256 sc1
    v_mfma_f32_16x16x32_bf16 v[72:75], a[132:135], a[80:83], v[72:75]
    ds_read_b64_tr_b16 a[126:127], v163 offset:25600
    s_add_u32 s50, s50, 2048
    s_waitcnt lgkmcnt(8)
    v_mfma_f32_16x16x32_bf16 v[80:83], a[136:139], a[80:83], v[80:83]
    ds_read_b64_tr_b16 a[128:129], v164 offset:24576
    v_mfma_f32_16x16x32_bf16 v[84:87], a[136:139], a[84:87], v[84:87]
    ds_read_b64_tr_b16 a[130:131], v164 offset:25600
    v_mfma_f32_16x16x32_bf16 v[92:95], a[140:143], a[84:87], v[92:95]
    ds_read_b64_tr_b16 a[132:133], v165 offset:24576
    buffer_load_dwordx4 v5, s[28:31], s49 offen offset:1024 lds
    v_mfma_f32_16x16x32_bf16 v[88:91], a[140:143], a[80:83], v[88:91]
    ds_read_b64_tr_b16 a[134:135], v165 offset:25600
    s_add_u32 s49, s49, 65536
    s_waitcnt vmcnt(21) lgkmcnt(8)
    v_mfma_f32_16x16x32_bf16 v[32:35], a[112:115], a[88:91], v[32:35]
    ds_read_b64_tr_b16 a[136:137], v166 offset:24576
    v_mfma_f32_16x16x32_bf16 v[36:39], a[112:115], a[92:95], v[36:39]
    ds_read_b64_tr_b16 a[138:139], v166 offset:25600
    v_mfma_f32_16x16x32_bf16 v[44:47], a[116:119], a[92:95], v[44:47]
    ds_read_b64_tr_b16 a[140:141], v167 offset:24576
    buffer_load_dwordx4 a[24:27], v3, s[36:39], s50 offen offset:0 sc1
    v_mfma_f32_16x16x32_bf16 v[40:43], a[116:119], a[88:91], v[40:43]
    ds_read_b64_tr_b16 a[142:143], v167 offset:25600
    s_waitcnt vmcnt(33)
    s_barrier
    s_waitcnt lgkmcnt(8)
    v_mfma_f32_16x16x32_bf16 v[48:51], a[120:123], a[88:91], v[48:51]
    ds_read_b64_tr_b16 a[112:113], v160 offset:32768
    v_mfma_f32_16x16x32_bf16 v[52:55], a[120:123], a[92:95], v[52:55]
    ds_read_b64_tr_b16 a[114:115], v160 offset:33792
    s_add_u32 m0, s48, 65536
    v_mfma_f32_16x16x32_bf16 v[60:63], a[124:127], a[92:95], v[60:63]
    ds_read_b64_tr_b16 a[116:117], v161 offset:32768
    buffer_load_dwordx4 v4, s[28:31], s49 offen lds
    v_mfma_f32_16x16x32_bf16 v[56:59], a[124:127], a[88:91], v[56:59]
    ds_read_b64_tr_b16 a[118:119], v161 offset:33792
    s_waitcnt lgkmcnt(8)
    v_mfma_f32_16x16x32_bf16 v[64:67], a[128:131], a[88:91], v[64:67]
    ds_read_b64_tr_b16 a[120:121], v162 offset:32768
    v_mfma_f32_16x16x32_bf16 v[68:71], a[128:131], a[92:95], v[68:71]
    ds_read_b64_tr_b16 a[122:123], v162 offset:33792
    v_mfma_f32_16x16x32_bf16 v[76:79], a[132:135], a[92:95], v[76:79]
    ds_read_b64_tr_b16 a[124:125], v163 offset:32768
    buffer_load_dwordx4 a[28:31], v3, s[36:39], s50 offen offset:256 sc1
    v_mfma_f32_16x16x32_bf16 v[72:75], a[132:135], a[88:91], v[72:75]
    ds_read_b64_tr_b16 a[126:127], v163 offset:33792
    s_add_u32 s50, s50, 2048
    s_waitcnt lgkmcnt(8)
    v_mfma_f32_16x16x32_bf16 v[80:83], a[136:139], a[88:91], v[80:83]
    ds_read_b64_tr_b16 a[128:129], v164 offset:32768
    v_mfma_f32_16x16x32_bf16 v[84:87], a[136:139], a[92:95], v[84:87]
    ds_read_b64_tr_b16 a[130:131], v164 offset:33792
    v_mfma_f32_16x16x32_bf16 v[92:95], a[140:143], a[92:95], v[92:95]
    ds_read_b64_tr_b16 a[132:133], v165 offset:32768
    buffer_load_dwordx4 v5, s[28:31], s49 offen offset:1024 lds
    v_mfma_f32_16x16x32_bf16 v[88:91], a[140:143], a[88:91], v[88:91]
    ds_read_b64_tr_b16 a[134:135], v165 offset:33792
    s_add_u32 s49, s49, 65536
    s_waitcnt vmcnt(21) lgkmcnt(8)
    v_mfma_f32_16x16x32_bf16 v[32:35], a[112:115], a[96:99], v[32:35]
    ds_read_b64_tr_b16 a[136:137], v166 offset:32768
    v_mfma_f32_16x16x32_bf16 v[36:39], a[112:115], a[100:103], v[36:39]
    ds_read_b64_tr_b16 a[138:139], v166 offset:33792
    v_mfma_f32_16x16x32_bf16 v[44:47], a[116:119], a[100:103], v[44:47]
    ds_read_b64_tr_b16 a[140:141], v167 offset:32768
    buffer_load_dwordx4 a[32:35], v3, s[36:39], s50 offen offset:0 sc1
    v_mfma_f32_16x16x32_bf16 v[40:43], a[116:119], a[96:99], v[40:43]
    ds_read_b64_tr_b16 a[142:143], v167 offset:33792
    s_waitcnt lgkmcnt(8)
    v_mfma_f32_16x16x32_bf16 v[48:51], a[120:123], a[96:99], v[48:51]
    ds_read_b64_tr_b16 a[112:113], v160 offset:40960
    v_mfma_f32_16x16x32_bf16 v[52:55], a[120:123], a[100:103], v[52:55]
    ds_read_b64_tr_b16 a[114:115], v160 offset:41984
    s_add_u32 m0, s48, 73728
    v_mfma_f32_16x16x32_bf16 v[60:63], a[124:127], a[100:103], v[60:63]
    ds_read_b64_tr_b16 a[116:117], v161 offset:40960
    buffer_load_dwordx4 v4, s[28:31], s49 offen lds
    v_mfma_f32_16x16x32_bf16 v[56:59], a[124:127], a[96:99], v[56:59]
    ds_read_b64_tr_b16 a[118:119], v161 offset:41984
    s_waitcnt lgkmcnt(8)
    v_mfma_f32_16x16x32_bf16 v[64:67], a[128:131], a[96:99], v[64:67]
    ds_read_b64_tr_b16 a[120:121], v162 offset:40960
    v_mfma_f32_16x16x32_bf16 v[68:71], a[128:131], a[100:103], v[68:71]
    ds_read_b64_tr_b16 a[122:123], v162 offset:41984
    v_mfma_f32_16x16x32_bf16 v[76:79], a[132:135], a[100:103], v[76:79]
    ds_read_b64_tr_b16 a[124:125], v163 offset:40960
    buffer_load_dwordx4 a[36:39], v3, s[36:39], s50 offen offset:256 sc1
    v_mfma_f32_16x16x32_bf16 v[72:75], a[132:135], a[96:99], v[72:75]
    ds_read_b64_tr_b16 a[126:127], v163 offset:41984
    s_add_u32 s50, s50, 2048
    s_waitcnt lgkmcnt(8)
    v_mfma_f32_16x16x32_bf16 v[80:83], a[136:139], a[96:99], v[80:83]
    ds_read_b64_tr_b16 a[128:129], v164 offset:40960
    v_mfma_f32_16x16x32_bf16 v[84:87], a[136:139], a[100:103], v[84:87]
    ds_read_b64_tr_b16 a[130:131], v164 offset:41984
    v_mfma_f32_16x16x32_bf16 v[92:95], a[140:143], a[100:103], v[92:95]
    ds_read_b64_tr_b16 a[132:133], v165 offset:40960
    buffer_load_dwordx4 v5, s[28:31], s49 offen offset:1024 lds
    v_mfma_f32_16x16x32_bf16 v[88:91], a[140:143], a[96:99], v[88:91]
    ds_read_b64_tr_b16 a[134:135], v165 offset:41984
    s_add_u32 s49, s49, 65536
    s_waitcnt vmcnt(21) lgkmcnt(8)
    v_mfma_f32_16x16x32_bf16 v[32:35], a[112:115], a[104:107], v[32:35]
    ds_read_b64_tr_b16 a[136:137], v166 offset:40960
    v_mfma_f32_16x16x32_bf16 v[36:39], a[112:115], a[108:111], v[36:39]
    ds_read_b64_tr_b16 a[138:139], v166 offset:41984
    v_mfma_f32_16x16x32_bf16 v[44:47], a[116:119], a[108:111], v[44:47]
    ds_read_b64_tr_b16 a[140:141], v167 offset:40960
    buffer_load_dwordx4 a[40:43], v3, s[36:39], s50 offen offset:0 sc1
    v_mfma_f32_16x16x32_bf16 v[40:43], a[116:119], a[104:107], v[40:43]
    ds_read_b64_tr_b16 a[142:143], v167 offset:41984
    s_waitcnt vmcnt(33)
    s_barrier
    s_waitcnt lgkmcnt(8)
    v_mfma_f32_16x16x32_bf16 v[48:51], a[120:123], a[104:107], v[48:51]
    ds_read_b64_tr_b16 a[112:113], v6 offset:0
    v_mfma_f32_16x16x32_bf16 v[52:55], a[120:123], a[108:111], v[52:55]
    ds_read_b64_tr_b16 a[114:115], v6 offset:1024
    s_add_u32 m0, s48, 81920
    v_mfma_f32_16x16x32_bf16 v[60:63], a[124:127], a[108:111], v[60:63]
    ds_read_b64_tr_b16 a[116:117], v7 offset:0
    buffer_load_dwordx4 v4, s[28:31], s49 offen lds
    v_mfma_f32_16x16x32_bf16 v[56:59], a[124:127], a[104:107], v[56:59]
    ds_read_b64_tr_b16 a[118:119], v7 offset:1024
    s_waitcnt lgkmcnt(8)
    v_mfma_f32_16x16x32_bf16 v[64:67], a[128:131], a[104:107], v[64:67]
    ds_read_b64_tr_b16 a[120:121], v8 offset:0
    v_mfma_f32_16x16x32_bf16 v[68:71], a[128:131], a[108:111], v[68:71]
    ds_read_b64_tr_b16 a[122:123], v8 offset:1024
    v_mfma_f32_16x16x32_bf16 v[76:79], a[132:135], a[108:111], v[76:79]
    ds_read_b64_tr_b16 a[124:125], v9 offset:0
    buffer_load_dwordx4 a[44:47], v3, s[36:39], s50 offen offset:256 sc1
    v_mfma_f32_16x16x32_bf16 v[72:75], a[132:135], a[104:107], v[72:75]
    ds_read_b64_tr_b16 a[126:127], v9 offset:1024
    s_add_u32 s50, s50, 2048
    s_waitcnt lgkmcnt(8)
    v_mfma_f32_16x16x32_bf16 v[80:83], a[136:139], a[104:107], v[80:83]
    ds_read_b64_tr_b16 a[128:129], v10 offset:0
    v_mfma_f32_16x16x32_bf16 v[84:87], a[136:139], a[108:111], v[84:87]
    ds_read_b64_tr_b16 a[130:131], v10 offset:1024
    v_mfma_f32_16x16x32_bf16 v[92:95], a[140:143], a[108:111], v[92:95]
    ds_read_b64_tr_b16 a[132:133], v11 offset:0
    buffer_load_dwordx4 v5, s[28:31], s49 offen offset:1024 lds
    v_mfma_f32_16x16x32_bf16 v[88:91], a[140:143], a[104:107], v[88:91]
    ds_read_b64_tr_b16 a[134:135], v11 offset:1024
    s_add_u32 s49, s49, 65536
    s_sub_u32 s51, s51, 1
    s_cmp_lg_u32 s51, 0
    s_cbranch_scc1 P5_loop
C_p5t:
    s_waitcnt vmcnt(21) lgkmcnt(8)
    v_mfma_f32_16x16x32_bf16 v[32:35], a[112:115], a[0:3], v[32:35]
    ds_read_b64_tr_b16 a[136:137], v12 offset:0
    v_mfma_f32_16x16x32_bf16 v[36:39], a[112:115], a[4:7], v[36:39]
    ds_read_b64_tr_b16 a[138:139], v12 offset:1024
    v_mfma_f32_16x16x32_bf16 v[44:47], a[116:119], a[4:7], v[44:47]
    ds_read_b64_tr_b16 a[140:141], v13 offset:0
    buffer_load_dwordx4 a[48:51], v3, s[36:39], s50 offen offset:0 sc1
    v_mfma_f32_16x16x32_bf16 v[40:43], a[116:119], a[0:3], v[40:43]
    ds_read_b64_tr_b16 a[142:143], v13 offset:1024
    s_waitcnt lgkmcnt(8)
    v_mfma_f32_16x16x32_bf16 v[48:51], a[120:123], a[0:3], v[48:51]
    ds_read_b64_tr_b16 a[112:113], v6 offset:8192
    v_mfma_f32_16x16x32_bf16 v[52:55], a[120:123], a[4:7], v[52:55]
    ds_read_b64_tr_b16 a[114:115], v6 offset:9216
    s_add_u32 m0, s48, 90112
    v_mfma_f32_16x16x32_bf16 v[60:63], a[124:127], a[4:7], v[60:63]
    ds_read_b64_tr_b16 a[116:117], v7 offset:8192
    buffer_load_dwordx4 v4, s[28:31], s49 offen lds
    v_mfma_f32_16x16x32_bf16 v[56:59], a[124:127], a[0:3], v[56:59]
    ds_read_b64_tr_b16 a[118:119], v7 offset:9216
    s_waitcnt lgkmcnt(8)
    v_mfma_f32_16x16x32_bf16 v[64:67], a[128:131], a[0:3], v[64:67]
    ds_read_b64_tr_b16 a[120:121], v8 offset:8192
    v_mfma_f32_16x16x32_bf16 v[68:71], a[128:131], a[4:7], v[68:71]
    ds_read_b64_tr_b16 a[122:123], v8 offset:9216
    v_mfma_f32_16x16x32_bf16 v[76:79], a[132:135], a[4:7], v[76:79]
    ds_read_b64_tr_b16 a[124:125], v9 offset:8192
    buffer_load_dwordx4 a[52:55], v3, s[36:39], s50 offen offset:256 sc1
    v_mfma_f32_16x16x32_bf16 v[72:75], a[132:135], a[0:3], v[72:75]
    ds_read_b64_tr_b16 a[126:127], v9 offset:9216
    s_add_u32 s50, s50, 2048
    s_waitcnt lgkmcnt(8)
    v_mfma_f32_16x16x32_bf16 v[80:83], a[136:139], a[0:3], v[80:83]
    ds_read_b64_tr_b16 a[128:129], v10 offset:8192
    v_mfma_f32_16x16x32_bf16 v[84:87], a[136:139], a[4:7], v[84:87]
    ds_read_b64_tr_b16 a[130:131], v10 offset:9216
    v_mfma_f32_16x16x32_bf16 v[92:95], a[140:143], a[4:7], v[92:95]
    ds_read_b64_tr_b16 a[132:133], v11 offset:8192
    buffer_load_dwordx4 v5, s[28:31], s49 offen offset:1024 lds
    v_mfma_f32_16x16x32_bf16 v[88:91], a[140:143], a[0:3], v[88:91]
    ds_read_b64_tr_b16 a[134:135], v11 offset:9216
    s_add_u32 s49, s49, 65536
    s_waitcnt vmcnt(21) lgkmcnt(8)
    v_mfma_f32_16x16x32_bf16 v[32:35], a[112:115], a[8:11], v[32:35]
    ds_read_b64_tr_b16 a[136:137], v12 offset:8192
    v_mfma_f32_16x16x32_bf16 v[36:39], a[112:115], a[12:15], v[36:39]
    ds_read_b64_tr_b16 a[138:139], v12 offset:9216
    v_mfma_f32_16x16x32_bf16 v[44:47], a[116:119], a[12:15], v[44:47]
    ds_read_b64_tr_b16 a[140:141], v13 offset:8192
    buffer_load_dwordx4 a[56:59], v3, s[36:39], s50 offen offset:0 sc1
    v_mfma_f32_16x16x32_bf16 v[40:43], a[116:119], a[8:11], v[40:43]
    ds_read_b64_tr_b16 a[142:143], v13 offset:9216
    s_waitcnt vmcnt(33)
    s_barrier
    s_waitcnt lgkmcnt(8)
    v_mfma_f32_16x16x32_bf16 v[48:51], a[120:123], a[8:11], v[48:51]
    ds_read_b64_tr_b16 a[112:113], v6 offset:16384
    v_mfma_f32_16x16x32_bf16 v[52:55], a[120:123], a[12:15], v[52:55]
    ds_read_b64_tr_b16 a[114:115], v6 offset:17408
    s_add_u32 m0, s48, 98304
    v_mfma_f32_16x16x32_bf16 v[60:63], a[124:127], a[12:15], v[60:63]
    ds_read_b64_tr_b16 a[116:117], v7 offset:16384
    buffer_load_dwordx4 v4, s[28:31], s49 offen lds
    v_mfma_f32_16x16x32_bf16 v[56:59], a[124:127], a[8:11], v[56:59]
    ds_read_b64_tr_b16 a[118:119], v7 offset:17408
    s_waitcnt lgkmcnt(8)
    v_mfma_f32_16x16x32_bf16 v[64:67], a[128:131], a[8:11], v[64:67]
    ds_read_b64_tr_b16 a[120:121], v8 offset:16384
    v_mfma_f32_16x16x32_bf16 v[68:71], a[128:131], a[12:15], v[68:71]
    ds_read_b64_tr_b16 a[122:123], v8 offset:17408
    v_mfma_f32_16x16x32_bf16 v[76:79], a[132:135], a[12:15], v[76:79]
    ds_read_b64_tr_b16 a[124:125], v9 offset:16384
    buffer_load_dwordx4 a[60:63], v3, s[36:39], s50 offen offset:256 sc1
    v_mfma_f32_16x16x32_bf16 v[72:75], a[132:135], a[8:11], v[72:75]
    ds_read_b64_tr_b16 a[126:127], v9 offset:17408
    s_add_u32 s50, s50, 2048
    s_waitcnt lgkmcnt(8)
    v_mfma_f32_16x16x32_bf16 v[80:83], a[136:139], a[8:11], v[80:83]
    ds_read_b64_tr_b16 a[128:129], v10 offset:16384
    v_mfma_f32_16x16x32_bf16 v[84:87], a[136:139], a[12:15], v[84:87]
    ds_read_b64_tr_b16 a[130:131], v10 offset:17408
    v_mfma_f32_16x16x32_bf16 v[92:95], a[140:143], a[12:15], v[92:95]
    ds_read_b64_tr_b16 a[132:133], v11 offset:16384
    buffer_load_dwordx4 v5, s[28:31], s49 offen offset:1024 lds
    v_mfma_f32_16x16x32_bf16 v[88:91], a[140:143], a[8:11], v[88:91]
    ds_read_b64_tr_b16 a[134:135], v11 offset:17408
    s_add_u32 s49, s49, 65536
    s_waitcnt vmcnt(21) lgkmcnt(8)
    v_mfma_f32_16x16x32_bf16 v[32:35], a[112:115], a[16:19], v[32:35]
    ds_read_b64_tr_b16 a[136:137], v12 offset:16384
    v_mfma_f32_16x16x32_bf16 v[36:39], a[112:115], a[20:23], v[36:39]
    ds_read_b64_tr_b16 a[138:139], v12 offset:17408
    v_mfma_f32_16x16x32_bf16 v[44:47], a[116:119], a[20:23], v[44:47]
    ds_read_b64_tr_b16 a[140:141], v13 offset:16384
    buffer_load_dwordx4 a[64:67], v3, s[36:39], s50 offen offset:0 sc1
    v_mfma_f32_16x16x32_bf16 v[40:43], a[116:119], a[16:19], v[40:43]
    ds_read_b64_tr_b16 a[142:143], v13 offset:17408
    s_waitcnt lgkmcnt(8)
    v_mfma_f32_16x16x32_bf16 v[48:51], a[120:123], a[16:19], v[48:51]
    ds_read_b64_tr_b16 a[112:113], v6 offset:24576
    v_mfma_f32_16x16x32_bf16 v[52:55], a[120:123], a[20:23], v[52:55]
    ds_read_b64_tr_b16 a[114:115], v6 offset:25600
    s_add_u32 m0, s48, 106496
    v_mfma_f32_16x16x32_bf16 v[60:63], a[124:127], a[20:23], v[60:63]
    ds_read_b64_tr_b16 a[116:117], v7 offset:24576
    buffer_load_dwordx4 v4, s[28:31], s49 offen lds
    v_mfma_f32_16x16x32_bf16 v[56:59], a[124:127], a[16:19], v[56:59]
    ds_read_b64_tr_b16 a[118:119], v7 offset:25600
    s_waitcnt lgkmcnt(8)
    v_mfma_f32_16x16x32_bf16 v[64:67], a[128:131], a[16:19], v[64:67]
    ds_read_b64_tr_b16 a[120:121], v8 offset:24576
    v_mfma_f32_16x16x32_bf16 v[68:71], a[128:131], a[20:23], v[68:71]
    ds_read_b64_tr_b16 a[122:123], v8 offset:25600
    v_mfma_f32_16x16x32_bf16 v[76:79], a[132:135], a[20:23], v[76:79]
    ds_read_b64_tr_b16 a[124:125], v9 offset:24576
    buffer_load_dwordx4 a[68:71], v3, s[36:39], s50 offen offset:256 sc1
    v_mfma_f32_16x16x32_bf16 v[72:75], a[132:135], a[16:19], v[72:75]
    ds_read_b64_tr_b16 a[126:127], v9 offset:25600
    s_add_u32 s50, s50, 2048
    s_waitcnt lgkmcnt(8)
    v_mfma_f32_16x16x32_bf16 v[80:83], a[136:139], a[16:19], v[80:83]
    ds_read_b64_tr_b16 a[128:129], v10 offset:24576
    v_mfma_f32_16x16x32_bf16 v[84:87], a[136:139], a[20:23], v[84:87]
    ds_read_b64_tr_b16 a[130:131], v10 offset:25600
    v_mfma_f32_16x16x32_bf16 v[92:95], a[140:143], a[20:23], v[92:95]
    ds_read_b64_tr_b16 a[132:133], v11 offset:24576
    buffer_load_dwordx4 v5, s[28:31], s49 offen offset:1024 lds
    v_mfma_f32_16x16x32_bf16 v[88:91], a[140:143], a[16:19], v[88:91]
    ds_read_b64_tr_b16 a[134:135], v11 offset:25600
    s_add_u32 s49, s49, 65536
    s_waitcnt vmcnt(21) lgkmcnt(8)
    v_mfma_f32_16x16x32_bf16 v[32:35], a[112:115], a[24:27], v[32:35]
    ds_read_b64_tr_b16 a[136:137], v12 offset:24576
    v_mfma_f32_16x16x32_bf16 v[36:39], a[112:115], a[28:31], v[36:39]
    ds_read_b64_tr_b16 a[138:139], v12 offset:25600
    v_mfma_f32_16x16x32_bf16 v[44:47], a[116:119], a[28:31], v[44:47]
    ds_read_b64_tr_b16 a[140:141], v13 offset:24576
    v_mfma_f32_16x16x32_bf16 v[40:43], a[116:119], a[24:27], v[40:43]
    ds_read_b64_tr_b16 a[142:143], v13 offset:25600
    s_waitcnt vmcnt(32)
    s_barrier
    s_waitcnt lgkmcnt(8)
    v_mfma_f32_16x16x32_bf16 v[48:51], a[120:123], a[24:27], v[48:51]
    ds_read_b64_tr_b16 a[112:113], v10 offset:32768
    buffer_load_dwordx4 a[72:75], v3, s[36:39], s50 offen offset:0 sc1
    v_mfma_f32_16x16x32_bf16 v[52:55], a[120:123], a[28:31], v[52:55]
    ds_read_b64_tr_b16 a[114:115], v10 offset:33792
    v_mfma_f32_16x16x32_bf16 v[60:63], a[124:127], a[28:31], v[60:63]
    ds_read_b64_tr_b16 a[116:117], v11 offset:32768
    v_mfma_f32_16x16x32_bf16 v[56:59], a[124:127], a[24:27], v[56:59]
    ds_read_b64_tr_b16 a[118:119], v11 offset:33792
    s_waitcnt lgkmcnt(8)
    v_mfma_f32_16x16x32_bf16 v[64:67], a[128:131], a[24:27], v[64:67]
    ds_read_b64_tr_b16 a[120:121], v12 offset:32768
    v_mfma_f32_16x16x32_bf16 v[68:71], a[128:131], a[28:31], v[68:71]
    ds_read_b64_tr_b16 a[122:123], v12 offset:33792
    v_mfma_f32_16x16x32_bf16 v[76:79], a[132:135], a[28:31], v[76:79]
    ds_read_b64_tr_b16 a[124:125], v13 offset:32768
    v_mfma_f32_16x16x32_bf16 v[72:75], a[132:135], a[24:27], v[72:75]
    ds_read_b64_tr_b16 a[126:127], v13 offset:33792
    s_waitcnt lgkmcnt(8)
    v_mfma_f32_16x16x32_bf16 v[80:83], a[136:139], a[24:27], v[80:83]
    ds_read_b64_tr_b16 a[128:129], v10 offset:40960
    buffer_load_dwordx4 a[76:79], v3, s[36:39], s50 offen offset:256 sc1
    v_mfma_f32_16x16x32_bf16 v[84:87], a[136:139], a[28:31], v[84:87]
    ds_read_b64_tr_b16 a[130:131], v10 offset:41984
    s_add_u32 s50, s50, 2048
    v_mfma_f32_16x16x32_bf16 v[92:95], a[140:143], a[28:31], v[92:95]
    ds_read_b64_tr_b16 a[132:133], v11 offset:40960
    v_mfma_f32_16x16x32_bf16 v[88:91], a[140:143], a[24:27], v[88:91]
    ds_read_b64_tr_b16 a[134:135], v11 offset:41984
    s_waitcnt vmcnt(19) lgkmcnt(8)
    v_mfma_f32_16x16x32_bf16 v[64:67], a[112:115], a[32:35], v[64:67]
    ds_read_b64_tr_b16 a[136:137], v12 offset:40960
    v_mfma_f32_16x16x32_bf16 v[68:71], a[112:115], a[36:39], v[68:71]
    ds_read_b64_tr_b16 a[138:139], v12 offset:41984
    v_mfma_f32_16x16x32_bf16 v[76:79], a[116:119], a[36:39], v[76:79]
    ds_read_b64_tr_b16 a[140:141], v13 offset:40960
    buffer_load_dwordx4 a[80:83], v3, s[36:39], s50 offen offset:0 sc1
    v_mfma_f32_16x16x32_bf16 v[72:75], a[116:119], a[32:35], v[72:75]
    ds_read_b64_tr_b16 a[142:143], v13 offset:41984
    s_waitcnt vmcnt(27)
    s_barrier
    s_waitcnt lgkmcnt(8)
    v_mfma_f32_16x16x32_bf16 v[80:83], a[120:123], a[32:35], v[80:83]
    ds_read_b64_tr_b16 a[112:113], v10 offset:49152
    v_mfma_f32_16x16x32_bf16 v[84:87], a[120:123], a[36:39], v[84:87]
    ds_read_b64_tr_b16 a[114:115], v10 offset:50176
    v_mfma_f32_16x16x32_bf16 v[92:95], a[124:127], a[36:39], v[92:95]
    ds_read_b64_tr_b16 a[116:117], v11 offset:49152
    buffer_load_dwordx4 a[84:87], v3, s[36:39], s50 offen offset:256 sc1
    v_mfma_f32_16x16x32_bf16 v[88:91], a[124:127], a[32:35], v[88:91]
    ds_read_b64_tr_b16 a[118:119], v11 offset:50176
    s_add_u32 s50, s50, 2048
    s_waitcnt vmcnt(17) lgkmcnt(8)
    v_mfma_f32_16x16x32_bf16 v[64:67], a[128:131], a[40:43], v[64:67]
    ds_read_b64_tr_b16 a[120:121], v12 offset:49152
    v_mfma_f32_16x16x32_bf16 v[68:71], a[128:131], a[44:47], v[68:71]
    ds_read_b64_tr_b16 a[122:123], v12 offset:50176
    v_mfma_f32_16x16x32_bf16 v[76:79], a[132:135], a[44:47], v[76:79]
    ds_read_b64_tr_b16 a[124:125], v13 offset:49152
    buffer_load_dwordx4 a[88:91], v3, s[36:39], s50 offen offset:0 sc1
    v_mfma_f32_16x16x32_bf16 v[72:75], a[132:135], a[40:43], v[72:75]
    ds_read_b64_tr_b16 a[126:127], v13 offset:50176
    s_waitcnt lgkmcnt(8)
    v_mfma_f32_16x16x32_bf16 v[80:83], a[136:139], a[40:43], v[80:83]
    ds_read_b64_tr_b16 a[128:129], v10 offset:57344
    v_mfma_f32_16x16x32_bf16 v[84:87], a[136:139], a[44:47], v[84:87]
    ds_read_b64_tr_b16 a[130:131], v10 offset:58368
    v_mfma_f32_16x16x32_bf16 v[92:95], a[140:143], a[44:47], v[92:95]
    ds_read_b64_tr_b16 a[132:133], v11 offset:57344
    buffer_load_dwordx4 a[92:95], v3, s[36:39], s50 offen offset:256 sc1
    v_mfma_f32_16x16x32_bf16 v[88:91], a[140:143], a[40:43], v[88:91]
    ds_read_b64_tr_b16 a[134:135], v11 offset:58368
    s_add_u32 s50, s50, 2048
    s_waitcnt vmcnt(15) lgkmcnt(8)
    v_mfma_f32_16x16x32_bf16 v[64:67], a[112:115], a[48:51], v[64:67]
    ds_read_b64_tr_b16 a[136:137], v12 offset:57344
    v_mfma_f32_16x16x32_bf16 v[68:71], a[112:115], a[52:55], v[68:71]
    ds_read_b64_tr_b16 a[138:139], v12 offset:58368
    v_mfma_f32_16x16x32_bf16 v[76:79], a[116:119], a[52:55], v[76:79]
    ds_read_b64_tr_b16 a[140:141], v13 offset:57344
    buffer_load_dwordx4 a[96:99], v3, s[36:39], s50 offen offset:0 sc1
    v_mfma_f32_16x16x32_bf16 v[72:75], a[116:119], a[48:51], v[72:75]
    ds_read_b64_tr_b16 a[142:143], v13 offset:58368
    s_waitcnt vmcnt(23)
    s_barrier
    s_waitcnt lgkmcnt(8)
    v_mfma_f32_16x16x32_bf16 v[80:83], a[120:123], a[48:51], v[80:83]
    ds_read_b64_tr_b16 a[112:113], v164 offset:0
    v_mfma_f32_16x16x32_bf16 v[84:87], a[120:123], a[52:55], v[84:87]
    ds_read_b64_tr_b16 a[114:115], v164 offset:1024
    v_mfma_f32_16x16x32_bf16 v[92:95], a[124:127], a[52:55], v[92:95]
    ds_read_b64_tr_b16 a[116:117], v165 offset:0
    buffer_load_dwordx4 a[100:103], v3, s[36:39], s50 offen offset:256 sc1
    v_mfma_f32_16x16x32_bf16 v[88:91], a[124:127], a[48:51], v[88:91]
    ds_read_b64_tr_b16 a[118:119], v165 offset:1024
    s_add_u32 s50, s50, 2048
    s_waitcnt vmcnt(13) lgkmcnt(8)
    v_mfma_f32_16x16x32_bf16 v[64:67], a[128:131], a[56:59], v[64:67]
    ds_read_b64_tr_b16 a[120:121], v166 offset:0
    v_mfma_f32_16x16x32_bf16 v[68:71], a[128:131], a[60:63], v[68:71]
    ds_read_b64_tr_b16 a[122:123], v166 offset:1024
    v_mfma_f32_16x16x32_bf16 v[76:79], a[132:135], a[60:63], v[76:79]
    ds_read_b64_tr_b16 a[124:125], v167 offset:0
    buffer_load_dwordx4 a[104:107], v3, s[36:39], s50 offen offset:0 sc1
    v_mfma_f32_16x16x32_bf16 v[72:75], a[132:135], a[56:59], v[72:75]
    ds_read_b64_tr_b16 a[126:127], v167 offset:1024
    s_waitcnt lgkmcnt(8)
    v_mfma_f32_16x16x32_bf16 v[80:83], a[136:139], a[56:59], v[80:83]
    ds_read_b64_tr_b16 a[128:129], v164 offset:8192
    v_mfma_f32_16x16x32_bf16 v[84:87], a[136:139], a[60:63], v[84:87]
    ds_read_b64_tr_b16 a[130:131], v164 offset:9216
    v_mfma_f32_16x16x32_bf16 v[92:95], a[140:143], a[60:63], v[92:95]
    ds_read_b64_tr_b16 a[132:133], v165 offset:8192
    buffer_load_dwordx4 a[108:111], v3, s[36:39], s50 offen offset:256 sc1
    v_mfma_f32_16x16x32_bf16 v[88:91], a[140:143], a[56:59], v[88:91]
    ds_read_b64_tr_b16 a[134:135], v165 offset:9216
    s_add_u32 s50, s50, 2048
    s_waitcnt vmcnt(11) lgkmcnt(8)
    v_mfma_f32_16x16x32_bf16 v[64:67], a[112:115], a[64:67], v[64:67]
    ds_read_b64_tr_b16 a[136:137], v166 offset:8192
    v_mfma_f32_16x16x32_bf16 v[68:71], a[112:115], a[68:71], v[68:71]
    ds_read_b64_tr_b16 a[138:139], v166 offset:9216
    v_mfma_f32_16x16x32_bf16 v[76:79], a[116:119], a[68:71], v[76:79]
    ds_read_b64_tr_b16 a[140:141], v167 offset:8192
    v_mfma_f32_16x16x32_bf16 v[72:75], a[116:119], a[64:67], v[72:75]
    ds_read_b64_tr_b16 a[142:143], v167 offset:9216
    s_waitcnt vmcnt(18)
    s_barrier
    s_waitcnt lgkmcnt(8)
    v_mfma_f32_16x16x32_bf16 v[80:83], a[120:123], a[64:67], v[80:83]
    ds_read_b64_tr_b16 a[112:113], v164 offset:16384
    v_mfma_f32_16x16x32_bf16 v[84:87], a[120:123], a[68:71], v[84:87]
    ds_read_b64_tr_b16 a[114:115], v164 offset:17408
    v_mfma_f32_16x16x32_bf16 v[92:95], a[124:127], a[68:71], v[92:95]
    ds_read_b64_tr_b16 a[116:117], v165 offset:16384
    v_mfma_f32_16x16x32_bf16 v[88:91], a[124:127], a[64:67], v[88:91]
    ds_read_b64_tr_b16 a[118:119], v165 offset:17408
    s_waitcnt vmcnt(8) lgkmcnt(8)
    v_mfma_f32_16x16x32_bf16 v[64:67], a[128:131], a[72:75], v[64:67]
    ds_read_b64_tr_b16 a[120:121], v166 offset:16384
    v_mfma_f32_16x16x32_bf16 v[68:71], a[128:131], a[76:79], v[68:71]
    ds_read_b64_tr_b16 a[122:123], v166 offset:17408
    v_mfma_f32_16x16x32_bf16 v[76:79], a[132:135], a[76:79], v[76:79]
    ds_read_b64_tr_b16 a[124:125], v167 offset:16384
    v_mfma_f32_16x16x32_bf16 v[72:75], a[132:135], a[72:75], v[72:75]
    ds_read_b64_tr_b16 a[126:127], v167 offset:17408
    s_waitcnt lgkmcnt(8)
    v_mfma_f32_16x16x32_bf16 v[80:83], a[136:139], a[72:75], v[80:83]
    ds_read_b64_tr_b16 a[128:129], v164 offset:24576
    v_mfma_f32_16x16x32_bf16 v[84:87], a[136:139], a[76:79], v[84:87]
    ds_read_b64_tr_b16 a[130:131], v164 offset:25600
    v_mfma_f32_16x16x32_bf16 v[92:95], a[140:143], a[76:79], v[92:95]
    ds_read_b64_tr_b16 a[132:133], v165 offset:24576
    v_mfma_f32_16x16x32_bf16 v[88:91], a[140:143], a[72:75], v[88:91]
    ds_read_b64_tr_b16 a[134:135], v165 offset:25600
    s_waitcnt vmcnt(6) lgkmcnt(8)
    v_mfma_f32_16x16x32_bf16 v[64:67], a[112:115], a[80:83], v[64:67]
    ds_read_b64_tr_b16 a[136:137], v166 offset:24576
    v_mfma_f32_16x16x32_bf16 v[68:71], a[112:115], a[84:87], v[68:71]
    ds_read_b64_tr_b16 a[138:139], v166 offset:25600
    v_mfma_f32_16x16x32_bf16 v[76:79], a[116:119], a[84:87], v[76:79]
    ds_read_b64_tr_b16 a[140:141], v167 offset:24576
    v_mfma_f32_16x16x32_bf16 v[72:75], a[116:119], a[80:83], v[72:75]
    ds_read_b64_tr_b16 a[142:143], v167 offset:25600
    s_waitcnt vmcnt(10)
    s_barrier
    s_waitcnt lgkmcnt(8)
    v_mfma_f32_16x16x32_bf16 v[80:83], a[120:123], a[80:83], v[80:83]
    ds_read_b64_tr_b16 a[112:113], v164 offset:32768
    v_mfma_f32_16x16x32_bf16 v[84:87], a[120:123], a[84:87], v[84:87]
    ds_read_b64_tr_b16 a[114:115], v164 offset:33792
    v_mfma_f32_16x16x32_bf16 v[92:95], a[124:127], a[84:87], v[92:95]
    ds_read_b64_tr_b16 a[116:117], v165 offset:32768
    v_mfma_f32_16x16x32_bf16 v[88:91], a[124:127], a[80:83], v[88:91]
    ds_read_b64_tr_b16 a[118:119], v165 offset:33792
    s_waitcnt vmcnt(4) lgkmcnt(8)
    v_mfma_f32_16x16x32_bf16 v[64:67], a[128:131], a[88:91], v[64:67]
    ds_read_b64_tr_b16 a[120:121], v166 offset:32768
    v_mfma_f32_16x16x32_bf16 v[68:71], a[128:131], a[92:95], v[68:71]
    ds_read_b64_tr_b16 a[122:123], v166 offset:33792
    v_mfma_f32_16x16x32_bf16 v[76:79], a[132:135], a[92:95], v[76:79]
    ds_read_b64_tr_b16 a[124:125], v167 offset:32768
    v_mfma_f32_16x16x32_bf16 v[72:75], a[132:135], a[88:91], v[72:75]
    ds_read_b64_tr_b16 a[126:127], v167 offset:33792
    s_waitcnt lgkmcnt(8)
    v_mfma_f32_16x16x32_bf16 v[80:83], a[136:139], a[88:91], v[80:83]
    ds_read_b64_tr_b16 a[128:129], v164 offset:40960
    v_mfma_f32_16x16x32_bf16 v[84:87], a[136:139], a[92:95], v[84:87]
    ds_read_b64_tr_b16 a[130:131], v164 offset:41984
    v_mfma_f32_16x16x32_bf16 v[92:95], a[140:143], a[92:95], v[92:95]
    ds_read_b64_tr_b16 a[132:133], v165 offset:40960
    v_mfma_f32_16x16x32_bf16 v[88:91], a[140:143], a[88:91], v[88:91]
    ds_read_b64_tr_b16 a[134:135], v165 offset:41984
    s_waitcnt vmcnt(2) lgkmcnt(8)
    v_mfma_f32_16x16x32_bf16 v[64:67], a[112:115], a[96:99], v[64:67]
    ds_read_b64_tr_b16 a[136:137], v166 offset:40960
    v_mfma_f32_16x16x32_bf16 v[68:71], a[112:115], a[100:103], v[68:71]
    ds_read_b64_tr_b16 a[138:139], v166 offset:41984
    v_mfma_f32_16x16x32_bf16 v[76:79], a[116:119], a[100:103], v[76:79]
    ds_read_b64_tr_b16 a[140:141], v167 offset:40960
    v_mfma_f32_16x16x32_bf16 v[72:75], a[116:119], a[96:99], v[72:75]
    ds_read_b64_tr_b16 a[142:143], v167 offset:41984
    s_waitcnt lgkmcnt(8)
    v_mfma_f32_16x16x32_bf16 v[80:83], a[120:123], a[96:99], v[80:83]
    v_mfma_f32_16x16x32_bf16 v[84:87], a[120:123], a[100:103], v[84:87]
    v_mfma_f32_16x16x32_bf16 v[92:95], a[124:127], a[100:103], v[92:95]
    v_mfma_f32_16x16x32_bf16 v[88:91], a[124:127], a[96:99], v[88:91]
    s_waitcnt vmcnt(0) lgkmcnt(4)
    v_mfma_f32_16x16x32_bf16 v[64:67], a[128:131], a[104:107], v[64:67]
    v_mfma_f32_16x16x32_bf16 v[68:71], a[128:131], a[108:111], v[68:71]
    v_mfma_f32_16x16x32_bf16 v[76:79], a[132:135], a[108:111], v[76:79]
    v_mfma_f32_16x16x32_bf16 v[72:75], a[132:135], a[104:107], v[72:75]
    s_waitcnt lgkmcnt(0)
    v_mfma_f32_16x16x32_bf16 v[80:83], a[136:139], a[104:107], v[80:83]
    v_mfma_f32_16x16x32_bf16 v[84:87], a[136:139], a[108:111], v[84:87]
    v_mfma_f32_16x16x32_bf16 v[92:95], a[140:143], a[108:111], v[92:95]
    v_mfma_f32_16x16x32_bf16 v[88:91], a[140:143], a[104:107], v[88:91]
    buffer_store_dwordx4 v[64:67], v137, s[32:35], 0 offen offset:0 sc1
    buffer_store_dwordx4 v[68:71], v137, s[32:35], 0 offen offset:1024 sc1
    s_nop 0
    buffer_store_dwordx4 v[72:75], v137, s[32:35], 0 offen offset:2048 sc1
    buffer_store_dwordx4 v[76:79], v137, s[32:35], 0 offen offset:3072 sc1
    buffer_store_dwordx4 v[80:83], v137, s[32:35], s54 offen offset:0 sc1
    buffer_store_dwordx4 v[84:87], v137, s[32:35], s54 offen offset:1024 sc1
    s_nop 0
    buffer_store_dwordx4 v[88:91], v137, s[32:35], s54 offen offset:2048 sc1
    buffer_store_dwordx4 v[92:95], v137, s[32:35], s54 offen offset:3072 sc1
    v_lshlrev_b32 v16, 20, v0
    v_mov_b32 v17, s10
    s_xor_b32 s52, s57, 128
    v_mov_b32 v18, s52
    ds_read_b64_tr_b16 a[112:113], v6 offset:32768
    ds_read_b64_tr_b16 a[114:115], v6 offset:33792
    ds_read_b64_tr_b16 a[116:117], v7 offset:32768
    ds_read_b64_tr_b16 a[118:119], v7 offset:33792
    ds_read_b64_tr_b16 a[120:121], v8 offset:32768
    ds_read_b64_tr_b16 a[122:123], v8 offset:33792
    ds_read_b64_tr_b16 a[124:125], v9 offset:32768
    ds_read_b64_tr_b16 a[126:127], v9 offset:33792
    ds_read_b64_tr_b16 a[128:129], v6 offset:40960
    ds_read_b64_tr_b16 a[130:131], v6 offset:41984
    ds_read_b64_tr_b16 a[132:133], v7 offset:40960
    ds_read_b64_tr_b16 a[134:135], v7 offset:41984
    s_waitcnt lgkmcnt(10)
    v_mfma_f32_16x16x32_bf16 v[32:35], a[112:115], a[32:35], v[32:35]
    ds_read_b64_tr_b16 a[136:137], v8 offset:40960
    v_mfma_f32_16x16x32_bf16 v[36:39], a[112:115], a[36:39], v[36:39]
    ds_read_b64_tr_b16 a[138:139], v8 offset:41984
    s_waitcnt lgkmcnt(10)
    v_mfma_f32_16x16x32_bf16 v[44:47], a[116:119], a[36:39], v[44:47]
    ds_read_b64_tr_b16 a[140:141], v9 offset:40960
    v_mfma_f32_16x16x32_bf16 v[40:43], a[116:119], a[32:35], v[40:43]
    ds_read_b64_tr_b16 a[142:143], v9 offset:41984
    s_waitcnt lgkmcnt(10)
    v_mfma_f32_16x16x32_bf16 v[48:51], a[120:123], a[32:35], v[48:51]
    ds_read_b64_tr_b16 a[112:113], v6 offset:49152
    v_mfma_f32_16x16x32_bf16 v[52:55], a[120:123], a[36:39], v[52:55]
    ds_read_b64_tr_b16 a[114:115], v6 offset:50176
    s_waitcnt lgkmcnt(10)
    v_mfma_f32_16x16x32_bf16 v[60:63], a[124:127], a[36:39], v[60:63]
    ds_read_b64_tr_b16 a[116:117], v7 offset:49152
    v_mfma_f32_16x16x32_bf16 v[56:59], a[124:127], a[32:35], v[56:59]
    ds_read_b64_tr_b16 a[118:119], v7 offset:50176
    s_waitcnt lgkmcnt(10)
    v_mfma_f32_16x16x32_bf16 v[32:35], a[128:131], a[40:43], v[32:35]
    ds_read_b64_tr_b16 a[120:121], v8 offset:49152
    v_mfma_f32_16x16x32_bf16 v[36:39], a[128:131], a[44:47], v[36:39]
    ds_read_b64_tr_b16 a[122:123], v8 offset:50176
    s_waitcnt lgkmcnt(10)
    v_mfma_f32_16x16x32_bf16 v[44:47], a[132:135], a[44:47], v[44:47]
    ds_read_b64_tr_b16 a[124:125], v9 offset:49152
    v_mfma_f32_16x16x32_bf16 v[40:43], a[132:135], a[40:43], v[40:43]
    ds_read_b64_tr_b16 a[126:127], v9 offset:50176
    s_waitcnt lgkmcnt(10)
    v_mfma_f32_16x16x32_bf16 v[48:51], a[136:139], a[40:43], v[48:51]
    ds_read_b64_tr_b16 a[128:129], v6 offset:57344
    v_mfma_f32_16x16x32_bf16 v[52:55], a[136:139], a[44:47], v[52:55]
    ds_read_b64_tr_b16 a[130:131], v6 offset:58368
    s_waitcnt lgkmcnt(10)
    v_mfma_f32_16x16x32_bf16 v[60:63], a[140:143], a[44:47], v[60:63]
    ds_read_b64_tr_b16 a[132:133], v7 offset:57344
    v_mfma_f32_16x16x32_bf16 v[56:59], a[140:143], a[40:43], v[56:59]
    ds_read_b64_tr_b16 a[134:135], v7 offset:58368
    s_waitcnt lgkmcnt(10)
    v_mfma_f32_16x16x32_bf16 v[32:35], a[112:115], a[48:51], v[32:35]
    ds_read_b64_tr_b16 a[136:137], v8 offset:57344
    v_mfma_f32_16x16x32_bf16 v[36:39], a[112:115], a[52:55], v[36:39]
    ds_read_b64_tr_b16 a[138:139], v8 offset:58368
    s_waitcnt lgkmcnt(10)
    v_mfma_f32_16x16x32_bf16 v[44:47], a[116:119], a[52:55], v[44:47]
    ds_read_b64_tr_b16 a[140:141], v9 offset:57344
    v_mfma_f32_16x16x32_bf16 v[40:43], a[116:119], a[48:51], v[40:43]
    ds_read_b64_tr_b16 a[142:143], v9 offset:58368
    s_waitcnt lgkmcnt(10)
    v_mfma_f32_16x16x32_bf16 v[48:51], a[120:123], a[48:51], v[48:51]
    ds_read_b64_tr_b16 a[112:113], v160 offset:0
    v_mfma_f32_16x16x32_bf16 v[52:55], a[120:123], a[52:55], v[52:55]
    ds_read_b64_tr_b16 a[114:115], v160 offset:1024
    s_waitcnt lgkmcnt(10)
    v_mfma_f32_16x16x32_bf16 v[60:63], a[124:127], a[52:55], v[60:63]
    ds_read_b64_tr_b16 a[116:117], v161 offset:0
    v_mfma_f32_16x16x32_bf16 v[56:59], a[124:127], a[48:51], v[56:59]
    ds_read_b64_tr_b16 a[118:119], v161 offset:1024
    s_waitcnt lgkmcnt(10)
    v_mfma_f32_16x16x32_bf16 v[32:35], a[128:131], a[56:59], v[32:35]
    ds_read_b64_tr_b16 a[120:121], v162 offset:0
    v_mfma_f32_16x16x32_bf16 v[36:39], a[128:131], a[60:63], v[36:39]
    ds_read_b64_tr_b16 a[122:123], v162 offset:1024
    s_waitcnt lgkmcnt(10)
    v_mfma_f32_16x16x32_bf16 v[44:47], a[132:135], a[60:63], v[44:47]
    ds_read_b64_tr_b16 a[124:125], v163 offset:0
    v_mfma_f32_16x16x32_bf16 v[40:43], a[132:135], a[56:59], v[40:43]
    ds_read_b64_tr_b16 a[126:127], v163 offset:1024
    s_waitcnt lgkmcnt(10)
    v_mfma_f32_16x16x32_bf16 v[48:51], a[136:139], a[56:59], v[48:51]
    ds_read_b64_tr_b16 a[128:129], v160 offset:8192
    v_mfma_f32_16x16x32_bf16 v[52:55], a[136:139], a[60:63], v[52:55]
    ds_read_b64_tr_b16 a[130:131], v160 offset:9216
    s_waitcnt lgkmcnt(10)
    v_mfma_f32_16x16x32_bf16 v[60:63], a[140:143], a[60:63], v[60:63]
    ds_read_b64_tr_b16 a[132:133], v161 offset:8192
    v_mfma_f32_16x16x32_bf16 v[56:59], a[140:143], a[56:59], v[56:59]
    ds_read_b64_tr_b16 a[134:135], v161 offset:9216
    s_waitcnt lgkmcnt(10)
    v_mfma_f32_16x16x32_bf16 v[32:35], a[112:115], a[64:67], v[32:35]
    ds_read_b64_tr_b16 a[136:137], v162 offset:8192
    v_mfma_f32_16x16x32_bf16 v[36:39], a[112:115], a[68:71], v[36:39]
    ds_read_b64_tr_b16 a[138:139], v162 offset:9216
    s_waitcnt lgkmcnt(10)
    v_mfma_f32_16x16x32_bf16 v[44:47], a[116:119], a[68:71], v[44:47]
    ds_read_b64_tr_b16 a[140:141], v163 offset:8192
    v_mfma_f32_16x16x32_bf16 v[40:43], a[116:119], a[64:67], v[40:43]
    ds_read_b64_tr_b16 a[142:143], v163 offset:9216
    s_waitcnt lgkmcnt(10)
    v_mfma_f32_16x16x32_bf16 v[48:51], a[120:123], a[64:67], v[48:51]
    ds_read_b64_tr_b16 a[112:113], v160 offset:16384
    v_mfma_f32_16x16x32_bf16 v[52:55], a[120:123], a[68:71], v[52:55]
    ds_read_b64_tr_b16 a[114:115], v160 offset:17408
    s_waitcnt lgkmcnt(10)
    v_mfma_f32_16x16x32_bf16 v[60:63], a[124:127], a[68:71], v[60:63]
    ds_read_b64_tr_b16 a[116:117], v161 offset:16384
    v_mfma_f32_16x16x32_bf16 v[56:59], a[124:127], a[64:67], v[56:59]
    ds_read_b64_tr_b16 a[118:119], v161 offset:17408
    s_waitcnt lgkmcnt(10)
    v_mfma_f32_16x16x32_bf16 v[32:35], a[128:131], a[72:75], v[32:35]
    ds_read_b64_tr_b16 a[120:121], v162 offset:16384
    v_mfma_f32_16x16x32_bf16 v[36:39], a[128:131], a[76:79], v[36:39]
    ds_read_b64_tr_b16 a[122:123], v162 offset:17408
    s_waitcnt lgkmcnt(10)
    v_mfma_f32_16x16x32_bf16 v[44:47], a[132:135], a[76:79], v[44:47]
    ds_read_b64_tr_b16 a[124:125], v163 offset:16384
    v_mfma_f32_16x16x32_bf16 v[40:43], a[132:135], a[72:75], v[40:43]
    ds_read_b64_tr_b16 a[126:127], v163 offset:17408
    s_waitcnt lgkmcnt(10)
    v_mfma_f32_16x16x32_bf16 v[48:51], a[136:139], a[72:75], v[48:51]
    ds_read_b64_tr_b16 a[128:129], v160 offset:24576
    v_mfma_f32_16x16x32_bf16 v[52:55], a[136:139], a[76:79], v[52:55]
    ds_read_b64_tr_b16 a[130:131], v160 offset:25600
    s_waitcnt lgkmcnt(10)
    v_mfma_f32_16x16x32_bf16 v[60:63], a[140:143], a[76:79], v[60:63]
    ds_read_b64_tr_b16 a[132:133], v161 offset:24576
    v_mfma_f32_16x16x32_bf16 v[56:59], a[140:143], a[72:75], v[56:59]
    ds_read_b64_tr_b16 a[134:135], v161 offset:25600
    s_waitcnt vmcnt(0)
    buffer_store_dword v17, v16, s[64:67], s57 offen sc1
    s_waitcnt lgkmcnt(10)
    v_mfma_f32_16x16x32_bf16 v[32:35], a[112:115], a[80:83], v[32:35]
    ds_read_b64_tr_b16 a[136:137], v162 offset:24576
    v_mfma_f32_16x16x32_bf16 v[36:39], a[112:115], a[84:87], v[36:39]
    ds_read_b64_tr_b16 a[138:139], v162 offset:25600
    s_waitcnt lgkmcnt(10)
    v_mfma_f32_16x16x32_bf16 v[44:47], a[116:119], a[84:87], v[44:47]
    ds_read_b64_tr_b16 a[140:141], v163 offset:24576
    v_mfma_f32_16x16x32_bf16 v[40:43], a[116:119], a[80:83], v[40:43]
    ds_read_b64_tr_b16 a[142:143], v163 offset:25600
    s_waitcnt lgkmcnt(10)
    v_mfma_f32_16x16x32_bf16 v[48:51], a[120:123], a[80:83], v[48:51]
    ds_read_b64_tr_b16 a[112:113], v160 offset:32768
    v_mfma_f32_16x16x32_bf16 v[52:55], a[120:123], a[84:87], v[52:55]
    ds_read_b64_tr_b16 a[114:115], v160 offset:33792
    s_waitcnt lgkmcnt(10)
    v_mfma_f32_16x16x32_bf16 v[60:63], a[124:127], a[84:87], v[60:63]
    ds_read_b64_tr_b16 a[116:117], v161 offset:32768
    v_mfma_f32_16x16x32_bf16 v[56:59], a[124:127], a[80:83], v[56:59]
    ds_read_b64_tr_b16 a[118:119], v161 offset:33792
    s_waitcnt lgkmcnt(10)
    v_mfma_f32_16x16x32_bf16 v[32:35], a[128:131], a[88:91], v[32:35]
    ds_read_b64_tr_b16 a[120:121], v162 offset:32768
    v_mfma_f32_16x16x32_bf16 v[36:39], a[128:131], a[92:95], v[36:39]
    ds_read_b64_tr_b16 a[122:123], v162 offset:33792
    s_waitcnt lgkmcnt(10)
    v_mfma_f32_16x16x32_bf16 v[44:47], a[132:135], a[92:95], v[44:47]
    ds_read_b64_tr_b16 a[124:125], v163 offset:32768
    v_mfma_f32_16x16x32_bf16 v[40:43], a[132:135], a[88:91], v[40:43]
    ds_read_b64_tr_b16 a[126:127], v163 offset:33792
    s_waitcnt lgkmcnt(10)
    v_mfma_f32_16x16x32_bf16 v[48:51], a[136:139], a[88:91], v[48:51]
    ds_read_b64_tr_b16 a[128:129], v160 offset:40960
    v_mfma_f32_16x16x32_bf16 v[52:55], a[136:139], a[92:95], v[52:55]
    ds_read_b64_tr_b16 a[130:131], v160 offset:41984
    s_waitcnt lgkmcnt(10)
    v_mfma_f32_16x16x32_bf16 v[60:63], a[140:143], a[92:95], v[60:63]
    ds_read_b64_tr_b16 a[132:133], v161 offset:40960
    v_mfma_f32_16x16x32_bf16 v[56:59], a[140:143], a[88:91], v[56:59]
    ds_read_b64_tr_b16 a[134:135], v161 offset:41984
    s_waitcnt lgkmcnt(10)
    v_mfma_f32_16x16x32_bf16 v[32:35], a[112:115], a[96:99], v[32:35]
    ds_read_b64_tr_b16 a[136:137], v162 offset:40960
    v_mfma_f32_16x16x32_bf16 v[36:39], a[112:115], a[100:103], v[36:39]
    ds_read_b64_tr_b16 a[138:139], v162 offset:41984
    s_waitcnt lgkmcnt(10)
    v_mfma_f32_16x16x32_bf16 v[44:47], a[116:119], a[100:103], v[44:47]
    ds_read_b64_tr_b16 a[140:141], v163 offset:40960
    v_mfma_f32_16x16x32_bf16 v[40:43], a[116:119], a[96:99], v[40:43]
    ds_read_b64_tr_b16 a[142:143], v163 offset:41984
    s_waitcnt lgkmcnt(10)
    v_mfma_f32_16x16x32_bf16 v[48:51], a[120:123], a[96:99], v[48:51]
    v_mfma_f32_16x16x32_bf16 v[52:55], a[120:123], a[100:103], v[52:55]
    s_waitcnt lgkmcnt(8)
    v_mfma_f32_16x16x32_bf16 v[60:63], a[124:127], a[100:103], v[60:63]
    v_mfma_f32_16x16x32_bf16 v[56:59], a[124:127], a[96:99], v[56:59]
    s_waitcnt lgkmcnt(6)
    v_mfma_f32_16x16x32_bf16 v[32:35], a[128:131], a[104:107], v[32:35]
    v_mfma_f32_16x16x32_bf16 v[36:39], a[128:131], a[108:111], v[36:39]
    s_waitcnt lgkmcnt(4)
    v_mfma_f32_16x16x32_bf16 v[44:47], a[132:135], a[108:111], v[44:47]
    v_mfma_f32_16x16x32_bf16 v[40:43], a[132:135], a[104:107], v[40:43]
    s_waitcnt lgkmcnt(2)
    v_mfma_f32_16x16x32_bf16 v[48:51], a[136:139], a[104:107], v[48:51]
    v_mfma_f32_16x16x32_bf16 v[52:55], a[136:139], a[108:111], v[52:55]
    s_waitcnt lgkmcnt(0)
    v_mfma_f32_16x16x32_bf16 v[60:63], a[140:143], a[108:111], v[60:63]
    v_mfma_f32_16x16x32_bf16 v[56:59], a[140:143], a[104:107], v[56:59]
    buffer_load_dword v19, v18, s[64:67], 0 offen sc1
    v_add_f32 v128, v128, v129
    v_add_f32 v130, v130, v131
    v_add_f32 v128, v128, v130
    v_mov_b32 v14, v128
    s_nop 1
    v_permlane16_swap_b32 v14, v128
    v_add_f32 v128, v14, v128
    v_mov_b32 v14, v128
    s_nop 1
    v_permlane32_swap_b32 v14, v128
    v_add_f32 v128, v14, v128
    v_mov_b32 v14, 0x3727c5ac
    v_fmac_f32 v14, 0x3a800000, v128
    v_rsq_f32 v140, v14
    v_add_f32 v132, v132, v133
    v_add_f32 v134, v134, v135
    v_add_f32 v132, v132, v134
    v_mov_b32 v14, v132
    s_nop 1
    v_permlane16_swap_b32 v14, v132
    v_add_f32 v132, v14, v132
    v_mov_b32 v14, v132
    s_nop 1
    v_permlane32_swap_b32 v14, v132
    v_add_f32 v132, v14, v132
    v_mov_b32 v14, 0x3727c5ac
    v_fmac_f32 v14, 0x3a800000, v132
    v_rsq_f32 v142, v14
    s_mov_b32 s52, 0x40000
    s_branch S5_chk
S5_poll:
    s_sleep 4
    buffer_load_dword v19, v18, s[64:67], 0 offen sc1
S5_chk:
    s_waitcnt vmcnt(0)
    v_cmp_ne_u32 vcc, s10, v19
    s_sub_u32 s52, s52, 1
    s_cbranch_scc1 S5_ok
    s_cbranch_vccnz S5_poll
S5_ok:
    buffer_load_dwordx4 v[64:67], v138, s[32:35], 0 offen offset:0 sc1
    buffer_load_dwordx4 v[72:75], v138, s[32:35], 0 offen offset:2048 sc1
    buffer_load_dwordx4 v[68:71], v138, s[32:35], 0 offen offset:1024 sc1
    buffer_load_dwordx4 v[76:79], v138, s[32:35], 0 offen offset:3072 sc1
    buffer_load_dwordx4 v[80:83], v138, s[32:35], s54 offen offset:0 sc1
    buffer_load_dwordx4 v[88:91], v138, s[32:35], s54 offen offset:2048 sc1
    buffer_load_dwordx4 v[84:87], v138, s[32:35], s54 offen offset:1024 sc1
    buffer_load_dwordx4 v[92:95], v138, s[32:35], s54 offen offset:3072 sc1
    s_waitcnt vmcnt(6)
    v_pk_add_f32 v[32:33], v[32:33], v[64:65]
    v_pk_fma_f32 v[32:33], v[32:33], v[140:141], v[96:97] op_sel_hi:[1,0,1]
    v_pk_add_f32 v[34:35], v[34:35], v[66:67]
    v_pk_fma_f32 v[34:35], v[34:35], v[140:141], v[98:99] op_sel_hi:[1,0,1]
    v_cvt_pk_bf16_f32 v144, v32, v33
    v_cvt_pk_bf16_f32 v145, v34, v35
    v_pk_add_f32 v[40:41], v[40:41], v[72:73]
    v_pk_fma_f32 v[40:41], v[40:41], v[140:141], v[104:105] op_sel_hi:[1,0,1]
    v_pk_add_f32 v[42:43], v[42:43], v[74:75]
    v_pk_fma_f32 v[42:43], v[42:43], v[140:141], v[106:107] op_sel_hi:[1,0,1]
    v_cvt_pk_bf16_f32 v146, v40, v41
    v_cvt_pk_bf16_f32 v147, v42, v43
    s_nop 0
    v_permlane16_swap_b32 v144, v146
    v_permlane16_swap_b32 v145, v147
    buffer_store_dwordx4 v[144:147], v139, s[40:43], 0 offen offset:0
    s_waitcnt vmcnt(5)
    v_pk_add_f32 v[36:37], v[36:37], v[68:69]
    v_pk_fma_f32 v[36:37], v[36:37], v[142:143], v[100:101] op_sel_hi:[1,0,1]
    v_pk_add_f32 v[38:39], v[38:39], v[70:71]
    v_pk_fma_f32 v[38:39], v[38:39], v[142:143], v[102:103] op_sel_hi:[1,0,1]
    v_cvt_pk_bf16_f32 v148, v36, v37
    v_cvt_pk_bf16_f32 v149, v38, v39
    v_pk_add_f32 v[44:45], v[44:45], v[76:77]
    v_pk_fma_f32 v[44:45], v[44:45], v[142:143], v[108:109] op_sel_hi:[1,0,1]
    v_pk_add_f32 v[46:47], v[46:47], v[78:79]
    v_pk_fma_f32 v[46:47], v[46:47], v[142:143], v[110:111] op_sel_hi:[1,0,1]
    v_cvt_pk_bf16_f32 v150, v44, v45
    v_cvt_pk_bf16_f32 v151, v46, v47
    s_nop 0
    v_permlane16_swap_b32 v148, v150
    v_permlane16_swap_b32 v149, v151
    buffer_store_dwordx4 v[148:151], v139, s[40:43], s53 offen offset:0
    s_waitcnt vmcnt(4)
    v_pk_add_f32 v[48:49], v[48:49], v[80:81]
    v_pk_fma_f32 v[48:49], v[48:49], v[140:141], v[112:113] op_sel_hi:[1,0,1]
    v_pk_add_f32 v[50:51], v[50:51], v[82:83]
    v_pk_fma_f32 v[50:51], v[50:51], v[140:141], v[114:115] op_sel_hi:[1,0,1]
    v_cvt_pk_bf16_f32 v152, v48, v49
    v_cvt_pk_bf16_f32 v153, v50, v51
    v_pk_add_f32 v[56:57], v[56:57], v[88:89]
    v_pk_fma_f32 v[56:57], v[56:57], v[140:141], v[120:121] op_sel_hi:[1,0,1]
    v_pk_add_f32 v[58:59], v[58:59], v[90:91]
    v_pk_fma_f32 v[58:59], v[58:59], v[140:141], v[122:123] op_sel_hi:[1,0,1]
    v_cvt_pk_bf16_f32 v154, v56, v57
    v_cvt_pk_bf16_f32 v155, v58, v59
    s_nop 0
    v_permlane16_swap_b32 v152, v154
    v_permlane16_swap_b32 v153, v155
    buffer_store_dwordx4 v[152:155], v139, s[40:43], 0 offen offset:64
    s_waitcnt vmcnt(3)
    v_pk_add_f32 v[52:53], v[52:53], v[84:85]
    v_pk_fma_f32 v[52:53], v[52:53], v[142:143], v[116:117] op_sel_hi:[1,0,1]
    v_pk_add_f32 v[54:55], v[54:55], v[86:87]
    v_pk_fma_f32 v[54:55], v[54:55], v[142:143], v[118:119] op_sel_hi:[1,0,1]
    v_cvt_pk_bf16_f32 v156, v52, v53
    v_cvt_pk_bf16_f32 v157, v54, v55
    v_pk_add_f32 v[60:61], v[60:61], v[92:93]
    v_pk_fma_f32 v[60:61], v[60:61], v[142:143], v[124:125] op_sel_hi:[1,0,1]
    v_pk_add_f32 v[62:63], v[62:63], v[94:95]
    v_pk_fma_f32 v[62:63], v[62:63], v[142:143], v[126:127] op_sel_hi:[1,0,1]
    v_cvt_pk_bf16_f32 v158, v60, v61
    v_cvt_pk_bf16_f32 v159, v62, v63
    s_nop 0
    v_permlane16_swap_b32 v156, v158
    v_permlane16_swap_b32 v157, v159
    buffer_store_dwordx4 v[156:159], v139, s[40:43], s53 offen offset:64
C_end:
L_end:
    s_endpgm
.section .rodata,"a"
.p2align 6
.amdhsa_kernel sequential_preLN__sliding_block__glu_gated_glu__prompt_kernel
  .amdhsa_next_free_vgpr 480
  .amdhsa_next_free_sgpr 102
  .amdhsa_accum_offset 256
  .amdhsa_group_segment_fixed_size 0
  .amdhsa_kernarg_size 80
  .amdhsa_user_sgpr_count 2
  .amdhsa_user_sgpr_kernarg_segment_ptr 1
  .amdhsa_system_sgpr_workgroup_id_x 1
  .amdhsa_float_denorm_mode_32 3
.end_amdhsa_kernel
```
